```python
import torch

def _softmax(x, axis=-1):
    return torch.softmax(x, dim=axis)
def _gelu(x):
    return torch.nn.functional.gelu(x, approximate="tanh")
def _silu(x):
    return torch.nn.functional.silu(x)
def _sigmoid(x):
    return torch.sigmoid(x)
def _layernorm(x, axis=-1, eps=1e-5):
    m = x.mean(dim=axis, keepdim=True)
    v = x.var(dim=axis, keepdim=True, unbiased=False)
    return (x - m) / torch.sqrt(v + eps)
def _scatter_add(tgt, idx, src, axis=0):
    return tgt.clone().index_add_(axis, idx, src)
def _segment_sum(src, seg, n):
    out = torch.zeros((n,) + src.shape[1:], dtype=src.dtype)
    return out.index_add_(0, seg, src)
def _pad(x, pw):
    flat = tuple(v for pair in reversed(pw) for v in pair)
    return torch.nn.functional.pad(x, flat)

kernel_name = 'standalone__mha_softmax__near_ridge'

def setup_inputs():

    _w = (lambda a: (lambda t: t.to(torch.bfloat16) if t.is_floating_point() else t)(torch.as_tensor(a)))
    B, H, Sq, Sk, D = 8, 16, 1312, 512, 256
    return {
        "q": _w((lambda *s: torch.randn(*s, dtype=torch.bfloat16) * 0.8)(B, H, Sq, D)),
        "k": _w((lambda *s: torch.randn(*s, dtype=torch.bfloat16) * 0.8)(B, H, Sk, D)),
        "v": _w((lambda *s: torch.randn(*s, dtype=torch.bfloat16) * 0.05)(B, H, Sk, D)),
    }

def reference(q, k, v):
    scale = q.shape[-1] ** -0.5
    scores = torch.einsum("bhqd,bhkd->bhqk", q, k) * scale
    p = _softmax(scores, axis=-1)
    return torch.einsum("bhqk,bhkd->bhqd", p, v)
```

```asm
; @launch grid=(256,1,1) block=(256,1,1) lds=163840
.amdgcn_target "amdgcn-amd-amdhsa--gfx950"
.text
.globl standalone__mha_softmax__near_ridge_kernel
.p2align 8
.type standalone__mha_softmax__near_ridge_kernel,@function
standalone__mha_softmax__near_ridge_kernel:
s_cmp_ge_u32 s2, 256
s_cbranch_scc1 L_exit
s_load_dwordx4 s[72:75], s[0:1], 0
s_load_dwordx4 s[76:79], s[0:1], 16
s_getpc_b64 s[4:5]
L_pc:
s_lshl_b32 s3, s2, 6
s_add_u32 s3, s3, L_table-L_pc
s_add_u32 s46, s4, s3
s_addc_u32 s47, s5, 0
s_load_dwordx16 s[80:95], s[46:47], 0
s_mov_b32 s96, s4
s_mov_b32 s97, s5
s_mov_b32 s98, L_warm_end-L_pc
s_mov_b32 s99, 0x20000
v_lshlrev_b32 v16, 5, v0
s_lshl_b32 s3, s2, 10
s_and_b32 s3, s3, 0xe000
buffer_load_dword v17, v16, s[96:99], s3 offen
v_readfirstlane_b32 s24, v0
v_and_b32 v10, 63, v0
s_lshr_b32 s24, s24, 6
v_and_b32 v11, 15, v10
v_lshrrev_b32 v14, 4, v10
v_lshrrev_b32 v15, 2, v11
v_lshlrev_b32 v1, 11, v15
v_and_b32 v6, 3, v11
v_lshl_add_u32 v1, v6, 6, v1
v_lshrrev_b32 v6, 3, v11
v_lshlrev_b32 v6, 1, v6
v_xor_b32 v6, v6, v14
v_lshl_add_u32 v1, v6, 4, v1
v_lshrrev_b32 v6, 1, v14
v_lshlrev_b32 v2, 10, v6
v_and_b32 v7, 1, v14
v_lshl_add_u32 v6, v7, 2, v15
v_lshl_add_u32 v2, v6, 6, v2
v_and_b32 v8, 3, v10
v_lshl_add_u32 v2, v8, 3, v2
v_lshl_add_u32 v2, v7, 5, v2
v_add_u32 v2, 65536, v2
v_xor_b32 v3, 32, v2
v_lshlrev_b32 v12, 9, v15
v_lshl_add_u32 v12, v14, 6, v12
v_lshl_add_u32 v12, v8, 4, v12
v_xor_b32 v13, 32, v12
v_add_u32 v13, 4096, v13
s_lshl_b32 s25, s24, 11
s_lshr_b32 s3, s24, 1
s_lshl_b32 s3, s3, 5
v_xor_b32 v4, s3, v12
v_add_u32 v4, s25, v4
v_lshrrev_b32 v6, 2, v10
v_and_b32 v6, 7, v6
v_lshlrev_b32 v5, 9, v6
v_lshrrev_b32 v6, 2, v6
v_lshlrev_b32 v6, 1, v6
v_xor_b32 v6, v6, v8
v_lshl_add_u32 v5, v6, 4, v5
v_lshrrev_b32 v6, 5, v10
v_lshl_add_u32 v5, v6, 6, v5
s_lshl_b32 s3, s24, 13
v_add_u32 v5, s3, v5
s_add_u32 s26, s3, 131072
s_add_u32 s28, s3, 98304
s_add_u32 s27, s3, 65536
s_cmp_eq_u32 s24, 0
s_cselect_b32 s27, 57344, s27
s_add_u32 s39, s3, 32768
s_cmp_eq_u32 s24, 3
s_cselect_b32 s39, 65536, s39
v_lshrrev_b32 v6, 1, v14
v_lshrrev_b32 v9, 1, v11
v_xor_b32 v6, v6, v9
v_lshlrev_b32 v6, 3, v6
v_lshl_add_u32 v6, v7, 12, v6
v_lshl_add_u32 v6, v11, 6, v6
v_add_u32 v15, s28, v6
v_lshrrev_b32 v6, 3, v10
v_and_b32 v9, 7, v10
v_xor_b32 v9, v9, v14
v_lshlrev_b32 v9, 4, v9
v_lshl_add_u32 v14, v6, 9, v9
s_mov_b32 s35, 0x3db8aa3b
s_mov_b32 s37, 0
s_mov_b32 s38, 0
s_mov_b32 s10, 85983232
s_mov_b32 s11, 0x20000
s_mov_b32 s14, 33554432
s_mov_b32 s15, 0x20000
s_mov_b32 s18, 33554432
s_mov_b32 s19, 0x20000
s_mov_b32 s22, 85983232
s_mov_b32 s23, 0x20000
s_mul_i32 s6, s24, 3
s_waitcnt lgkmcnt(0)
s_mov_b64 s[12:13], s[74:75]
s_mov_b64 s[8:9], s[72:73]
s_mov_b64 s[16:17], s[76:77]
s_sub_u32 s3, s82, 12
s_min_u32 s4, s3, s24
s_add_u32 s4, s4, s6
s_lshl_b32 s4, s4, 13
s_add_u32 s48, s80, s4
s_mov_b32 s49, s81
s_add_u32 s51, s48, 24576
s_cmp_lt_u32 s24, s3
s_cselect_b32 s50, 4, 3
s_cselect_b32 s51, s51, 0x7fff0000
s_mov_b32 s29, s49
s_sub_u32 s32, s49, 32768
s_add_u32 m0, s25, 8192
s_nop 0
buffer_load_dwordx4 v4, s[12:15], s29 offen offset:0 lds
s_add_u32 m0, s25, 8960
s_nop 0
buffer_load_dwordx4 v4, s[12:15], s29 offen offset:256 lds
s_add_u32 s29, s29, 8192
s_add_u32 m0, s25, 16384
s_nop 0
buffer_load_dwordx4 v4, s[12:15], s29 offen offset:0 lds
s_add_u32 m0, s25, 17152
s_nop 0
buffer_load_dwordx4 v4, s[12:15], s29 offen offset:256 lds
s_add_u32 s29, s29, 8192
s_add_u32 m0, s25, 24576
s_nop 0
buffer_load_dwordx4 v4, s[12:15], s29 offen offset:0 lds
s_add_u32 m0, s25, 25344
s_nop 0
buffer_load_dwordx4 v4, s[12:15], s29 offen offset:256 lds
s_add_u32 s29, s29, 8192
s_add_u32 s45, s48, 8192
s_add_u32 s46, s48, 16384
s_add_u32 s47, s48, 24576
s_cmp_eq_u32 s90, 0x7fff0000
s_cbranch_scc1 L_nohelp
s_add_u32 m0, s25, 32768
s_nop 0
buffer_load_dwordx4 v4, s[12:15], s29 offen offset:0 lds
s_add_u32 m0, s25, 33536
s_nop 0
buffer_load_dwordx4 v4, s[12:15], s29 offen offset:256 lds
s_add_u32 s29, s29, 8192
s_add_u32 m0, s25, 40960
s_nop 0
buffer_load_dwordx4 v4, s[12:15], s29 offen offset:0 lds
s_add_u32 m0, s25, 41728
s_nop 0
buffer_load_dwordx4 v4, s[12:15], s29 offen offset:256 lds
s_add_u32 s29, s29, 8192
s_add_u32 m0, s25, 49152
s_nop 0
buffer_load_dwordx4 v4, s[12:15], s29 offen offset:0 lds
s_add_u32 m0, s25, 49920
s_nop 0
buffer_load_dwordx4 v4, s[12:15], s29 offen offset:256 lds
s_add_u32 s29, s29, 8192
s_add_u32 s32, s32, 32768
s_add_u32 s33, s32, 4096
s_add_u32 m0, s25, 65536
s_nop 0
buffer_load_dwordx4 v5, s[16:19], s32 offen offset:0 lds
s_add_u32 m0, s25, 66560
s_nop 0
buffer_load_dwordx4 v5, s[16:19], s33 offen offset:0 lds
s_sub_u32 s4, s92, 12
s_add_u32 s5, s24, 1
s_min_u32 s4, s4, s5
s_mul_i32 s5, s5, 3
s_add_u32 s4, s4, s5
s_lshl_b32 s3, s4, 13
s_add_u32 s3, s3, s90
s_sub_u32 s3, s3, 12288
v_lshlrev_b32 v11, 4, v10
buffer_load_dwordx4 v[96:99], v11, s[8:11], s3 offen offset:0
buffer_load_dwordx4 v[100:103], v11, s[8:11], s3 offen offset:1024
buffer_load_dwordx4 v[104:107], v11, s[8:11], s3 offen offset:2048
buffer_load_dwordx4 v[108:111], v11, s[8:11], s3 offen offset:3072
s_add_u32 s3, s3, 4096
buffer_load_dwordx4 v[112:115], v11, s[8:11], s3 offen offset:0
buffer_load_dwordx4 v[116:119], v11, s[8:11], s3 offen offset:1024
buffer_load_dwordx4 v[120:123], v11, s[8:11], s3 offen offset:2048
buffer_load_dwordx4 v[124:127], v11, s[8:11], s3 offen offset:3072
s_add_u32 s3, s3, 4096
buffer_load_dwordx4 v[128:131], v11, s[8:11], s3 offen offset:0
buffer_load_dwordx4 v[132:135], v11, s[8:11], s3 offen offset:1024
buffer_load_dwordx4 v[136:139], v11, s[8:11], s3 offen offset:2048
buffer_load_dwordx4 v[140:143], v11, s[8:11], s3 offen offset:3072
L_nohelp:
s_add_u32 m0, s26, 0
s_nop 0
buffer_load_dwordx4 v12, s[8:11], s48 offen offset:0 nt lds
buffer_load_dwordx4 v12, s[8:11], s48 offen offset:2048 nt lds
s_add_u32 m0, s26, 768
s_nop 0
buffer_load_dwordx4 v12, s[8:11], s48 offen offset:256 nt lds
buffer_load_dwordx4 v12, s[8:11], s48 offen offset:2304 nt lds
s_add_u32 m0, s26, 4096
s_nop 0
buffer_load_dwordx4 v13, s[8:11], s48 offen offset:0 nt lds
buffer_load_dwordx4 v13, s[8:11], s48 offen offset:2048 nt lds
s_add_u32 m0, s26, 4864
s_nop 0
buffer_load_dwordx4 v13, s[8:11], s48 offen offset:256 nt lds
buffer_load_dwordx4 v13, s[8:11], s48 offen offset:2304 nt lds
s_add_u32 m0, s27, 0
s_nop 0
buffer_load_dwordx4 v12, s[8:11], s45 offen offset:0 nt lds
buffer_load_dwordx4 v12, s[8:11], s45 offen offset:2048 nt lds
s_add_u32 m0, s27, 768
s_nop 0
buffer_load_dwordx4 v12, s[8:11], s45 offen offset:256 nt lds
buffer_load_dwordx4 v12, s[8:11], s45 offen offset:2304 nt lds
s_add_u32 m0, s27, 4096
s_nop 0
buffer_load_dwordx4 v13, s[8:11], s45 offen offset:0 nt lds
buffer_load_dwordx4 v13, s[8:11], s45 offen offset:2048 nt lds
s_add_u32 m0, s27, 4864
s_nop 0
buffer_load_dwordx4 v13, s[8:11], s45 offen offset:256 nt lds
buffer_load_dwordx4 v13, s[8:11], s45 offen offset:2304 nt lds
s_add_u32 m0, s28, 0
s_nop 0
buffer_load_dwordx4 v12, s[8:11], s46 offen offset:0 nt lds
buffer_load_dwordx4 v12, s[8:11], s46 offen offset:2048 nt lds
s_add_u32 m0, s28, 768
s_nop 0
buffer_load_dwordx4 v12, s[8:11], s46 offen offset:256 nt lds
buffer_load_dwordx4 v12, s[8:11], s46 offen offset:2304 nt lds
s_add_u32 m0, s28, 4096
s_nop 0
buffer_load_dwordx4 v13, s[8:11], s46 offen offset:0 nt lds
buffer_load_dwordx4 v13, s[8:11], s46 offen offset:2048 nt lds
s_add_u32 m0, s28, 4864
s_nop 0
buffer_load_dwordx4 v13, s[8:11], s46 offen offset:256 nt lds
buffer_load_dwordx4 v13, s[8:11], s46 offen offset:2304 nt lds
s_mov_b64 s[20:21], s[78:79]
s_mov_b32 s72, 0x7fff0000
s_mov_b32 s73, 0x7fff0000
s_mov_b32 s74, 0x7fff0000
s_mov_b32 s75, 0x7fff0000
s_mov_b32 s76, 0x7fff0000
s_mov_b32 s77, 0x7fff0000
s_mov_b32 s78, 0x7fff0000
s_mov_b32 s79, 0x7fff0000
s_sub_u32 s3, s85, 12
s_min_u32 s4, s3, s24
s_add_u32 s4, s4, s6
s_lshl_b32 s4, s4, 13
s_add_u32 s52, s83, s4
s_mov_b32 s53, s84
s_add_u32 s55, s52, 24576
s_cmp_lt_u32 s24, s3
s_cselect_b32 s54, 4, 3
s_cselect_b32 s55, s55, 0x7fff0000
s_sub_u32 s3, s88, 12
s_min_u32 s4, s3, s24
s_add_u32 s4, s4, s6
s_lshl_b32 s4, s4, 13
s_add_u32 s56, s86, s4
s_mov_b32 s57, s87
s_add_u32 s59, s56, 24576
s_cmp_lt_u32 s24, s3
s_cselect_b32 s58, 4, 3
s_cselect_b32 s59, s59, 0x7fff0000
s_mov_b32 s60, 0x7fff0000
s_mov_b32 s61, 0x7fff0000
s_mov_b32 s62, 0
s_mov_b32 s63, 0x7fff0000
s_lshl_b32 s3, s91, 2
s_add_u32 s3, s3, s24
s_lshl_b32 s34, s3, 11
s_cmp_eq_u32 s90, 0x7fff0000
s_cselect_b32 s34, 0x40000000, s34
s_lshr_b32 s3, s2, 1
s_and_b32 s3, s3, 28
s_add_u32 s3, s3, s24
s_lshl_b32 s95, s3, 11
s_and_b32 s95, s95, 0xffff
s_add_u32 s95, s95, L_v4-L_pc
s_mov_b32 s80, s48
s_mov_b32 s81, s49
s_mov_b32 s82, s50
s_mov_b32 s83, s52
s_mov_b32 s84, s53
s_mov_b32 s85, s54
s_mov_b32 s86, s56
s_mov_b32 s87, s57
s_mov_b32 s88, s58
s_waitcnt vmcnt(16)
v_add_u32 v10, s26, v1
ds_read_b128 a[0:3], v10 offset:0
ds_read_b128 a[4:7], v10 offset:256
ds_read_b128 a[8:11], v10 offset:512
ds_read_b128 a[12:15], v10 offset:768
ds_read_b128 a[16:19], v10 offset:1024
ds_read_b128 a[20:23], v10 offset:1280
ds_read_b128 a[24:27], v10 offset:1536
ds_read_b128 a[28:31], v10 offset:1792
s_cmp_lt_u32 s50, 4
s_cbranch_scc1 L_noq3
s_waitcnt lgkmcnt(0)
s_add_u32 m0, s26, 0
s_nop 0
buffer_load_dwordx4 v12, s[8:11], s47 offen offset:0 nt lds
buffer_load_dwordx4 v12, s[8:11], s47 offen offset:2048 nt lds
s_add_u32 m0, s26, 768
s_nop 0
buffer_load_dwordx4 v12, s[8:11], s47 offen offset:256 nt lds
buffer_load_dwordx4 v12, s[8:11], s47 offen offset:2304 nt lds
s_add_u32 m0, s26, 4096
s_nop 0
buffer_load_dwordx4 v13, s[8:11], s47 offen offset:0 nt lds
buffer_load_dwordx4 v13, s[8:11], s47 offen offset:2048 nt lds
s_add_u32 m0, s26, 4864
s_nop 0
buffer_load_dwordx4 v13, s[8:11], s47 offen offset:256 nt lds
buffer_load_dwordx4 v13, s[8:11], s47 offen offset:2304 nt lds
L_noq3:
s_branch L_iw0
L_iwa:
s_waitcnt vmcnt(8)
v_add_u32 v11, s27, v1
ds_read_b128 a[32:35], v11 offset:0
ds_read_b128 a[36:39], v11 offset:256
ds_read_b128 a[40:43], v11 offset:512
ds_read_b128 a[44:47], v11 offset:768
ds_read_b128 a[48:51], v11 offset:1024
ds_read_b128 a[52:55], v11 offset:1280
ds_read_b128 a[56:59], v11 offset:1536
ds_read_b128 a[60:63], v11 offset:1792
s_waitcnt vmcnt(24)
s_barrier
ds_read_b128 a[128:131], v1 offset:8192
ds_read_b128 a[132:135], v1 offset:8448
ds_read_b128 a[136:139], v1 offset:8704
ds_read_b128 a[140:143], v1 offset:8960
ds_read_b128 a[144:147], v1 offset:9216
ds_read_b128 a[148:151], v1 offset:9472
s_cmp_lg_u32 s90, 0x7fff0000
s_cbranch_scc1 L_nolate
s_add_u32 m0, s25, 32768
s_nop 0
buffer_load_dwordx4 v4, s[12:15], s29 offen offset:0 lds
s_add_u32 m0, s25, 33536
s_nop 0
buffer_load_dwordx4 v4, s[12:15], s29 offen offset:256 lds
s_add_u32 s29, s29, 8192
s_add_u32 m0, s25, 40960
s_nop 0
buffer_load_dwordx4 v4, s[12:15], s29 offen offset:0 lds
s_add_u32 m0, s25, 41728
s_nop 0
buffer_load_dwordx4 v4, s[12:15], s29 offen offset:256 lds
s_add_u32 s29, s29, 8192
s_add_u32 m0, s25, 49152
s_nop 0
buffer_load_dwordx4 v4, s[12:15], s29 offen offset:0 lds
s_add_u32 m0, s25, 49920
s_nop 0
buffer_load_dwordx4 v4, s[12:15], s29 offen offset:256 lds
s_add_u32 s29, s29, 8192
s_add_u32 s32, s32, 32768
s_add_u32 s33, s32, 4096
s_add_u32 m0, s25, 65536
s_nop 0
buffer_load_dwordx4 v5, s[16:19], s32 offen offset:0 lds
s_add_u32 m0, s25, 66560
s_nop 0
buffer_load_dwordx4 v5, s[16:19], s33 offen offset:0 lds
s_waitcnt vmcnt(8)
s_branch L_osok
L_nolate:
s_branch L_iw3a
L_iwb:
s_waitcnt vmcnt(0)
L_osok:
v_add_u32 v10, s28, v1
ds_read_b128 a[64:67], v10 offset:0
ds_read_b128 a[68:71], v10 offset:256
ds_read_b128 a[72:75], v10 offset:512
ds_read_b128 a[76:79], v10 offset:768
ds_read_b128 a[80:83], v10 offset:1024
ds_read_b128 a[84:87], v10 offset:1280
ds_read_b128 a[88:91], v10 offset:1536
ds_read_b128 a[92:95], v10 offset:1792
s_mov_b32 s44, s48
s_add_u32 s30, s49, 262144
s_mov_b32 s70, s50
s_mov_b32 s31, s53
s_mov_b32 s94, s52
s_add_u32 s41, s52, 8192
s_add_u32 s42, s52, 16384
s_mov_b32 s43, s55
s_mov_b64 s[48:49], s[52:53]
s_mov_b64 s[50:51], s[54:55]
s_mov_b64 s[52:53], s[56:57]
s_mov_b64 s[54:55], s[58:59]
s_mov_b64 s[56:57], s[60:61]
s_mov_b64 s[58:59], s[62:63]
s_mov_b32 s36, 3
s_mov_b32 s90, s42
s_add_u32 s92, s34, s31
s_add_u32 s91, s92, 24576
s_mov_b32 s93, s26
s_cmp_lt_u32 s70, 4
s_cbranch_scc1 L_first
s_waitcnt vmcnt(0)
v_add_u32 v11, s26, v1
ds_read_b128 a[96:99], v11 offset:0
ds_read_b128 a[100:103], v11 offset:256
ds_read_b128 a[104:107], v11 offset:512
ds_read_b128 a[108:111], v11 offset:768
ds_read_b128 a[112:115], v11 offset:1024
ds_read_b128 a[116:119], v11 offset:1280
ds_read_b128 a[120:123], v11 offset:1536
ds_read_b128 a[124:127], v11 offset:1792
L_first:
L_pass:
s_waitcnt lgkmcnt(0)
s_barrier
s_cmp_eq_u32 s70, 3
s_cbranch_scc1 L_v3
.p2align 6
L_v4:
v_mfma_f32_16x16x32_bf16 v[32:35], a[128:131], a[0:3], 0
s_add_u32 m0, s25, 73600
ds_read_b128 a[152:155], v1 offset:9728
ds_read_b128 a[156:159], v1 offset:9984
v_mfma_f32_16x16x32_bf16 v[32:35], a[132:135], a[4:7], v[32:35]
v_mov_b32 v6, 0
v_mov_b32 v7, 0
v_mfma_f32_16x16x32_bf16 v[36:39], a[128:131], a[32:35], 0
buffer_load_dwordx4 v5, s[16:19], s32 offen offset:128 lds
v_mfma_f32_16x16x32_bf16 v[36:39], a[132:135], a[36:39], v[36:39]
s_add_u32 m0, s25, 74624
v_mov_b32 v8, 0
v_mov_b32 v9, 0
v_mfma_f32_16x16x32_bf16 v[40:43], a[128:131], a[64:67], 0
buffer_load_dwordx4 v5, s[16:19], s33 offen offset:128 lds
v_mfma_f32_16x16x32_bf16 v[40:43], a[132:135], a[68:71], v[40:43]
s_add_u32 m0, s25, 81664
v_mbcnt_lo_u32_b32 v11, -1, 0
v_mbcnt_hi_u32_b32 v11, -1, v11
v_mfma_f32_16x16x32_bf16 v[44:47], a[128:131], a[96:99], 0
buffer_load_dwordx4 v5, s[16:19], s32 offen offset:256 lds
v_mfma_f32_16x16x32_bf16 v[44:47], a[132:135], a[100:103], v[44:47]
ds_read_b128 a[128:131], v1 offset:16384
ds_read_b128 a[132:135], v1 offset:16640
v_mfma_f32_16x16x32_bf16 v[32:35], a[136:139], a[8:11], v[32:35]
s_add_u32 m0, s25, 82688
v_lshlrev_b32 v11, 5, v11
v_mfma_f32_16x16x32_bf16 v[32:35], a[140:143], a[12:15], v[32:35]
buffer_load_dwordx4 v5, s[16:19], s33 offen offset:256 lds
v_mfma_f32_16x16x32_bf16 v[36:39], a[136:139], a[40:43], v[36:39]
s_add_u32 m0, s25, 89728
v_mfma_f32_16x16x32_bf16 v[36:39], a[140:143], a[44:47], v[36:39]
v_mfma_f32_16x16x32_bf16 v[40:43], a[136:139], a[72:75], v[40:43]
buffer_load_dwordx4 v5, s[16:19], s32 offen offset:384 lds
v_mfma_f32_16x16x32_bf16 v[40:43], a[140:143], a[76:79], v[40:43]
v_mfma_f32_16x16x32_bf16 v[44:47], a[136:139], a[104:107], v[44:47]
s_add_u32 m0, s25, 90752
v_mfma_f32_16x16x32_bf16 v[44:47], a[140:143], a[108:111], v[44:47]
ds_read_b128 a[136:139], v1 offset:16896
ds_read_b128 a[140:143], v1 offset:17152
v_mfma_f32_16x16x32_bf16 v[32:35], a[144:147], a[16:19], v[32:35]
buffer_load_dwordx4 v5, s[16:19], s33 offen offset:384 lds
v_mfma_f32_16x16x32_bf16 v[32:35], a[148:151], a[20:23], v[32:35]
v_mfma_f32_16x16x32_bf16 v[36:39], a[144:147], a[48:51], v[36:39]
s_add_u32 m0, s25, 57344
v_mfma_f32_16x16x32_bf16 v[36:39], a[148:151], a[52:55], v[36:39]
v_mfma_f32_16x16x32_bf16 v[40:43], a[144:147], a[80:83], v[40:43]
buffer_load_dwordx4 v4, s[12:15], s29 offen offset:0 lds
v_mfma_f32_16x16x32_bf16 v[40:43], a[148:151], a[84:87], v[40:43]
v_mfma_f32_16x16x32_bf16 v[44:47], a[144:147], a[112:115], v[44:47]
s_add_u32 m0, s25, 58112
v_mfma_f32_16x16x32_bf16 v[44:47], a[148:151], a[116:119], v[44:47]
s_waitcnt lgkmcnt(4)
ds_read_b128 a[144:147], v1 offset:17408
ds_read_b128 a[148:151], v1 offset:17664
v_mfma_f32_16x16x32_bf16 v[32:35], a[152:155], a[24:27], v[32:35]
buffer_load_dwordx4 v4, s[12:15], s29 offen offset:256 lds
v_mfma_f32_16x16x32_bf16 v[32:35], a[156:159], a[28:31], v[32:35]
v_mfma_f32_16x16x32_bf16 v[36:39], a[152:155], a[56:59], v[36:39]
s_add_u32 s29, s29, 8192
v_mfma_f32_16x16x32_bf16 v[36:39], a[156:159], a[60:63], v[36:39]
v_mfma_f32_16x16x32_bf16 v[40:43], a[152:155], a[88:91], v[40:43]
v_mfma_f32_16x16x32_bf16 v[40:43], a[156:159], a[92:95], v[40:43]
s_nop 2
v_max3_f32 v64, v32, v33, v34
v_max_f32 v64, v64, v35
v_mfma_f32_16x16x32_bf16 v[44:47], a[152:155], a[120:123], v[44:47]
v_mfma_f32_16x16x32_bf16 v[44:47], a[156:159], a[124:127], v[44:47]
s_waitcnt lgkmcnt(4)
ds_read_b128 a[152:155], v1 offset:17920
ds_read_b128 a[156:159], v1 offset:18176
v_mfma_f32_16x16x32_bf16 v[80:83], a[128:131], a[0:3], 0
v_max3_f32 v65, v36, v37, v38
v_max_f32 v65, v65, v39
v_mfma_f32_16x16x32_bf16 v[80:83], a[132:135], a[4:7], v[80:83]
v_max3_f32 v66, v40, v41, v42
v_max_f32 v66, v66, v43
v_mfma_f32_16x16x32_bf16 v[84:87], a[128:131], a[32:35], 0
v_mfma_f32_16x16x32_bf16 v[84:87], a[132:135], a[36:39], v[84:87]
v_max3_f32 v67, v44, v45, v46
v_max_f32 v67, v67, v47
v_mfma_f32_16x16x32_bf16 v[88:91], a[128:131], a[64:67], 0
v_mfma_f32_16x16x32_bf16 v[88:91], a[132:135], a[68:71], v[88:91]
v_permlane16_swap_b32 v64, v65
v_mfma_f32_16x16x32_bf16 v[92:95], a[128:131], a[96:99], 0
v_permlane16_swap_b32 v66, v67
v_mfma_f32_16x16x32_bf16 v[92:95], a[132:135], a[100:103], v[92:95]
s_waitcnt lgkmcnt(4)
v_max_f32 v64, v64, v65
v_max_f32 v66, v66, v67
v_mfma_f32_16x16x32_bf16 v[80:83], a[136:139], a[8:11], v[80:83]
ds_read_b128 a[128:131], v1 offset:24576
ds_read_b128 a[132:135], v1 offset:24832
v_mfma_f32_16x16x32_bf16 v[80:83], a[140:143], a[12:15], v[80:83]
v_permlane32_swap_b32 v64, v66
v_mfma_f32_16x16x32_bf16 v[84:87], a[136:139], a[40:43], v[84:87]
v_min_f32 v16, -v64, -v66
v_mov_b32 v24, v16
v_mfma_f32_16x16x32_bf16 v[84:87], a[140:143], a[44:47], v[84:87]
v_mfma_f32_16x16x32_bf16 v[88:91], a[136:139], a[72:75], v[88:91]
v_permlane32_swap_b32 v16, v24
v_mfma_f32_16x16x32_bf16 v[88:91], a[140:143], a[76:79], v[88:91]
v_mov_b32 v20, v16
v_mov_b32 v28, v24
v_mfma_f32_16x16x32_bf16 v[92:95], a[136:139], a[104:107], v[92:95]
v_mfma_f32_16x16x32_bf16 v[92:95], a[140:143], a[108:111], v[92:95]
s_waitcnt lgkmcnt(4)
v_permlane16_swap_b32 v16, v20
v_mfma_f32_16x16x32_bf16 v[80:83], a[144:147], a[16:19], v[80:83]
v_permlane16_swap_b32 v24, v28
v_mfma_f32_16x16x32_bf16 v[80:83], a[148:151], a[20:23], v[80:83]
v_mul_f32 v72, s35, v16
v_fma_f32 v32, v32, s35, v72
v_mfma_f32_16x16x32_bf16 v[84:87], a[144:147], a[48:51], v[84:87]
v_fma_f32 v33, v33, s35, v72
v_mul_f32 v73, s35, v20
v_mfma_f32_16x16x32_bf16 v[84:87], a[148:151], a[52:55], v[84:87]
v_exp_f32 v192, v32
v_mfma_f32_16x16x32_bf16 v[88:91], a[144:147], a[80:83], v[88:91]
v_mul_f32 v74, s35, v24
v_mul_f32 v75, s35, v28
v_mfma_f32_16x16x32_bf16 v[88:91], a[148:151], a[84:87], v[88:91]
ds_read_b128 a[136:139], v1 offset:25088
ds_read_b128 a[140:143], v1 offset:25344
v_mfma_f32_16x16x32_bf16 v[92:95], a[144:147], a[112:115], v[92:95]
v_exp_f32 v193, v33
v_mfma_f32_16x16x32_bf16 v[92:95], a[148:151], a[116:119], v[92:95]
s_waitcnt lgkmcnt(4)
v_fma_f32 v34, v34, s35, v72
v_fma_f32 v35, v35, s35, v72
v_mfma_f32_16x16x32_bf16 v[80:83], a[152:155], a[24:27], v[80:83]
v_exp_f32 v194, v34
v_mfma_f32_16x16x32_bf16 v[80:83], a[156:159], a[28:31], v[80:83]
v_mov_b32 v17, v16
v_mov_b32 v18, v16
v_mfma_f32_16x16x32_bf16 v[84:87], a[152:155], a[56:59], v[84:87]
v_exp_f32 v195, v35
v_mfma_f32_16x16x32_bf16 v[84:87], a[156:159], a[60:63], v[84:87]
v_mov_b32 v19, v16
v_cvt_pk_bf16_f32 v32, v192, v193
v_mfma_f32_16x16x32_bf16 v[88:91], a[152:155], a[88:91], v[88:91]
v_cvt_pk_bf16_f32 v33, v194, v195
v_mov_b32 v21, v20
v_mfma_f32_16x16x32_bf16 v[88:91], a[156:159], a[92:95], v[88:91]
ds_read_b128 a[144:147], v1 offset:25600
ds_read_b128 a[148:151], v1 offset:25856
v_mfma_f32_16x16x32_bf16 v[92:95], a[152:155], a[120:123], v[92:95]
v_mov_b32 v22, v20
v_fma_f32 v36, v36, s35, v73
v_mfma_f32_16x16x32_bf16 v[92:95], a[156:159], a[124:127], v[92:95]
s_waitcnt lgkmcnt(4)
v_mov_b32 v23, v20
v_fma_f32 v37, v37, s35, v73
v_mfma_f32_16x16x32_bf16 v[48:51], a[128:131], a[0:3], v[16:19]
ds_read_b128 a[152:155], v1 offset:26112
ds_read_b128 a[156:159], v1 offset:26368
v_mfma_f32_16x16x32_bf16 v[48:51], a[132:135], a[4:7], v[48:51]
v_exp_f32 v196, v36
v_mfma_f32_16x16x32_bf16 v[52:55], a[128:131], a[32:35], v[20:23]
v_mov_b32 v25, v24
v_mov_b32 v26, v24
v_mov_b32 v27, v24
v_mfma_f32_16x16x32_bf16 v[52:55], a[132:135], a[36:39], v[52:55]
v_exp_f32 v197, v37
v_mfma_f32_16x16x32_bf16 v[56:59], a[128:131], a[64:67], v[24:27]
v_mov_b32 v29, v28
v_mov_b32 v30, v28
v_mov_b32 v31, v28
v_mfma_f32_16x16x32_bf16 v[56:59], a[132:135], a[68:71], v[56:59]
v_fma_f32 v38, v38, s35, v73
v_fma_f32 v39, v39, s35, v73
v_mfma_f32_16x16x32_bf16 v[60:63], a[128:131], a[96:99], v[28:31]
v_exp_f32 v198, v38
v_mfma_f32_16x16x32_bf16 v[60:63], a[132:135], a[100:103], v[60:63]
s_waitcnt vmcnt(8) lgkmcnt(0)
v_exp_f32 v199, v39
v_mfma_f32_16x16x32_bf16 v[48:51], a[136:139], a[8:11], v[48:51]
s_barrier
v_mfma_f32_16x16x32_bf16 v[48:51], a[140:143], a[12:15], v[48:51]
v_cvt_pk_bf16_f32 v36, v196, v197
v_cvt_pk_bf16_f32 v37, v198, v199
v_mfma_f32_16x16x32_bf16 v[52:55], a[136:139], a[40:43], v[52:55]
v_fma_f32 v40, v40, s35, v74
v_fma_f32 v41, v41, s35, v74
v_mfma_f32_16x16x32_bf16 v[52:55], a[140:143], a[44:47], v[52:55]
v_exp_f32 v200, v40
v_mfma_f32_16x16x32_bf16 v[56:59], a[136:139], a[72:75], v[56:59]
v_exp_f32 v201, v41
v_mfma_f32_16x16x32_bf16 v[56:59], a[140:143], a[76:79], v[56:59]
v_fma_f32 v42, v42, s35, v74
v_fma_f32 v43, v43, s35, v74
v_mfma_f32_16x16x32_bf16 v[60:63], a[136:139], a[104:107], v[60:63]
v_exp_f32 v202, v42
v_mfma_f32_16x16x32_bf16 v[60:63], a[140:143], a[108:111], v[60:63]
ds_read_b128 a[128:131], v1 offset:32768
ds_read_b128 a[132:135], v1 offset:33024
v_mfma_f32_16x16x32_bf16 v[48:51], a[144:147], a[16:19], v[48:51]
v_exp_f32 v203, v43
v_mfma_f32_16x16x32_bf16 v[48:51], a[148:151], a[20:23], v[48:51]
v_cvt_pk_bf16_f32 v40, v200, v201
v_cvt_pk_bf16_f32 v41, v202, v203
v_mfma_f32_16x16x32_bf16 v[52:55], a[144:147], a[48:51], v[52:55]
v_fma_f32 v44, v44, s35, v75
v_fma_f32 v45, v45, s35, v75
v_mfma_f32_16x16x32_bf16 v[52:55], a[148:151], a[52:55], v[52:55]
v_exp_f32 v204, v44
v_mfma_f32_16x16x32_bf16 v[56:59], a[144:147], a[80:83], v[56:59]
v_exp_f32 v205, v45
v_mfma_f32_16x16x32_bf16 v[56:59], a[148:151], a[84:87], v[56:59]
ds_read_b128 a[136:139], v1 offset:33280
ds_read_b128 a[140:143], v1 offset:33536
v_mfma_f32_16x16x32_bf16 v[60:63], a[144:147], a[112:115], v[60:63]
v_fma_f32 v46, v46, s35, v75
v_fma_f32 v47, v47, s35, v75
v_mfma_f32_16x16x32_bf16 v[60:63], a[148:151], a[116:119], v[60:63]
v_exp_f32 v206, v46
v_mfma_f32_16x16x32_bf16 v[48:51], a[152:155], a[24:27], v[48:51]
v_exp_f32 v207, v47
v_mfma_f32_16x16x32_bf16 v[48:51], a[156:159], a[28:31], v[48:51]
v_cvt_pk_bf16_f32 v44, v204, v205
v_cvt_pk_bf16_f32 v45, v206, v207
v_mfma_f32_16x16x32_bf16 v[52:55], a[152:155], a[56:59], v[52:55]
v_fma_f32 v80, v80, s35, v72
v_fma_f32 v81, v81, s35, v72
v_mfma_f32_16x16x32_bf16 v[52:55], a[156:159], a[60:63], v[52:55]
v_exp_f32 v208, v80
v_mfma_f32_16x16x32_bf16 v[56:59], a[152:155], a[88:91], v[56:59]
v_exp_f32 v209, v81
v_mfma_f32_16x16x32_bf16 v[56:59], a[156:159], a[92:95], v[56:59]
ds_read_b128 a[144:147], v1 offset:33792
ds_read_b128 a[148:151], v1 offset:34048
v_mfma_f32_16x16x32_bf16 v[60:63], a[152:155], a[120:123], v[60:63]
v_fma_f32 v82, v82, s35, v72
v_fma_f32 v83, v83, s35, v72
v_fma_f32 v84, v84, s35, v73
v_fma_f32 v85, v85, s35, v73
v_fma_f32 v86, v86, s35, v73
v_fma_f32 v87, v87, s35, v73
v_fma_f32 v88, v88, s35, v74
v_fma_f32 v89, v89, s35, v74
v_fma_f32 v90, v90, s35, v74
v_fma_f32 v91, v91, s35, v74
v_fma_f32 v92, v92, s35, v75
v_fma_f32 v93, v93, s35, v75
v_fma_f32 v94, v94, s35, v75
v_fma_f32 v95, v95, s35, v75
v_mfma_f32_16x16x32_bf16 v[60:63], a[156:159], a[124:127], v[60:63]
s_waitcnt lgkmcnt(4)
v_exp_f32 v210, v82
v_mfma_f32_16x16x32_bf16 v[64:67], a[128:131], a[0:3], v[16:19]
v_exp_f32 v211, v83
v_mfma_f32_16x16x32_bf16 v[64:67], a[132:135], a[4:7], v[64:67]
v_cvt_pk_bf16_f32 v34, v208, v209
v_cvt_pk_bf16_f32 v35, v210, v211
v_mfma_f32_16x16x32_bf16 v[68:71], a[128:131], a[32:35], v[20:23]
v_exp_f32 v212, v84
v_mfma_f32_16x16x32_bf16 v[68:71], a[132:135], a[36:39], v[68:71]
v_exp_f32 v213, v85
v_mfma_f32_16x16x32_bf16 v[72:75], a[128:131], a[64:67], v[24:27]
v_exp_f32 v214, v86
v_mfma_f32_16x16x32_bf16 v[72:75], a[132:135], a[68:71], v[72:75]
ds_read_b128 a[152:155], v1 offset:34304
ds_read_b128 a[156:159], v1 offset:34560
v_mfma_f32_16x16x32_bf16 v[76:79], a[128:131], a[96:99], v[28:31]
v_exp_f32 v215, v87
v_mfma_f32_16x16x32_bf16 v[76:79], a[132:135], a[100:103], v[76:79]
s_waitcnt lgkmcnt(4)
v_cvt_pk_bf16_f32 v38, v212, v213
v_cvt_pk_bf16_f32 v39, v214, v215
v_mfma_f32_16x16x32_bf16 v[64:67], a[136:139], a[8:11], v[64:67]
v_exp_f32 v216, v88
v_mfma_f32_16x16x32_bf16 v[64:67], a[140:143], a[12:15], v[64:67]
v_exp_f32 v217, v89
v_mfma_f32_16x16x32_bf16 v[68:71], a[136:139], a[40:43], v[68:71]
v_exp_f32 v218, v90
v_mfma_f32_16x16x32_bf16 v[68:71], a[140:143], a[44:47], v[68:71]
v_exp_f32 v219, v91
v_mfma_f32_16x16x32_bf16 v[72:75], a[136:139], a[72:75], v[72:75]
v_cvt_pk_bf16_f32 v42, v216, v217
v_cvt_pk_bf16_f32 v43, v218, v219
v_mfma_f32_16x16x32_bf16 v[72:75], a[140:143], a[76:79], v[72:75]
ds_read_b128 a[128:131], v1 offset:40960
ds_read_b128 a[132:135], v1 offset:41216
v_mfma_f32_16x16x32_bf16 v[76:79], a[136:139], a[104:107], v[76:79]
v_exp_f32 v220, v92
v_mfma_f32_16x16x32_bf16 v[76:79], a[140:143], a[108:111], v[76:79]
s_waitcnt lgkmcnt(4)
v_exp_f32 v221, v93
v_mfma_f32_16x16x32_bf16 v[64:67], a[144:147], a[16:19], v[64:67]
v_exp_f32 v222, v94
v_mfma_f32_16x16x32_bf16 v[64:67], a[148:151], a[20:23], v[64:67]
v_exp_f32 v223, v95
v_mfma_f32_16x16x32_bf16 v[68:71], a[144:147], a[48:51], v[68:71]
v_cvt_pk_bf16_f32 v46, v220, v221
v_cvt_pk_bf16_f32 v47, v222, v223
v_mfma_f32_16x16x32_bf16 v[68:71], a[148:151], a[52:55], v[68:71]
v_mul_f32 v48, s35, v48
v_mul_f32 v49, s35, v49
v_mfma_f32_16x16x32_bf16 v[72:75], a[144:147], a[80:83], v[72:75]
v_exp_f32 v224, v48
v_mfma_f32_16x16x32_bf16 v[72:75], a[148:151], a[84:87], v[72:75]
ds_read_b128 a[136:139], v1 offset:41472
ds_read_b128 a[140:143], v1 offset:41728
v_mfma_f32_16x16x32_bf16 v[76:79], a[144:147], a[112:115], v[76:79]
v_exp_f32 v225, v49
v_mfma_f32_16x16x32_bf16 v[76:79], a[148:151], a[116:119], v[76:79]
s_waitcnt lgkmcnt(4)
v_mul_f32 v50, s35, v50
v_mul_f32 v51, s35, v51
v_mfma_f32_16x16x32_bf16 v[64:67], a[152:155], a[24:27], v[64:67]
v_exp_f32 v226, v50
v_mfma_f32_16x16x32_bf16 v[64:67], a[156:159], a[28:31], v[64:67]
v_exp_f32 v227, v51
v_mfma_f32_16x16x32_bf16 v[68:71], a[152:155], a[56:59], v[68:71]
s_add_u32 m0, s25, 0
v_cvt_pk_bf16_f32 v48, v224, v225
v_cvt_pk_bf16_f32 v49, v226, v227
v_mfma_f32_16x16x32_bf16 v[68:71], a[156:159], a[60:63], v[68:71]
v_mul_f32 v52, s35, v52
v_mul_f32 v53, s35, v53
v_mfma_f32_16x16x32_bf16 v[72:75], a[152:155], a[88:91], v[72:75]
v_exp_f32 v228, v52
v_mfma_f32_16x16x32_bf16 v[72:75], a[156:159], a[92:95], v[72:75]
ds_read_b128 a[144:147], v1 offset:41984
ds_read_b128 a[148:151], v1 offset:42240
v_mfma_f32_16x16x32_bf16 v[76:79], a[152:155], a[120:123], v[76:79]
v_exp_f32 v229, v53
v_mfma_f32_16x16x32_bf16 v[76:79], a[156:159], a[124:127], v[76:79]
s_waitcnt lgkmcnt(4)
v_mul_f32 v54, s35, v54
v_mul_f32 v55, s35, v55
v_mfma_f32_16x16x32_bf16 v[80:83], a[128:131], a[0:3], v[16:19]
v_exp_f32 v230, v54
v_mfma_f32_16x16x32_bf16 v[80:83], a[132:135], a[4:7], v[80:83]
v_exp_f32 v231, v55
v_mfma_f32_16x16x32_bf16 v[84:87], a[128:131], a[32:35], v[20:23]
v_cvt_pk_bf16_f32 v52, v228, v229
v_cvt_pk_bf16_f32 v53, v230, v231
v_mfma_f32_16x16x32_bf16 v[84:87], a[132:135], a[36:39], v[84:87]
v_mul_f32 v56, s35, v56
v_mul_f32 v57, s35, v57
v_mfma_f32_16x16x32_bf16 v[88:91], a[128:131], a[64:67], v[24:27]
v_exp_f32 v232, v56
v_mfma_f32_16x16x32_bf16 v[88:91], a[132:135], a[68:71], v[88:91]
ds_read_b128 a[152:155], v1 offset:42496
ds_read_b128 a[156:159], v1 offset:42752
v_mfma_f32_16x16x32_bf16 v[92:95], a[128:131], a[96:99], v[28:31]
v_exp_f32 v233, v57
v_mfma_f32_16x16x32_bf16 v[92:95], a[132:135], a[100:103], v[92:95]
s_waitcnt lgkmcnt(4)
v_mul_f32 v58, s35, v58
v_mul_f32 v59, s35, v59
v_mfma_f32_16x16x32_bf16 v[80:83], a[136:139], a[8:11], v[80:83]
v_exp_f32 v234, v58
v_mfma_f32_16x16x32_bf16 v[80:83], a[140:143], a[12:15], v[80:83]
v_exp_f32 v235, v59
v_mfma_f32_16x16x32_bf16 v[84:87], a[136:139], a[40:43], v[84:87]
v_cvt_pk_bf16_f32 v56, v232, v233
v_cvt_pk_bf16_f32 v57, v234, v235
v_mfma_f32_16x16x32_bf16 v[84:87], a[140:143], a[44:47], v[84:87]
v_mul_f32 v60, s35, v60
v_mul_f32 v61, s35, v61
v_mfma_f32_16x16x32_bf16 v[88:91], a[136:139], a[72:75], v[88:91]
v_exp_f32 v236, v60
v_mfma_f32_16x16x32_bf16 v[88:91], a[140:143], a[76:79], v[88:91]
ds_read_b64_tr_b16 a[128:129], v2 offset:0
ds_read_b64_tr_b16 a[130:131], v2 offset:2048
ds_read_b64_tr_b16 a[132:133], v3 offset:0
ds_read_b64_tr_b16 a[134:135], v3 offset:2048
v_mfma_f32_16x16x32_bf16 v[92:95], a[136:139], a[104:107], v[92:95]
v_exp_f32 v237, v61
v_mfma_f32_16x16x32_bf16 v[92:95], a[140:143], a[108:111], v[92:95]
s_waitcnt lgkmcnt(6)
v_mul_f32 v62, s35, v62
v_mul_f32 v63, s35, v63
v_mfma_f32_16x16x32_bf16 v[80:83], a[144:147], a[16:19], v[80:83]
v_exp_f32 v238, v62
v_mfma_f32_16x16x32_bf16 v[80:83], a[148:151], a[20:23], v[80:83]
v_exp_f32 v239, v63
v_mfma_f32_16x16x32_bf16 v[84:87], a[144:147], a[48:51], v[84:87]
v_cvt_pk_bf16_f32 v60, v236, v237
v_cvt_pk_bf16_f32 v61, v238, v239
v_mfma_f32_16x16x32_bf16 v[84:87], a[148:151], a[52:55], v[84:87]
v_mul_f32 v64, s35, v64
v_mul_f32 v65, s35, v65
v_mfma_f32_16x16x32_bf16 v[88:91], a[144:147], a[80:83], v[88:91]
buffer_load_dwordx4 v4, s[12:15], s29 offen offset:0 lds
v_mfma_f32_16x16x32_bf16 v[88:91], a[148:151], a[84:87], v[88:91]
s_add_u32 m0, s25, 768
ds_read_b64_tr_b16 a[136:137], v2 offset:512
ds_read_b64_tr_b16 a[138:139], v2 offset:2560
ds_read_b64_tr_b16 a[140:141], v3 offset:512
ds_read_b64_tr_b16 a[142:143], v3 offset:2560
v_mfma_f32_16x16x32_bf16 v[92:95], a[144:147], a[112:115], v[92:95]
v_exp_f32 v64, v64
v_mfma_f32_16x16x32_bf16 v[92:95], a[148:151], a[116:119], v[92:95]
s_waitcnt lgkmcnt(8)
v_exp_f32 v65, v65
v_mfma_f32_16x16x32_bf16 v[80:83], a[152:155], a[24:27], v[80:83]
v_mul_f32 v66, s35, v66
v_mul_f32 v67, s35, v67
v_mfma_f32_16x16x32_bf16 v[80:83], a[156:159], a[28:31], v[80:83]
v_exp_f32 v66, v66
v_mfma_f32_16x16x32_bf16 v[84:87], a[152:155], a[56:59], v[84:87]
v_exp_f32 v67, v67
v_mfma_f32_16x16x32_bf16 v[84:87], a[156:159], a[60:63], v[84:87]
v_cvt_pk_bf16_f32 v50, v64, v65
v_cvt_pk_bf16_f32 v51, v66, v67
v_mfma_f32_16x16x32_bf16 v[88:91], a[152:155], a[88:91], v[88:91]
buffer_load_dwordx4 v4, s[12:15], s29 offen offset:256 lds
v_mfma_f32_16x16x32_bf16 v[88:91], a[156:159], a[92:95], v[88:91]
s_add_u32 s29, s29, 8192
ds_read_b64_tr_b16 a[144:145], v2 offset:4096
ds_read_b64_tr_b16 a[146:147], v2 offset:6144
ds_read_b64_tr_b16 a[148:149], v3 offset:4096
ds_read_b64_tr_b16 a[150:151], v3 offset:6144
v_mfma_f32_16x16x32_bf16 v[92:95], a[152:155], a[120:123], v[92:95]
s_add_u32 s32, s32, 32768
v_mul_f32 v68, s35, v68
v_mul_f32 v69, s35, v69
v_mfma_f32_16x16x32_bf16 v[92:95], a[156:159], a[124:127], v[92:95]
s_waitcnt lgkmcnt(8)
v_exp_f32 v68, v68
v_mfma_f32_16x16x32_bf16 v[96:99], a[128:131], v[32:35], 0
s_add_u32 s33, s32, 4096
v_exp_f32 v69, v69
v_mfma_f32_16x16x32_bf16 v[112:115], a[132:135], v[32:35], 0
s_add_u32 m0, s25, 98304
v_mul_f32 v70, s35, v70
v_mul_f32 v71, s35, v71
v_mfma_f32_16x16x32_bf16 v[100:103], a[128:131], v[36:39], 0
v_exp_f32 v70, v70
v_mfma_f32_16x16x32_bf16 v[116:119], a[132:135], v[36:39], 0
v_exp_f32 v71, v71
v_mfma_f32_16x16x32_bf16 v[104:107], a[128:131], v[40:43], 0
v_cvt_pk_bf16_f32 v54, v68, v69
v_cvt_pk_bf16_f32 v55, v70, v71
v_mfma_f32_16x16x32_bf16 v[120:123], a[132:135], v[40:43], 0
ds_read_b64_tr_b16 a[152:153], v2 offset:4608
ds_read_b64_tr_b16 a[154:155], v2 offset:6656
ds_read_b64_tr_b16 a[156:157], v3 offset:4608
ds_read_b64_tr_b16 a[158:159], v3 offset:6656
v_mfma_f32_16x16x32_bf16 v[108:111], a[128:131], v[44:47], 0
v_mul_f32 v72, s35, v72
v_mul_f32 v73, s35, v73
v_mfma_f32_16x16x32_bf16 v[124:127], a[132:135], v[44:47], 0
s_waitcnt lgkmcnt(8)
v_exp_f32 v72, v72
v_mfma_f32_16x16x32_bf16 v[128:131], a[136:139], v[32:35], 0
v_exp_f32 v73, v73
v_mfma_f32_16x16x32_bf16 v[144:147], a[140:143], v[32:35], 0
v_mul_f32 v74, s35, v74
v_mul_f32 v75, s35, v75
v_mfma_f32_16x16x32_bf16 v[132:135], a[136:139], v[36:39], 0
v_exp_f32 v74, v74
v_mfma_f32_16x16x32_bf16 v[148:151], a[140:143], v[36:39], 0
v_exp_f32 v75, v75
v_mfma_f32_16x16x32_bf16 v[136:139], a[136:139], v[40:43], 0
v_cvt_pk_bf16_f32 v58, v72, v73
v_cvt_pk_bf16_f32 v59, v74, v75
v_mfma_f32_16x16x32_bf16 v[152:155], a[140:143], v[40:43], 0
ds_read_b128 a[128:131], v1 offset:49152
ds_read_b128 a[132:135], v1 offset:49408
v_mfma_f32_16x16x32_bf16 v[140:143], a[136:139], v[44:47], 0
v_mul_f32 v76, s35, v76
v_mul_f32 v77, s35, v77
v_mfma_f32_16x16x32_bf16 v[156:159], a[140:143], v[44:47], 0
s_waitcnt lgkmcnt(6)
buffer_load_dwordx4 v5, s[16:19], s32 offen offset:0 lds
v_mfma_f32_16x16x32_bf16 v[96:99], a[144:147], v[48:51], v[96:99]
s_add_u32 m0, s25, 99328
v_exp_f32 v76, v76
v_mfma_f32_16x16x32_bf16 v[112:115], a[148:151], v[48:51], v[112:115]
v_exp_f32 v77, v77
v_mfma_f32_16x16x32_bf16 v[100:103], a[144:147], v[52:55], v[100:103]
v_mul_f32 v78, s35, v78
v_mul_f32 v79, s35, v79
v_mfma_f32_16x16x32_bf16 v[116:119], a[148:151], v[52:55], v[116:119]
v_exp_f32 v78, v78
v_exp_f32 v79, v79
v_mfma_f32_16x16x32_bf16 v[104:107], a[144:147], v[56:59], v[104:107]
v_cvt_pk_bf16_f32 v62, v76, v77
v_cvt_pk_bf16_f32 v63, v78, v79
v_mfma_f32_16x16x32_bf16 v[120:123], a[148:151], v[56:59], v[120:123]
ds_read_b128 a[136:139], v1 offset:49664
ds_read_b128 a[140:143], v1 offset:49920
v_mfma_f32_16x16x32_bf16 v[108:111], a[144:147], v[60:63], v[108:111]
buffer_load_dwordx4 v5, s[16:19], s33 offen offset:0 lds
v_mfma_f32_16x16x32_bf16 v[124:127], a[148:151], v[60:63], v[124:127]
s_waitcnt lgkmcnt(4)
v_add_f32 v6, v6, v64
v_add_f32 v6, v6, v65
v_mfma_f32_16x16x32_bf16 v[128:131], a[152:155], v[48:51], v[128:131]
s_add_u32 m0, s25, 8192
v_add_f32 v6, v6, v66
v_mul_f32 v80, s35, v80
v_mfma_f32_16x16x32_bf16 v[144:147], a[156:159], v[48:51], v[144:147]
v_add_f32 v6, v6, v67
v_mul_f32 v81, s35, v81
v_mfma_f32_16x16x32_bf16 v[132:135], a[152:155], v[52:55], v[132:135]
v_add_f32 v7, v7, v68
v_add_f32 v7, v7, v69
v_mfma_f32_16x16x32_bf16 v[148:151], a[156:159], v[52:55], v[148:151]
v_exp_f32 v80, v80
v_mfma_f32_16x16x32_bf16 v[136:139], a[152:155], v[56:59], v[136:139]
v_exp_f32 v81, v81
v_mfma_f32_16x16x32_bf16 v[152:155], a[156:159], v[56:59], v[152:155]
ds_read_b128 a[144:147], v1 offset:50176
ds_read_b128 a[148:151], v1 offset:50432
v_mfma_f32_16x16x32_bf16 v[140:143], a[152:155], v[60:63], v[140:143]
v_add_f32 v7, v7, v70
v_add_f32 v7, v7, v71
v_add_f32 v8, v8, v72
v_add_f32 v8, v8, v73
v_add_f32 v8, v8, v74
v_add_f32 v8, v8, v75
v_add_f32 v9, v9, v76
v_add_f32 v9, v9, v77
v_add_f32 v9, v9, v78
v_add_f32 v9, v9, v79
v_mfma_f32_16x16x32_bf16 v[156:159], a[156:159], v[60:63], v[156:159]
s_waitcnt lgkmcnt(4)
v_mul_f32 v82, s35, v82
v_mul_f32 v83, s35, v83
v_mfma_f32_16x16x32_bf16 v[64:67], a[128:131], a[0:3], v[16:19]
ds_read_b128 a[152:155], v1 offset:50688
ds_read_b128 a[156:159], v1 offset:50944
v_mfma_f32_16x16x32_bf16 v[64:67], a[132:135], a[4:7], v[64:67]
v_exp_f32 v82, v82
v_mfma_f32_16x16x32_bf16 v[68:71], a[128:131], a[32:35], v[20:23]
buffer_load_dwordx4 v4, s[12:15], s29 offen offset:0 lds
v_mfma_f32_16x16x32_bf16 v[68:71], a[132:135], a[36:39], v[68:71]
s_add_u32 m0, s25, 8960
v_exp_f32 v83, v83
v_mfma_f32_16x16x32_bf16 v[72:75], a[128:131], a[64:67], v[24:27]
v_add_f32 v6, v6, v80
v_add_f32 v6, v6, v81
v_mfma_f32_16x16x32_bf16 v[72:75], a[132:135], a[68:71], v[72:75]
v_add_f32 v6, v6, v82
v_add_f32 v6, v6, v83
v_mfma_f32_16x16x32_bf16 v[76:79], a[128:131], a[96:99], v[28:31]
v_cvt_pk_bf16_f32 v80, v80, v81
v_cvt_pk_bf16_f32 v81, v82, v83
v_mfma_f32_16x16x32_bf16 v[76:79], a[132:135], a[100:103], v[76:79]
s_waitcnt vmcnt(5) lgkmcnt(0)
v_mul_f32 v84, s35, v84
v_mul_f32 v85, s35, v85
v_mfma_f32_16x16x32_bf16 v[64:67], a[136:139], a[8:11], v[64:67]
s_barrier
v_mfma_f32_16x16x32_bf16 v[64:67], a[140:143], a[12:15], v[64:67]
v_exp_f32 v84, v84
v_mfma_f32_16x16x32_bf16 v[68:71], a[136:139], a[40:43], v[68:71]
v_exp_f32 v85, v85
v_mfma_f32_16x16x32_bf16 v[68:71], a[140:143], a[44:47], v[68:71]
v_mul_f32 v86, s35, v86
v_mul_f32 v87, s35, v87
v_mfma_f32_16x16x32_bf16 v[72:75], a[136:139], a[72:75], v[72:75]
buffer_load_dwordx4 v4, s[12:15], s29 offen offset:256 lds
v_mfma_f32_16x16x32_bf16 v[72:75], a[140:143], a[76:79], v[72:75]
s_add_u32 s29, s29, 8192
v_exp_f32 v86, v86
v_mfma_f32_16x16x32_bf16 v[76:79], a[136:139], a[104:107], v[76:79]
s_add_u32 m0, s25, 16384
v_exp_f32 v87, v87
v_mfma_f32_16x16x32_bf16 v[76:79], a[140:143], a[108:111], v[76:79]
ds_read_b64_tr_b16 a[128:129], v2 offset:8192
ds_read_b64_tr_b16 a[130:131], v2 offset:10240
ds_read_b64_tr_b16 a[132:133], v2 offset:12288
ds_read_b64_tr_b16 a[134:135], v2 offset:14336
v_mfma_f32_16x16x32_bf16 v[64:67], a[144:147], a[16:19], v[64:67]
v_add_f32 v7, v7, v84
v_add_f32 v7, v7, v85
v_mfma_f32_16x16x32_bf16 v[64:67], a[148:151], a[20:23], v[64:67]
v_add_f32 v7, v7, v86
v_add_f32 v7, v7, v87
v_mfma_f32_16x16x32_bf16 v[68:71], a[144:147], a[48:51], v[68:71]
v_cvt_pk_bf16_f32 v84, v84, v85
v_cvt_pk_bf16_f32 v85, v86, v87
v_mfma_f32_16x16x32_bf16 v[68:71], a[148:151], a[52:55], v[68:71]
v_mul_f32 v88, s35, v88
v_mul_f32 v89, s35, v89
v_mfma_f32_16x16x32_bf16 v[72:75], a[144:147], a[80:83], v[72:75]
v_exp_f32 v88, v88
v_mfma_f32_16x16x32_bf16 v[72:75], a[148:151], a[84:87], v[72:75]
ds_read_b64_tr_b16 a[136:137], v3 offset:8192
ds_read_b64_tr_b16 a[138:139], v3 offset:10240
ds_read_b64_tr_b16 a[140:141], v3 offset:12288
ds_read_b64_tr_b16 a[142:143], v3 offset:14336
v_mfma_f32_16x16x32_bf16 v[76:79], a[144:147], a[112:115], v[76:79]
v_exp_f32 v89, v89
v_mfma_f32_16x16x32_bf16 v[76:79], a[148:151], a[116:119], v[76:79]
v_mul_f32 v90, s35, v90
v_mul_f32 v91, s35, v91
v_mfma_f32_16x16x32_bf16 v[64:67], a[152:155], a[24:27], v[64:67]
v_exp_f32 v90, v90
v_mfma_f32_16x16x32_bf16 v[64:67], a[156:159], a[28:31], v[64:67]
buffer_load_dwordx4 v4, s[12:15], s29 offen offset:0 lds
v_mfma_f32_16x16x32_bf16 v[68:71], a[152:155], a[56:59], v[68:71]
s_add_u32 m0, s25, 17152
v_exp_f32 v91, v91
v_mfma_f32_16x16x32_bf16 v[68:71], a[156:159], a[60:63], v[68:71]
v_add_f32 v8, v8, v88
v_add_f32 v8, v8, v89
v_mfma_f32_16x16x32_bf16 v[72:75], a[152:155], a[88:91], v[72:75]
v_add_f32 v8, v8, v90
v_add_f32 v8, v8, v91
v_mfma_f32_16x16x32_bf16 v[72:75], a[156:159], a[92:95], v[72:75]
ds_read_b64_tr_b16 a[144:145], v2 offset:8704
ds_read_b64_tr_b16 a[146:147], v2 offset:10752
ds_read_b64_tr_b16 a[148:149], v2 offset:12800
ds_read_b64_tr_b16 a[150:151], v2 offset:14848
v_mfma_f32_16x16x32_bf16 v[76:79], a[152:155], a[120:123], v[76:79]
v_cvt_pk_bf16_f32 v88, v88, v89
v_cvt_pk_bf16_f32 v89, v90, v91
v_mfma_f32_16x16x32_bf16 v[76:79], a[156:159], a[124:127], v[76:79]
s_waitcnt lgkmcnt(8)
v_mul_f32 v92, s35, v92
v_mul_f32 v93, s35, v93
v_mfma_f32_16x16x32_bf16 a[160:163], a[128:131], v[32:35], 0
v_exp_f32 v92, v92
v_mfma_f32_16x16x32_bf16 a[160:163], a[132:135], v[48:51], a[160:163]
v_exp_f32 v93, v93
v_mfma_f32_16x16x32_bf16 a[164:167], a[128:131], v[36:39], 0
v_mul_f32 v94, s35, v94
v_mul_f32 v95, s35, v95
v_mfma_f32_16x16x32_bf16 a[164:167], a[132:135], v[52:55], a[164:167]
v_exp_f32 v94, v94
v_exp_f32 v95, v95
v_mfma_f32_16x16x32_bf16 a[168:171], a[128:131], v[40:43], 0
v_add_f32 v9, v9, v92
v_add_f32 v9, v9, v93
v_add_f32 v9, v9, v94
v_add_f32 v9, v9, v95
v_cvt_pk_bf16_f32 v92, v92, v93
v_cvt_pk_bf16_f32 v93, v94, v95
v_mfma_f32_16x16x32_bf16 a[168:171], a[132:135], v[56:59], a[168:171]
ds_read_b64_tr_b16 a[152:153], v3 offset:8704
ds_read_b64_tr_b16 a[154:155], v3 offset:10752
ds_read_b64_tr_b16 a[156:157], v3 offset:12800
ds_read_b64_tr_b16 a[158:159], v3 offset:14848
v_mfma_f32_16x16x32_bf16 a[172:175], a[128:131], v[44:47], 0
buffer_load_dwordx4 v4, s[12:15], s29 offen offset:256 lds
v_mfma_f32_16x16x32_bf16 a[172:175], a[132:135], v[60:63], a[172:175]
s_waitcnt lgkmcnt(8)
v_mul_f32 v64, s35, v64
v_mul_f32 v65, s35, v65
v_mfma_f32_16x16x32_bf16 a[176:179], a[136:139], v[32:35], 0
s_add_u32 s29, s29, 8192
v_exp_f32 v64, v64
v_mfma_f32_16x16x32_bf16 a[176:179], a[140:143], v[48:51], a[176:179]
s_add_u32 m0, s25, 106368
ds_read_b64_tr_b16 a[128:129], v2 offset:16384
v_add_f32 v6, v6, v64
v_mfma_f32_16x16x32_bf16 a[180:183], a[136:139], v[36:39], 0
v_exp_f32 v65, v65
v_mfma_f32_16x16x32_bf16 a[180:183], a[140:143], v[52:55], a[180:183]
ds_read_b64_tr_b16 a[130:131], v2 offset:18432
ds_read_b64_tr_b16 a[132:133], v2 offset:20480
v_mfma_f32_16x16x32_bf16 a[184:187], a[136:139], v[40:43], 0
ds_read_b64_tr_b16 a[134:135], v2 offset:22528
v_mul_f32 v66, s35, v66
v_mfma_f32_16x16x32_bf16 a[184:187], a[140:143], v[56:59], a[184:187]
v_mul_f32 v67, s35, v67
v_add_f32 v6, v6, v65
v_mfma_f32_16x16x32_bf16 a[188:191], a[136:139], v[44:47], 0
v_exp_f32 v66, v66
v_mfma_f32_16x16x32_bf16 a[188:191], a[140:143], v[60:63], a[188:191]
s_waitcnt lgkmcnt(8)
v_exp_f32 v67, v67
v_mfma_f32_16x16x32_bf16 a[192:195], a[144:147], v[32:35], 0
v_add_f32 v6, v6, v66
v_cvt_pk_bf16_f32 v82, v64, v65
v_mfma_f32_16x16x32_bf16 a[192:195], a[148:151], v[48:51], a[192:195]
buffer_load_dwordx4 v5, s[16:19], s32 offen offset:128 lds
v_mfma_f32_16x16x32_bf16 a[196:199], a[144:147], v[36:39], 0
s_add_u32 m0, s25, 107392
ds_read_b64_tr_b16 a[136:137], v3 offset:16384
ds_read_b64_tr_b16 a[138:139], v3 offset:18432
v_mfma_f32_16x16x32_bf16 a[196:199], a[148:151], v[52:55], a[196:199]
ds_read_b64_tr_b16 a[140:141], v3 offset:20480
ds_read_b64_tr_b16 a[142:143], v3 offset:22528
v_mfma_f32_16x16x32_bf16 a[200:203], a[144:147], v[40:43], 0
v_cvt_pk_bf16_f32 v83, v66, v67
v_add_f32 v6, v6, v67
v_mfma_f32_16x16x32_bf16 a[200:203], a[148:151], v[56:59], a[200:203]
v_mul_f32 v68, s35, v68
v_mul_f32 v69, s35, v69
v_mfma_f32_16x16x32_bf16 a[204:207], a[144:147], v[44:47], 0
v_exp_f32 v68, v68
v_mfma_f32_16x16x32_bf16 a[204:207], a[148:151], v[60:63], a[204:207]
s_waitcnt lgkmcnt(8)
ds_read_b64_tr_b16 a[144:145], v2 offset:16896
v_add_f32 v7, v7, v68
v_mfma_f32_16x16x32_bf16 a[208:211], a[152:155], v[32:35], 0
buffer_load_dwordx4 v5, s[16:19], s33 offen offset:128 lds
v_mfma_f32_16x16x32_bf16 a[208:211], a[156:159], v[48:51], a[208:211]
s_add_u32 m0, s25, 114432
v_exp_f32 v69, v69
v_mfma_f32_16x16x32_bf16 a[212:215], a[152:155], v[36:39], 0
ds_read_b64_tr_b16 a[146:147], v2 offset:18944
ds_read_b64_tr_b16 a[148:149], v2 offset:20992
v_mfma_f32_16x16x32_bf16 a[212:215], a[156:159], v[52:55], a[212:215]
ds_read_b64_tr_b16 a[150:151], v2 offset:23040
v_mul_f32 v70, s35, v70
v_mfma_f32_16x16x32_bf16 a[216:219], a[152:155], v[40:43], 0
v_add_f32 v7, v7, v69
v_mul_f32 v71, s35, v71
v_mfma_f32_16x16x32_bf16 a[216:219], a[156:159], v[56:59], a[216:219]
v_exp_f32 v70, v70
v_mfma_f32_16x16x32_bf16 a[220:223], a[152:155], v[44:47], 0
v_add_f32 v7, v7, v70
v_cvt_pk_bf16_f32 v86, v68, v69
v_mfma_f32_16x16x32_bf16 a[220:223], a[156:159], v[60:63], a[220:223]
s_waitcnt lgkmcnt(8)
buffer_load_dwordx4 v5, s[16:19], s32 offen offset:256 lds
v_mfma_f32_16x16x32_bf16 a[224:227], a[128:131], v[32:35], 0
s_add_u32 m0, s25, 115456
v_exp_f32 v71, v71
v_mfma_f32_16x16x32_bf16 a[224:227], a[132:135], v[48:51], a[224:227]
v_cvt_pk_bf16_f32 v87, v70, v71
v_add_f32 v7, v7, v71
v_mfma_f32_16x16x32_bf16 a[228:231], a[128:131], v[36:39], 0
ds_read_b64_tr_b16 a[152:153], v3 offset:16896
ds_read_b64_tr_b16 a[154:155], v3 offset:18944
v_mfma_f32_16x16x32_bf16 a[228:231], a[132:135], v[52:55], a[228:231]
ds_read_b64_tr_b16 a[156:157], v3 offset:20992
ds_read_b64_tr_b16 a[158:159], v3 offset:23040
v_mfma_f32_16x16x32_bf16 a[232:235], a[128:131], v[40:43], 0
v_mul_f32 v72, s35, v72
v_mul_f32 v73, s35, v73
v_mfma_f32_16x16x32_bf16 a[232:235], a[132:135], v[56:59], a[232:235]
v_exp_f32 v72, v72
v_mfma_f32_16x16x32_bf16 a[236:239], a[128:131], v[44:47], 0
v_add_f32 v8, v8, v72
v_mul_f32 v74, s35, v74
v_mfma_f32_16x16x32_bf16 a[236:239], a[132:135], v[60:63], a[236:239]
s_waitcnt lgkmcnt(8)
buffer_load_dwordx4 v5, s[16:19], s33 offen offset:256 lds
v_mfma_f32_16x16x32_bf16 a[240:243], a[136:139], v[32:35], 0
s_add_u32 m0, s25, 122496
v_exp_f32 v73, v73
v_mfma_f32_16x16x32_bf16 a[240:243], a[140:143], v[48:51], a[240:243]
ds_read_b128 a[128:131], v1 offset:57344
v_add_f32 v8, v8, v73
v_mfma_f32_16x16x32_bf16 a[244:247], a[136:139], v[36:39], 0
ds_read_b128 a[132:135], v1 offset:57600
v_mul_f32 v75, s35, v75
v_mfma_f32_16x16x32_bf16 a[244:247], a[140:143], v[52:55], a[244:247]
v_exp_f32 v74, v74
v_mfma_f32_16x16x32_bf16 a[248:251], a[136:139], v[40:43], 0
v_add_f32 v8, v8, v74
v_cvt_pk_bf16_f32 v90, v72, v73
v_mfma_f32_16x16x32_bf16 a[248:251], a[140:143], v[56:59], a[248:251]
buffer_load_dwordx4 v5, s[16:19], s32 offen offset:384 lds
v_mfma_f32_16x16x32_bf16 a[252:255], a[136:139], v[44:47], 0
s_add_u32 m0, s25, 123520
v_exp_f32 v75, v75
v_mfma_f32_16x16x32_bf16 a[252:255], a[140:143], v[60:63], a[252:255]
s_waitcnt lgkmcnt(6)
v_add_f32 v8, v8, v75
v_cvt_pk_bf16_f32 v91, v74, v75
v_mfma_f32_16x16x32_bf16 v[160:163], a[144:147], v[32:35], 0
ds_read_b128 a[136:139], v1 offset:57856
v_mul_f32 v76, s35, v76
v_mfma_f32_16x16x32_bf16 v[160:163], a[148:151], v[48:51], v[160:163]
ds_read_b128 a[140:143], v1 offset:58112
v_mul_f32 v77, s35, v77
v_mfma_f32_16x16x32_bf16 v[164:167], a[144:147], v[36:39], 0
buffer_load_dwordx4 v5, s[16:19], s33 offen offset:384 lds
v_mfma_f32_16x16x32_bf16 v[164:167], a[148:151], v[52:55], v[164:167]
s_add_u32 m0, s25, 24576
v_exp_f32 v76, v76
v_mfma_f32_16x16x32_bf16 v[168:171], a[144:147], v[40:43], 0
v_add_f32 v9, v9, v76
v_mul_f32 v78, s35, v78
v_mfma_f32_16x16x32_bf16 v[168:171], a[148:151], v[56:59], v[168:171]
v_exp_f32 v77, v77
v_mfma_f32_16x16x32_bf16 v[172:175], a[144:147], v[44:47], 0
v_add_f32 v9, v9, v77
v_mul_f32 v79, s35, v79
v_mfma_f32_16x16x32_bf16 v[172:175], a[148:151], v[60:63], v[172:175]
s_waitcnt lgkmcnt(4)
ds_read_b128 a[144:147], v1 offset:58368
ds_read_b128 a[148:151], v1 offset:58624
v_mfma_f32_16x16x32_bf16 v[176:179], a[152:155], v[32:35], 0
v_exp_f32 v78, v78
v_mfma_f32_16x16x32_bf16 v[176:179], a[156:159], v[48:51], v[176:179]
v_add_f32 v9, v9, v78
v_cvt_pk_bf16_f32 v94, v76, v77
v_mfma_f32_16x16x32_bf16 v[180:183], a[152:155], v[36:39], 0
buffer_load_dwordx4 v4, s[12:15], s29 offen offset:0 lds
v_mfma_f32_16x16x32_bf16 v[180:183], a[156:159], v[52:55], v[180:183]
s_add_u32 m0, s25, 25344
v_exp_f32 v79, v79
v_mfma_f32_16x16x32_bf16 v[184:187], a[152:155], v[40:43], 0
v_add_f32 v9, v9, v79
v_add_f32 v6, v6, v192
v_mfma_f32_16x16x32_bf16 v[184:187], a[156:159], v[56:59], v[184:187]
v_add_f32 v6, v6, v193
v_cvt_pk_bf16_f32 v95, v78, v79
v_mfma_f32_16x16x32_bf16 v[188:191], a[152:155], v[44:47], 0
v_add_f32 v6, v6, v194
v_add_f32 v6, v6, v195
v_mfma_f32_16x16x32_bf16 v[188:191], a[156:159], v[60:63], v[188:191]
s_waitcnt lgkmcnt(4)
v_add_f32 v7, v7, v196
v_add_f32 v7, v7, v197
v_mfma_f32_16x16x32_bf16 v[64:67], a[128:131], a[0:3], v[16:19]
buffer_load_dwordx4 v4, s[12:15], s29 offen offset:256 lds
v_mfma_f32_16x16x32_bf16 v[64:67], a[132:135], a[4:7], v[64:67]
s_add_u32 s29, s29, 8192
ds_read_b128 a[152:155], v1 offset:58880
ds_read_b128 a[156:159], v1 offset:59136
v_mfma_f32_16x16x32_bf16 v[68:71], a[128:131], a[32:35], v[20:23]
s_add_u32 m0, s25, 32768
v_add_f32 v7, v7, v198
v_add_f32 v7, v7, v199
v_mfma_f32_16x16x32_bf16 v[68:71], a[132:135], a[36:39], v[68:71]
v_add_f32 v8, v8, v200
v_add_f32 v8, v8, v201
v_mfma_f32_16x16x32_bf16 v[72:75], a[128:131], a[64:67], v[24:27]
v_add_f32 v8, v8, v202
v_add_f32 v8, v8, v203
v_mfma_f32_16x16x32_bf16 v[72:75], a[132:135], a[68:71], v[72:75]
v_add_f32 v9, v9, v204
v_add_f32 v9, v9, v205
v_mfma_f32_16x16x32_bf16 v[76:79], a[128:131], a[96:99], v[28:31]
v_add_f32 v9, v9, v206
v_add_f32 v9, v9, v207
v_mfma_f32_16x16x32_bf16 v[76:79], a[132:135], a[100:103], v[76:79]
s_waitcnt lgkmcnt(4)
v_add_f32 v6, v6, v208
v_add_f32 v6, v6, v209
v_mfma_f32_16x16x32_bf16 v[64:67], a[136:139], a[8:11], v[64:67]
v_add_f32 v6, v6, v210
v_add_f32 v6, v6, v211
v_mfma_f32_16x16x32_bf16 v[64:67], a[140:143], a[12:15], v[64:67]
ds_read_b64_tr_b16 a[128:129], v2 offset:24576
v_add_f32 v7, v7, v212
v_mfma_f32_16x16x32_bf16 v[68:71], a[136:139], a[40:43], v[68:71]
ds_read_b64_tr_b16 a[130:131], v2 offset:26624
ds_read_b64_tr_b16 a[132:133], v2 offset:28672
v_mfma_f32_16x16x32_bf16 v[68:71], a[140:143], a[44:47], v[68:71]
ds_read_b64_tr_b16 a[134:135], v2 offset:30720
v_add_f32 v7, v7, v213
v_mfma_f32_16x16x32_bf16 v[72:75], a[136:139], a[72:75], v[72:75]
v_add_f32 v7, v7, v214
v_add_f32 v7, v7, v215
v_mfma_f32_16x16x32_bf16 v[72:75], a[140:143], a[76:79], v[72:75]
v_add_f32 v8, v8, v216
v_add_f32 v8, v8, v217
v_mfma_f32_16x16x32_bf16 v[76:79], a[136:139], a[104:107], v[76:79]
v_add_f32 v8, v8, v218
v_add_f32 v8, v8, v219
v_mfma_f32_16x16x32_bf16 v[76:79], a[140:143], a[108:111], v[76:79]
s_waitcnt lgkmcnt(6)
buffer_load_dwordx4 v4, s[12:15], s29 offen offset:0 lds
v_mfma_f32_16x16x32_bf16 v[64:67], a[144:147], a[16:19], v[64:67]
s_add_u32 m0, s25, 33536
v_add_f32 v9, v9, v220
v_add_f32 v9, v9, v221
v_mfma_f32_16x16x32_bf16 v[64:67], a[148:151], a[20:23], v[64:67]
v_add_f32 v9, v9, v222
v_add_f32 v9, v9, v223
v_mfma_f32_16x16x32_bf16 v[68:71], a[144:147], a[48:51], v[68:71]
v_add_f32 v6, v6, v224
v_add_f32 v6, v6, v225
v_mfma_f32_16x16x32_bf16 v[68:71], a[148:151], a[52:55], v[68:71]
v_add_f32 v6, v6, v226
v_add_f32 v6, v6, v227
v_mfma_f32_16x16x32_bf16 v[72:75], a[144:147], a[80:83], v[72:75]
ds_read_b64_tr_b16 a[136:137], v3 offset:24576
ds_read_b64_tr_b16 a[138:139], v3 offset:26624
v_mfma_f32_16x16x32_bf16 v[72:75], a[148:151], a[84:87], v[72:75]
ds_read_b64_tr_b16 a[140:141], v3 offset:28672
ds_read_b64_tr_b16 a[142:143], v3 offset:30720
v_mfma_f32_16x16x32_bf16 v[76:79], a[144:147], a[112:115], v[76:79]
v_add_f32 v7, v7, v228
v_add_f32 v7, v7, v229
v_mfma_f32_16x16x32_bf16 v[76:79], a[148:151], a[116:119], v[76:79]
s_waitcnt lgkmcnt(8)
buffer_load_dwordx4 v4, s[12:15], s29 offen offset:256 lds
v_mfma_f32_16x16x32_bf16 v[64:67], a[152:155], a[24:27], v[64:67]
s_add_u32 s29, s29, 8192
v_add_f32 v7, v7, v230
v_add_f32 v7, v7, v231
v_mfma_f32_16x16x32_bf16 v[64:67], a[156:159], a[28:31], v[64:67]
s_add_u32 m0, s25, 40960
v_add_f32 v8, v8, v232
v_add_f32 v8, v8, v233
v_mfma_f32_16x16x32_bf16 v[68:71], a[152:155], a[56:59], v[68:71]
v_add_f32 v8, v8, v234
v_add_f32 v8, v8, v235
v_mfma_f32_16x16x32_bf16 v[68:71], a[156:159], a[60:63], v[68:71]
v_add_f32 v9, v9, v236
v_add_f32 v9, v9, v237
v_mfma_f32_16x16x32_bf16 v[72:75], a[152:155], a[88:91], v[72:75]
v_add_f32 v9, v9, v238
v_add_f32 v9, v9, v239
v_mfma_f32_16x16x32_bf16 v[72:75], a[156:159], a[92:95], v[72:75]
ds_read_b64_tr_b16 a[144:145], v2 offset:25088
ds_read_b64_tr_b16 a[146:147], v2 offset:27136
ds_read_b64_tr_b16 a[148:149], v2 offset:29184
ds_read_b64_tr_b16 a[150:151], v2 offset:31232
v_mfma_f32_16x16x32_bf16 v[76:79], a[152:155], a[120:123], v[76:79]
buffer_load_dwordx4 v4, s[12:15], s29 offen offset:0 lds
v_mfma_f32_16x16x32_bf16 v[76:79], a[156:159], a[124:127], v[76:79]
s_waitcnt lgkmcnt(8)
ds_read_b64_tr_b16 a[152:153], v3 offset:25088
ds_read_b64_tr_b16 a[154:155], v3 offset:27136
v_mfma_f32_16x16x32_bf16 v[192:195], a[128:131], v[32:35], 0
s_add_u32 m0, s25, 41728
ds_read_b64_tr_b16 a[156:157], v3 offset:29184
ds_read_b64_tr_b16 a[158:159], v3 offset:31232
v_mfma_f32_16x16x32_bf16 v[192:195], a[132:135], v[48:51], v[192:195]
buffer_load_dwordx4 v4, s[12:15], s29 offen offset:256 lds
v_mfma_f32_16x16x32_bf16 v[196:199], a[128:131], v[36:39], 0
s_add_u32 s29, s29, 8192
v_mul_f32 v64, s35, v64
v_mul_f32 v65, s35, v65
v_mfma_f32_16x16x32_bf16 v[196:199], a[132:135], v[52:55], v[196:199]
s_add_u32 m0, s25, 49152
v_exp_f32 v64, v64
v_mfma_f32_16x16x32_bf16 v[200:203], a[128:131], v[40:43], 0
v_exp_f32 v65, v65
v_mfma_f32_16x16x32_bf16 v[200:203], a[132:135], v[56:59], v[200:203]
buffer_load_dwordx4 v4, s[12:15], s29 offen offset:0 lds
v_mfma_f32_16x16x32_bf16 v[204:207], a[128:131], v[44:47], 0
s_add_u32 m0, s25, 49920
v_mul_f32 v66, s35, v66
v_mul_f32 v67, s35, v67
v_mfma_f32_16x16x32_bf16 v[204:207], a[132:135], v[60:63], v[204:207]
s_waitcnt vmcnt(13) lgkmcnt(0)
v_exp_f32 v66, v66
v_mfma_f32_16x16x32_bf16 v[208:211], a[136:139], v[32:35], 0
s_barrier
v_mfma_f32_16x16x32_bf16 v[208:211], a[140:143], v[48:51], v[208:211]
v_exp_f32 v67, v67
v_mfma_f32_16x16x32_bf16 v[212:215], a[136:139], v[36:39], 0
v_add_f32 v6, v6, v64
v_add_f32 v6, v6, v65
v_mfma_f32_16x16x32_bf16 v[212:215], a[140:143], v[52:55], v[212:215]
ds_read_b128 a[128:131], v1 offset:0
ds_read_b128 a[132:135], v1 offset:256
v_mfma_f32_16x16x32_bf16 v[216:219], a[136:139], v[40:43], 0
buffer_load_dwordx4 v4, s[12:15], s29 offen offset:256 lds
v_mfma_f32_16x16x32_bf16 v[216:219], a[140:143], v[56:59], v[216:219]
s_add_u32 s29, s29, 8192
v_add_f32 v6, v6, v66
v_add_f32 v6, v6, v67
v_mfma_f32_16x16x32_bf16 v[220:223], a[136:139], v[44:47], 0
s_add_u32 s32, s32, 32768
v_cvt_pk_bf16_f32 v64, v64, v65
v_cvt_pk_bf16_f32 v65, v66, v67
v_mfma_f32_16x16x32_bf16 v[220:223], a[140:143], v[60:63], v[220:223]
v_mul_f32 v68, s35, v68
v_mul_f32 v69, s35, v69
v_mfma_f32_16x16x32_bf16 v[224:227], a[144:147], v[32:35], 0
s_add_u32 s33, s32, 4096
v_exp_f32 v68, v68
v_mfma_f32_16x16x32_bf16 v[224:227], a[148:151], v[48:51], v[224:227]
s_add_u32 m0, s25, 65536
v_exp_f32 v69, v69
v_mfma_f32_16x16x32_bf16 v[228:231], a[144:147], v[36:39], 0
ds_read_b128 a[136:139], v1 offset:512
v_mul_f32 v70, s35, v70
v_mfma_f32_16x16x32_bf16 v[228:231], a[148:151], v[52:55], v[228:231]
ds_read_b128 a[140:143], v1 offset:768
v_mul_f32 v71, s35, v71
v_mfma_f32_16x16x32_bf16 v[232:235], a[144:147], v[40:43], 0
v_exp_f32 v70, v70
v_mfma_f32_16x16x32_bf16 v[232:235], a[148:151], v[56:59], v[232:235]
v_exp_f32 v71, v71
v_mfma_f32_16x16x32_bf16 v[236:239], a[144:147], v[44:47], 0
v_add_f32 v7, v7, v68
v_add_f32 v7, v7, v69
v_mfma_f32_16x16x32_bf16 v[236:239], a[148:151], v[60:63], v[236:239]
v_add_f32 v7, v7, v70
v_add_f32 v7, v7, v71
v_mfma_f32_16x16x32_bf16 v[240:243], a[152:155], v[32:35], 0
v_cvt_pk_bf16_f32 v68, v68, v69
v_cvt_pk_bf16_f32 v69, v70, v71
v_mfma_f32_16x16x32_bf16 v[240:243], a[156:159], v[48:51], v[240:243]
v_mul_f32 v72, s35, v72
v_mul_f32 v73, s35, v73
v_mfma_f32_16x16x32_bf16 v[244:247], a[152:155], v[36:39], 0
buffer_load_dwordx4 v5, s[16:19], s32 offen offset:0 lds
v_mfma_f32_16x16x32_bf16 v[244:247], a[156:159], v[52:55], v[244:247]
s_add_u32 m0, s25, 66560
v_exp_f32 v72, v72
v_mfma_f32_16x16x32_bf16 v[248:251], a[152:155], v[40:43], 0
ds_read_b128 a[144:147], v1 offset:1024
ds_read_b128 a[148:151], v1 offset:1280
v_mfma_f32_16x16x32_bf16 v[248:251], a[156:159], v[56:59], v[248:251]
v_exp_f32 v73, v73
v_mfma_f32_16x16x32_bf16 v[252:255], a[152:155], v[44:47], 0
v_mul_f32 v74, s35, v74
v_mul_f32 v75, s35, v75
v_exp_f32 v74, v74
v_exp_f32 v75, v75
v_mfma_f32_16x16x32_bf16 v[252:255], a[156:159], v[60:63], v[252:255]
s_waitcnt lgkmcnt(4)
buffer_load_dwordx4 v5, s[16:19], s33 offen offset:0 lds
v_add_f32 v8, v8, v72
v_add_f32 v8, v8, v73
v_add_f32 v8, v8, v74
v_add_f32 v8, v8, v75
v_cvt_pk_bf16_f32 v72, v72, v73
v_cvt_pk_bf16_f32 v73, v74, v75
L_loop4:
v_mfma_f32_16x16x32_bf16 v[48:51], a[128:131], a[0:3], v[16:19]
ds_read_b128 a[152:155], v1 offset:1536
ds_read_b128 a[156:159], v1 offset:1792
v_mfma_f32_16x16x32_bf16 v[48:51], a[132:135], a[4:7], v[48:51]
v_mul_f32 v76, s35, v76
v_mul_f32 v77, s35, v77
v_mfma_f32_16x16x32_bf16 v[52:55], a[128:131], a[32:35], v[20:23]
s_add_u32 m0, s25, 73600
v_exp_f32 v76, v76
v_mfma_f32_16x16x32_bf16 v[52:55], a[132:135], a[36:39], v[52:55]
buffer_load_dwordx4 v5, s[16:19], s32 offen offset:128 lds
v_mfma_f32_16x16x32_bf16 v[56:59], a[128:131], a[64:67], v[24:27]
s_add_u32 m0, s25, 74624
v_exp_f32 v77, v77
v_mfma_f32_16x16x32_bf16 v[56:59], a[132:135], a[68:71], v[56:59]
v_mul_f32 v78, s35, v78
v_mul_f32 v79, s35, v79
v_mfma_f32_16x16x32_bf16 v[60:63], a[128:131], a[96:99], v[28:31]
buffer_load_dwordx4 v5, s[16:19], s33 offen offset:128 lds
v_mfma_f32_16x16x32_bf16 v[60:63], a[132:135], a[100:103], v[60:63]
s_waitcnt lgkmcnt(4)
ds_read_b128 a[128:131], v1 offset:8192
ds_read_b128 a[132:135], v1 offset:8448
v_mfma_f32_16x16x32_bf16 v[48:51], a[136:139], a[8:11], v[48:51]
s_add_u32 m0, s25, 81664
v_exp_f32 v78, v78
v_mfma_f32_16x16x32_bf16 v[48:51], a[140:143], a[12:15], v[48:51]
v_mfma_f32_16x16x32_bf16 v[52:55], a[136:139], a[40:43], v[52:55]
buffer_load_dwordx4 v5, s[16:19], s32 offen offset:256 lds
v_mfma_f32_16x16x32_bf16 v[52:55], a[140:143], a[44:47], v[52:55]
v_exp_f32 v79, v79
v_mfma_f32_16x16x32_bf16 v[56:59], a[136:139], a[72:75], v[56:59]
s_add_u32 m0, s25, 82688
v_mfma_f32_16x16x32_bf16 v[56:59], a[140:143], a[76:79], v[56:59]
v_add_f32 v9, v9, v76
v_mfma_f32_16x16x32_bf16 v[60:63], a[136:139], a[104:107], v[60:63]
v_mfma_f32_16x16x32_bf16 v[60:63], a[140:143], a[108:111], v[60:63]
s_waitcnt lgkmcnt(4)
ds_read_b128 a[136:139], v1 offset:8704
ds_read_b128 a[140:143], v1 offset:8960
v_mfma_f32_16x16x32_bf16 v[48:51], a[144:147], a[16:19], v[48:51]
v_add_f32 v9, v9, v77
v_add_f32 v9, v9, v78
v_mfma_f32_16x16x32_bf16 v[48:51], a[148:151], a[20:23], v[48:51]
buffer_load_dwordx4 v5, s[16:19], s33 offen offset:256 lds
v_mfma_f32_16x16x32_bf16 v[52:55], a[144:147], a[48:51], v[52:55]
s_add_u32 m0, s25, 89728
v_add_f32 v9, v9, v79
v_mfma_f32_16x16x32_bf16 v[52:55], a[148:151], a[52:55], v[52:55]
v_cvt_pk_bf16_f32 v76, v76, v77
v_mfma_f32_16x16x32_bf16 v[56:59], a[144:147], a[80:83], v[56:59]
buffer_load_dwordx4 v5, s[16:19], s32 offen offset:384 lds
v_mfma_f32_16x16x32_bf16 v[56:59], a[148:151], a[84:87], v[56:59]
v_cvt_pk_bf16_f32 v77, v78, v79
v_mfma_f32_16x16x32_bf16 v[60:63], a[144:147], a[112:115], v[60:63]
v_mfma_f32_16x16x32_bf16 v[60:63], a[148:151], a[116:119], v[60:63]
s_waitcnt lgkmcnt(4)
ds_read_b128 a[144:147], v1 offset:9216
ds_read_b128 a[148:151], v1 offset:9472
v_mfma_f32_16x16x32_bf16 v[48:51], a[152:155], a[24:27], v[48:51]
s_add_u32 m0, s25, 90752
v_mfma_f32_16x16x32_bf16 v[48:51], a[156:159], a[28:31], v[48:51]
v_mfma_f32_16x16x32_bf16 v[52:55], a[152:155], a[56:59], v[52:55]
buffer_load_dwordx4 v5, s[16:19], s33 offen offset:384 lds
v_mfma_f32_16x16x32_bf16 v[52:55], a[156:159], a[60:63], v[52:55]
v_mfma_f32_16x16x32_bf16 v[56:59], a[152:155], a[88:91], v[56:59]
v_mfma_f32_16x16x32_bf16 v[56:59], a[156:159], a[92:95], v[56:59]
s_nop 2
v_mul_f32 v48, s35, v48
v_mul_f32 v49, s35, v49
v_mfma_f32_16x16x32_bf16 v[60:63], a[152:155], a[120:123], v[60:63]
v_exp_f32 v48, v48
v_mfma_f32_16x16x32_bf16 v[60:63], a[156:159], a[124:127], v[60:63]
s_waitcnt lgkmcnt(4)
ds_read_b128 a[152:155], v1 offset:9728
ds_read_b128 a[156:159], v1 offset:9984
v_mfma_f32_16x16x32_bf16 v[32:35], a[128:131], a[0:3], v[16:19]
v_exp_f32 v49, v49
v_mfma_f32_16x16x32_bf16 v[32:35], a[132:135], a[4:7], v[32:35]
v_mul_f32 v50, s35, v50
v_mul_f32 v51, s35, v51
v_mfma_f32_16x16x32_bf16 v[36:39], a[128:131], a[32:35], v[20:23]
v_exp_f32 v50, v50
v_mfma_f32_16x16x32_bf16 v[36:39], a[132:135], a[36:39], v[36:39]
v_exp_f32 v51, v51
v_mfma_f32_16x16x32_bf16 v[40:43], a[128:131], a[64:67], v[24:27]
v_cvt_pk_bf16_f32 v66, v48, v49
v_cvt_pk_bf16_f32 v67, v50, v51
v_mfma_f32_16x16x32_bf16 v[40:43], a[132:135], a[68:71], v[40:43]
v_mul_f32 v52, s35, v52
v_mul_f32 v53, s35, v53
v_mfma_f32_16x16x32_bf16 v[44:47], a[128:131], a[96:99], v[28:31]
v_exp_f32 v52, v52
v_mfma_f32_16x16x32_bf16 v[44:47], a[132:135], a[100:103], v[44:47]
s_waitcnt lgkmcnt(4)
ds_read_b64_tr_b16 a[128:129], v2 offset:32768
ds_read_b64_tr_b16 a[130:131], v2 offset:34816
v_mfma_f32_16x16x32_bf16 v[32:35], a[136:139], a[8:11], v[32:35]
ds_read_b64_tr_b16 a[132:133], v2 offset:36864
ds_read_b64_tr_b16 a[134:135], v2 offset:38912
v_mfma_f32_16x16x32_bf16 v[32:35], a[140:143], a[12:15], v[32:35]
v_exp_f32 v53, v53
v_mfma_f32_16x16x32_bf16 v[36:39], a[136:139], a[40:43], v[36:39]
v_mul_f32 v54, s35, v54
v_mul_f32 v55, s35, v55
v_mfma_f32_16x16x32_bf16 v[36:39], a[140:143], a[44:47], v[36:39]
v_exp_f32 v54, v54
v_mfma_f32_16x16x32_bf16 v[40:43], a[136:139], a[72:75], v[40:43]
v_exp_f32 v55, v55
v_mfma_f32_16x16x32_bf16 v[40:43], a[140:143], a[76:79], v[40:43]
v_cvt_pk_bf16_f32 v70, v52, v53
v_cvt_pk_bf16_f32 v71, v54, v55
v_mfma_f32_16x16x32_bf16 v[44:47], a[136:139], a[104:107], v[44:47]
v_mul_f32 v56, s35, v56
v_mul_f32 v57, s35, v57
v_mfma_f32_16x16x32_bf16 v[44:47], a[140:143], a[108:111], v[44:47]
s_waitcnt lgkmcnt(6)
ds_read_b64_tr_b16 a[136:137], v3 offset:32768
ds_read_b64_tr_b16 a[138:139], v3 offset:34816
v_mfma_f32_16x16x32_bf16 v[32:35], a[144:147], a[16:19], v[32:35]
ds_read_b64_tr_b16 a[140:141], v3 offset:36864
ds_read_b64_tr_b16 a[142:143], v3 offset:38912
v_mfma_f32_16x16x32_bf16 v[32:35], a[148:151], a[20:23], v[32:35]
v_exp_f32 v56, v56
v_mfma_f32_16x16x32_bf16 v[36:39], a[144:147], a[48:51], v[36:39]
v_exp_f32 v57, v57
v_mfma_f32_16x16x32_bf16 v[36:39], a[148:151], a[52:55], v[36:39]
v_mul_f32 v58, s35, v58
v_mul_f32 v59, s35, v59
v_mfma_f32_16x16x32_bf16 v[40:43], a[144:147], a[80:83], v[40:43]
v_exp_f32 v58, v58
v_mfma_f32_16x16x32_bf16 v[40:43], a[148:151], a[84:87], v[40:43]
v_exp_f32 v59, v59
v_mfma_f32_16x16x32_bf16 v[44:47], a[144:147], a[112:115], v[44:47]
v_cvt_pk_bf16_f32 v74, v56, v57
v_cvt_pk_bf16_f32 v75, v58, v59
v_mfma_f32_16x16x32_bf16 v[44:47], a[148:151], a[116:119], v[44:47]
s_waitcnt lgkmcnt(8)
ds_read_b64_tr_b16 a[144:145], v2 offset:33280
ds_read_b64_tr_b16 a[146:147], v2 offset:35328
v_mfma_f32_16x16x32_bf16 v[32:35], a[152:155], a[24:27], v[32:35]
ds_read_b64_tr_b16 a[148:149], v2 offset:37376
ds_read_b64_tr_b16 a[150:151], v2 offset:39424
v_mfma_f32_16x16x32_bf16 v[32:35], a[156:159], a[28:31], v[32:35]
v_mul_f32 v60, s35, v60
v_mul_f32 v61, s35, v61
v_mfma_f32_16x16x32_bf16 v[36:39], a[152:155], a[56:59], v[36:39]
v_exp_f32 v60, v60
v_mfma_f32_16x16x32_bf16 v[36:39], a[156:159], a[60:63], v[36:39]
v_exp_f32 v61, v61
v_mfma_f32_16x16x32_bf16 v[40:43], a[152:155], a[88:91], v[40:43]
v_mul_f32 v62, s35, v62
v_mul_f32 v63, s35, v63
v_mfma_f32_16x16x32_bf16 v[40:43], a[156:159], a[92:95], v[40:43]
v_exp_f32 v62, v62
v_mfma_f32_16x16x32_bf16 v[44:47], a[152:155], a[120:123], v[44:47]
v_exp_f32 v63, v63
v_mfma_f32_16x16x32_bf16 v[44:47], a[156:159], a[124:127], v[44:47]
s_waitcnt lgkmcnt(8)
ds_read_b64_tr_b16 a[152:153], v3 offset:33280
ds_read_b64_tr_b16 a[154:155], v3 offset:35328
v_mfma_f32_16x16x32_bf16 v[96:99], a[128:131], v[80:83], v[96:99]
ds_read_b64_tr_b16 a[156:157], v3 offset:37376
ds_read_b64_tr_b16 a[158:159], v3 offset:39424
v_mfma_f32_16x16x32_bf16 v[96:99], a[132:135], v[64:67], v[96:99]
v_cvt_pk_bf16_f32 v78, v60, v61
v_cvt_pk_bf16_f32 v79, v62, v63
v_mfma_f32_16x16x32_bf16 v[100:103], a[128:131], v[84:87], v[100:103]
v_add_f32 v6, v6, v48
v_add_f32 v6, v6, v49
v_mfma_f32_16x16x32_bf16 v[100:103], a[132:135], v[68:71], v[100:103]
v_mul_f32 v32, s35, v32
v_mul_f32 v33, s35, v33
v_mfma_f32_16x16x32_bf16 v[104:107], a[128:131], v[88:91], v[104:107]
v_add_f32 v6, v6, v50
v_add_f32 v6, v6, v51
v_mfma_f32_16x16x32_bf16 v[104:107], a[132:135], v[72:75], v[104:107]
v_exp_f32 v32, v32
v_mfma_f32_16x16x32_bf16 v[108:111], a[128:131], v[92:95], v[108:111]
v_exp_f32 v33, v33
v_mfma_f32_16x16x32_bf16 v[108:111], a[132:135], v[76:79], v[108:111]
s_waitcnt lgkmcnt(8)
ds_read_b128 a[128:131], v1 offset:16384
ds_read_b128 a[132:135], v1 offset:16640
v_mfma_f32_16x16x32_bf16 v[112:115], a[136:139], v[80:83], v[112:115]
v_add_f32 v7, v7, v52
v_mul_f32 v34, s35, v34
v_mfma_f32_16x16x32_bf16 v[112:115], a[140:143], v[64:67], v[112:115]
v_mul_f32 v35, s35, v35
v_add_f32 v7, v7, v53
v_mfma_f32_16x16x32_bf16 v[116:119], a[136:139], v[84:87], v[116:119]
s_add_u32 m0, s25, 57344
v_exp_f32 v34, v34
v_mfma_f32_16x16x32_bf16 v[116:119], a[140:143], v[68:71], v[116:119]
v_exp_f32 v35, v35
v_mfma_f32_16x16x32_bf16 v[120:123], a[136:139], v[88:91], v[120:123]
v_add_f32 v7, v7, v54
v_add_f32 v6, v6, v32
v_mfma_f32_16x16x32_bf16 v[120:123], a[140:143], v[72:75], v[120:123]
v_add_f32 v7, v7, v55
v_add_f32 v6, v6, v33
v_mfma_f32_16x16x32_bf16 v[124:127], a[136:139], v[92:95], v[124:127]
v_add_f32 v6, v6, v34
v_add_f32 v8, v8, v56
v_mfma_f32_16x16x32_bf16 v[124:127], a[140:143], v[76:79], v[124:127]
s_waitcnt lgkmcnt(6)
ds_read_b128 a[136:139], v1 offset:16896
ds_read_b128 a[140:143], v1 offset:17152
v_mfma_f32_16x16x32_bf16 v[128:131], a[144:147], v[80:83], v[128:131]
v_add_f32 v6, v6, v35
v_cvt_pk_bf16_f32 v32, v32, v33
v_mfma_f32_16x16x32_bf16 v[128:131], a[148:151], v[64:67], v[128:131]
buffer_load_dwordx4 v4, s[12:15], s29 offen offset:0 lds
v_mfma_f32_16x16x32_bf16 v[132:135], a[144:147], v[84:87], v[132:135]
s_add_u32 m0, s25, 58112
v_add_f32 v8, v8, v57
v_cvt_pk_bf16_f32 v33, v34, v35
v_mfma_f32_16x16x32_bf16 v[132:135], a[148:151], v[68:71], v[132:135]
v_mul_f32 v36, s35, v36
v_add_f32 v8, v8, v58
v_mfma_f32_16x16x32_bf16 v[136:139], a[144:147], v[88:91], v[136:139]
v_mul_f32 v37, s35, v37
v_add_f32 v8, v8, v59
v_mfma_f32_16x16x32_bf16 v[136:139], a[148:151], v[72:75], v[136:139]
v_exp_f32 v36, v36
v_mfma_f32_16x16x32_bf16 v[140:143], a[144:147], v[92:95], v[140:143]
v_exp_f32 v37, v37
v_mfma_f32_16x16x32_bf16 v[140:143], a[148:151], v[76:79], v[140:143]
s_waitcnt lgkmcnt(4)
ds_read_b128 a[144:147], v1 offset:17408
v_add_f32 v9, v9, v60
v_mfma_f32_16x16x32_bf16 v[144:147], a[152:155], v[80:83], v[144:147]
ds_read_b128 a[148:151], v1 offset:17664
v_mul_f32 v38, s35, v38
v_mfma_f32_16x16x32_bf16 v[144:147], a[156:159], v[64:67], v[144:147]
v_add_f32 v9, v9, v61
v_mul_f32 v39, s35, v39
v_mfma_f32_16x16x32_bf16 v[148:151], a[152:155], v[84:87], v[148:151]
v_exp_f32 v38, v38
v_mfma_f32_16x16x32_bf16 v[148:151], a[156:159], v[68:71], v[148:151]
v_add_f32 v9, v9, v62
v_add_f32 v9, v9, v63
v_mfma_f32_16x16x32_bf16 v[152:155], a[152:155], v[88:91], v[152:155]
v_exp_f32 v39, v39
v_mfma_f32_16x16x32_bf16 v[152:155], a[156:159], v[72:75], v[152:155]
buffer_load_dwordx4 v4, s[12:15], s29 offen offset:256 lds
v_mfma_f32_16x16x32_bf16 v[156:159], a[152:155], v[92:95], v[156:159]
s_add_u32 s29, s29, 8192
v_add_f32 v7, v7, v36
v_add_f32 v7, v7, v37
v_mfma_f32_16x16x32_bf16 v[156:159], a[156:159], v[76:79], v[156:159]
s_waitcnt lgkmcnt(4)
ds_read_b128 a[152:155], v1 offset:17920
v_add_f32 v7, v7, v38
v_mfma_f32_16x16x32_bf16 v[48:51], a[128:131], a[0:3], v[16:19]
ds_read_b128 a[156:159], v1 offset:18176
v_add_f32 v7, v7, v39
v_mfma_f32_16x16x32_bf16 v[48:51], a[132:135], a[4:7], v[48:51]
v_cvt_pk_bf16_f32 v36, v36, v37
v_cvt_pk_bf16_f32 v37, v38, v39
v_mfma_f32_16x16x32_bf16 v[52:55], a[128:131], a[32:35], v[20:23]
v_mul_f32 v40, s35, v40
v_mul_f32 v41, s35, v41
v_mfma_f32_16x16x32_bf16 v[52:55], a[132:135], a[36:39], v[52:55]
v_exp_f32 v40, v40
v_mfma_f32_16x16x32_bf16 v[56:59], a[128:131], a[64:67], v[24:27]
v_exp_f32 v41, v41
v_mfma_f32_16x16x32_bf16 v[56:59], a[132:135], a[68:71], v[56:59]
v_mul_f32 v42, s35, v42
v_mul_f32 v43, s35, v43
v_mfma_f32_16x16x32_bf16 v[60:63], a[128:131], a[96:99], v[28:31]
v_exp_f32 v42, v42
v_mfma_f32_16x16x32_bf16 v[60:63], a[132:135], a[100:103], v[60:63]
s_waitcnt vmcnt(16) lgkmcnt(0)
v_exp_f32 v43, v43
v_mfma_f32_16x16x32_bf16 v[48:51], a[136:139], a[8:11], v[48:51]
s_barrier
v_mfma_f32_16x16x32_bf16 v[48:51], a[140:143], a[12:15], v[48:51]
ds_read_b64_tr_b16 a[128:129], v2 offset:40960
ds_read_b64_tr_b16 a[130:131], v2 offset:43008
v_mfma_f32_16x16x32_bf16 v[52:55], a[136:139], a[40:43], v[52:55]
ds_read_b64_tr_b16 a[132:133], v2 offset:45056
ds_read_b64_tr_b16 a[134:135], v2 offset:47104
v_mfma_f32_16x16x32_bf16 v[52:55], a[140:143], a[44:47], v[52:55]
v_add_f32 v8, v8, v40
v_add_f32 v8, v8, v41
v_mfma_f32_16x16x32_bf16 v[56:59], a[136:139], a[72:75], v[56:59]
v_add_f32 v8, v8, v42
v_add_f32 v8, v8, v43
v_mfma_f32_16x16x32_bf16 v[56:59], a[140:143], a[76:79], v[56:59]
v_cvt_pk_bf16_f32 v40, v40, v41
v_cvt_pk_bf16_f32 v41, v42, v43
v_mfma_f32_16x16x32_bf16 v[60:63], a[136:139], a[104:107], v[60:63]
v_mul_f32 v44, s35, v44
v_mul_f32 v45, s35, v45
v_mfma_f32_16x16x32_bf16 v[60:63], a[140:143], a[108:111], v[60:63]
ds_read_b64_tr_b16 a[136:137], v3 offset:40960
ds_read_b64_tr_b16 a[138:139], v3 offset:43008
v_mfma_f32_16x16x32_bf16 v[48:51], a[144:147], a[16:19], v[48:51]
ds_read_b64_tr_b16 a[140:141], v3 offset:45056
ds_read_b64_tr_b16 a[142:143], v3 offset:47104
v_mfma_f32_16x16x32_bf16 v[48:51], a[148:151], a[20:23], v[48:51]
v_exp_f32 v44, v44
v_mfma_f32_16x16x32_bf16 v[52:55], a[144:147], a[48:51], v[52:55]
v_exp_f32 v45, v45
v_mfma_f32_16x16x32_bf16 v[52:55], a[148:151], a[52:55], v[52:55]
v_mul_f32 v46, s35, v46
v_mul_f32 v47, s35, v47
v_mfma_f32_16x16x32_bf16 v[56:59], a[144:147], a[80:83], v[56:59]
v_exp_f32 v46, v46
v_mfma_f32_16x16x32_bf16 v[56:59], a[148:151], a[84:87], v[56:59]
buffer_load_dword v10, v11, s[96:99], s95 offen
v_mfma_f32_16x16x32_bf16 v[60:63], a[144:147], a[112:115], v[60:63]
s_add_u32 m0, s25, 0
v_exp_f32 v47, v47
v_mfma_f32_16x16x32_bf16 v[60:63], a[148:151], a[116:119], v[60:63]
ds_read_b64_tr_b16 a[144:145], v2 offset:41472
ds_read_b64_tr_b16 a[146:147], v2 offset:43520
v_mfma_f32_16x16x32_bf16 v[48:51], a[152:155], a[24:27], v[48:51]
ds_read_b64_tr_b16 a[148:149], v2 offset:45568
ds_read_b64_tr_b16 a[150:151], v2 offset:47616
v_mfma_f32_16x16x32_bf16 v[48:51], a[156:159], a[28:31], v[48:51]
v_add_f32 v9, v9, v44
v_add_f32 v9, v9, v45
v_mfma_f32_16x16x32_bf16 v[52:55], a[152:155], a[56:59], v[52:55]
v_add_f32 v9, v9, v46
v_add_f32 v9, v9, v47
v_mfma_f32_16x16x32_bf16 v[52:55], a[156:159], a[60:63], v[52:55]
v_cvt_pk_bf16_f32 v44, v44, v45
v_cvt_pk_bf16_f32 v45, v46, v47
v_mfma_f32_16x16x32_bf16 v[56:59], a[152:155], a[88:91], v[56:59]
buffer_load_dwordx4 v4, s[12:15], s29 offen offset:0 lds
v_mfma_f32_16x16x32_bf16 v[56:59], a[156:159], a[92:95], v[56:59]
s_add_u32 m0, s25, 768
v_mul_f32 v48, s35, v48
v_mul_f32 v49, s35, v49
v_mfma_f32_16x16x32_bf16 v[60:63], a[152:155], a[120:123], v[60:63]
v_exp_f32 v48, v48
v_mfma_f32_16x16x32_bf16 v[60:63], a[156:159], a[124:127], v[60:63]
s_waitcnt lgkmcnt(8)
ds_read_b64_tr_b16 a[152:153], v3 offset:41472
ds_read_b64_tr_b16 a[154:155], v3 offset:43520
v_mfma_f32_16x16x32_bf16 a[160:163], a[128:131], v[80:83], a[160:163]
ds_read_b64_tr_b16 a[156:157], v3 offset:45568
ds_read_b64_tr_b16 a[158:159], v3 offset:47616
v_mfma_f32_16x16x32_bf16 a[160:163], a[132:135], v[64:67], a[160:163]
v_add_f32 v6, v6, v48
v_mul_f32 v50, s35, v50
v_mfma_f32_16x16x32_bf16 a[164:167], a[128:131], v[84:87], a[164:167]
v_exp_f32 v49, v49
v_mfma_f32_16x16x32_bf16 a[164:167], a[132:135], v[68:71], a[164:167]
buffer_load_dwordx4 v4, s[12:15], s29 offen offset:256 lds
v_mfma_f32_16x16x32_bf16 a[168:171], a[128:131], v[88:91], a[168:171]
s_add_u32 s29, s29, 8192
v_mul_f32 v51, s35, v51
v_add_f32 v6, v6, v49
v_mfma_f32_16x16x32_bf16 a[168:171], a[132:135], v[72:75], a[168:171]
v_exp_f32 v50, v50
v_mfma_f32_16x16x32_bf16 a[172:175], a[128:131], v[92:95], a[172:175]
v_exp_f32 v51, v51
v_mfma_f32_16x16x32_bf16 a[172:175], a[132:135], v[76:79], a[172:175]
s_waitcnt lgkmcnt(8)
ds_read_b64_tr_b16 a[128:129], v2 offset:49152
ds_read_b64_tr_b16 a[130:131], v2 offset:51200
v_mfma_f32_16x16x32_bf16 a[176:179], a[136:139], v[80:83], a[176:179]
s_cmp_eq_u32 s29, s30
ds_read_b64_tr_b16 a[132:133], v2 offset:53248
ds_read_b64_tr_b16 a[134:135], v2 offset:55296
v_mfma_f32_16x16x32_bf16 a[176:179], a[140:143], v[64:67], a[176:179]
v_add_f32 v6, v6, v50
v_cvt_pk_bf16_f32 v34, v48, v49
v_mfma_f32_16x16x32_bf16 a[180:183], a[136:139], v[84:87], a[180:183]
v_cvt_pk_bf16_f32 v35, v50, v51
v_add_f32 v6, v6, v51
v_mfma_f32_16x16x32_bf16 a[180:183], a[140:143], v[68:71], a[180:183]
v_mul_f32 v52, s35, v52
v_mul_f32 v53, s35, v53
v_mfma_f32_16x16x32_bf16 a[184:187], a[136:139], v[88:91], a[184:187]
s_cselect_b32 s29, s31, s29
v_exp_f32 v52, v52
v_mfma_f32_16x16x32_bf16 a[184:187], a[140:143], v[72:75], a[184:187]
v_add_f32 v7, v7, v52
v_mfma_f32_16x16x32_bf16 a[188:191], a[136:139], v[92:95], a[188:191]
v_exp_f32 v53, v53
v_mfma_f32_16x16x32_bf16 a[188:191], a[140:143], v[76:79], a[188:191]
s_waitcnt lgkmcnt(8)
ds_read_b64_tr_b16 a[136:137], v3 offset:49152
ds_read_b64_tr_b16 a[138:139], v3 offset:51200
v_mfma_f32_16x16x32_bf16 a[192:195], a[144:147], v[80:83], a[192:195]
s_add_u32 m0, s25, 8192
ds_read_b64_tr_b16 a[140:141], v3 offset:53248
ds_read_b64_tr_b16 a[142:143], v3 offset:55296
v_mfma_f32_16x16x32_bf16 a[192:195], a[148:151], v[64:67], a[192:195]
v_mul_f32 v54, s35, v54
v_add_f32 v7, v7, v53
v_mfma_f32_16x16x32_bf16 a[196:199], a[144:147], v[84:87], a[196:199]
v_exp_f32 v54, v54
v_mfma_f32_16x16x32_bf16 a[196:199], a[148:151], v[68:71], a[196:199]
v_mul_f32 v55, s35, v55
v_mfma_f32_16x16x32_bf16 a[200:203], a[144:147], v[88:91], a[200:203]
buffer_load_dwordx4 v4, s[12:15], s29 offen offset:0 lds
v_mfma_f32_16x16x32_bf16 a[200:203], a[148:151], v[72:75], a[200:203]
v_exp_f32 v55, v55
v_mfma_f32_16x16x32_bf16 a[204:207], a[144:147], v[92:95], a[204:207]
v_add_f32 v7, v7, v54
v_cvt_pk_bf16_f32 v38, v52, v53
v_mfma_f32_16x16x32_bf16 a[204:207], a[148:151], v[76:79], a[204:207]
s_waitcnt lgkmcnt(8)
ds_read_b64_tr_b16 a[144:145], v2 offset:49664
ds_read_b64_tr_b16 a[146:147], v2 offset:51712
v_mfma_f32_16x16x32_bf16 a[208:211], a[152:155], v[80:83], a[208:211]
s_add_u32 m0, s25, 8960
ds_read_b64_tr_b16 a[148:149], v2 offset:53760
ds_read_b64_tr_b16 a[150:151], v2 offset:55808
v_mfma_f32_16x16x32_bf16 a[208:211], a[156:159], v[64:67], a[208:211]
v_cvt_pk_bf16_f32 v39, v54, v55
v_add_f32 v7, v7, v55
v_mfma_f32_16x16x32_bf16 a[212:215], a[152:155], v[84:87], a[212:215]
v_mul_f32 v56, s35, v56
v_mul_f32 v57, s35, v57
v_mfma_f32_16x16x32_bf16 a[212:215], a[156:159], v[68:71], a[212:215]
v_exp_f32 v56, v56
v_mfma_f32_16x16x32_bf16 a[216:219], a[152:155], v[88:91], a[216:219]
buffer_load_dwordx4 v4, s[12:15], s29 offen offset:256 lds
v_mfma_f32_16x16x32_bf16 a[216:219], a[156:159], v[72:75], a[216:219]
v_exp_f32 v57, v57
v_mfma_f32_16x16x32_bf16 a[220:223], a[152:155], v[92:95], a[220:223]
v_add_f32 v8, v8, v56
v_mfma_f32_16x16x32_bf16 a[220:223], a[156:159], v[76:79], a[220:223]
s_waitcnt lgkmcnt(8)
ds_read_b64_tr_b16 a[152:153], v3 offset:49664
ds_read_b64_tr_b16 a[154:155], v3 offset:51712
v_mfma_f32_16x16x32_bf16 a[224:227], a[128:131], v[80:83], a[224:227]
s_add_u32 s29, s29, 8192
ds_read_b64_tr_b16 a[156:157], v3 offset:53760
ds_read_b64_tr_b16 a[158:159], v3 offset:55808
v_mfma_f32_16x16x32_bf16 a[224:227], a[132:135], v[64:67], a[224:227]
v_add_f32 v8, v8, v57
v_mul_f32 v58, s35, v58
v_mfma_f32_16x16x32_bf16 a[228:231], a[128:131], v[84:87], a[228:231]
v_exp_f32 v58, v58
v_mfma_f32_16x16x32_bf16 a[228:231], a[132:135], v[68:71], a[228:231]
v_mul_f32 v59, s35, v59
v_add_f32 v8, v8, v58
v_mfma_f32_16x16x32_bf16 a[232:235], a[128:131], v[88:91], a[232:235]
v_exp_f32 v59, v59
v_mfma_f32_16x16x32_bf16 a[232:235], a[132:135], v[72:75], a[232:235]
buffer_load_dword v10, v11, s[12:15], s91 offen
v_mfma_f32_16x16x32_bf16 a[236:239], a[128:131], v[92:95], a[236:239]
v_cvt_pk_bf16_f32 v42, v56, v57
v_add_f32 v8, v8, v59
v_mfma_f32_16x16x32_bf16 a[236:239], a[132:135], v[76:79], a[236:239]
s_waitcnt lgkmcnt(8)
ds_read_b128 a[128:131], v1 offset:24576
ds_read_b128 a[132:135], v1 offset:24832
v_mfma_f32_16x16x32_bf16 a[240:243], a[136:139], v[80:83], a[240:243]
s_add_u32 s91, s91, 24576
v_cvt_pk_bf16_f32 v43, v58, v59
v_mul_f32 v60, s35, v60
v_mfma_f32_16x16x32_bf16 a[240:243], a[140:143], v[64:67], a[240:243]
v_mul_f32 v61, s35, v61
v_mfma_f32_16x16x32_bf16 a[244:247], a[136:139], v[84:87], a[244:247]
v_exp_f32 v60, v60
v_mfma_f32_16x16x32_bf16 a[244:247], a[140:143], v[68:71], a[244:247]
s_add_u32 m0, s25, 16384
v_add_f32 v9, v9, v60
v_mfma_f32_16x16x32_bf16 a[248:251], a[136:139], v[88:91], a[248:251]
v_exp_f32 v61, v61
v_mfma_f32_16x16x32_bf16 a[248:251], a[140:143], v[72:75], a[248:251]
v_add_f32 v9, v9, v61
v_mfma_f32_16x16x32_bf16 a[252:255], a[136:139], v[92:95], a[252:255]
v_mul_f32 v62, s35, v62
v_mfma_f32_16x16x32_bf16 a[252:255], a[140:143], v[76:79], a[252:255]
s_waitcnt lgkmcnt(6)
ds_read_b128 a[136:139], v1 offset:25088
ds_read_b128 a[140:143], v1 offset:25344
v_mfma_f32_16x16x32_bf16 v[160:163], a[144:147], v[80:83], v[160:163]
buffer_load_dwordx4 v4, s[12:15], s29 offen offset:0 lds
v_mfma_f32_16x16x32_bf16 v[160:163], a[148:151], v[64:67], v[160:163]
v_exp_f32 v62, v62
v_mfma_f32_16x16x32_bf16 v[164:167], a[144:147], v[84:87], v[164:167]
v_mul_f32 v63, s35, v63
v_add_f32 v9, v9, v62
v_mfma_f32_16x16x32_bf16 v[164:167], a[148:151], v[68:71], v[164:167]
s_add_u32 m0, s25, 17152
v_exp_f32 v63, v63
v_mfma_f32_16x16x32_bf16 v[168:171], a[144:147], v[88:91], v[168:171]
v_add_f32 v9, v9, v63
v_cvt_pk_bf16_f32 v46, v60, v61
v_mfma_f32_16x16x32_bf16 v[168:171], a[148:151], v[72:75], v[168:171]
v_cvt_pk_bf16_f32 v47, v62, v63
v_mfma_f32_16x16x32_bf16 v[172:175], a[144:147], v[92:95], v[172:175]
v_mfma_f32_16x16x32_bf16 v[172:175], a[148:151], v[76:79], v[172:175]
s_waitcnt lgkmcnt(4)
ds_read_b128 a[144:147], v1 offset:25600
ds_read_b128 a[148:151], v1 offset:25856
v_mfma_f32_16x16x32_bf16 v[176:179], a[152:155], v[80:83], v[176:179]
buffer_load_dwordx4 v4, s[12:15], s29 offen offset:256 lds
v_mfma_f32_16x16x32_bf16 v[176:179], a[156:159], v[64:67], v[176:179]
v_mfma_f32_16x16x32_bf16 v[180:183], a[152:155], v[84:87], v[180:183]
v_mfma_f32_16x16x32_bf16 v[180:183], a[156:159], v[68:71], v[180:183]
s_add_u32 s29, s29, 8192
v_mfma_f32_16x16x32_bf16 v[184:187], a[152:155], v[88:91], v[184:187]
v_mfma_f32_16x16x32_bf16 v[184:187], a[156:159], v[72:75], v[184:187]
v_mfma_f32_16x16x32_bf16 v[188:191], a[152:155], v[92:95], v[188:191]
v_mfma_f32_16x16x32_bf16 v[188:191], a[156:159], v[76:79], v[188:191]
s_waitcnt lgkmcnt(4)
ds_read_b128 a[152:155], v1 offset:26112
ds_read_b128 a[156:159], v1 offset:26368
v_mfma_f32_16x16x32_bf16 v[48:51], a[128:131], a[0:3], v[16:19]
buffer_load_dword v10, v11, s[16:19], s92 offen
v_mfma_f32_16x16x32_bf16 v[48:51], a[132:135], a[4:7], v[48:51]
v_mfma_f32_16x16x32_bf16 v[52:55], a[128:131], a[32:35], v[20:23]
v_mfma_f32_16x16x32_bf16 v[52:55], a[132:135], a[36:39], v[52:55]
s_add_u32 s92, s92, 24576
v_mfma_f32_16x16x32_bf16 v[56:59], a[128:131], a[64:67], v[24:27]
v_mfma_f32_16x16x32_bf16 v[56:59], a[132:135], a[68:71], v[56:59]
v_mfma_f32_16x16x32_bf16 v[60:63], a[128:131], a[96:99], v[28:31]
v_mfma_f32_16x16x32_bf16 v[60:63], a[132:135], a[100:103], v[60:63]
s_waitcnt lgkmcnt(4)
ds_read_b64_tr_b16 a[128:129], v2 offset:57344
ds_read_b64_tr_b16 a[130:131], v2 offset:59392
v_mfma_f32_16x16x32_bf16 v[48:51], a[136:139], a[8:11], v[48:51]
s_add_u32 s32, s32, 32768
ds_read_b64_tr_b16 a[132:133], v2 offset:61440
ds_read_b64_tr_b16 a[134:135], v2 offset:63488
v_mfma_f32_16x16x32_bf16 v[48:51], a[140:143], a[12:15], v[48:51]
v_mfma_f32_16x16x32_bf16 v[52:55], a[136:139], a[40:43], v[52:55]
v_mfma_f32_16x16x32_bf16 v[52:55], a[140:143], a[44:47], v[52:55]
s_add_u32 s33, s32, 4096
v_mfma_f32_16x16x32_bf16 v[56:59], a[136:139], a[72:75], v[56:59]
v_mfma_f32_16x16x32_bf16 v[56:59], a[140:143], a[76:79], v[56:59]
v_mfma_f32_16x16x32_bf16 v[60:63], a[136:139], a[104:107], v[60:63]
v_mfma_f32_16x16x32_bf16 v[60:63], a[140:143], a[108:111], v[60:63]
s_waitcnt lgkmcnt(6)
ds_read_b64_tr_b16 a[136:137], v3 offset:57344
ds_read_b64_tr_b16 a[138:139], v3 offset:59392
v_mfma_f32_16x16x32_bf16 v[48:51], a[144:147], a[16:19], v[48:51]
s_add_u32 m0, s25, 98304
ds_read_b64_tr_b16 a[140:141], v3 offset:61440
ds_read_b64_tr_b16 a[142:143], v3 offset:63488
v_mfma_f32_16x16x32_bf16 v[48:51], a[148:151], a[20:23], v[48:51]
v_mfma_f32_16x16x32_bf16 v[52:55], a[144:147], a[48:51], v[52:55]
v_mfma_f32_16x16x32_bf16 v[52:55], a[148:151], a[52:55], v[52:55]
buffer_load_dwordx4 v5, s[16:19], s32 offen offset:0 lds
v_mfma_f32_16x16x32_bf16 v[56:59], a[144:147], a[80:83], v[56:59]
v_mfma_f32_16x16x32_bf16 v[56:59], a[148:151], a[84:87], v[56:59]
v_mfma_f32_16x16x32_bf16 v[60:63], a[144:147], a[112:115], v[60:63]
v_mfma_f32_16x16x32_bf16 v[60:63], a[148:151], a[116:119], v[60:63]
s_waitcnt lgkmcnt(8)
ds_read_b64_tr_b16 a[144:145], v2 offset:57856
ds_read_b64_tr_b16 a[146:147], v2 offset:59904
v_mfma_f32_16x16x32_bf16 v[48:51], a[152:155], a[24:27], v[48:51]
s_add_u32 m0, s25, 99328
ds_read_b64_tr_b16 a[148:149], v2 offset:61952
ds_read_b64_tr_b16 a[150:151], v2 offset:64000
v_mfma_f32_16x16x32_bf16 v[48:51], a[156:159], a[28:31], v[48:51]
v_mfma_f32_16x16x32_bf16 v[52:55], a[152:155], a[56:59], v[52:55]
v_mfma_f32_16x16x32_bf16 v[52:55], a[156:159], a[60:63], v[52:55]
buffer_load_dwordx4 v5, s[16:19], s33 offen offset:0 lds
v_mfma_f32_16x16x32_bf16 v[56:59], a[152:155], a[88:91], v[56:59]
v_mfma_f32_16x16x32_bf16 v[56:59], a[156:159], a[92:95], v[56:59]
s_nop 2
v_mul_f32 v48, s35, v48
v_mul_f32 v49, s35, v49
v_mfma_f32_16x16x32_bf16 v[60:63], a[152:155], a[120:123], v[60:63]
v_exp_f32 v48, v48
v_mfma_f32_16x16x32_bf16 v[60:63], a[156:159], a[124:127], v[60:63]
s_waitcnt lgkmcnt(8)
ds_read_b64_tr_b16 a[152:153], v3 offset:57856
ds_read_b64_tr_b16 a[154:155], v3 offset:59904
v_mfma_f32_16x16x32_bf16 v[192:195], a[128:131], v[80:83], v[192:195]
ds_read_b64_tr_b16 a[156:157], v3 offset:61952
ds_read_b64_tr_b16 a[158:159], v3 offset:64000
v_mfma_f32_16x16x32_bf16 v[192:195], a[132:135], v[64:67], v[192:195]
v_exp_f32 v49, v49
v_mfma_f32_16x16x32_bf16 v[196:199], a[128:131], v[84:87], v[196:199]
v_mul_f32 v50, s35, v50
v_mul_f32 v51, s35, v51
v_mfma_f32_16x16x32_bf16 v[196:199], a[132:135], v[68:71], v[196:199]
v_exp_f32 v50, v50
v_mfma_f32_16x16x32_bf16 v[200:203], a[128:131], v[88:91], v[200:203]
v_exp_f32 v51, v51
v_mfma_f32_16x16x32_bf16 v[200:203], a[132:135], v[72:75], v[200:203]
v_add_f32 v6, v6, v48
v_add_f32 v6, v6, v49
v_mfma_f32_16x16x32_bf16 v[204:207], a[128:131], v[92:95], v[204:207]
v_add_f32 v6, v6, v50
v_add_f32 v6, v6, v51
v_mfma_f32_16x16x32_bf16 v[204:207], a[132:135], v[76:79], v[204:207]
s_waitcnt vmcnt(19) lgkmcnt(0)
v_cvt_pk_bf16_f32 v48, v48, v49
v_cvt_pk_bf16_f32 v49, v50, v51
v_mfma_f32_16x16x32_bf16 v[208:211], a[136:139], v[80:83], v[208:211]
s_barrier
v_mfma_f32_16x16x32_bf16 v[208:211], a[140:143], v[64:67], v[208:211]
ds_read_b128 a[128:131], v1 offset:32768
ds_read_b128 a[132:135], v1 offset:33024
v_mfma_f32_16x16x32_bf16 v[212:215], a[136:139], v[84:87], v[212:215]
v_mul_f32 v52, s35, v52
v_mul_f32 v53, s35, v53
v_mfma_f32_16x16x32_bf16 v[212:215], a[140:143], v[68:71], v[212:215]
v_exp_f32 v52, v52
v_mfma_f32_16x16x32_bf16 v[216:219], a[136:139], v[88:91], v[216:219]
v_exp_f32 v53, v53
v_mfma_f32_16x16x32_bf16 v[216:219], a[140:143], v[72:75], v[216:219]
v_mul_f32 v54, s35, v54
v_mul_f32 v55, s35, v55
v_mfma_f32_16x16x32_bf16 v[220:223], a[136:139], v[92:95], v[220:223]
v_exp_f32 v54, v54
v_mfma_f32_16x16x32_bf16 v[220:223], a[140:143], v[76:79], v[220:223]
ds_read_b128 a[136:139], v1 offset:33280
ds_read_b128 a[140:143], v1 offset:33536
v_mfma_f32_16x16x32_bf16 v[224:227], a[144:147], v[80:83], v[224:227]
v_exp_f32 v55, v55
v_mfma_f32_16x16x32_bf16 v[224:227], a[148:151], v[64:67], v[224:227]
v_add_f32 v7, v7, v52
v_add_f32 v7, v7, v53
v_mfma_f32_16x16x32_bf16 v[228:231], a[144:147], v[84:87], v[228:231]
v_add_f32 v7, v7, v54
v_add_f32 v7, v7, v55
v_mfma_f32_16x16x32_bf16 v[228:231], a[148:151], v[68:71], v[228:231]
v_cvt_pk_bf16_f32 v52, v52, v53
v_cvt_pk_bf16_f32 v53, v54, v55
v_mfma_f32_16x16x32_bf16 v[232:235], a[144:147], v[88:91], v[232:235]
v_mul_f32 v56, s35, v56
v_mul_f32 v57, s35, v57
v_mfma_f32_16x16x32_bf16 v[232:235], a[148:151], v[72:75], v[232:235]
v_exp_f32 v56, v56
v_mfma_f32_16x16x32_bf16 v[236:239], a[144:147], v[92:95], v[236:239]
v_exp_f32 v57, v57
v_mfma_f32_16x16x32_bf16 v[236:239], a[148:151], v[76:79], v[236:239]
ds_read_b128 a[144:147], v1 offset:33792
ds_read_b128 a[148:151], v1 offset:34048
v_mfma_f32_16x16x32_bf16 v[240:243], a[152:155], v[80:83], v[240:243]
v_mul_f32 v58, s35, v58
v_mul_f32 v59, s35, v59
v_mfma_f32_16x16x32_bf16 v[240:243], a[156:159], v[64:67], v[240:243]
v_exp_f32 v58, v58
v_mfma_f32_16x16x32_bf16 v[244:247], a[152:155], v[84:87], v[244:247]
s_sub_u32 s36, s36, 1
v_exp_f32 v59, v59
v_mfma_f32_16x16x32_bf16 v[244:247], a[156:159], v[68:71], v[244:247]
s_cmp_eq_u32 s36, 0
v_add_f32 v8, v8, v56
v_add_f32 v8, v8, v57
v_mfma_f32_16x16x32_bf16 v[248:251], a[152:155], v[88:91], v[248:251]
v_add_f32 v8, v8, v58
v_add_f32 v8, v8, v59
v_mfma_f32_16x16x32_bf16 v[248:251], a[156:159], v[72:75], v[248:251]
v_cvt_pk_bf16_f32 v56, v56, v57
v_cvt_pk_bf16_f32 v57, v58, v59
v_mfma_f32_16x16x32_bf16 v[252:255], a[152:155], v[92:95], v[252:255]
v_mfma_f32_16x16x32_bf16 v[252:255], a[156:159], v[76:79], v[252:255]
s_waitcnt lgkmcnt(4)
s_cbranch_scc1 L_i6_4
v_mfma_f32_16x16x32_bf16 v[64:67], a[128:131], a[0:3], v[16:19]
ds_read_b128 a[152:155], v1 offset:34304
ds_read_b128 a[156:159], v1 offset:34560
v_mfma_f32_16x16x32_bf16 v[64:67], a[132:135], a[4:7], v[64:67]
v_mul_f32 v60, s35, v60
v_mul_f32 v61, s35, v61
v_mfma_f32_16x16x32_bf16 v[68:71], a[128:131], a[32:35], v[20:23]
s_add_u32 m0, s25, 106368
v_exp_f32 v60, v60
v_mfma_f32_16x16x32_bf16 v[68:71], a[132:135], a[36:39], v[68:71]
buffer_load_dwordx4 v5, s[16:19], s32 offen offset:128 lds
v_mfma_f32_16x16x32_bf16 v[72:75], a[128:131], a[64:67], v[24:27]
s_add_u32 m0, s25, 107392
v_exp_f32 v61, v61
v_mfma_f32_16x16x32_bf16 v[72:75], a[132:135], a[68:71], v[72:75]
v_mul_f32 v62, s35, v62
v_mul_f32 v63, s35, v63
v_mfma_f32_16x16x32_bf16 v[76:79], a[128:131], a[96:99], v[28:31]
buffer_load_dwordx4 v5, s[16:19], s33 offen offset:128 lds
v_mfma_f32_16x16x32_bf16 v[76:79], a[132:135], a[100:103], v[76:79]
s_waitcnt lgkmcnt(4)
ds_read_b128 a[128:131], v1 offset:40960
ds_read_b128 a[132:135], v1 offset:41216
v_mfma_f32_16x16x32_bf16 v[64:67], a[136:139], a[8:11], v[64:67]
s_add_u32 m0, s25, 114432
v_exp_f32 v62, v62
v_mfma_f32_16x16x32_bf16 v[64:67], a[140:143], a[12:15], v[64:67]
v_mfma_f32_16x16x32_bf16 v[68:71], a[136:139], a[40:43], v[68:71]
buffer_load_dwordx4 v5, s[16:19], s32 offen offset:256 lds
v_mfma_f32_16x16x32_bf16 v[68:71], a[140:143], a[44:47], v[68:71]
v_exp_f32 v63, v63
v_mfma_f32_16x16x32_bf16 v[72:75], a[136:139], a[72:75], v[72:75]
s_add_u32 m0, s25, 115456
v_mfma_f32_16x16x32_bf16 v[72:75], a[140:143], a[76:79], v[72:75]
v_add_f32 v9, v9, v60
v_mfma_f32_16x16x32_bf16 v[76:79], a[136:139], a[104:107], v[76:79]
v_mfma_f32_16x16x32_bf16 v[76:79], a[140:143], a[108:111], v[76:79]
s_waitcnt lgkmcnt(4)
ds_read_b128 a[136:139], v1 offset:41472
ds_read_b128 a[140:143], v1 offset:41728
v_mfma_f32_16x16x32_bf16 v[64:67], a[144:147], a[16:19], v[64:67]
v_add_f32 v9, v9, v61
v_add_f32 v9, v9, v62
v_mfma_f32_16x16x32_bf16 v[64:67], a[148:151], a[20:23], v[64:67]
buffer_load_dwordx4 v5, s[16:19], s33 offen offset:256 lds
v_mfma_f32_16x16x32_bf16 v[68:71], a[144:147], a[48:51], v[68:71]
s_add_u32 m0, s25, 122496
v_add_f32 v9, v9, v63
v_mfma_f32_16x16x32_bf16 v[68:71], a[148:151], a[52:55], v[68:71]
v_cvt_pk_bf16_f32 v60, v60, v61
v_mfma_f32_16x16x32_bf16 v[72:75], a[144:147], a[80:83], v[72:75]
buffer_load_dwordx4 v5, s[16:19], s32 offen offset:384 lds
v_mfma_f32_16x16x32_bf16 v[72:75], a[148:151], a[84:87], v[72:75]
v_cvt_pk_bf16_f32 v61, v62, v63
v_mfma_f32_16x16x32_bf16 v[76:79], a[144:147], a[112:115], v[76:79]
v_mfma_f32_16x16x32_bf16 v[76:79], a[148:151], a[116:119], v[76:79]
s_waitcnt lgkmcnt(4)
ds_read_b128 a[144:147], v1 offset:41984
ds_read_b128 a[148:151], v1 offset:42240
v_mfma_f32_16x16x32_bf16 v[64:67], a[152:155], a[24:27], v[64:67]
s_add_u32 m0, s25, 123520
v_mfma_f32_16x16x32_bf16 v[64:67], a[156:159], a[28:31], v[64:67]
v_mfma_f32_16x16x32_bf16 v[68:71], a[152:155], a[56:59], v[68:71]
buffer_load_dwordx4 v5, s[16:19], s33 offen offset:384 lds
v_mfma_f32_16x16x32_bf16 v[68:71], a[156:159], a[60:63], v[68:71]
v_mfma_f32_16x16x32_bf16 v[72:75], a[152:155], a[88:91], v[72:75]
v_mfma_f32_16x16x32_bf16 v[72:75], a[156:159], a[92:95], v[72:75]
s_nop 2
v_mul_f32 v64, s35, v64
v_mul_f32 v65, s35, v65
v_mfma_f32_16x16x32_bf16 v[76:79], a[152:155], a[120:123], v[76:79]
v_exp_f32 v64, v64
v_mfma_f32_16x16x32_bf16 v[76:79], a[156:159], a[124:127], v[76:79]
s_waitcnt lgkmcnt(4)
ds_read_b128 a[152:155], v1 offset:42496
ds_read_b128 a[156:159], v1 offset:42752
v_mfma_f32_16x16x32_bf16 v[80:83], a[128:131], a[0:3], v[16:19]
v_exp_f32 v65, v65
v_mfma_f32_16x16x32_bf16 v[80:83], a[132:135], a[4:7], v[80:83]
v_mul_f32 v66, s35, v66
v_mul_f32 v67, s35, v67
v_mfma_f32_16x16x32_bf16 v[84:87], a[128:131], a[32:35], v[20:23]
v_exp_f32 v66, v66
v_mfma_f32_16x16x32_bf16 v[84:87], a[132:135], a[36:39], v[84:87]
v_exp_f32 v67, v67
v_mfma_f32_16x16x32_bf16 v[88:91], a[128:131], a[64:67], v[24:27]
v_cvt_pk_bf16_f32 v50, v64, v65
v_cvt_pk_bf16_f32 v51, v66, v67
v_mfma_f32_16x16x32_bf16 v[88:91], a[132:135], a[68:71], v[88:91]
v_mul_f32 v68, s35, v68
v_mul_f32 v69, s35, v69
v_mfma_f32_16x16x32_bf16 v[92:95], a[128:131], a[96:99], v[28:31]
v_exp_f32 v68, v68
v_mfma_f32_16x16x32_bf16 v[92:95], a[132:135], a[100:103], v[92:95]
s_waitcnt lgkmcnt(4)
ds_read_b64_tr_b16 a[128:129], v2 offset:0
ds_read_b64_tr_b16 a[130:131], v2 offset:2048
v_mfma_f32_16x16x32_bf16 v[80:83], a[136:139], a[8:11], v[80:83]
ds_read_b64_tr_b16 a[132:133], v2 offset:4096
ds_read_b64_tr_b16 a[134:135], v2 offset:6144
v_mfma_f32_16x16x32_bf16 v[80:83], a[140:143], a[12:15], v[80:83]
v_exp_f32 v69, v69
v_mfma_f32_16x16x32_bf16 v[84:87], a[136:139], a[40:43], v[84:87]
v_mul_f32 v70, s35, v70
v_mul_f32 v71, s35, v71
v_mfma_f32_16x16x32_bf16 v[84:87], a[140:143], a[44:47], v[84:87]
v_exp_f32 v70, v70
v_mfma_f32_16x16x32_bf16 v[88:91], a[136:139], a[72:75], v[88:91]
v_exp_f32 v71, v71
v_mfma_f32_16x16x32_bf16 v[88:91], a[140:143], a[76:79], v[88:91]
v_cvt_pk_bf16_f32 v54, v68, v69
v_cvt_pk_bf16_f32 v55, v70, v71
v_mfma_f32_16x16x32_bf16 v[92:95], a[136:139], a[104:107], v[92:95]
v_mul_f32 v72, s35, v72
v_mul_f32 v73, s35, v73
v_mfma_f32_16x16x32_bf16 v[92:95], a[140:143], a[108:111], v[92:95]
s_waitcnt lgkmcnt(6)
ds_read_b64_tr_b16 a[136:137], v3 offset:0
ds_read_b64_tr_b16 a[138:139], v3 offset:2048
v_mfma_f32_16x16x32_bf16 v[80:83], a[144:147], a[16:19], v[80:83]
ds_read_b64_tr_b16 a[140:141], v3 offset:4096
ds_read_b64_tr_b16 a[142:143], v3 offset:6144
v_mfma_f32_16x16x32_bf16 v[80:83], a[148:151], a[20:23], v[80:83]
v_exp_f32 v72, v72
v_mfma_f32_16x16x32_bf16 v[84:87], a[144:147], a[48:51], v[84:87]
v_exp_f32 v73, v73
v_mfma_f32_16x16x32_bf16 v[84:87], a[148:151], a[52:55], v[84:87]
v_mul_f32 v74, s35, v74
v_mul_f32 v75, s35, v75
v_mfma_f32_16x16x32_bf16 v[88:91], a[144:147], a[80:83], v[88:91]
v_exp_f32 v74, v74
v_mfma_f32_16x16x32_bf16 v[88:91], a[148:151], a[84:87], v[88:91]
v_exp_f32 v75, v75
v_mfma_f32_16x16x32_bf16 v[92:95], a[144:147], a[112:115], v[92:95]
v_cvt_pk_bf16_f32 v58, v72, v73
v_cvt_pk_bf16_f32 v59, v74, v75
v_mfma_f32_16x16x32_bf16 v[92:95], a[148:151], a[116:119], v[92:95]
s_waitcnt lgkmcnt(8)
ds_read_b64_tr_b16 a[144:145], v2 offset:512
ds_read_b64_tr_b16 a[146:147], v2 offset:2560
v_mfma_f32_16x16x32_bf16 v[80:83], a[152:155], a[24:27], v[80:83]
ds_read_b64_tr_b16 a[148:149], v2 offset:4608
ds_read_b64_tr_b16 a[150:151], v2 offset:6656
v_mfma_f32_16x16x32_bf16 v[80:83], a[156:159], a[28:31], v[80:83]
v_mul_f32 v76, s35, v76
v_mul_f32 v77, s35, v77
v_mfma_f32_16x16x32_bf16 v[84:87], a[152:155], a[56:59], v[84:87]
v_exp_f32 v76, v76
v_mfma_f32_16x16x32_bf16 v[84:87], a[156:159], a[60:63], v[84:87]
v_exp_f32 v77, v77
v_mfma_f32_16x16x32_bf16 v[88:91], a[152:155], a[88:91], v[88:91]
v_mul_f32 v78, s35, v78
v_mul_f32 v79, s35, v79
v_mfma_f32_16x16x32_bf16 v[88:91], a[156:159], a[92:95], v[88:91]
v_exp_f32 v78, v78
v_mfma_f32_16x16x32_bf16 v[92:95], a[152:155], a[120:123], v[92:95]
v_exp_f32 v79, v79
v_mfma_f32_16x16x32_bf16 v[92:95], a[156:159], a[124:127], v[92:95]
s_waitcnt lgkmcnt(8)
ds_read_b64_tr_b16 a[152:153], v3 offset:512
ds_read_b64_tr_b16 a[154:155], v3 offset:2560
v_mfma_f32_16x16x32_bf16 v[96:99], a[128:131], v[32:35], v[96:99]
ds_read_b64_tr_b16 a[156:157], v3 offset:4608
ds_read_b64_tr_b16 a[158:159], v3 offset:6656
v_mfma_f32_16x16x32_bf16 v[96:99], a[132:135], v[48:51], v[96:99]
v_cvt_pk_bf16_f32 v62, v76, v77
v_cvt_pk_bf16_f32 v63, v78, v79
v_mfma_f32_16x16x32_bf16 v[100:103], a[128:131], v[36:39], v[100:103]
v_add_f32 v6, v6, v64
v_add_f32 v6, v6, v65
v_mfma_f32_16x16x32_bf16 v[100:103], a[132:135], v[52:55], v[100:103]
v_mul_f32 v80, s35, v80
v_mul_f32 v81, s35, v81
v_mfma_f32_16x16x32_bf16 v[104:107], a[128:131], v[40:43], v[104:107]
v_add_f32 v6, v6, v66
v_add_f32 v6, v6, v67
v_mfma_f32_16x16x32_bf16 v[104:107], a[132:135], v[56:59], v[104:107]
v_exp_f32 v80, v80
v_mfma_f32_16x16x32_bf16 v[108:111], a[128:131], v[44:47], v[108:111]
v_exp_f32 v81, v81
v_mfma_f32_16x16x32_bf16 v[108:111], a[132:135], v[60:63], v[108:111]
s_waitcnt lgkmcnt(8)
ds_read_b128 a[128:131], v1 offset:49152
ds_read_b128 a[132:135], v1 offset:49408
v_mfma_f32_16x16x32_bf16 v[112:115], a[136:139], v[32:35], v[112:115]
v_add_f32 v7, v7, v68
v_mul_f32 v82, s35, v82
v_mfma_f32_16x16x32_bf16 v[112:115], a[140:143], v[48:51], v[112:115]
v_mul_f32 v83, s35, v83
v_add_f32 v7, v7, v69
v_mfma_f32_16x16x32_bf16 v[116:119], a[136:139], v[36:39], v[116:119]
s_add_u32 m0, s25, 24576
v_exp_f32 v82, v82
v_mfma_f32_16x16x32_bf16 v[116:119], a[140:143], v[52:55], v[116:119]
v_exp_f32 v83, v83
v_mfma_f32_16x16x32_bf16 v[120:123], a[136:139], v[40:43], v[120:123]
v_add_f32 v7, v7, v70
v_add_f32 v6, v6, v80
v_mfma_f32_16x16x32_bf16 v[120:123], a[140:143], v[56:59], v[120:123]
v_add_f32 v7, v7, v71
v_add_f32 v6, v6, v81
v_mfma_f32_16x16x32_bf16 v[124:127], a[136:139], v[44:47], v[124:127]
v_add_f32 v6, v6, v82
v_add_f32 v8, v8, v72
v_mfma_f32_16x16x32_bf16 v[124:127], a[140:143], v[60:63], v[124:127]
s_waitcnt lgkmcnt(6)
ds_read_b128 a[136:139], v1 offset:49664
ds_read_b128 a[140:143], v1 offset:49920
v_mfma_f32_16x16x32_bf16 v[128:131], a[144:147], v[32:35], v[128:131]
v_add_f32 v6, v6, v83
v_cvt_pk_bf16_f32 v80, v80, v81
v_mfma_f32_16x16x32_bf16 v[128:131], a[148:151], v[48:51], v[128:131]
buffer_load_dwordx4 v4, s[12:15], s29 offen offset:0 lds
v_mfma_f32_16x16x32_bf16 v[132:135], a[144:147], v[36:39], v[132:135]
s_add_u32 m0, s25, 25344
v_add_f32 v8, v8, v73
v_cvt_pk_bf16_f32 v81, v82, v83
v_mfma_f32_16x16x32_bf16 v[132:135], a[148:151], v[52:55], v[132:135]
v_mul_f32 v84, s35, v84
v_add_f32 v8, v8, v74
v_mfma_f32_16x16x32_bf16 v[136:139], a[144:147], v[40:43], v[136:139]
v_mul_f32 v85, s35, v85
v_add_f32 v8, v8, v75
v_mfma_f32_16x16x32_bf16 v[136:139], a[148:151], v[56:59], v[136:139]
v_exp_f32 v84, v84
v_mfma_f32_16x16x32_bf16 v[140:143], a[144:147], v[44:47], v[140:143]
v_exp_f32 v85, v85
v_mfma_f32_16x16x32_bf16 v[140:143], a[148:151], v[60:63], v[140:143]
s_waitcnt lgkmcnt(4)
ds_read_b128 a[144:147], v1 offset:50176
v_add_f32 v9, v9, v76
v_mfma_f32_16x16x32_bf16 v[144:147], a[152:155], v[32:35], v[144:147]
ds_read_b128 a[148:151], v1 offset:50432
v_mul_f32 v86, s35, v86
v_mfma_f32_16x16x32_bf16 v[144:147], a[156:159], v[48:51], v[144:147]
v_add_f32 v9, v9, v77
v_mul_f32 v87, s35, v87
v_mfma_f32_16x16x32_bf16 v[148:151], a[152:155], v[36:39], v[148:151]
v_exp_f32 v86, v86
v_mfma_f32_16x16x32_bf16 v[148:151], a[156:159], v[52:55], v[148:151]
v_add_f32 v9, v9, v78
v_add_f32 v9, v9, v79
v_mfma_f32_16x16x32_bf16 v[152:155], a[152:155], v[40:43], v[152:155]
v_exp_f32 v87, v87
v_mfma_f32_16x16x32_bf16 v[152:155], a[156:159], v[56:59], v[152:155]
buffer_load_dwordx4 v4, s[12:15], s29 offen offset:256 lds
v_mfma_f32_16x16x32_bf16 v[156:159], a[152:155], v[44:47], v[156:159]
s_add_u32 s29, s29, 8192
v_add_f32 v7, v7, v84
v_add_f32 v7, v7, v85
v_mfma_f32_16x16x32_bf16 v[156:159], a[156:159], v[60:63], v[156:159]
s_waitcnt lgkmcnt(4)
ds_read_b128 a[152:155], v1 offset:50688
v_add_f32 v7, v7, v86
v_mfma_f32_16x16x32_bf16 v[64:67], a[128:131], a[0:3], v[16:19]
ds_read_b128 a[156:159], v1 offset:50944
v_add_f32 v7, v7, v87
v_mfma_f32_16x16x32_bf16 v[64:67], a[132:135], a[4:7], v[64:67]
v_cvt_pk_bf16_f32 v84, v84, v85
v_cvt_pk_bf16_f32 v85, v86, v87
v_mfma_f32_16x16x32_bf16 v[68:71], a[128:131], a[32:35], v[20:23]
v_mul_f32 v88, s35, v88
v_mul_f32 v89, s35, v89
v_mfma_f32_16x16x32_bf16 v[68:71], a[132:135], a[36:39], v[68:71]
v_exp_f32 v88, v88
v_mfma_f32_16x16x32_bf16 v[72:75], a[128:131], a[64:67], v[24:27]
v_exp_f32 v89, v89
v_mfma_f32_16x16x32_bf16 v[72:75], a[132:135], a[68:71], v[72:75]
v_mul_f32 v90, s35, v90
v_mul_f32 v91, s35, v91
v_mfma_f32_16x16x32_bf16 v[76:79], a[128:131], a[96:99], v[28:31]
v_exp_f32 v90, v90
v_mfma_f32_16x16x32_bf16 v[76:79], a[132:135], a[100:103], v[76:79]
s_waitcnt vmcnt(19) lgkmcnt(0)
v_exp_f32 v91, v91
v_mfma_f32_16x16x32_bf16 v[64:67], a[136:139], a[8:11], v[64:67]
s_barrier
v_mfma_f32_16x16x32_bf16 v[64:67], a[140:143], a[12:15], v[64:67]
ds_read_b64_tr_b16 a[128:129], v2 offset:8192
ds_read_b64_tr_b16 a[130:131], v2 offset:10240
v_mfma_f32_16x16x32_bf16 v[68:71], a[136:139], a[40:43], v[68:71]
ds_read_b64_tr_b16 a[132:133], v2 offset:12288
ds_read_b64_tr_b16 a[134:135], v2 offset:14336
v_mfma_f32_16x16x32_bf16 v[68:71], a[140:143], a[44:47], v[68:71]
v_add_f32 v8, v8, v88
v_add_f32 v8, v8, v89
v_mfma_f32_16x16x32_bf16 v[72:75], a[136:139], a[72:75], v[72:75]
v_add_f32 v8, v8, v90
v_add_f32 v8, v8, v91
v_mfma_f32_16x16x32_bf16 v[72:75], a[140:143], a[76:79], v[72:75]
v_cvt_pk_bf16_f32 v88, v88, v89
v_cvt_pk_bf16_f32 v89, v90, v91
v_mfma_f32_16x16x32_bf16 v[76:79], a[136:139], a[104:107], v[76:79]
v_mul_f32 v92, s35, v92
v_mul_f32 v93, s35, v93
v_mfma_f32_16x16x32_bf16 v[76:79], a[140:143], a[108:111], v[76:79]
ds_read_b64_tr_b16 a[136:137], v3 offset:8192
ds_read_b64_tr_b16 a[138:139], v3 offset:10240
v_mfma_f32_16x16x32_bf16 v[64:67], a[144:147], a[16:19], v[64:67]
s_add_u32 m0, s25, 32768
ds_read_b64_tr_b16 a[140:141], v3 offset:12288
ds_read_b64_tr_b16 a[142:143], v3 offset:14336
v_mfma_f32_16x16x32_bf16 v[64:67], a[148:151], a[20:23], v[64:67]
v_exp_f32 v92, v92
v_mfma_f32_16x16x32_bf16 v[68:71], a[144:147], a[48:51], v[68:71]
v_exp_f32 v93, v93
v_mfma_f32_16x16x32_bf16 v[68:71], a[148:151], a[52:55], v[68:71]
v_mul_f32 v94, s35, v94
v_mul_f32 v95, s35, v95
v_mfma_f32_16x16x32_bf16 v[72:75], a[144:147], a[80:83], v[72:75]
v_exp_f32 v94, v94
v_mfma_f32_16x16x32_bf16 v[72:75], a[148:151], a[84:87], v[72:75]
v_exp_f32 v95, v95
v_mfma_f32_16x16x32_bf16 v[76:79], a[144:147], a[112:115], v[76:79]
v_add_f32 v9, v9, v92
v_add_f32 v9, v9, v93
v_mfma_f32_16x16x32_bf16 v[76:79], a[148:151], a[116:119], v[76:79]
ds_read_b64_tr_b16 a[144:145], v2 offset:8704
ds_read_b64_tr_b16 a[146:147], v2 offset:10752
v_mfma_f32_16x16x32_bf16 v[64:67], a[152:155], a[24:27], v[64:67]
ds_read_b64_tr_b16 a[148:149], v2 offset:12800
ds_read_b64_tr_b16 a[150:151], v2 offset:14848
v_mfma_f32_16x16x32_bf16 v[64:67], a[156:159], a[28:31], v[64:67]
buffer_load_dwordx4 v4, s[12:15], s29 offen offset:0 lds
v_mfma_f32_16x16x32_bf16 v[68:71], a[152:155], a[56:59], v[68:71]
s_add_u32 m0, s25, 33536
v_add_f32 v9, v9, v94
v_add_f32 v9, v9, v95
v_mfma_f32_16x16x32_bf16 v[68:71], a[156:159], a[60:63], v[68:71]
v_cvt_pk_bf16_f32 v92, v92, v93
v_cvt_pk_bf16_f32 v93, v94, v95
v_mfma_f32_16x16x32_bf16 v[72:75], a[152:155], a[88:91], v[72:75]
buffer_load_dwordx4 v4, s[12:15], s29 offen offset:256 lds
v_mfma_f32_16x16x32_bf16 v[72:75], a[156:159], a[92:95], v[72:75]
v_mul_f32 v64, s35, v64
v_mul_f32 v65, s35, v65
v_mfma_f32_16x16x32_bf16 v[76:79], a[152:155], a[120:123], v[76:79]
v_exp_f32 v64, v64
v_mfma_f32_16x16x32_bf16 v[76:79], a[156:159], a[124:127], v[76:79]
s_waitcnt lgkmcnt(8)
ds_read_b64_tr_b16 a[152:153], v3 offset:8704
ds_read_b64_tr_b16 a[154:155], v3 offset:10752
v_mfma_f32_16x16x32_bf16 a[160:163], a[128:131], v[32:35], a[160:163]
s_add_u32 s29, s29, 8192
ds_read_b64_tr_b16 a[156:157], v3 offset:12800
ds_read_b64_tr_b16 a[158:159], v3 offset:14848
v_mfma_f32_16x16x32_bf16 a[160:163], a[132:135], v[48:51], a[160:163]
v_add_f32 v6, v6, v64
v_mul_f32 v66, s35, v66
v_mfma_f32_16x16x32_bf16 a[164:167], a[128:131], v[36:39], a[164:167]
v_exp_f32 v65, v65
v_mfma_f32_16x16x32_bf16 a[164:167], a[132:135], v[52:55], a[164:167]
s_add_u32 m0, s93, 0
v_mul_f32 v67, s35, v67
v_add_f32 v6, v6, v65
v_mfma_f32_16x16x32_bf16 a[168:171], a[128:131], v[40:43], a[168:171]
v_exp_f32 v66, v66
v_mfma_f32_16x16x32_bf16 a[168:171], a[132:135], v[56:59], a[168:171]
v_exp_f32 v67, v67
v_mfma_f32_16x16x32_bf16 a[172:175], a[128:131], v[44:47], a[172:175]
v_add_f32 v6, v6, v66
v_mfma_f32_16x16x32_bf16 a[172:175], a[132:135], v[60:63], a[172:175]
s_waitcnt lgkmcnt(8)
ds_read_b64_tr_b16 a[128:129], v2 offset:16384
ds_read_b64_tr_b16 a[130:131], v2 offset:18432
v_mfma_f32_16x16x32_bf16 a[176:179], a[136:139], v[32:35], a[176:179]
ds_read_b64_tr_b16 a[132:133], v2 offset:20480
ds_read_b64_tr_b16 a[134:135], v2 offset:22528
v_mfma_f32_16x16x32_bf16 a[176:179], a[140:143], v[48:51], a[176:179]
buffer_load_dwordx4 v12, s[8:11], s94 offen offset:0 nt lds
v_mfma_f32_16x16x32_bf16 a[180:183], a[136:139], v[36:39], a[180:183]
v_cvt_pk_bf16_f32 v82, v64, v65
v_cvt_pk_bf16_f32 v83, v66, v67
v_mfma_f32_16x16x32_bf16 a[180:183], a[140:143], v[52:55], a[180:183]
v_add_f32 v6, v6, v67
v_mul_f32 v68, s35, v68
v_mfma_f32_16x16x32_bf16 a[184:187], a[136:139], v[40:43], a[184:187]
buffer_load_dwordx4 v12, s[8:11], s94 offen offset:2048 nt lds
v_mfma_f32_16x16x32_bf16 a[184:187], a[140:143], v[56:59], a[184:187]
v_exp_f32 v68, v68
v_mfma_f32_16x16x32_bf16 a[188:191], a[136:139], v[44:47], a[188:191]
v_mul_f32 v69, s35, v69
v_add_f32 v7, v7, v68
v_mfma_f32_16x16x32_bf16 a[188:191], a[140:143], v[60:63], a[188:191]
s_waitcnt lgkmcnt(8)
ds_read_b64_tr_b16 a[136:137], v3 offset:16384
ds_read_b64_tr_b16 a[138:139], v3 offset:18432
v_mfma_f32_16x16x32_bf16 a[192:195], a[144:147], v[32:35], a[192:195]
s_add_u32 m0, s25, 40960
ds_read_b64_tr_b16 a[140:141], v3 offset:20480
ds_read_b64_tr_b16 a[142:143], v3 offset:22528
v_mfma_f32_16x16x32_bf16 a[192:195], a[148:151], v[48:51], a[192:195]
v_exp_f32 v69, v69
v_mfma_f32_16x16x32_bf16 a[196:199], a[144:147], v[36:39], a[196:199]
v_mul_f32 v70, s35, v70
v_add_f32 v7, v7, v69
v_mfma_f32_16x16x32_bf16 a[196:199], a[148:151], v[52:55], a[196:199]
v_exp_f32 v70, v70
v_mfma_f32_16x16x32_bf16 a[200:203], a[144:147], v[40:43], a[200:203]
v_mul_f32 v71, s35, v71
v_add_f32 v7, v7, v70
v_mfma_f32_16x16x32_bf16 a[200:203], a[148:151], v[56:59], a[200:203]
buffer_load_dwordx4 v4, s[12:15], s29 offen offset:0 lds
v_mfma_f32_16x16x32_bf16 a[204:207], a[144:147], v[44:47], a[204:207]
s_add_u32 m0, s25, 41728
v_exp_f32 v71, v71
v_mfma_f32_16x16x32_bf16 a[204:207], a[148:151], v[60:63], a[204:207]
s_waitcnt lgkmcnt(8)
ds_read_b64_tr_b16 a[144:145], v2 offset:16896
ds_read_b64_tr_b16 a[146:147], v2 offset:18944
v_mfma_f32_16x16x32_bf16 a[208:211], a[152:155], v[32:35], a[208:211]
ds_read_b64_tr_b16 a[148:149], v2 offset:20992
ds_read_b64_tr_b16 a[150:151], v2 offset:23040
v_mfma_f32_16x16x32_bf16 a[208:211], a[156:159], v[48:51], a[208:211]
v_cvt_pk_bf16_f32 v86, v68, v69
v_cvt_pk_bf16_f32 v87, v70, v71
v_mfma_f32_16x16x32_bf16 a[212:215], a[152:155], v[36:39], a[212:215]
v_add_f32 v7, v7, v71
v_mul_f32 v72, s35, v72
v_mfma_f32_16x16x32_bf16 a[212:215], a[156:159], v[52:55], a[212:215]
buffer_load_dwordx4 v4, s[12:15], s29 offen offset:256 lds
v_mfma_f32_16x16x32_bf16 a[216:219], a[152:155], v[40:43], a[216:219]
v_exp_f32 v72, v72
v_mfma_f32_16x16x32_bf16 a[216:219], a[156:159], v[56:59], a[216:219]
v_mul_f32 v73, s35, v73
v_add_f32 v8, v8, v72
v_mfma_f32_16x16x32_bf16 a[220:223], a[152:155], v[44:47], a[220:223]
s_add_u32 s29, s29, 8192
v_exp_f32 v73, v73
v_mfma_f32_16x16x32_bf16 a[220:223], a[156:159], v[60:63], a[220:223]
s_waitcnt lgkmcnt(8)
ds_read_b64_tr_b16 a[152:153], v3 offset:16896
ds_read_b64_tr_b16 a[154:155], v3 offset:18944
v_mfma_f32_16x16x32_bf16 a[224:227], a[128:131], v[32:35], a[224:227]
ds_read_b64_tr_b16 a[156:157], v3 offset:20992
ds_read_b64_tr_b16 a[158:159], v3 offset:23040
v_mfma_f32_16x16x32_bf16 a[224:227], a[132:135], v[48:51], a[224:227]
v_add_f32 v8, v8, v73
v_mul_f32 v74, s35, v74
v_mfma_f32_16x16x32_bf16 a[228:231], a[128:131], v[36:39], a[228:231]
s_add_u32 m0, s93, 4096
v_exp_f32 v74, v74
v_mfma_f32_16x16x32_bf16 a[228:231], a[132:135], v[52:55], a[228:231]
v_mul_f32 v75, s35, v75
v_add_f32 v8, v8, v74
v_mfma_f32_16x16x32_bf16 a[232:235], a[128:131], v[40:43], a[232:235]
v_exp_f32 v75, v75
v_mfma_f32_16x16x32_bf16 a[232:235], a[132:135], v[56:59], a[232:235]
v_cvt_pk_bf16_f32 v90, v72, v73
v_mfma_f32_16x16x32_bf16 a[236:239], a[128:131], v[44:47], a[236:239]
buffer_load_dwordx4 v13, s[8:11], s94 offen offset:0 nt lds
v_mfma_f32_16x16x32_bf16 a[236:239], a[132:135], v[60:63], a[236:239]
s_waitcnt lgkmcnt(8)
ds_read_b128 a[128:131], v1 offset:57344
ds_read_b128 a[132:135], v1 offset:57600
v_mfma_f32_16x16x32_bf16 a[240:243], a[136:139], v[32:35], a[240:243]
v_add_f32 v8, v8, v75
v_cvt_pk_bf16_f32 v91, v74, v75
v_mfma_f32_16x16x32_bf16 a[240:243], a[140:143], v[48:51], a[240:243]
v_mul_f32 v76, s35, v76
v_mul_f32 v77, s35, v77
v_mfma_f32_16x16x32_bf16 a[244:247], a[136:139], v[36:39], a[244:247]
buffer_load_dwordx4 v13, s[8:11], s94 offen offset:2048 nt lds
v_mfma_f32_16x16x32_bf16 a[244:247], a[140:143], v[52:55], a[244:247]
v_exp_f32 v76, v76
v_mfma_f32_16x16x32_bf16 a[248:251], a[136:139], v[40:43], a[248:251]
v_exp_f32 v77, v77
v_mfma_f32_16x16x32_bf16 a[248:251], a[140:143], v[56:59], a[248:251]
s_add_u32 s93, s93, 1024
v_add_f32 v9, v9, v76
v_add_f32 v9, v9, v77
v_mfma_f32_16x16x32_bf16 a[252:255], a[136:139], v[44:47], a[252:255]
v_mul_f32 v78, s35, v78
v_mfma_f32_16x16x32_bf16 a[252:255], a[140:143], v[60:63], a[252:255]
s_waitcnt lgkmcnt(6)
ds_read_b128 a[136:139], v1 offset:57856
ds_read_b128 a[140:143], v1 offset:58112
v_mfma_f32_16x16x32_bf16 v[160:163], a[144:147], v[32:35], v[160:163]
v_exp_f32 v78, v78
v_mfma_f32_16x16x32_bf16 v[160:163], a[148:151], v[48:51], v[160:163]
s_add_u32 s94, s94, 256
v_mul_f32 v79, s35, v79
v_add_f32 v9, v9, v78
v_mfma_f32_16x16x32_bf16 v[164:167], a[144:147], v[36:39], v[164:167]
v_exp_f32 v79, v79
v_mfma_f32_16x16x32_bf16 v[164:167], a[148:151], v[52:55], v[164:167]
v_mfma_f32_16x16x32_bf16 v[168:171], a[144:147], v[40:43], v[168:171]
v_add_f32 v9, v9, v79
v_cvt_pk_bf16_f32 v94, v76, v77
v_mfma_f32_16x16x32_bf16 v[168:171], a[148:151], v[56:59], v[168:171]
s_add_u32 m0, s25, 49152
v_cvt_pk_bf16_f32 v95, v78, v79
v_mfma_f32_16x16x32_bf16 v[172:175], a[144:147], v[44:47], v[172:175]
v_mfma_f32_16x16x32_bf16 v[172:175], a[148:151], v[60:63], v[172:175]
s_waitcnt lgkmcnt(4)
ds_read_b128 a[144:147], v1 offset:58368
ds_read_b128 a[148:151], v1 offset:58624
v_mfma_f32_16x16x32_bf16 v[176:179], a[152:155], v[32:35], v[176:179]
v_mfma_f32_16x16x32_bf16 v[176:179], a[156:159], v[48:51], v[176:179]
buffer_load_dwordx4 v4, s[12:15], s29 offen offset:0 lds
v_mfma_f32_16x16x32_bf16 v[180:183], a[152:155], v[36:39], v[180:183]
v_mfma_f32_16x16x32_bf16 v[180:183], a[156:159], v[52:55], v[180:183]
v_mfma_f32_16x16x32_bf16 v[184:187], a[152:155], v[40:43], v[184:187]
s_add_u32 m0, s25, 49920
v_mfma_f32_16x16x32_bf16 v[184:187], a[156:159], v[56:59], v[184:187]
v_mfma_f32_16x16x32_bf16 v[188:191], a[152:155], v[44:47], v[188:191]
v_mfma_f32_16x16x32_bf16 v[188:191], a[156:159], v[60:63], v[188:191]
s_waitcnt lgkmcnt(4)
ds_read_b128 a[152:155], v1 offset:58880
ds_read_b128 a[156:159], v1 offset:59136
v_mfma_f32_16x16x32_bf16 v[64:67], a[128:131], a[0:3], v[16:19]
buffer_load_dwordx4 v4, s[12:15], s29 offen offset:256 lds
v_mfma_f32_16x16x32_bf16 v[64:67], a[132:135], a[4:7], v[64:67]
v_mfma_f32_16x16x32_bf16 v[68:71], a[128:131], a[32:35], v[20:23]
v_mfma_f32_16x16x32_bf16 v[68:71], a[132:135], a[36:39], v[68:71]
v_mfma_f32_16x16x32_bf16 v[72:75], a[128:131], a[64:67], v[24:27]
s_add_u32 s29, s29, 8192
v_mfma_f32_16x16x32_bf16 v[72:75], a[132:135], a[68:71], v[72:75]
v_mfma_f32_16x16x32_bf16 v[76:79], a[128:131], a[96:99], v[28:31]
v_mfma_f32_16x16x32_bf16 v[76:79], a[132:135], a[100:103], v[76:79]
s_waitcnt lgkmcnt(4)
ds_read_b64_tr_b16 a[128:129], v2 offset:24576
ds_read_b64_tr_b16 a[130:131], v2 offset:26624
v_mfma_f32_16x16x32_bf16 v[64:67], a[136:139], a[8:11], v[64:67]
s_add_u32 s32, s32, 32768
ds_read_b64_tr_b16 a[132:133], v2 offset:28672
ds_read_b64_tr_b16 a[134:135], v2 offset:30720
v_mfma_f32_16x16x32_bf16 v[64:67], a[140:143], a[12:15], v[64:67]
v_mfma_f32_16x16x32_bf16 v[68:71], a[136:139], a[40:43], v[68:71]
v_mfma_f32_16x16x32_bf16 v[68:71], a[140:143], a[44:47], v[68:71]
v_mfma_f32_16x16x32_bf16 v[72:75], a[136:139], a[72:75], v[72:75]
s_add_u32 s33, s32, 4096
v_mfma_f32_16x16x32_bf16 v[72:75], a[140:143], a[76:79], v[72:75]
v_mfma_f32_16x16x32_bf16 v[76:79], a[136:139], a[104:107], v[76:79]
v_mfma_f32_16x16x32_bf16 v[76:79], a[140:143], a[108:111], v[76:79]
s_waitcnt lgkmcnt(6)
ds_read_b64_tr_b16 a[136:137], v3 offset:24576
ds_read_b64_tr_b16 a[138:139], v3 offset:26624
v_mfma_f32_16x16x32_bf16 v[64:67], a[144:147], a[16:19], v[64:67]
s_add_u32 m0, s25, 65536
ds_read_b64_tr_b16 a[140:141], v3 offset:28672
ds_read_b64_tr_b16 a[142:143], v3 offset:30720
v_mfma_f32_16x16x32_bf16 v[64:67], a[148:151], a[20:23], v[64:67]
v_mfma_f32_16x16x32_bf16 v[68:71], a[144:147], a[48:51], v[68:71]
v_mfma_f32_16x16x32_bf16 v[68:71], a[148:151], a[52:55], v[68:71]
buffer_load_dwordx4 v5, s[16:19], s32 offen offset:0 lds
v_mfma_f32_16x16x32_bf16 v[72:75], a[144:147], a[80:83], v[72:75]
v_mfma_f32_16x16x32_bf16 v[72:75], a[148:151], a[84:87], v[72:75]
v_mfma_f32_16x16x32_bf16 v[76:79], a[144:147], a[112:115], v[76:79]
v_mfma_f32_16x16x32_bf16 v[76:79], a[148:151], a[116:119], v[76:79]
s_waitcnt lgkmcnt(8)
ds_read_b64_tr_b16 a[144:145], v2 offset:25088
ds_read_b64_tr_b16 a[146:147], v2 offset:27136
v_mfma_f32_16x16x32_bf16 v[64:67], a[152:155], a[24:27], v[64:67]
s_add_u32 m0, s25, 66560
ds_read_b64_tr_b16 a[148:149], v2 offset:29184
ds_read_b64_tr_b16 a[150:151], v2 offset:31232
v_mfma_f32_16x16x32_bf16 v[64:67], a[156:159], a[28:31], v[64:67]
v_mfma_f32_16x16x32_bf16 v[68:71], a[152:155], a[56:59], v[68:71]
v_mfma_f32_16x16x32_bf16 v[68:71], a[156:159], a[60:63], v[68:71]
buffer_load_dwordx4 v5, s[16:19], s33 offen offset:0 lds
v_mfma_f32_16x16x32_bf16 v[72:75], a[152:155], a[88:91], v[72:75]
v_mfma_f32_16x16x32_bf16 v[72:75], a[156:159], a[92:95], v[72:75]
s_nop 2
v_mul_f32 v64, s35, v64
v_mul_f32 v65, s35, v65
v_mfma_f32_16x16x32_bf16 v[76:79], a[152:155], a[120:123], v[76:79]
v_exp_f32 v64, v64
v_mfma_f32_16x16x32_bf16 v[76:79], a[156:159], a[124:127], v[76:79]
s_waitcnt lgkmcnt(8)
ds_read_b64_tr_b16 a[152:153], v3 offset:25088
ds_read_b64_tr_b16 a[154:155], v3 offset:27136
v_mfma_f32_16x16x32_bf16 v[192:195], a[128:131], v[32:35], v[192:195]
ds_read_b64_tr_b16 a[156:157], v3 offset:29184
ds_read_b64_tr_b16 a[158:159], v3 offset:31232
v_mfma_f32_16x16x32_bf16 v[192:195], a[132:135], v[48:51], v[192:195]
v_exp_f32 v65, v65
v_mfma_f32_16x16x32_bf16 v[196:199], a[128:131], v[36:39], v[196:199]
v_mul_f32 v66, s35, v66
v_mul_f32 v67, s35, v67
v_mfma_f32_16x16x32_bf16 v[196:199], a[132:135], v[52:55], v[196:199]
v_exp_f32 v66, v66
v_mfma_f32_16x16x32_bf16 v[200:203], a[128:131], v[40:43], v[200:203]
v_exp_f32 v67, v67
v_mfma_f32_16x16x32_bf16 v[200:203], a[132:135], v[56:59], v[200:203]
v_add_f32 v6, v6, v64
v_add_f32 v6, v6, v65
v_mfma_f32_16x16x32_bf16 v[204:207], a[128:131], v[44:47], v[204:207]
v_add_f32 v6, v6, v66
v_add_f32 v6, v6, v67
v_mfma_f32_16x16x32_bf16 v[204:207], a[132:135], v[60:63], v[204:207]
s_waitcnt vmcnt(20) lgkmcnt(0)
v_cvt_pk_bf16_f32 v64, v64, v65
v_cvt_pk_bf16_f32 v65, v66, v67
v_mfma_f32_16x16x32_bf16 v[208:211], a[136:139], v[32:35], v[208:211]
s_barrier
v_mfma_f32_16x16x32_bf16 v[208:211], a[140:143], v[48:51], v[208:211]
ds_read_b128 a[128:131], v1 offset:0
ds_read_b128 a[132:135], v1 offset:256
v_mfma_f32_16x16x32_bf16 v[212:215], a[136:139], v[36:39], v[212:215]
v_mul_f32 v68, s35, v68
v_mul_f32 v69, s35, v69
v_mfma_f32_16x16x32_bf16 v[212:215], a[140:143], v[52:55], v[212:215]
v_exp_f32 v68, v68
v_mfma_f32_16x16x32_bf16 v[216:219], a[136:139], v[40:43], v[216:219]
v_exp_f32 v69, v69
v_mfma_f32_16x16x32_bf16 v[216:219], a[140:143], v[56:59], v[216:219]
v_mul_f32 v70, s35, v70
v_mul_f32 v71, s35, v71
v_mfma_f32_16x16x32_bf16 v[220:223], a[136:139], v[44:47], v[220:223]
v_exp_f32 v70, v70
v_mfma_f32_16x16x32_bf16 v[220:223], a[140:143], v[60:63], v[220:223]
ds_read_b128 a[136:139], v1 offset:512
ds_read_b128 a[140:143], v1 offset:768
v_mfma_f32_16x16x32_bf16 v[224:227], a[144:147], v[32:35], v[224:227]
v_exp_f32 v71, v71
v_mfma_f32_16x16x32_bf16 v[224:227], a[148:151], v[48:51], v[224:227]
v_add_f32 v7, v7, v68
v_add_f32 v7, v7, v69
v_mfma_f32_16x16x32_bf16 v[228:231], a[144:147], v[36:39], v[228:231]
v_add_f32 v7, v7, v70
v_add_f32 v7, v7, v71
v_mfma_f32_16x16x32_bf16 v[228:231], a[148:151], v[52:55], v[228:231]
v_cvt_pk_bf16_f32 v68, v68, v69
v_cvt_pk_bf16_f32 v69, v70, v71
v_mfma_f32_16x16x32_bf16 v[232:235], a[144:147], v[40:43], v[232:235]
v_mul_f32 v72, s35, v72
v_mul_f32 v73, s35, v73
v_mfma_f32_16x16x32_bf16 v[232:235], a[148:151], v[56:59], v[232:235]
v_exp_f32 v72, v72
v_mfma_f32_16x16x32_bf16 v[236:239], a[144:147], v[44:47], v[236:239]
v_exp_f32 v73, v73
v_mfma_f32_16x16x32_bf16 v[236:239], a[148:151], v[60:63], v[236:239]
ds_read_b128 a[144:147], v1 offset:1024
ds_read_b128 a[148:151], v1 offset:1280
v_mfma_f32_16x16x32_bf16 v[240:243], a[152:155], v[32:35], v[240:243]
v_mul_f32 v74, s35, v74
v_mul_f32 v75, s35, v75
v_mfma_f32_16x16x32_bf16 v[240:243], a[156:159], v[48:51], v[240:243]
v_exp_f32 v74, v74
v_mfma_f32_16x16x32_bf16 v[244:247], a[152:155], v[36:39], v[244:247]
v_exp_f32 v75, v75
v_mfma_f32_16x16x32_bf16 v[244:247], a[156:159], v[52:55], v[244:247]
v_add_f32 v8, v8, v72
v_add_f32 v8, v8, v73
v_mfma_f32_16x16x32_bf16 v[248:251], a[152:155], v[40:43], v[248:251]
v_add_f32 v8, v8, v74
v_add_f32 v8, v8, v75
v_mfma_f32_16x16x32_bf16 v[248:251], a[156:159], v[56:59], v[248:251]
v_cvt_pk_bf16_f32 v72, v72, v73
v_cvt_pk_bf16_f32 v73, v74, v75
v_mfma_f32_16x16x32_bf16 v[252:255], a[152:155], v[44:47], v[252:255]
v_mfma_f32_16x16x32_bf16 v[252:255], a[156:159], v[60:63], v[252:255]
s_waitcnt lgkmcnt(4)
s_branch L_loop4
L_iw4a:
s_branch L_iw4b
L_i6_4:
v_mfma_f32_16x16x32_bf16 v[64:67], a[128:131], a[0:3], v[16:19]
ds_read_b128 a[152:155], v1 offset:34304
ds_read_b128 a[156:159], v1 offset:34560
v_mfma_f32_16x16x32_bf16 v[64:67], a[132:135], a[4:7], v[64:67]
v_mul_f32 v60, s35, v60
v_mul_f32 v61, s35, v61
v_mfma_f32_16x16x32_bf16 v[68:71], a[128:131], a[32:35], v[20:23]
s_add_u32 m0, s25, 106368
v_exp_f32 v60, v60
v_mfma_f32_16x16x32_bf16 v[68:71], a[132:135], a[36:39], v[68:71]
buffer_load_dwordx4 v5, s[16:19], s32 offen offset:128 lds
v_mfma_f32_16x16x32_bf16 v[72:75], a[128:131], a[64:67], v[24:27]
s_add_u32 m0, s25, 107392
v_exp_f32 v61, v61
v_mfma_f32_16x16x32_bf16 v[72:75], a[132:135], a[68:71], v[72:75]
v_mul_f32 v62, s35, v62
v_mul_f32 v63, s35, v63
v_mfma_f32_16x16x32_bf16 v[76:79], a[128:131], a[96:99], v[28:31]
buffer_load_dwordx4 v5, s[16:19], s33 offen offset:128 lds
v_mfma_f32_16x16x32_bf16 v[76:79], a[132:135], a[100:103], v[76:79]
s_waitcnt lgkmcnt(4)
ds_read_b128 a[128:131], v1 offset:40960
ds_read_b128 a[132:135], v1 offset:41216
v_mfma_f32_16x16x32_bf16 v[64:67], a[136:139], a[8:11], v[64:67]
s_add_u32 m0, s25, 114432
v_exp_f32 v62, v62
v_mfma_f32_16x16x32_bf16 v[64:67], a[140:143], a[12:15], v[64:67]
v_mfma_f32_16x16x32_bf16 v[68:71], a[136:139], a[40:43], v[68:71]
buffer_load_dwordx4 v5, s[16:19], s32 offen offset:256 lds
v_mfma_f32_16x16x32_bf16 v[68:71], a[140:143], a[44:47], v[68:71]
v_exp_f32 v63, v63
v_mfma_f32_16x16x32_bf16 v[72:75], a[136:139], a[72:75], v[72:75]
s_add_u32 m0, s25, 115456
v_mfma_f32_16x16x32_bf16 v[72:75], a[140:143], a[76:79], v[72:75]
v_add_f32 v9, v9, v60
v_mfma_f32_16x16x32_bf16 v[76:79], a[136:139], a[104:107], v[76:79]
v_mfma_f32_16x16x32_bf16 v[76:79], a[140:143], a[108:111], v[76:79]
s_waitcnt lgkmcnt(4)
ds_read_b128 a[136:139], v1 offset:41472
ds_read_b128 a[140:143], v1 offset:41728
v_mfma_f32_16x16x32_bf16 v[64:67], a[144:147], a[16:19], v[64:67]
v_add_f32 v9, v9, v61
v_add_f32 v9, v9, v62
v_mfma_f32_16x16x32_bf16 v[64:67], a[148:151], a[20:23], v[64:67]
buffer_load_dwordx4 v5, s[16:19], s33 offen offset:256 lds
v_mfma_f32_16x16x32_bf16 v[68:71], a[144:147], a[48:51], v[68:71]
s_add_u32 m0, s25, 122496
v_add_f32 v9, v9, v63
v_mfma_f32_16x16x32_bf16 v[68:71], a[148:151], a[52:55], v[68:71]
v_cvt_pk_bf16_f32 v60, v60, v61
v_mfma_f32_16x16x32_bf16 v[72:75], a[144:147], a[80:83], v[72:75]
buffer_load_dwordx4 v5, s[16:19], s32 offen offset:384 lds
v_mfma_f32_16x16x32_bf16 v[72:75], a[148:151], a[84:87], v[72:75]
v_cvt_pk_bf16_f32 v61, v62, v63
v_mfma_f32_16x16x32_bf16 v[76:79], a[144:147], a[112:115], v[76:79]
v_mfma_f32_16x16x32_bf16 v[76:79], a[148:151], a[116:119], v[76:79]
s_waitcnt lgkmcnt(4)
ds_read_b128 a[144:147], v1 offset:41984
ds_read_b128 a[148:151], v1 offset:42240
v_mfma_f32_16x16x32_bf16 v[64:67], a[152:155], a[24:27], v[64:67]
s_add_u32 m0, s25, 123520
v_mfma_f32_16x16x32_bf16 v[64:67], a[156:159], a[28:31], v[64:67]
v_mfma_f32_16x16x32_bf16 v[68:71], a[152:155], a[56:59], v[68:71]
buffer_load_dwordx4 v5, s[16:19], s33 offen offset:384 lds
v_mfma_f32_16x16x32_bf16 v[68:71], a[156:159], a[60:63], v[68:71]
v_mfma_f32_16x16x32_bf16 v[72:75], a[152:155], a[88:91], v[72:75]
v_mfma_f32_16x16x32_bf16 v[72:75], a[156:159], a[92:95], v[72:75]
s_nop 2
v_mul_f32 v64, s35, v64
v_mul_f32 v65, s35, v65
v_mfma_f32_16x16x32_bf16 v[76:79], a[152:155], a[120:123], v[76:79]
v_exp_f32 v64, v64
v_mfma_f32_16x16x32_bf16 v[76:79], a[156:159], a[124:127], v[76:79]
s_waitcnt lgkmcnt(4)
ds_read_b128 a[152:155], v1 offset:42496
ds_read_b128 a[156:159], v1 offset:42752
v_mfma_f32_16x16x32_bf16 v[80:83], a[128:131], a[0:3], v[16:19]
v_exp_f32 v65, v65
v_mfma_f32_16x16x32_bf16 v[80:83], a[132:135], a[4:7], v[80:83]
v_mul_f32 v66, s35, v66
v_mul_f32 v67, s35, v67
v_mfma_f32_16x16x32_bf16 v[84:87], a[128:131], a[32:35], v[20:23]
v_exp_f32 v66, v66
v_mfma_f32_16x16x32_bf16 v[84:87], a[132:135], a[36:39], v[84:87]
v_exp_f32 v67, v67
v_mfma_f32_16x16x32_bf16 v[88:91], a[128:131], a[64:67], v[24:27]
v_cvt_pk_bf16_f32 v50, v64, v65
v_cvt_pk_bf16_f32 v51, v66, v67
v_mfma_f32_16x16x32_bf16 v[88:91], a[132:135], a[68:71], v[88:91]
v_mul_f32 v68, s35, v68
v_mul_f32 v69, s35, v69
v_mfma_f32_16x16x32_bf16 v[92:95], a[128:131], a[96:99], v[28:31]
v_exp_f32 v68, v68
v_mfma_f32_16x16x32_bf16 v[92:95], a[132:135], a[100:103], v[92:95]
s_waitcnt lgkmcnt(4)
ds_read_b64_tr_b16 a[128:129], v2 offset:0
ds_read_b64_tr_b16 a[130:131], v2 offset:2048
v_mfma_f32_16x16x32_bf16 v[80:83], a[136:139], a[8:11], v[80:83]
ds_read_b64_tr_b16 a[132:133], v2 offset:4096
ds_read_b64_tr_b16 a[134:135], v2 offset:6144
v_mfma_f32_16x16x32_bf16 v[80:83], a[140:143], a[12:15], v[80:83]
v_exp_f32 v69, v69
v_mfma_f32_16x16x32_bf16 v[84:87], a[136:139], a[40:43], v[84:87]
v_mul_f32 v70, s35, v70
v_mul_f32 v71, s35, v71
v_mfma_f32_16x16x32_bf16 v[84:87], a[140:143], a[44:47], v[84:87]
v_exp_f32 v70, v70
v_mfma_f32_16x16x32_bf16 v[88:91], a[136:139], a[72:75], v[88:91]
v_exp_f32 v71, v71
v_mfma_f32_16x16x32_bf16 v[88:91], a[140:143], a[76:79], v[88:91]
v_cvt_pk_bf16_f32 v54, v68, v69
v_cvt_pk_bf16_f32 v55, v70, v71
v_mfma_f32_16x16x32_bf16 v[92:95], a[136:139], a[104:107], v[92:95]
v_mul_f32 v72, s35, v72
v_mul_f32 v73, s35, v73
v_mfma_f32_16x16x32_bf16 v[92:95], a[140:143], a[108:111], v[92:95]
s_waitcnt lgkmcnt(6)
ds_read_b64_tr_b16 a[136:137], v3 offset:0
ds_read_b64_tr_b16 a[138:139], v3 offset:2048
v_mfma_f32_16x16x32_bf16 v[80:83], a[144:147], a[16:19], v[80:83]
ds_read_b64_tr_b16 a[140:141], v3 offset:4096
ds_read_b64_tr_b16 a[142:143], v3 offset:6144
v_mfma_f32_16x16x32_bf16 v[80:83], a[148:151], a[20:23], v[80:83]
v_exp_f32 v72, v72
v_mfma_f32_16x16x32_bf16 v[84:87], a[144:147], a[48:51], v[84:87]
v_exp_f32 v73, v73
v_mfma_f32_16x16x32_bf16 v[84:87], a[148:151], a[52:55], v[84:87]
v_mul_f32 v74, s35, v74
v_mul_f32 v75, s35, v75
v_mfma_f32_16x16x32_bf16 v[88:91], a[144:147], a[80:83], v[88:91]
v_exp_f32 v74, v74
v_mfma_f32_16x16x32_bf16 v[88:91], a[148:151], a[84:87], v[88:91]
v_exp_f32 v75, v75
v_mfma_f32_16x16x32_bf16 v[92:95], a[144:147], a[112:115], v[92:95]
v_cvt_pk_bf16_f32 v58, v72, v73
v_cvt_pk_bf16_f32 v59, v74, v75
v_mfma_f32_16x16x32_bf16 v[92:95], a[148:151], a[116:119], v[92:95]
s_waitcnt lgkmcnt(8)
ds_read_b64_tr_b16 a[144:145], v2 offset:512
ds_read_b64_tr_b16 a[146:147], v2 offset:2560
v_mfma_f32_16x16x32_bf16 v[80:83], a[152:155], a[24:27], v[80:83]
ds_read_b64_tr_b16 a[148:149], v2 offset:4608
ds_read_b64_tr_b16 a[150:151], v2 offset:6656
v_mfma_f32_16x16x32_bf16 v[80:83], a[156:159], a[28:31], v[80:83]
v_mul_f32 v76, s35, v76
v_mul_f32 v77, s35, v77
v_mfma_f32_16x16x32_bf16 v[84:87], a[152:155], a[56:59], v[84:87]
v_exp_f32 v76, v76
v_mfma_f32_16x16x32_bf16 v[84:87], a[156:159], a[60:63], v[84:87]
v_exp_f32 v77, v77
v_mfma_f32_16x16x32_bf16 v[88:91], a[152:155], a[88:91], v[88:91]
v_mul_f32 v78, s35, v78
v_mul_f32 v79, s35, v79
v_mfma_f32_16x16x32_bf16 v[88:91], a[156:159], a[92:95], v[88:91]
v_exp_f32 v78, v78
v_mfma_f32_16x16x32_bf16 v[92:95], a[152:155], a[120:123], v[92:95]
v_exp_f32 v79, v79
v_mfma_f32_16x16x32_bf16 v[92:95], a[156:159], a[124:127], v[92:95]
s_waitcnt lgkmcnt(8)
ds_read_b64_tr_b16 a[152:153], v3 offset:512
ds_read_b64_tr_b16 a[154:155], v3 offset:2560
v_mfma_f32_16x16x32_bf16 v[96:99], a[128:131], v[32:35], v[96:99]
ds_read_b64_tr_b16 a[156:157], v3 offset:4608
ds_read_b64_tr_b16 a[158:159], v3 offset:6656
v_mfma_f32_16x16x32_bf16 v[96:99], a[132:135], v[48:51], v[96:99]
v_cvt_pk_bf16_f32 v62, v76, v77
v_cvt_pk_bf16_f32 v63, v78, v79
v_mfma_f32_16x16x32_bf16 v[100:103], a[128:131], v[36:39], v[100:103]
v_add_f32 v6, v6, v64
v_add_f32 v6, v6, v65
v_mfma_f32_16x16x32_bf16 v[100:103], a[132:135], v[52:55], v[100:103]
v_mul_f32 v80, s35, v80
v_mul_f32 v81, s35, v81
v_mfma_f32_16x16x32_bf16 v[104:107], a[128:131], v[40:43], v[104:107]
v_add_f32 v6, v6, v66
v_add_f32 v6, v6, v67
v_mfma_f32_16x16x32_bf16 v[104:107], a[132:135], v[56:59], v[104:107]
v_exp_f32 v80, v80
v_mfma_f32_16x16x32_bf16 v[108:111], a[128:131], v[44:47], v[108:111]
v_exp_f32 v81, v81
v_mfma_f32_16x16x32_bf16 v[108:111], a[132:135], v[60:63], v[108:111]
s_waitcnt lgkmcnt(8)
ds_read_b128 a[128:131], v1 offset:49152
ds_read_b128 a[132:135], v1 offset:49408
v_mfma_f32_16x16x32_bf16 v[112:115], a[136:139], v[32:35], v[112:115]
v_add_f32 v7, v7, v68
v_mul_f32 v82, s35, v82
v_mfma_f32_16x16x32_bf16 v[112:115], a[140:143], v[48:51], v[112:115]
v_mul_f32 v83, s35, v83
v_add_f32 v7, v7, v69
v_mfma_f32_16x16x32_bf16 v[116:119], a[136:139], v[36:39], v[116:119]
s_add_u32 m0, s25, 24576
v_exp_f32 v82, v82
v_mfma_f32_16x16x32_bf16 v[116:119], a[140:143], v[52:55], v[116:119]
v_exp_f32 v83, v83
v_mfma_f32_16x16x32_bf16 v[120:123], a[136:139], v[40:43], v[120:123]
v_add_f32 v7, v7, v70
v_add_f32 v6, v6, v80
v_mfma_f32_16x16x32_bf16 v[120:123], a[140:143], v[56:59], v[120:123]
v_add_f32 v7, v7, v71
v_add_f32 v6, v6, v81
v_mfma_f32_16x16x32_bf16 v[124:127], a[136:139], v[44:47], v[124:127]
v_add_f32 v6, v6, v82
v_add_f32 v8, v8, v72
v_mfma_f32_16x16x32_bf16 v[124:127], a[140:143], v[60:63], v[124:127]
s_waitcnt lgkmcnt(6)
ds_read_b128 a[136:139], v1 offset:49664
ds_read_b128 a[140:143], v1 offset:49920
v_mfma_f32_16x16x32_bf16 v[128:131], a[144:147], v[32:35], v[128:131]
v_add_f32 v6, v6, v83
v_cvt_pk_bf16_f32 v80, v80, v81
v_mfma_f32_16x16x32_bf16 v[128:131], a[148:151], v[48:51], v[128:131]
buffer_load_dwordx4 v4, s[12:15], s29 offen offset:0 lds
v_mfma_f32_16x16x32_bf16 v[132:135], a[144:147], v[36:39], v[132:135]
s_add_u32 m0, s25, 25344
v_add_f32 v8, v8, v73
v_cvt_pk_bf16_f32 v81, v82, v83
v_mfma_f32_16x16x32_bf16 v[132:135], a[148:151], v[52:55], v[132:135]
v_mul_f32 v84, s35, v84
v_add_f32 v8, v8, v74
v_mfma_f32_16x16x32_bf16 v[136:139], a[144:147], v[40:43], v[136:139]
v_mul_f32 v85, s35, v85
v_add_f32 v8, v8, v75
v_mfma_f32_16x16x32_bf16 v[136:139], a[148:151], v[56:59], v[136:139]
v_exp_f32 v84, v84
v_mfma_f32_16x16x32_bf16 v[140:143], a[144:147], v[44:47], v[140:143]
v_exp_f32 v85, v85
v_mfma_f32_16x16x32_bf16 v[140:143], a[148:151], v[60:63], v[140:143]
s_waitcnt lgkmcnt(4)
ds_read_b128 a[144:147], v1 offset:50176
v_add_f32 v9, v9, v76
v_mfma_f32_16x16x32_bf16 v[144:147], a[152:155], v[32:35], v[144:147]
ds_read_b128 a[148:151], v1 offset:50432
v_mul_f32 v86, s35, v86
v_mfma_f32_16x16x32_bf16 v[144:147], a[156:159], v[48:51], v[144:147]
v_add_f32 v9, v9, v77
v_mul_f32 v87, s35, v87
v_mfma_f32_16x16x32_bf16 v[148:151], a[152:155], v[36:39], v[148:151]
v_exp_f32 v86, v86
v_mfma_f32_16x16x32_bf16 v[148:151], a[156:159], v[52:55], v[148:151]
v_add_f32 v9, v9, v78
v_add_f32 v9, v9, v79
v_mfma_f32_16x16x32_bf16 v[152:155], a[152:155], v[40:43], v[152:155]
v_exp_f32 v87, v87
v_mfma_f32_16x16x32_bf16 v[152:155], a[156:159], v[56:59], v[152:155]
buffer_load_dwordx4 v4, s[12:15], s29 offen offset:256 lds
v_mfma_f32_16x16x32_bf16 v[156:159], a[152:155], v[44:47], v[156:159]
s_add_u32 s29, s29, 8192
v_add_f32 v7, v7, v84
v_add_f32 v7, v7, v85
v_mfma_f32_16x16x32_bf16 v[156:159], a[156:159], v[60:63], v[156:159]
s_waitcnt lgkmcnt(4)
ds_read_b128 a[152:155], v1 offset:50688
v_add_f32 v7, v7, v86
v_mfma_f32_16x16x32_bf16 v[64:67], a[128:131], a[0:3], v[16:19]
ds_read_b128 a[156:159], v1 offset:50944
v_add_f32 v7, v7, v87
v_mfma_f32_16x16x32_bf16 v[64:67], a[132:135], a[4:7], v[64:67]
v_cvt_pk_bf16_f32 v84, v84, v85
v_cvt_pk_bf16_f32 v85, v86, v87
v_mfma_f32_16x16x32_bf16 v[68:71], a[128:131], a[32:35], v[20:23]
v_mul_f32 v88, s35, v88
v_mul_f32 v89, s35, v89
v_mfma_f32_16x16x32_bf16 v[68:71], a[132:135], a[36:39], v[68:71]
v_exp_f32 v88, v88
v_mfma_f32_16x16x32_bf16 v[72:75], a[128:131], a[64:67], v[24:27]
v_exp_f32 v89, v89
v_mfma_f32_16x16x32_bf16 v[72:75], a[132:135], a[68:71], v[72:75]
v_mul_f32 v90, s35, v90
v_mul_f32 v91, s35, v91
v_mfma_f32_16x16x32_bf16 v[76:79], a[128:131], a[96:99], v[28:31]
v_exp_f32 v90, v90
v_mfma_f32_16x16x32_bf16 v[76:79], a[132:135], a[100:103], v[76:79]
s_waitcnt vmcnt(19) lgkmcnt(0)
v_exp_f32 v91, v91
v_mfma_f32_16x16x32_bf16 v[64:67], a[136:139], a[8:11], v[64:67]
s_barrier
v_mfma_f32_16x16x32_bf16 v[64:67], a[140:143], a[12:15], v[64:67]
s_add_u32 m0, s39, 0
ds_read_b64_tr_b16 a[128:129], v2 offset:8192
ds_read_b64_tr_b16 a[130:131], v2 offset:10240
v_mfma_f32_16x16x32_bf16 v[68:71], a[136:139], a[40:43], v[68:71]
ds_read_b64_tr_b16 a[132:133], v2 offset:12288
ds_read_b64_tr_b16 a[134:135], v2 offset:14336
v_mfma_f32_16x16x32_bf16 v[68:71], a[140:143], a[44:47], v[68:71]
v_add_f32 v8, v8, v88
v_add_f32 v8, v8, v89
v_mfma_f32_16x16x32_bf16 v[72:75], a[136:139], a[72:75], v[72:75]
v_add_f32 v8, v8, v90
v_add_f32 v8, v8, v91
v_mfma_f32_16x16x32_bf16 v[72:75], a[140:143], a[76:79], v[72:75]
v_cvt_pk_bf16_f32 v88, v88, v89
v_cvt_pk_bf16_f32 v89, v90, v91
v_mfma_f32_16x16x32_bf16 v[76:79], a[136:139], a[104:107], v[76:79]
v_mul_f32 v92, s35, v92
v_mul_f32 v93, s35, v93
v_mfma_f32_16x16x32_bf16 v[76:79], a[140:143], a[108:111], v[76:79]
ds_read_b64_tr_b16 a[136:137], v3 offset:8192
ds_read_b64_tr_b16 a[138:139], v3 offset:10240
v_mfma_f32_16x16x32_bf16 v[64:67], a[144:147], a[16:19], v[64:67]
ds_read_b64_tr_b16 a[140:141], v3 offset:12288
ds_read_b64_tr_b16 a[142:143], v3 offset:14336
v_mfma_f32_16x16x32_bf16 v[64:67], a[148:151], a[20:23], v[64:67]
v_exp_f32 v92, v92
v_mfma_f32_16x16x32_bf16 v[68:71], a[144:147], a[48:51], v[68:71]
v_exp_f32 v93, v93
v_mfma_f32_16x16x32_bf16 v[68:71], a[148:151], a[52:55], v[68:71]
buffer_load_dwordx4 v12, s[8:11], s41 offen offset:0 nt lds
v_mfma_f32_16x16x32_bf16 v[72:75], a[144:147], a[80:83], v[72:75]
v_mul_f32 v94, s35, v94
v_mul_f32 v95, s35, v95
v_mfma_f32_16x16x32_bf16 v[72:75], a[148:151], a[84:87], v[72:75]
v_exp_f32 v94, v94
v_mfma_f32_16x16x32_bf16 v[76:79], a[144:147], a[112:115], v[76:79]
v_exp_f32 v95, v95
v_mfma_f32_16x16x32_bf16 v[76:79], a[148:151], a[116:119], v[76:79]
ds_read_b64_tr_b16 a[144:145], v2 offset:8704
ds_read_b64_tr_b16 a[146:147], v2 offset:10752
v_mfma_f32_16x16x32_bf16 v[64:67], a[152:155], a[24:27], v[64:67]
ds_read_b64_tr_b16 a[148:149], v2 offset:12800
ds_read_b64_tr_b16 a[150:151], v2 offset:14848
v_mfma_f32_16x16x32_bf16 v[64:67], a[156:159], a[28:31], v[64:67]
v_add_f32 v9, v9, v92
v_add_f32 v9, v9, v93
v_mfma_f32_16x16x32_bf16 v[68:71], a[152:155], a[56:59], v[68:71]
v_add_f32 v9, v9, v94
v_add_f32 v9, v9, v95
v_mfma_f32_16x16x32_bf16 v[68:71], a[156:159], a[60:63], v[68:71]
v_cvt_pk_bf16_f32 v92, v92, v93
v_cvt_pk_bf16_f32 v93, v94, v95
v_mfma_f32_16x16x32_bf16 v[72:75], a[152:155], a[88:91], v[72:75]
buffer_load_dwordx4 v12, s[8:11], s41 offen offset:2048 nt lds
v_mfma_f32_16x16x32_bf16 v[72:75], a[156:159], a[92:95], v[72:75]
v_mul_f32 v64, s35, v64
v_mul_f32 v65, s35, v65
v_mfma_f32_16x16x32_bf16 v[76:79], a[152:155], a[120:123], v[76:79]
v_exp_f32 v64, v64
v_mfma_f32_16x16x32_bf16 v[76:79], a[156:159], a[124:127], v[76:79]
s_waitcnt lgkmcnt(8)
ds_read_b64_tr_b16 a[152:153], v3 offset:8704
ds_read_b64_tr_b16 a[154:155], v3 offset:10752
v_mfma_f32_16x16x32_bf16 a[160:163], a[128:131], v[32:35], a[160:163]
ds_read_b64_tr_b16 a[156:157], v3 offset:12800
ds_read_b64_tr_b16 a[158:159], v3 offset:14848
v_mfma_f32_16x16x32_bf16 a[160:163], a[132:135], v[48:51], a[160:163]
v_add_f32 v6, v6, v64
v_mul_f32 v66, s35, v66
v_mfma_f32_16x16x32_bf16 a[164:167], a[128:131], v[36:39], a[164:167]
s_add_u32 m0, s39, 768
v_exp_f32 v65, v65
v_mfma_f32_16x16x32_bf16 a[164:167], a[132:135], v[52:55], a[164:167]
v_mul_f32 v67, s35, v67
v_add_f32 v6, v6, v65
v_mfma_f32_16x16x32_bf16 a[168:171], a[128:131], v[40:43], a[168:171]
v_exp_f32 v66, v66
v_mfma_f32_16x16x32_bf16 a[168:171], a[132:135], v[56:59], a[168:171]
v_exp_f32 v67, v67
v_mfma_f32_16x16x32_bf16 a[172:175], a[128:131], v[44:47], a[172:175]
v_add_f32 v6, v6, v66
v_mfma_f32_16x16x32_bf16 a[172:175], a[132:135], v[60:63], a[172:175]
s_waitcnt lgkmcnt(8)
ds_read_b64_tr_b16 a[128:129], v2 offset:16384
ds_read_b64_tr_b16 a[130:131], v2 offset:18432
v_mfma_f32_16x16x32_bf16 a[176:179], a[136:139], v[32:35], a[176:179]
ds_read_b64_tr_b16 a[132:133], v2 offset:20480
ds_read_b64_tr_b16 a[134:135], v2 offset:22528
v_mfma_f32_16x16x32_bf16 a[176:179], a[140:143], v[48:51], a[176:179]
v_cvt_pk_bf16_f32 v82, v64, v65
v_cvt_pk_bf16_f32 v83, v66, v67
v_mfma_f32_16x16x32_bf16 a[180:183], a[136:139], v[36:39], a[180:183]
v_add_f32 v6, v6, v67
v_mul_f32 v68, s35, v68
v_mfma_f32_16x16x32_bf16 a[180:183], a[140:143], v[52:55], a[180:183]
v_mul_f32 v69, s35, v69
v_mfma_f32_16x16x32_bf16 a[184:187], a[136:139], v[40:43], a[184:187]
v_exp_f32 v68, v68
v_mfma_f32_16x16x32_bf16 a[184:187], a[140:143], v[56:59], a[184:187]
buffer_load_dwordx4 v12, s[8:11], s41 offen offset:256 nt lds
v_mfma_f32_16x16x32_bf16 a[188:191], a[136:139], v[44:47], a[188:191]
v_exp_f32 v69, v69
v_mfma_f32_16x16x32_bf16 a[188:191], a[140:143], v[60:63], a[188:191]
s_waitcnt lgkmcnt(8)
ds_read_b64_tr_b16 a[136:137], v3 offset:16384
ds_read_b64_tr_b16 a[138:139], v3 offset:18432
v_mfma_f32_16x16x32_bf16 a[192:195], a[144:147], v[32:35], a[192:195]
ds_read_b64_tr_b16 a[140:141], v3 offset:20480
ds_read_b64_tr_b16 a[142:143], v3 offset:22528
v_mfma_f32_16x16x32_bf16 a[192:195], a[148:151], v[48:51], a[192:195]
v_add_f32 v7, v7, v68
v_mul_f32 v70, s35, v70
v_mfma_f32_16x16x32_bf16 a[196:199], a[144:147], v[36:39], a[196:199]
v_add_f32 v7, v7, v69
v_mul_f32 v71, s35, v71
v_mfma_f32_16x16x32_bf16 a[196:199], a[148:151], v[52:55], a[196:199]
v_exp_f32 v70, v70
v_mfma_f32_16x16x32_bf16 a[200:203], a[144:147], v[40:43], a[200:203]
v_exp_f32 v71, v71
v_mfma_f32_16x16x32_bf16 a[200:203], a[148:151], v[56:59], a[200:203]
v_add_f32 v7, v7, v70
v_mfma_f32_16x16x32_bf16 a[204:207], a[144:147], v[44:47], a[204:207]
buffer_load_dwordx4 v12, s[8:11], s41 offen offset:2304 nt lds
v_mfma_f32_16x16x32_bf16 a[204:207], a[148:151], v[60:63], a[204:207]
s_waitcnt lgkmcnt(8)
ds_read_b64_tr_b16 a[144:145], v2 offset:16896
ds_read_b64_tr_b16 a[146:147], v2 offset:18944
v_mfma_f32_16x16x32_bf16 a[208:211], a[152:155], v[32:35], a[208:211]
ds_read_b64_tr_b16 a[148:149], v2 offset:20992
ds_read_b64_tr_b16 a[150:151], v2 offset:23040
v_mfma_f32_16x16x32_bf16 a[208:211], a[156:159], v[48:51], a[208:211]
v_cvt_pk_bf16_f32 v86, v68, v69
v_cvt_pk_bf16_f32 v87, v70, v71
v_mfma_f32_16x16x32_bf16 a[212:215], a[152:155], v[36:39], a[212:215]
v_add_f32 v7, v7, v71
v_mul_f32 v72, s35, v72
v_mfma_f32_16x16x32_bf16 a[212:215], a[156:159], v[52:55], a[212:215]
v_exp_f32 v72, v72
v_mfma_f32_16x16x32_bf16 a[216:219], a[152:155], v[40:43], a[216:219]
v_mul_f32 v73, s35, v73
v_add_f32 v8, v8, v72
v_mfma_f32_16x16x32_bf16 a[216:219], a[156:159], v[56:59], a[216:219]
v_exp_f32 v73, v73
v_mfma_f32_16x16x32_bf16 a[220:223], a[152:155], v[44:47], a[220:223]
v_mfma_f32_16x16x32_bf16 a[220:223], a[156:159], v[60:63], a[220:223]
s_waitcnt lgkmcnt(8)
ds_read_b64_tr_b16 a[152:153], v3 offset:16896
ds_read_b64_tr_b16 a[154:155], v3 offset:18944
v_mfma_f32_16x16x32_bf16 a[224:227], a[128:131], v[32:35], a[224:227]
s_add_u32 m0, s39, 4096
ds_read_b64_tr_b16 a[156:157], v3 offset:20992
ds_read_b64_tr_b16 a[158:159], v3 offset:23040
v_mfma_f32_16x16x32_bf16 a[224:227], a[132:135], v[48:51], a[224:227]
v_add_f32 v8, v8, v73
v_mul_f32 v74, s35, v74
v_mfma_f32_16x16x32_bf16 a[228:231], a[128:131], v[36:39], a[228:231]
v_exp_f32 v74, v74
v_mfma_f32_16x16x32_bf16 a[228:231], a[132:135], v[52:55], a[228:231]
v_mul_f32 v75, s35, v75
v_add_f32 v8, v8, v74
v_mfma_f32_16x16x32_bf16 a[232:235], a[128:131], v[40:43], a[232:235]
v_exp_f32 v75, v75
v_mfma_f32_16x16x32_bf16 a[232:235], a[132:135], v[56:59], a[232:235]
v_cvt_pk_bf16_f32 v90, v72, v73
v_mfma_f32_16x16x32_bf16 a[236:239], a[128:131], v[44:47], a[236:239]
v_add_f32 v8, v8, v75
v_cvt_pk_bf16_f32 v91, v74, v75
v_mfma_f32_16x16x32_bf16 a[236:239], a[132:135], v[60:63], a[236:239]
s_waitcnt lgkmcnt(8)
ds_read_b128 a[128:131], v1 offset:57344
ds_read_b128 a[132:135], v1 offset:57600
v_mfma_f32_16x16x32_bf16 a[240:243], a[136:139], v[32:35], a[240:243]
v_mul_f32 v76, s35, v76
v_mfma_f32_16x16x32_bf16 a[240:243], a[140:143], v[48:51], a[240:243]
buffer_load_dwordx4 v13, s[8:11], s41 offen offset:0 nt lds
v_mfma_f32_16x16x32_bf16 a[244:247], a[136:139], v[36:39], a[244:247]
v_exp_f32 v76, v76
v_mfma_f32_16x16x32_bf16 a[244:247], a[140:143], v[52:55], a[244:247]
v_mul_f32 v77, s35, v77
v_add_f32 v9, v9, v76
v_mfma_f32_16x16x32_bf16 a[248:251], a[136:139], v[40:43], a[248:251]
v_exp_f32 v77, v77
v_mfma_f32_16x16x32_bf16 a[248:251], a[140:143], v[56:59], a[248:251]
v_add_f32 v9, v9, v77
v_mfma_f32_16x16x32_bf16 a[252:255], a[136:139], v[44:47], a[252:255]
v_mul_f32 v78, s35, v78
v_mfma_f32_16x16x32_bf16 a[252:255], a[140:143], v[60:63], a[252:255]
s_waitcnt lgkmcnt(6)
ds_read_b128 a[136:139], v1 offset:57856
ds_read_b128 a[140:143], v1 offset:58112
v_mfma_f32_16x16x32_bf16 v[160:163], a[144:147], v[32:35], v[160:163]
v_exp_f32 v78, v78
v_mfma_f32_16x16x32_bf16 v[160:163], a[148:151], v[48:51], v[160:163]
v_mul_f32 v79, s35, v79
v_add_f32 v9, v9, v78
v_mfma_f32_16x16x32_bf16 v[164:167], a[144:147], v[36:39], v[164:167]
v_exp_f32 v79, v79
v_mfma_f32_16x16x32_bf16 v[164:167], a[148:151], v[52:55], v[164:167]
buffer_load_dwordx4 v13, s[8:11], s41 offen offset:2048 nt lds
v_mfma_f32_16x16x32_bf16 v[168:171], a[144:147], v[40:43], v[168:171]
v_add_f32 v9, v9, v79
v_cvt_pk_bf16_f32 v94, v76, v77
v_mfma_f32_16x16x32_bf16 v[168:171], a[148:151], v[56:59], v[168:171]
v_cvt_pk_bf16_f32 v95, v78, v79
v_mfma_f32_16x16x32_bf16 v[172:175], a[144:147], v[44:47], v[172:175]
v_mfma_f32_16x16x32_bf16 v[172:175], a[148:151], v[60:63], v[172:175]
s_waitcnt lgkmcnt(4)
ds_read_b128 a[144:147], v1 offset:58368
ds_read_b128 a[148:151], v1 offset:58624
v_mfma_f32_16x16x32_bf16 v[176:179], a[152:155], v[32:35], v[176:179]
v_mfma_f32_16x16x32_bf16 v[176:179], a[156:159], v[48:51], v[176:179]
v_mfma_f32_16x16x32_bf16 v[180:183], a[152:155], v[36:39], v[180:183]
v_mfma_f32_16x16x32_bf16 v[180:183], a[156:159], v[52:55], v[180:183]
v_mfma_f32_16x16x32_bf16 v[184:187], a[152:155], v[40:43], v[184:187]
v_mfma_f32_16x16x32_bf16 v[184:187], a[156:159], v[56:59], v[184:187]
s_add_u32 m0, s39, 4864
v_mfma_f32_16x16x32_bf16 v[188:191], a[152:155], v[44:47], v[188:191]
v_mfma_f32_16x16x32_bf16 v[188:191], a[156:159], v[60:63], v[188:191]
s_waitcnt lgkmcnt(4)
ds_read_b128 a[152:155], v1 offset:58880
ds_read_b128 a[156:159], v1 offset:59136
v_mfma_f32_16x16x32_bf16 v[64:67], a[128:131], a[0:3], v[16:19]
v_mfma_f32_16x16x32_bf16 v[64:67], a[132:135], a[4:7], v[64:67]
v_mfma_f32_16x16x32_bf16 v[68:71], a[128:131], a[32:35], v[20:23]
v_mfma_f32_16x16x32_bf16 v[68:71], a[132:135], a[36:39], v[68:71]
v_mfma_f32_16x16x32_bf16 v[72:75], a[128:131], a[64:67], v[24:27]
v_mfma_f32_16x16x32_bf16 v[72:75], a[132:135], a[68:71], v[72:75]
v_mfma_f32_16x16x32_bf16 v[76:79], a[128:131], a[96:99], v[28:31]
v_mfma_f32_16x16x32_bf16 v[76:79], a[132:135], a[100:103], v[76:79]
s_waitcnt lgkmcnt(4)
ds_read_b64_tr_b16 a[128:129], v2 offset:24576
ds_read_b64_tr_b16 a[130:131], v2 offset:26624
v_mfma_f32_16x16x32_bf16 v[64:67], a[136:139], a[8:11], v[64:67]
ds_read_b64_tr_b16 a[132:133], v2 offset:28672
ds_read_b64_tr_b16 a[134:135], v2 offset:30720
v_mfma_f32_16x16x32_bf16 v[64:67], a[140:143], a[12:15], v[64:67]
buffer_load_dwordx4 v13, s[8:11], s41 offen offset:256 nt lds
v_mfma_f32_16x16x32_bf16 v[68:71], a[136:139], a[40:43], v[68:71]
v_mfma_f32_16x16x32_bf16 v[68:71], a[140:143], a[44:47], v[68:71]
v_mfma_f32_16x16x32_bf16 v[72:75], a[136:139], a[72:75], v[72:75]
v_mfma_f32_16x16x32_bf16 v[72:75], a[140:143], a[76:79], v[72:75]
v_mfma_f32_16x16x32_bf16 v[76:79], a[136:139], a[104:107], v[76:79]
v_mfma_f32_16x16x32_bf16 v[76:79], a[140:143], a[108:111], v[76:79]
s_waitcnt lgkmcnt(6)
ds_read_b64_tr_b16 a[136:137], v3 offset:24576
ds_read_b64_tr_b16 a[138:139], v3 offset:26624
v_mfma_f32_16x16x32_bf16 v[64:67], a[144:147], a[16:19], v[64:67]
ds_read_b64_tr_b16 a[140:141], v3 offset:28672
ds_read_b64_tr_b16 a[142:143], v3 offset:30720
v_mfma_f32_16x16x32_bf16 v[64:67], a[148:151], a[20:23], v[64:67]
buffer_load_dwordx4 v13, s[8:11], s41 offen offset:2304 nt lds
v_mfma_f32_16x16x32_bf16 v[68:71], a[144:147], a[48:51], v[68:71]
v_mfma_f32_16x16x32_bf16 v[68:71], a[148:151], a[52:55], v[68:71]
v_mfma_f32_16x16x32_bf16 v[72:75], a[144:147], a[80:83], v[72:75]
v_mfma_f32_16x16x32_bf16 v[72:75], a[148:151], a[84:87], v[72:75]
v_mfma_f32_16x16x32_bf16 v[76:79], a[144:147], a[112:115], v[76:79]
v_mfma_f32_16x16x32_bf16 v[76:79], a[148:151], a[116:119], v[76:79]
s_waitcnt lgkmcnt(8)
ds_read_b64_tr_b16 a[144:145], v2 offset:25088
ds_read_b64_tr_b16 a[146:147], v2 offset:27136
v_mfma_f32_16x16x32_bf16 v[64:67], a[152:155], a[24:27], v[64:67]
ds_read_b64_tr_b16 a[148:149], v2 offset:29184
ds_read_b64_tr_b16 a[150:151], v2 offset:31232
v_mfma_f32_16x16x32_bf16 v[64:67], a[156:159], a[28:31], v[64:67]
v_mfma_f32_16x16x32_bf16 v[68:71], a[152:155], a[56:59], v[68:71]
v_mfma_f32_16x16x32_bf16 v[68:71], a[156:159], a[60:63], v[68:71]
v_mfma_f32_16x16x32_bf16 v[72:75], a[152:155], a[88:91], v[72:75]
v_mfma_f32_16x16x32_bf16 v[72:75], a[156:159], a[92:95], v[72:75]
s_nop 3
v_mul_f32 v64, s35, v64
v_mul_f32 v65, s35, v65
v_mfma_f32_16x16x32_bf16 v[76:79], a[152:155], a[120:123], v[76:79]
v_exp_f32 v64, v64
v_mfma_f32_16x16x32_bf16 v[76:79], a[156:159], a[124:127], v[76:79]
s_waitcnt lgkmcnt(8)
ds_read_b64_tr_b16 a[152:153], v3 offset:25088
ds_read_b64_tr_b16 a[154:155], v3 offset:27136
v_mfma_f32_16x16x32_bf16 v[192:195], a[128:131], v[32:35], v[192:195]
ds_read_b64_tr_b16 a[156:157], v3 offset:29184
ds_read_b64_tr_b16 a[158:159], v3 offset:31232
v_mfma_f32_16x16x32_bf16 v[192:195], a[132:135], v[48:51], v[192:195]
v_exp_f32 v65, v65
v_mfma_f32_16x16x32_bf16 v[196:199], a[128:131], v[36:39], v[196:199]
v_mul_f32 v66, s35, v66
v_mul_f32 v67, s35, v67
v_mfma_f32_16x16x32_bf16 v[196:199], a[132:135], v[52:55], v[196:199]
v_exp_f32 v66, v66
v_mfma_f32_16x16x32_bf16 v[200:203], a[128:131], v[40:43], v[200:203]
v_exp_f32 v67, v67
v_mfma_f32_16x16x32_bf16 v[200:203], a[132:135], v[56:59], v[200:203]
v_add_f32 v6, v6, v64
v_add_f32 v6, v6, v65
v_mfma_f32_16x16x32_bf16 v[204:207], a[128:131], v[44:47], v[204:207]
v_add_f32 v6, v6, v66
v_add_f32 v6, v6, v67
v_mfma_f32_16x16x32_bf16 v[204:207], a[132:135], v[60:63], v[204:207]
s_waitcnt vmcnt(8) lgkmcnt(0)
v_cvt_pk_bf16_f32 v64, v64, v65
v_cvt_pk_bf16_f32 v65, v66, v67
v_mfma_f32_16x16x32_bf16 v[208:211], a[136:139], v[32:35], v[208:211]
s_barrier
v_mfma_f32_16x16x32_bf16 v[208:211], a[140:143], v[48:51], v[208:211]
ds_read_b128 a[128:131], v1 offset:0
ds_read_b128 a[132:135], v1 offset:256
v_mfma_f32_16x16x32_bf16 v[212:215], a[136:139], v[36:39], v[212:215]
v_mul_f32 v68, s35, v68
v_mul_f32 v69, s35, v69
v_mfma_f32_16x16x32_bf16 v[212:215], a[140:143], v[52:55], v[212:215]
v_exp_f32 v68, v68
v_mfma_f32_16x16x32_bf16 v[216:219], a[136:139], v[40:43], v[216:219]
v_exp_f32 v69, v69
v_mfma_f32_16x16x32_bf16 v[216:219], a[140:143], v[56:59], v[216:219]
v_mul_f32 v70, s35, v70
v_mul_f32 v71, s35, v71
v_mfma_f32_16x16x32_bf16 v[220:223], a[136:139], v[44:47], v[220:223]
v_exp_f32 v70, v70
v_mfma_f32_16x16x32_bf16 v[220:223], a[140:143], v[60:63], v[220:223]
ds_read_b128 a[136:139], v1 offset:512
ds_read_b128 a[140:143], v1 offset:768
v_mfma_f32_16x16x32_bf16 v[224:227], a[144:147], v[32:35], v[224:227]
v_exp_f32 v71, v71
v_mfma_f32_16x16x32_bf16 v[224:227], a[148:151], v[48:51], v[224:227]
v_add_f32 v7, v7, v68
v_add_f32 v7, v7, v69
v_mfma_f32_16x16x32_bf16 v[228:231], a[144:147], v[36:39], v[228:231]
v_add_f32 v7, v7, v70
v_add_f32 v7, v7, v71
v_mfma_f32_16x16x32_bf16 v[228:231], a[148:151], v[52:55], v[228:231]
v_cvt_pk_bf16_f32 v68, v68, v69
v_cvt_pk_bf16_f32 v69, v70, v71
v_mfma_f32_16x16x32_bf16 v[232:235], a[144:147], v[40:43], v[232:235]
v_mul_f32 v72, s35, v72
v_mul_f32 v73, s35, v73
v_mfma_f32_16x16x32_bf16 v[232:235], a[148:151], v[56:59], v[232:235]
v_exp_f32 v72, v72
v_mfma_f32_16x16x32_bf16 v[236:239], a[144:147], v[44:47], v[236:239]
v_exp_f32 v73, v73
v_mfma_f32_16x16x32_bf16 v[236:239], a[148:151], v[60:63], v[236:239]
ds_read_b128 a[144:147], v1 offset:1024
ds_read_b128 a[148:151], v1 offset:1280
v_mfma_f32_16x16x32_bf16 v[240:243], a[152:155], v[32:35], v[240:243]
v_mul_f32 v74, s35, v74
v_mul_f32 v75, s35, v75
v_mfma_f32_16x16x32_bf16 v[240:243], a[156:159], v[48:51], v[240:243]
v_exp_f32 v74, v74
v_mfma_f32_16x16x32_bf16 v[244:247], a[152:155], v[36:39], v[244:247]
v_exp_f32 v75, v75
v_mfma_f32_16x16x32_bf16 v[244:247], a[156:159], v[52:55], v[244:247]
v_add_f32 v8, v8, v72
v_add_f32 v8, v8, v73
v_mfma_f32_16x16x32_bf16 v[248:251], a[152:155], v[40:43], v[248:251]
v_add_f32 v8, v8, v74
v_add_f32 v8, v8, v75
v_mfma_f32_16x16x32_bf16 v[248:251], a[156:159], v[56:59], v[248:251]
v_cvt_pk_bf16_f32 v72, v72, v73
v_cvt_pk_bf16_f32 v73, v74, v75
v_mfma_f32_16x16x32_bf16 v[252:255], a[152:155], v[44:47], v[252:255]
v_mfma_f32_16x16x32_bf16 v[252:255], a[156:159], v[60:63], v[252:255]
s_waitcnt lgkmcnt(4)
s_cmp_lt_u32 s37, 2
s_cbranch_scc1 L_i7_4
v_mfma_f32_16x16x32_bf16 v[48:51], a[128:131], a[0:3], v[16:19]
ds_read_b128 a[152:155], v1 offset:1536
ds_read_b128 a[156:159], v1 offset:1792
v_mfma_f32_16x16x32_bf16 v[48:51], a[132:135], a[4:7], v[48:51]
v_mul_f32 v76, s35, v76
v_mul_f32 v77, s35, v77
v_mfma_f32_16x16x32_bf16 v[52:55], a[128:131], a[32:35], v[20:23]
s_add_u32 s72, s44, 0
v_exp_f32 v76, v76
v_mfma_f32_16x16x32_bf16 v[52:55], a[132:135], a[36:39], v[52:55]
s_add_u32 s73, s44, 4096
v_exp_f32 v77, v77
v_mfma_f32_16x16x32_bf16 v[56:59], a[128:131], a[64:67], v[24:27]
s_add_u32 s74, s44, 8192
v_mul_f32 v78, s35, v78
v_xor_b32 v37, 16, v15
v_mfma_f32_16x16x32_bf16 v[56:59], a[132:135], a[68:71], v[56:59]
v_xor_b32 v38, 32, v15
v_mul_f32 v79, s35, v79
v_mfma_f32_16x16x32_bf16 v[60:63], a[128:131], a[96:99], v[28:31]
v_xor_b32 v39, 48, v15
v_mbcnt_lo_u32_b32 v40, -1, 0
v_mfma_f32_16x16x32_bf16 v[60:63], a[132:135], a[100:103], v[60:63]
s_waitcnt lgkmcnt(4)
ds_read_b64_tr_b16 a[128:129], v2 offset:32768
ds_read_b64_tr_b16 a[130:131], v2 offset:34816
v_mfma_f32_16x16x32_bf16 v[48:51], a[136:139], a[8:11], v[48:51]
s_add_u32 s75, s44, 12288
ds_read_b64_tr_b16 a[132:133], v3 offset:32768
ds_read_b64_tr_b16 a[134:135], v3 offset:34816
v_mfma_f32_16x16x32_bf16 v[48:51], a[140:143], a[12:15], v[48:51]
v_exp_f32 v78, v78
v_mfma_f32_16x16x32_bf16 v[52:55], a[136:139], a[40:43], v[52:55]
v_mbcnt_hi_u32_b32 v40, -1, v40
v_lshl_add_u32 v40, v40, 3, s28
v_mfma_f32_16x16x32_bf16 v[52:55], a[140:143], a[44:47], v[52:55]
s_add_u32 s76, s44, 16384
v_exp_f32 v79, v79
v_mfma_f32_16x16x32_bf16 v[56:59], a[136:139], a[72:75], v[56:59]
v_xor_b32 v42, 32, v40
v_add_f32 v9, v9, v76
v_mfma_f32_16x16x32_bf16 v[56:59], a[140:143], a[76:79], v[56:59]
v_add_f32 v9, v9, v77
v_add_f32 v9, v9, v78
v_mfma_f32_16x16x32_bf16 v[60:63], a[136:139], a[104:107], v[60:63]
v_add_f32 v9, v9, v79
v_mfma_f32_16x16x32_bf16 v[60:63], a[140:143], a[108:111], v[60:63]
s_waitcnt lgkmcnt(6)
ds_read_b64_tr_b16 a[136:137], v2 offset:33280
ds_read_b64_tr_b16 a[138:139], v2 offset:35328
v_mfma_f32_16x16x32_bf16 v[48:51], a[144:147], a[16:19], v[48:51]
s_add_u32 s77, s44, 20480
ds_read_b64_tr_b16 a[140:141], v3 offset:33280
ds_read_b64_tr_b16 a[142:143], v3 offset:35328
v_mfma_f32_16x16x32_bf16 v[48:51], a[148:151], a[20:23], v[48:51]
v_cvt_pk_bf16_f32 v76, v76, v77
v_cvt_pk_bf16_f32 v77, v78, v79
v_mfma_f32_16x16x32_bf16 v[52:55], a[144:147], a[48:51], v[52:55]
v_mfma_f32_16x16x32_bf16 v[52:55], a[148:151], a[52:55], v[52:55]
s_add_u32 s78, s44, 24576
v_mfma_f32_16x16x32_bf16 v[56:59], a[144:147], a[80:83], v[56:59]
v_mfma_f32_16x16x32_bf16 v[56:59], a[148:151], a[84:87], v[56:59]
v_mfma_f32_16x16x32_bf16 v[60:63], a[144:147], a[112:115], v[60:63]
v_mfma_f32_16x16x32_bf16 v[60:63], a[148:151], a[116:119], v[60:63]
s_waitcnt lgkmcnt(8)
ds_read_b64_tr_b16 a[144:145], v2 offset:36864
ds_read_b64_tr_b16 a[146:147], v2 offset:38912
v_mfma_f32_16x16x32_bf16 v[48:51], a[152:155], a[24:27], v[48:51]
s_add_u32 s79, s44, 28672
ds_read_b64_tr_b16 a[148:149], v3 offset:36864
ds_read_b64_tr_b16 a[150:151], v3 offset:38912
v_mfma_f32_16x16x32_bf16 v[48:51], a[156:159], a[28:31], v[48:51]
v_mfma_f32_16x16x32_bf16 v[52:55], a[152:155], a[56:59], v[52:55]
v_mfma_f32_16x16x32_bf16 v[52:55], a[156:159], a[60:63], v[52:55]
v_mfma_f32_16x16x32_bf16 v[56:59], a[152:155], a[88:91], v[56:59]
v_mfma_f32_16x16x32_bf16 v[56:59], a[156:159], a[92:95], v[56:59]
s_nop 3
v_mul_f32 v48, s35, v48
v_mul_f32 v49, s35, v49
v_mfma_f32_16x16x32_bf16 v[60:63], a[152:155], a[120:123], v[60:63]
v_exp_f32 v48, v48
v_mfma_f32_16x16x32_bf16 v[60:63], a[156:159], a[124:127], v[60:63]
s_waitcnt lgkmcnt(8)
ds_read_b64_tr_b16 a[152:153], v2 offset:37376
ds_read_b64_tr_b16 a[154:155], v2 offset:39424
v_mfma_f32_16x16x32_bf16 v[96:99], a[128:131], v[80:83], v[96:99]
ds_read_b64_tr_b16 a[156:157], v3 offset:37376
ds_read_b64_tr_b16 a[158:159], v3 offset:39424
v_mfma_f32_16x16x32_bf16 v[112:115], a[132:135], v[80:83], v[112:115]
v_exp_f32 v49, v49
v_mfma_f32_16x16x32_bf16 v[100:103], a[128:131], v[84:87], v[100:103]
v_mul_f32 v50, s35, v50
v_mul_f32 v51, s35, v51
v_mfma_f32_16x16x32_bf16 v[116:119], a[132:135], v[84:87], v[116:119]
v_exp_f32 v50, v50
v_mfma_f32_16x16x32_bf16 v[104:107], a[128:131], v[88:91], v[104:107]
v_exp_f32 v51, v51
v_mfma_f32_16x16x32_bf16 v[120:123], a[132:135], v[88:91], v[120:123]
v_cvt_pk_bf16_f32 v66, v48, v49
v_cvt_pk_bf16_f32 v67, v50, v51
v_mfma_f32_16x16x32_bf16 v[108:111], a[128:131], v[92:95], v[108:111]
v_mul_f32 v52, s35, v52
v_mul_f32 v53, s35, v53
v_mfma_f32_16x16x32_bf16 v[124:127], a[132:135], v[92:95], v[124:127]
s_waitcnt lgkmcnt(8)
v_exp_f32 v52, v52
v_mfma_f32_16x16x32_bf16 v[128:131], a[136:139], v[80:83], v[128:131]
v_exp_f32 v53, v53
v_mfma_f32_16x16x32_bf16 v[144:147], a[140:143], v[80:83], v[144:147]
v_mul_f32 v54, s35, v54
v_mul_f32 v55, s35, v55
v_mfma_f32_16x16x32_bf16 v[132:135], a[136:139], v[84:87], v[132:135]
v_exp_f32 v54, v54
v_mfma_f32_16x16x32_bf16 v[148:151], a[140:143], v[84:87], v[148:151]
ds_read_b64_tr_b16 a[128:129], v2 offset:40960
ds_read_b64_tr_b16 a[130:131], v2 offset:43008
v_mfma_f32_16x16x32_bf16 v[136:139], a[136:139], v[88:91], v[136:139]
ds_read_b64_tr_b16 a[132:133], v2 offset:45056
ds_read_b64_tr_b16 a[134:135], v2 offset:47104
v_mfma_f32_16x16x32_bf16 v[152:155], a[140:143], v[88:91], v[152:155]
v_exp_f32 v55, v55
v_mfma_f32_16x16x32_bf16 v[140:143], a[136:139], v[92:95], v[140:143]
v_cvt_pk_bf16_f32 v70, v52, v53
v_cvt_pk_bf16_f32 v71, v54, v55
v_mfma_f32_16x16x32_bf16 v[156:159], a[140:143], v[92:95], v[156:159]
s_waitcnt lgkmcnt(8)
v_mul_f32 v56, s35, v56
v_mul_f32 v57, s35, v57
v_mfma_f32_16x16x32_bf16 v[96:99], a[144:147], v[64:67], v[96:99]
v_exp_f32 v56, v56
v_mfma_f32_16x16x32_bf16 v[112:115], a[148:151], v[64:67], v[112:115]
v_exp_f32 v57, v57
v_mul_f32 v58, s35, v58
v_mul_f32 v59, s35, v59
v_exp_f32 v58, v58
v_exp_f32 v59, v59
v_mfma_f32_16x16x32_bf16 v[100:103], a[144:147], v[68:71], v[100:103]
v_cvt_pk_bf16_f32 v74, v56, v57
v_cvt_pk_bf16_f32 v75, v58, v59
v_mfma_f32_16x16x32_bf16 v[116:119], a[148:151], v[68:71], v[116:119]
v_mul_f32 v60, s35, v60
v_mul_f32 v61, s35, v61
v_exp_f32 v60, v60
v_exp_f32 v61, v61
v_mul_f32 v62, s35, v62
v_mul_f32 v63, s35, v63
v_exp_f32 v62, v62
v_exp_f32 v63, v63
v_mfma_f32_16x16x32_bf16 v[104:107], a[144:147], v[72:75], v[104:107]
v_cvt_pk_bf16_f32 v78, v60, v61
v_cvt_pk_bf16_f32 v79, v62, v63
v_mfma_f32_16x16x32_bf16 v[120:123], a[148:151], v[72:75], v[120:123]
ds_read_b64_tr_b16 a[136:137], v3 offset:40960
ds_read_b64_tr_b16 a[138:139], v3 offset:43008
ds_read_b64_tr_b16 a[140:141], v3 offset:45056
ds_read_b64_tr_b16 a[142:143], v3 offset:47104
v_mfma_f32_16x16x32_bf16 v[108:111], a[144:147], v[76:79], v[108:111]
v_add_f32 v6, v6, v48
v_add_f32 v6, v6, v49
v_mfma_f32_16x16x32_bf16 v[124:127], a[148:151], v[76:79], v[124:127]
s_waitcnt lgkmcnt(8)
v_add_f32 v6, v6, v50
v_add_f32 v6, v6, v51
v_mfma_f32_16x16x32_bf16 v[128:131], a[152:155], v[64:67], v[128:131]
v_add_f32 v7, v7, v52
v_add_f32 v7, v7, v53
v_mfma_f32_16x16x32_bf16 v[144:147], a[156:159], v[64:67], v[144:147]
v_add_f32 v7, v7, v54
v_add_f32 v7, v7, v55
v_mfma_f32_16x16x32_bf16 v[132:135], a[152:155], v[68:71], v[132:135]
v_add_f32 v8, v8, v56
v_add_f32 v8, v8, v57
v_mfma_f32_16x16x32_bf16 v[148:151], a[156:159], v[68:71], v[148:151]
ds_read_b64_tr_b16 a[144:145], v2 offset:41472
v_add_f32 v8, v8, v58
v_mfma_f32_16x16x32_bf16 v[136:139], a[152:155], v[72:75], v[136:139]
ds_read_b64_tr_b16 a[146:147], v2 offset:43520
ds_read_b64_tr_b16 a[148:149], v2 offset:45568
v_mfma_f32_16x16x32_bf16 v[152:155], a[156:159], v[72:75], v[152:155]
ds_read_b64_tr_b16 a[150:151], v2 offset:47616
v_add_f32 v8, v8, v59
v_mfma_f32_16x16x32_bf16 v[140:143], a[152:155], v[76:79], v[140:143]
v_add_f32 v9, v9, v60
v_add_f32 v9, v9, v61
v_mfma_f32_16x16x32_bf16 v[156:159], a[156:159], v[76:79], v[156:159]
s_waitcnt lgkmcnt(8)
v_add_f32 v9, v9, v62
v_add_f32 v9, v9, v63
v_mfma_f32_16x16x32_bf16 a[160:163], a[128:131], v[80:83], a[160:163]
ds_read_b64_tr_b16 a[152:153], v3 offset:41472
ds_read_b64_tr_b16 a[154:155], v3 offset:43520
v_mfma_f32_16x16x32_bf16 a[160:163], a[132:135], v[64:67], a[160:163]
v_permlane16_swap_b32 v6, v7
v_mfma_f32_16x16x32_bf16 a[164:167], a[128:131], v[84:87], a[164:167]
v_permlane16_swap_b32 v8, v9
v_mfma_f32_16x16x32_bf16 a[164:167], a[132:135], v[68:71], a[164:167]
v_add_f32 v6, v6, v7
v_add_f32 v8, v8, v9
v_mfma_f32_16x16x32_bf16 a[168:171], a[128:131], v[88:91], a[168:171]
ds_read_b64_tr_b16 a[156:157], v3 offset:45568
ds_read_b64_tr_b16 a[158:159], v3 offset:47616
v_mfma_f32_16x16x32_bf16 a[168:171], a[132:135], v[72:75], a[168:171]
v_permlane32_swap_b32 v6, v8
v_mfma_f32_16x16x32_bf16 a[172:175], a[128:131], v[92:95], a[172:175]
v_add_f32 v41, v6, v8
v_rcp_f32 v32, v41
v_mfma_f32_16x16x32_bf16 a[172:175], a[132:135], v[76:79], a[172:175]
s_waitcnt lgkmcnt(8)
ds_read_b64_tr_b16 a[128:129], v2 offset:49152
v_mov_b32 v34, v32
v_mfma_f32_16x16x32_bf16 a[176:179], a[136:139], v[80:83], a[176:179]
ds_read_b64_tr_b16 a[130:131], v2 offset:51200
ds_read_b64_tr_b16 a[132:133], v2 offset:53248
v_mfma_f32_16x16x32_bf16 a[176:179], a[140:143], v[64:67], a[176:179]
v_permlane32_swap_b32 v32, v34
v_mov_b32 v33, v32
v_mov_b32 v35, v34
v_mfma_f32_16x16x32_bf16 a[180:183], a[136:139], v[84:87], a[180:183]
ds_read_b64_tr_b16 a[134:135], v2 offset:55296
v_mfma_f32_16x16x32_bf16 a[180:183], a[140:143], v[68:71], a[180:183]
v_permlane16_swap_b32 v32, v33
v_permlane16_swap_b32 v34, v35
v_cmp_ngt_f32 vcc, 0x58800000, v41
v_pk_mul_f32 v[96:97], v[96:97], v[32:33] op_sel:[0,0] op_sel_hi:[1,0]
v_pk_mul_f32 v[98:99], v[98:99], v[32:33] op_sel:[0,0] op_sel_hi:[1,0]
v_cvt_pk_bf16_f32 v96, v96, v97
v_cvt_pk_bf16_f32 v97, v98, v99
v_pk_mul_f32 v[100:101], v[100:101], v[32:33] op_sel:[0,1] op_sel_hi:[1,1]
v_pk_mul_f32 v[102:103], v[102:103], v[32:33] op_sel:[0,1] op_sel_hi:[1,1]
v_cvt_pk_bf16_f32 v100, v100, v101
v_cvt_pk_bf16_f32 v101, v102, v103
v_pk_mul_f32 v[104:105], v[104:105], v[34:35] op_sel:[0,0] op_sel_hi:[1,0]
v_pk_mul_f32 v[106:107], v[106:107], v[34:35] op_sel:[0,0] op_sel_hi:[1,0]
v_cvt_pk_bf16_f32 v104, v104, v105
v_cvt_pk_bf16_f32 v105, v106, v107
ds_write2st64_b64 v15, v[96:97], v[100:101] offset0:64 offset1:66
s_cbranch_vccz L_noflag4g
s_bitset1_b32 s38, s37
L_noflag4g:
v_pk_mul_f32 v[108:109], v[108:109], v[34:35] op_sel:[0,1] op_sel_hi:[1,1]
v_pk_mul_f32 v[110:111], v[110:111], v[34:35] op_sel:[0,1] op_sel_hi:[1,1]
v_cvt_pk_bf16_f32 v108, v108, v109
v_cvt_pk_bf16_f32 v109, v110, v111
v_pk_mul_f32 v[112:113], v[112:113], v[32:33] op_sel:[0,0] op_sel_hi:[1,0]
v_pk_mul_f32 v[114:115], v[114:115], v[32:33] op_sel:[0,0] op_sel_hi:[1,0]
v_cvt_pk_bf16_f32 v112, v112, v113
v_cvt_pk_bf16_f32 v113, v114, v115
ds_write2st64_b64 v15, v[104:105], v[108:109] offset0:68 offset1:70
v_pk_mul_f32 v[116:117], v[116:117], v[32:33] op_sel:[0,1] op_sel_hi:[1,1]
v_pk_mul_f32 v[118:119], v[118:119], v[32:33] op_sel:[0,1] op_sel_hi:[1,1]
v_cvt_pk_bf16_f32 v116, v116, v117
v_cvt_pk_bf16_f32 v117, v118, v119
v_pk_mul_f32 v[120:121], v[120:121], v[34:35] op_sel:[0,0] op_sel_hi:[1,0]
v_pk_mul_f32 v[122:123], v[122:123], v[34:35] op_sel:[0,0] op_sel_hi:[1,0]
v_cvt_pk_bf16_f32 v120, v120, v121
v_cvt_pk_bf16_f32 v121, v122, v123
ds_write2st64_b64 v37, v[112:113], v[116:117] offset0:64 offset1:66
v_pk_mul_f32 v[124:125], v[124:125], v[34:35] op_sel:[0,1] op_sel_hi:[1,1]
v_pk_mul_f32 v[126:127], v[126:127], v[34:35] op_sel:[0,1] op_sel_hi:[1,1]
v_cvt_pk_bf16_f32 v124, v124, v125
v_cvt_pk_bf16_f32 v125, v126, v127
v_pk_mul_f32 v[128:129], v[128:129], v[32:33] op_sel:[0,0] op_sel_hi:[1,0]
v_pk_mul_f32 v[130:131], v[130:131], v[32:33] op_sel:[0,0] op_sel_hi:[1,0]
v_cvt_pk_bf16_f32 v128, v128, v129
v_cvt_pk_bf16_f32 v129, v130, v131
ds_write2st64_b64 v37, v[120:121], v[124:125] offset0:68 offset1:70
v_pk_mul_f32 v[132:133], v[132:133], v[32:33] op_sel:[0,1] op_sel_hi:[1,1]
v_pk_mul_f32 v[134:135], v[134:135], v[32:33] op_sel:[0,1] op_sel_hi:[1,1]
v_cvt_pk_bf16_f32 v132, v132, v133
v_cvt_pk_bf16_f32 v133, v134, v135
v_pk_mul_f32 v[136:137], v[136:137], v[34:35] op_sel:[0,0] op_sel_hi:[1,0]
v_pk_mul_f32 v[138:139], v[138:139], v[34:35] op_sel:[0,0] op_sel_hi:[1,0]
v_cvt_pk_bf16_f32 v136, v136, v137
v_cvt_pk_bf16_f32 v137, v138, v139
ds_write2st64_b64 v38, v[128:129], v[132:133] offset0:64 offset1:66
v_pk_mul_f32 v[140:141], v[140:141], v[34:35] op_sel:[0,1] op_sel_hi:[1,1]
v_pk_mul_f32 v[142:143], v[142:143], v[34:35] op_sel:[0,1] op_sel_hi:[1,1]
v_cvt_pk_bf16_f32 v140, v140, v141
v_cvt_pk_bf16_f32 v141, v142, v143
v_pk_mul_f32 v[144:145], v[144:145], v[32:33] op_sel:[0,0] op_sel_hi:[1,0]
v_pk_mul_f32 v[146:147], v[146:147], v[32:33] op_sel:[0,0] op_sel_hi:[1,0]
v_cvt_pk_bf16_f32 v144, v144, v145
v_cvt_pk_bf16_f32 v145, v146, v147
ds_write2st64_b64 v38, v[136:137], v[140:141] offset0:68 offset1:70
v_pk_mul_f32 v[148:149], v[148:149], v[32:33] op_sel:[0,1] op_sel_hi:[1,1]
v_pk_mul_f32 v[150:151], v[150:151], v[32:33] op_sel:[0,1] op_sel_hi:[1,1]
v_cvt_pk_bf16_f32 v148, v148, v149
v_cvt_pk_bf16_f32 v149, v150, v151
v_pk_mul_f32 v[152:153], v[152:153], v[34:35] op_sel:[0,0] op_sel_hi:[1,0]
v_pk_mul_f32 v[154:155], v[154:155], v[34:35] op_sel:[0,0] op_sel_hi:[1,0]
v_cvt_pk_bf16_f32 v152, v152, v153
v_cvt_pk_bf16_f32 v153, v154, v155
ds_write2st64_b64 v39, v[144:145], v[148:149] offset0:64 offset1:66
v_pk_mul_f32 v[156:157], v[156:157], v[34:35] op_sel:[0,1] op_sel_hi:[1,1]
v_pk_mul_f32 v[158:159], v[158:159], v[34:35] op_sel:[0,1] op_sel_hi:[1,1]
v_cvt_pk_bf16_f32 v156, v156, v157
v_cvt_pk_bf16_f32 v157, v158, v159
ds_write2st64_b64 v39, v[152:153], v[156:157] offset0:68 offset1:70
v_mfma_f32_16x16x32_bf16 a[184:187], a[136:139], v[88:91], a[184:187]
ds_read2st64_b64 v[96:99], v40 offset0:64 offset1:72
v_accvgpr_read_b32 v48, a160
v_mfma_f32_16x16x32_bf16 a[184:187], a[140:143], v[72:75], a[184:187]
v_accvgpr_read_b32 v52, a164
v_accvgpr_read_b32 v56, a168
v_mfma_f32_16x16x32_bf16 a[188:191], a[136:139], v[92:95], a[188:191]
v_accvgpr_read_b32 v60, a172
v_accvgpr_read_b32 v49, a161
v_mfma_f32_16x16x32_bf16 a[188:191], a[140:143], v[76:79], a[188:191]
s_waitcnt lgkmcnt(15)
v_accvgpr_read_b32 v53, a165
v_accvgpr_read_b32 v57, a169
v_mfma_f32_16x16x32_bf16 a[192:195], a[144:147], v[80:83], a[192:195]
ds_read_b64_tr_b16 a[136:137], v3 offset:49152
v_accvgpr_read_b32 v61, a173
v_mfma_f32_16x16x32_bf16 a[192:195], a[148:151], v[64:67], a[192:195]
ds_read_b64_tr_b16 a[138:139], v3 offset:51200
ds_read_b64_tr_b16 a[140:141], v3 offset:53248
v_mfma_f32_16x16x32_bf16 a[196:199], a[144:147], v[84:87], a[196:199]
ds_read_b64_tr_b16 a[142:143], v3 offset:55296
ds_read2st64_b64 v[112:115], v42 offset0:65 offset1:73
v_mfma_f32_16x16x32_bf16 a[196:199], a[148:151], v[68:71], a[196:199]
v_accvgpr_read_b32 v50, a162
v_accvgpr_read_b32 v54, a166
v_mfma_f32_16x16x32_bf16 a[200:203], a[144:147], v[88:91], a[200:203]
v_accvgpr_read_b32 v58, a170
v_accvgpr_read_b32 v62, a174
v_mfma_f32_16x16x32_bf16 a[200:203], a[148:151], v[72:75], a[200:203]
v_accvgpr_read_b32 v51, a163
v_accvgpr_read_b32 v55, a167
v_mfma_f32_16x16x32_bf16 a[204:207], a[144:147], v[92:95], a[204:207]
v_accvgpr_read_b32 v59, a171
v_accvgpr_read_b32 v63, a175
v_mfma_f32_16x16x32_bf16 a[204:207], a[148:151], v[76:79], a[204:207]
s_waitcnt lgkmcnt(15)
ds_read2st64_b64 v[100:103], v40 offset0:66 offset1:74
v_accvgpr_read_b32 v128, a176
v_mfma_f32_16x16x32_bf16 a[208:211], a[152:155], v[80:83], a[208:211]
ds_read2st64_b64 v[116:119], v42 offset0:67 offset1:75
v_accvgpr_read_b32 v129, a177
v_mfma_f32_16x16x32_bf16 a[208:211], a[156:159], v[64:67], a[208:211]
v_accvgpr_read_b32 v130, a178
v_accvgpr_read_b32 v131, a179
v_mfma_f32_16x16x32_bf16 a[212:215], a[152:155], v[84:87], a[212:215]
ds_read2st64_b64 v[104:107], v40 offset0:68 offset1:76
v_accvgpr_read_b32 v132, a180
v_mfma_f32_16x16x32_bf16 a[212:215], a[156:159], v[68:71], a[212:215]
ds_read2st64_b64 v[120:123], v42 offset0:69 offset1:77
v_accvgpr_read_b32 v133, a181
v_mfma_f32_16x16x32_bf16 a[216:219], a[152:155], v[88:91], a[216:219]
v_accvgpr_read_b32 v134, a182
v_accvgpr_read_b32 v135, a183
v_mfma_f32_16x16x32_bf16 a[216:219], a[156:159], v[72:75], a[216:219]
ds_read2st64_b64 v[108:111], v40 offset0:70 offset1:78
ds_read2st64_b64 v[124:127], v42 offset0:71 offset1:79
ds_read_b64_tr_b16 a[144:145], v2 offset:49664
ds_read_b64_tr_b16 a[146:147], v2 offset:51712
ds_read_b64_tr_b16 a[148:149], v2 offset:53760
ds_read_b64_tr_b16 a[150:151], v2 offset:55808
v_mfma_f32_16x16x32_bf16 a[220:223], a[152:155], v[92:95], a[220:223]
s_waitcnt lgkmcnt(15)
buffer_store_dwordx4 v[96:99], v14, s[20:23], s72 offen offset:0 nt
v_mfma_f32_16x16x32_bf16 a[220:223], a[156:159], v[76:79], a[220:223]
v_accvgpr_read_b32 v136, a184
v_accvgpr_read_b32 v137, a185
v_mfma_f32_16x16x32_bf16 a[224:227], a[128:131], v[80:83], a[224:227]
v_accvgpr_read_b32 v138, a186
v_accvgpr_read_b32 v139, a187
v_mfma_f32_16x16x32_bf16 a[224:227], a[132:135], v[64:67], a[224:227]
s_waitcnt lgkmcnt(10)
buffer_store_dwordx4 v[112:115], v14, s[20:23], s73 offen offset:0 nt
v_mfma_f32_16x16x32_bf16 a[228:231], a[128:131], v[84:87], a[228:231]
s_waitcnt lgkmcnt(9)
buffer_store_dwordx4 v[100:103], v14, s[20:23], s74 offen offset:0 nt
s_waitcnt lgkmcnt(8)
buffer_store_dwordx4 v[116:119], v14, s[20:23], s75 offen offset:0 nt
s_waitcnt lgkmcnt(7)
buffer_store_dwordx4 v[104:107], v14, s[20:23], s76 offen offset:0 nt
s_waitcnt lgkmcnt(6)
buffer_store_dwordx4 v[120:123], v14, s[20:23], s77 offen offset:0 nt
s_waitcnt lgkmcnt(5)
buffer_store_dwordx4 v[108:111], v14, s[20:23], s78 offen offset:0 nt
s_waitcnt lgkmcnt(4)
buffer_store_dwordx4 v[124:127], v14, s[20:23], s79 offen offset:0 nt
v_accvgpr_read_b32 v140, a188
v_accvgpr_read_b32 v141, a189
v_accvgpr_read_b32 v142, a190
v_accvgpr_read_b32 v143, a191
v_accvgpr_read_b32 v144, a192
v_accvgpr_read_b32 v145, a193
v_accvgpr_read_b32 v146, a194
v_accvgpr_read_b32 v147, a195
v_mfma_f32_16x16x32_bf16 a[228:231], a[132:135], v[68:71], a[228:231]
ds_read_b64_tr_b16 a[152:153], v3 offset:49664
ds_read_b64_tr_b16 a[154:155], v3 offset:51712
v_pk_mul_f32 v[48:49], v[48:49], v[32:33] op_sel:[0,0] op_sel_hi:[1,0]
v_pk_mul_f32 v[50:51], v[50:51], v[32:33] op_sel:[0,0] op_sel_hi:[1,0]
v_cvt_pk_bf16_f32 v48, v48, v49
v_cvt_pk_bf16_f32 v49, v50, v51
v_pk_mul_f32 v[52:53], v[52:53], v[32:33] op_sel:[0,1] op_sel_hi:[1,1]
v_pk_mul_f32 v[54:55], v[54:55], v[32:33] op_sel:[0,1] op_sel_hi:[1,1]
v_cvt_pk_bf16_f32 v52, v52, v53
v_cvt_pk_bf16_f32 v53, v54, v55
v_pk_mul_f32 v[56:57], v[56:57], v[34:35] op_sel:[0,0] op_sel_hi:[1,0]
v_pk_mul_f32 v[58:59], v[58:59], v[34:35] op_sel:[0,0] op_sel_hi:[1,0]
v_cvt_pk_bf16_f32 v56, v56, v57
v_cvt_pk_bf16_f32 v57, v58, v59
ds_write2st64_b64 v15, v[48:49], v[52:53] offset0:64 offset1:66
v_pk_mul_f32 v[60:61], v[60:61], v[34:35] op_sel:[0,1] op_sel_hi:[1,1]
v_pk_mul_f32 v[62:63], v[62:63], v[34:35] op_sel:[0,1] op_sel_hi:[1,1]
v_cvt_pk_bf16_f32 v60, v60, v61
v_cvt_pk_bf16_f32 v61, v62, v63
v_pk_mul_f32 v[128:129], v[128:129], v[32:33] op_sel:[0,0] op_sel_hi:[1,0]
v_pk_mul_f32 v[130:131], v[130:131], v[32:33] op_sel:[0,0] op_sel_hi:[1,0]
v_cvt_pk_bf16_f32 v128, v128, v129
v_cvt_pk_bf16_f32 v129, v130, v131
ds_write2st64_b64 v15, v[56:57], v[60:61] offset0:68 offset1:70
v_pk_mul_f32 v[132:133], v[132:133], v[32:33] op_sel:[0,1] op_sel_hi:[1,1]
v_pk_mul_f32 v[134:135], v[134:135], v[32:33] op_sel:[0,1] op_sel_hi:[1,1]
v_cvt_pk_bf16_f32 v132, v132, v133
v_cvt_pk_bf16_f32 v133, v134, v135
v_pk_mul_f32 v[136:137], v[136:137], v[34:35] op_sel:[0,0] op_sel_hi:[1,0]
v_pk_mul_f32 v[138:139], v[138:139], v[34:35] op_sel:[0,0] op_sel_hi:[1,0]
v_cvt_pk_bf16_f32 v136, v136, v137
v_cvt_pk_bf16_f32 v137, v138, v139
ds_write2st64_b64 v37, v[128:129], v[132:133] offset0:64 offset1:66
v_pk_mul_f32 v[140:141], v[140:141], v[34:35] op_sel:[0,1] op_sel_hi:[1,1]
v_pk_mul_f32 v[142:143], v[142:143], v[34:35] op_sel:[0,1] op_sel_hi:[1,1]
v_cvt_pk_bf16_f32 v140, v140, v141
v_cvt_pk_bf16_f32 v141, v142, v143
v_pk_mul_f32 v[144:145], v[144:145], v[32:33] op_sel:[0,0] op_sel_hi:[1,0]
v_pk_mul_f32 v[146:147], v[146:147], v[32:33] op_sel:[0,0] op_sel_hi:[1,0]
v_cvt_pk_bf16_f32 v144, v144, v145
v_cvt_pk_bf16_f32 v145, v146, v147
ds_write2st64_b64 v37, v[136:137], v[140:141] offset0:68 offset1:70
v_accvgpr_read_b32 v148, a196
v_accvgpr_read_b32 v149, a197
v_accvgpr_read_b32 v150, a198
v_accvgpr_read_b32 v151, a199
v_pk_mul_f32 v[148:149], v[148:149], v[32:33] op_sel:[0,1] op_sel_hi:[1,1]
v_pk_mul_f32 v[150:151], v[150:151], v[32:33] op_sel:[0,1] op_sel_hi:[1,1]
v_cvt_pk_bf16_f32 v148, v148, v149
v_cvt_pk_bf16_f32 v149, v150, v151
v_accvgpr_read_b32 v152, a200
v_accvgpr_read_b32 v153, a201
v_accvgpr_read_b32 v154, a202
v_accvgpr_read_b32 v155, a203
v_pk_mul_f32 v[152:153], v[152:153], v[34:35] op_sel:[0,0] op_sel_hi:[1,0]
v_pk_mul_f32 v[154:155], v[154:155], v[34:35] op_sel:[0,0] op_sel_hi:[1,0]
v_cvt_pk_bf16_f32 v152, v152, v153
v_cvt_pk_bf16_f32 v153, v154, v155
ds_write2st64_b64 v38, v[144:145], v[148:149] offset0:64 offset1:66
v_accvgpr_read_b32 v156, a204
v_accvgpr_read_b32 v157, a205
v_accvgpr_read_b32 v158, a206
v_accvgpr_read_b32 v159, a207
v_pk_mul_f32 v[156:157], v[156:157], v[34:35] op_sel:[0,1] op_sel_hi:[1,1]
v_pk_mul_f32 v[158:159], v[158:159], v[34:35] op_sel:[0,1] op_sel_hi:[1,1]
v_cvt_pk_bf16_f32 v156, v156, v157
v_cvt_pk_bf16_f32 v157, v158, v159
v_accvgpr_read_b32 v16, a208
v_accvgpr_read_b32 v17, a209
v_accvgpr_read_b32 v18, a210
v_accvgpr_read_b32 v19, a211
v_pk_mul_f32 v[16:17], v[16:17], v[32:33] op_sel:[0,0] op_sel_hi:[1,0]
v_pk_mul_f32 v[18:19], v[18:19], v[32:33] op_sel:[0,0] op_sel_hi:[1,0]
v_cvt_pk_bf16_f32 v16, v16, v17
v_cvt_pk_bf16_f32 v17, v18, v19
ds_write2st64_b64 v38, v[152:153], v[156:157] offset0:68 offset1:70
v_accvgpr_read_b32 v20, a212
v_accvgpr_read_b32 v21, a213
v_accvgpr_read_b32 v22, a214
v_accvgpr_read_b32 v23, a215
v_pk_mul_f32 v[20:21], v[20:21], v[32:33] op_sel:[0,1] op_sel_hi:[1,1]
v_pk_mul_f32 v[22:23], v[22:23], v[32:33] op_sel:[0,1] op_sel_hi:[1,1]
v_cvt_pk_bf16_f32 v20, v20, v21
v_cvt_pk_bf16_f32 v21, v22, v23
v_accvgpr_read_b32 v24, a216
v_accvgpr_read_b32 v25, a217
v_accvgpr_read_b32 v26, a218
v_accvgpr_read_b32 v27, a219
v_pk_mul_f32 v[24:25], v[24:25], v[34:35] op_sel:[0,0] op_sel_hi:[1,0]
v_pk_mul_f32 v[26:27], v[26:27], v[34:35] op_sel:[0,0] op_sel_hi:[1,0]
v_cvt_pk_bf16_f32 v24, v24, v25
v_cvt_pk_bf16_f32 v25, v26, v27
ds_write2st64_b64 v39, v[16:17], v[20:21] offset0:64 offset1:66
v_accvgpr_read_b32 v28, a220
v_accvgpr_read_b32 v29, a221
v_accvgpr_read_b32 v30, a222
v_accvgpr_read_b32 v31, a223
v_pk_mul_f32 v[28:29], v[28:29], v[34:35] op_sel:[0,1] op_sel_hi:[1,1]
v_pk_mul_f32 v[30:31], v[30:31], v[34:35] op_sel:[0,1] op_sel_hi:[1,1]
v_cvt_pk_bf16_f32 v28, v28, v29
v_cvt_pk_bf16_f32 v29, v30, v31
ds_write2st64_b64 v39, v[24:25], v[28:29] offset0:68 offset1:70
v_mfma_f32_16x16x32_bf16 a[232:235], a[128:131], v[88:91], a[232:235]
ds_read_b64_tr_b16 a[156:157], v3 offset:53760
ds_read_b64_tr_b16 a[158:159], v3 offset:55808
v_mfma_f32_16x16x32_bf16 a[232:235], a[132:135], v[72:75], a[232:235]
ds_read2st64_b64 a[160:163], v40 offset0:64 offset1:72
ds_read2st64_b64 a[176:179], v42 offset0:65 offset1:73
v_mfma_f32_16x16x32_bf16 a[236:239], a[128:131], v[92:95], a[236:239]
ds_read2st64_b64 a[164:167], v40 offset0:66 offset1:74
v_accvgpr_read_b32 v48, a224
v_mfma_f32_16x16x32_bf16 a[236:239], a[132:135], v[76:79], a[236:239]
ds_read_b64_tr_b16 a[128:129], v2 offset:57344
ds_read_b64_tr_b16 a[130:131], v2 offset:59392
v_mfma_f32_16x16x32_bf16 a[240:243], a[136:139], v[80:83], a[240:243]
ds_read_b64_tr_b16 a[132:133], v2 offset:61440
ds_read_b64_tr_b16 a[134:135], v2 offset:63488
v_mfma_f32_16x16x32_bf16 a[240:243], a[140:143], v[64:67], a[240:243]
ds_read2st64_b64 a[180:183], v42 offset0:67 offset1:75
v_accvgpr_read_b32 v49, a225
v_mfma_f32_16x16x32_bf16 a[244:247], a[136:139], v[84:87], a[244:247]
v_accvgpr_read_b32 v50, a226
v_accvgpr_read_b32 v51, a227
v_mfma_f32_16x16x32_bf16 a[244:247], a[140:143], v[68:71], a[244:247]
ds_read2st64_b64 a[168:171], v40 offset0:68 offset1:76
v_accvgpr_read_b32 v52, a228
v_mfma_f32_16x16x32_bf16 a[248:251], a[136:139], v[88:91], a[248:251]
ds_read2st64_b64 a[184:187], v42 offset0:69 offset1:77
v_accvgpr_read_b32 v53, a229
v_mfma_f32_16x16x32_bf16 a[248:251], a[140:143], v[72:75], a[248:251]
v_accvgpr_read_b32 v54, a230
v_accvgpr_read_b32 v55, a231
v_mfma_f32_16x16x32_bf16 a[252:255], a[136:139], v[92:95], a[252:255]
s_waitcnt lgkmcnt(9)
buffer_store_dwordx4 a[160:163], v14, s[20:23], s72 offen offset:128 nt
v_mfma_f32_16x16x32_bf16 a[252:255], a[140:143], v[76:79], a[252:255]
ds_read2st64_b64 a[172:175], v40 offset0:70 offset1:78
v_accvgpr_read_b32 v56, a232
v_mfma_f32_16x16x32_bf16 v[160:163], a[144:147], v[80:83], v[160:163]
ds_read2st64_b64 a[188:191], v42 offset0:71 offset1:79
v_accvgpr_read_b32 v57, a233
v_mfma_f32_16x16x32_bf16 v[160:163], a[148:151], v[64:67], v[160:163]
v_accvgpr_read_b32 v58, a234
v_accvgpr_read_b32 v59, a235
v_mfma_f32_16x16x32_bf16 v[164:167], a[144:147], v[84:87], v[164:167]
v_accvgpr_read_b32 v60, a236
v_accvgpr_read_b32 v61, a237
v_mfma_f32_16x16x32_bf16 v[164:167], a[148:151], v[68:71], v[164:167]
s_waitcnt lgkmcnt(10)
buffer_store_dwordx4 a[176:179], v14, s[20:23], s73 offen offset:128 nt
v_mfma_f32_16x16x32_bf16 v[168:171], a[144:147], v[88:91], v[168:171]
ds_read_b64_tr_b16 a[136:137], v3 offset:57344
ds_read_b64_tr_b16 a[138:139], v3 offset:59392
v_mfma_f32_16x16x32_bf16 v[168:171], a[148:151], v[72:75], v[168:171]
ds_read_b64_tr_b16 a[140:141], v3 offset:61440
ds_read_b64_tr_b16 a[142:143], v3 offset:63488
v_mfma_f32_16x16x32_bf16 v[172:175], a[144:147], v[92:95], v[172:175]
v_accvgpr_read_b32 v62, a238
v_accvgpr_read_b32 v63, a239
v_mfma_f32_16x16x32_bf16 v[172:175], a[148:151], v[76:79], v[172:175]
v_accvgpr_read_b32 v128, a240
v_accvgpr_read_b32 v129, a241
v_mfma_f32_16x16x32_bf16 v[176:179], a[152:155], v[80:83], v[176:179]
v_accvgpr_read_b32 v130, a242
v_accvgpr_read_b32 v131, a243
v_mfma_f32_16x16x32_bf16 v[176:179], a[156:159], v[64:67], v[176:179]
s_waitcnt lgkmcnt(13)
buffer_store_dwordx4 a[164:167], v14, s[20:23], s74 offen offset:128 nt
v_mfma_f32_16x16x32_bf16 v[180:183], a[152:155], v[84:87], v[180:183]
v_accvgpr_read_b32 v132, a244
v_accvgpr_read_b32 v133, a245
v_mfma_f32_16x16x32_bf16 v[180:183], a[156:159], v[68:71], v[180:183]
v_accvgpr_read_b32 v134, a246
v_accvgpr_read_b32 v135, a247
v_mfma_f32_16x16x32_bf16 v[184:187], a[152:155], v[88:91], v[184:187]
v_accvgpr_read_b32 v136, a248
v_accvgpr_read_b32 v137, a249
v_mfma_f32_16x16x32_bf16 v[184:187], a[156:159], v[72:75], v[184:187]
ds_read_b64_tr_b16 a[144:145], v2 offset:57856
ds_read_b64_tr_b16 a[146:147], v2 offset:59904
ds_read_b64_tr_b16 a[148:149], v2 offset:61952
ds_read_b64_tr_b16 a[150:151], v2 offset:64000
v_mfma_f32_16x16x32_bf16 v[188:191], a[152:155], v[92:95], v[188:191]
s_waitcnt lgkmcnt(12)
buffer_store_dwordx4 a[180:183], v14, s[20:23], s75 offen offset:128 nt
v_mfma_f32_16x16x32_bf16 v[188:191], a[156:159], v[76:79], v[188:191]
v_accvgpr_read_b32 v138, a250
v_accvgpr_read_b32 v139, a251
v_mfma_f32_16x16x32_bf16 v[192:195], a[128:131], v[80:83], v[192:195]
v_accvgpr_read_b32 v140, a252
v_accvgpr_read_b32 v141, a253
v_mfma_f32_16x16x32_bf16 v[192:195], a[132:135], v[64:67], v[192:195]
v_accvgpr_read_b32 v142, a254
v_accvgpr_read_b32 v143, a255
v_mfma_f32_16x16x32_bf16 v[196:199], a[128:131], v[84:87], v[196:199]
s_waitcnt lgkmcnt(11)
buffer_store_dwordx4 a[168:171], v14, s[20:23], s76 offen offset:128 nt
s_waitcnt lgkmcnt(10)
buffer_store_dwordx4 a[184:187], v14, s[20:23], s77 offen offset:128 nt
s_waitcnt lgkmcnt(9)
buffer_store_dwordx4 a[172:175], v14, s[20:23], s78 offen offset:128 nt
s_waitcnt lgkmcnt(8)
buffer_store_dwordx4 a[188:191], v14, s[20:23], s79 offen offset:128 nt
v_mfma_f32_16x16x32_bf16 v[196:199], a[132:135], v[68:71], v[196:199]
ds_read_b64_tr_b16 a[152:153], v3 offset:57856
ds_read_b64_tr_b16 a[154:155], v3 offset:59904
v_pk_mul_f32 v[48:49], v[48:49], v[32:33] op_sel:[0,0] op_sel_hi:[1,0]
v_pk_mul_f32 v[50:51], v[50:51], v[32:33] op_sel:[0,0] op_sel_hi:[1,0]
v_cvt_pk_bf16_f32 v48, v48, v49
v_cvt_pk_bf16_f32 v49, v50, v51
v_pk_mul_f32 v[52:53], v[52:53], v[32:33] op_sel:[0,1] op_sel_hi:[1,1]
v_pk_mul_f32 v[54:55], v[54:55], v[32:33] op_sel:[0,1] op_sel_hi:[1,1]
v_cvt_pk_bf16_f32 v52, v52, v53
v_cvt_pk_bf16_f32 v53, v54, v55
v_pk_mul_f32 v[56:57], v[56:57], v[34:35] op_sel:[0,0] op_sel_hi:[1,0]
v_pk_mul_f32 v[58:59], v[58:59], v[34:35] op_sel:[0,0] op_sel_hi:[1,0]
v_cvt_pk_bf16_f32 v56, v56, v57
v_cvt_pk_bf16_f32 v57, v58, v59
ds_write2st64_b64 v15, v[48:49], v[52:53] offset0:64 offset1:66
v_pk_mul_f32 v[60:61], v[60:61], v[34:35] op_sel:[0,1] op_sel_hi:[1,1]
v_pk_mul_f32 v[62:63], v[62:63], v[34:35] op_sel:[0,1] op_sel_hi:[1,1]
v_cvt_pk_bf16_f32 v60, v60, v61
v_cvt_pk_bf16_f32 v61, v62, v63
v_pk_mul_f32 v[128:129], v[128:129], v[32:33] op_sel:[0,0] op_sel_hi:[1,0]
v_pk_mul_f32 v[130:131], v[130:131], v[32:33] op_sel:[0,0] op_sel_hi:[1,0]
v_cvt_pk_bf16_f32 v128, v128, v129
v_cvt_pk_bf16_f32 v129, v130, v131
ds_write2st64_b64 v15, v[56:57], v[60:61] offset0:68 offset1:70
v_pk_mul_f32 v[132:133], v[132:133], v[32:33] op_sel:[0,1] op_sel_hi:[1,1]
v_pk_mul_f32 v[134:135], v[134:135], v[32:33] op_sel:[0,1] op_sel_hi:[1,1]
v_cvt_pk_bf16_f32 v132, v132, v133
v_cvt_pk_bf16_f32 v133, v134, v135
v_pk_mul_f32 v[136:137], v[136:137], v[34:35] op_sel:[0,0] op_sel_hi:[1,0]
v_pk_mul_f32 v[138:139], v[138:139], v[34:35] op_sel:[0,0] op_sel_hi:[1,0]
v_cvt_pk_bf16_f32 v136, v136, v137
v_cvt_pk_bf16_f32 v137, v138, v139
ds_write2st64_b64 v37, v[128:129], v[132:133] offset0:64 offset1:66
v_pk_mul_f32 v[140:141], v[140:141], v[34:35] op_sel:[0,1] op_sel_hi:[1,1]
v_pk_mul_f32 v[142:143], v[142:143], v[34:35] op_sel:[0,1] op_sel_hi:[1,1]
v_cvt_pk_bf16_f32 v140, v140, v141
v_cvt_pk_bf16_f32 v141, v142, v143
v_pk_mul_f32 v[160:161], v[160:161], v[32:33] op_sel:[0,0] op_sel_hi:[1,0]
v_pk_mul_f32 v[162:163], v[162:163], v[32:33] op_sel:[0,0] op_sel_hi:[1,0]
v_cvt_pk_bf16_f32 v160, v160, v161
v_cvt_pk_bf16_f32 v161, v162, v163
ds_write2st64_b64 v37, v[136:137], v[140:141] offset0:68 offset1:70
v_pk_mul_f32 v[164:165], v[164:165], v[32:33] op_sel:[0,1] op_sel_hi:[1,1]
v_pk_mul_f32 v[166:167], v[166:167], v[32:33] op_sel:[0,1] op_sel_hi:[1,1]
v_cvt_pk_bf16_f32 v164, v164, v165
v_cvt_pk_bf16_f32 v165, v166, v167
v_pk_mul_f32 v[168:169], v[168:169], v[34:35] op_sel:[0,0] op_sel_hi:[1,0]
v_pk_mul_f32 v[170:171], v[170:171], v[34:35] op_sel:[0,0] op_sel_hi:[1,0]
v_cvt_pk_bf16_f32 v168, v168, v169
v_cvt_pk_bf16_f32 v169, v170, v171
ds_write2st64_b64 v38, v[160:161], v[164:165] offset0:64 offset1:66
v_pk_mul_f32 v[172:173], v[172:173], v[34:35] op_sel:[0,1] op_sel_hi:[1,1]
v_pk_mul_f32 v[174:175], v[174:175], v[34:35] op_sel:[0,1] op_sel_hi:[1,1]
v_cvt_pk_bf16_f32 v172, v172, v173
v_cvt_pk_bf16_f32 v173, v174, v175
v_pk_mul_f32 v[176:177], v[176:177], v[32:33] op_sel:[0,0] op_sel_hi:[1,0]
v_pk_mul_f32 v[178:179], v[178:179], v[32:33] op_sel:[0,0] op_sel_hi:[1,0]
v_cvt_pk_bf16_f32 v176, v176, v177
v_cvt_pk_bf16_f32 v177, v178, v179
ds_write2st64_b64 v38, v[168:169], v[172:173] offset0:68 offset1:70
v_pk_mul_f32 v[180:181], v[180:181], v[32:33] op_sel:[0,1] op_sel_hi:[1,1]
v_pk_mul_f32 v[182:183], v[182:183], v[32:33] op_sel:[0,1] op_sel_hi:[1,1]
v_cvt_pk_bf16_f32 v180, v180, v181
v_cvt_pk_bf16_f32 v181, v182, v183
v_pk_mul_f32 v[184:185], v[184:185], v[34:35] op_sel:[0,0] op_sel_hi:[1,0]
v_pk_mul_f32 v[186:187], v[186:187], v[34:35] op_sel:[0,0] op_sel_hi:[1,0]
v_cvt_pk_bf16_f32 v184, v184, v185
v_cvt_pk_bf16_f32 v185, v186, v187
ds_write2st64_b64 v39, v[176:177], v[180:181] offset0:64 offset1:66
v_pk_mul_f32 v[188:189], v[188:189], v[34:35] op_sel:[0,1] op_sel_hi:[1,1]
v_pk_mul_f32 v[190:191], v[190:191], v[34:35] op_sel:[0,1] op_sel_hi:[1,1]
v_cvt_pk_bf16_f32 v188, v188, v189
v_cvt_pk_bf16_f32 v189, v190, v191
ds_write2st64_b64 v39, v[184:185], v[188:189] offset0:68 offset1:70
v_mfma_f32_16x16x32_bf16 v[200:203], a[128:131], v[88:91], v[200:203]
ds_read_b64_tr_b16 a[156:157], v3 offset:61952
ds_read_b64_tr_b16 a[158:159], v3 offset:64000
v_mfma_f32_16x16x32_bf16 v[200:203], a[132:135], v[72:75], v[200:203]
ds_read2st64_b64 a[224:227], v40 offset0:64 offset1:72
ds_read2st64_b64 a[240:243], v42 offset0:65 offset1:73
v_mfma_f32_16x16x32_bf16 v[204:207], a[128:131], v[92:95], v[204:207]
ds_read2st64_b64 a[228:231], v40 offset0:66 offset1:74
v_mul_f32 v192, v192, v32
v_mfma_f32_16x16x32_bf16 v[204:207], a[132:135], v[76:79], v[204:207]
s_waitcnt lgkmcnt(15)
ds_read2st64_b64 a[244:247], v42 offset0:67 offset1:75
v_mul_f32 v193, v193, v32
v_mfma_f32_16x16x32_bf16 v[208:211], a[136:139], v[80:83], v[208:211]
v_mul_f32 v194, v194, v32
v_mul_f32 v195, v195, v32
v_mfma_f32_16x16x32_bf16 v[208:211], a[140:143], v[64:67], v[208:211]
ds_read2st64_b64 a[232:235], v40 offset0:68 offset1:76
v_cvt_pk_bf16_f32 v192, v192, v193
v_mfma_f32_16x16x32_bf16 v[212:215], a[136:139], v[84:87], v[212:215]
v_mul_f32 v196, v196, v33
v_cvt_pk_bf16_f32 v193, v194, v195
v_mfma_f32_16x16x32_bf16 v[212:215], a[140:143], v[68:71], v[212:215]
ds_read2st64_b64 a[248:251], v42 offset0:69 offset1:77
v_mul_f32 v197, v197, v33
v_mfma_f32_16x16x32_bf16 v[216:219], a[136:139], v[88:91], v[216:219]
v_mul_f32 v198, v198, v33
v_mul_f32 v199, v199, v33
v_mfma_f32_16x16x32_bf16 v[216:219], a[140:143], v[72:75], v[216:219]
s_waitcnt lgkmcnt(5)
buffer_store_dwordx4 a[224:227], v14, s[20:23], s72 offen offset:256 nt
v_mfma_f32_16x16x32_bf16 v[220:223], a[136:139], v[92:95], v[220:223]
ds_read2st64_b64 a[236:239], v40 offset0:70 offset1:78
v_cvt_pk_bf16_f32 v196, v196, v197
v_mfma_f32_16x16x32_bf16 v[220:223], a[140:143], v[76:79], v[220:223]
v_mul_f32 v200, v200, v34
v_cvt_pk_bf16_f32 v197, v198, v199
v_mfma_f32_16x16x32_bf16 v[224:227], a[144:147], v[80:83], v[224:227]
ds_read2st64_b64 a[252:255], v42 offset0:71 offset1:79
v_mul_f32 v201, v201, v34
v_mfma_f32_16x16x32_bf16 v[224:227], a[148:151], v[64:67], v[224:227]
v_mul_f32 v202, v202, v34
v_mul_f32 v203, v203, v34
v_mfma_f32_16x16x32_bf16 v[228:231], a[144:147], v[84:87], v[228:231]
v_cvt_pk_bf16_f32 v200, v200, v201
v_mul_f32 v204, v204, v35
v_mfma_f32_16x16x32_bf16 v[228:231], a[148:151], v[68:71], v[228:231]
s_waitcnt lgkmcnt(6)
buffer_store_dwordx4 a[240:243], v14, s[20:23], s73 offen offset:256 nt
v_mfma_f32_16x16x32_bf16 v[232:235], a[144:147], v[88:91], v[232:235]
v_cvt_pk_bf16_f32 v201, v202, v203
v_mul_f32 v205, v205, v35
v_mfma_f32_16x16x32_bf16 v[232:235], a[148:151], v[72:75], v[232:235]
v_mul_f32 v206, v206, v35
v_mul_f32 v207, v207, v35
v_mfma_f32_16x16x32_bf16 v[236:239], a[144:147], v[92:95], v[236:239]
v_cvt_pk_bf16_f32 v204, v204, v205
v_mul_f32 v208, v208, v32
v_mfma_f32_16x16x32_bf16 v[236:239], a[148:151], v[76:79], v[236:239]
v_cvt_pk_bf16_f32 v205, v206, v207
v_mul_f32 v209, v209, v32
v_mfma_f32_16x16x32_bf16 v[240:243], a[152:155], v[80:83], v[240:243]
s_waitcnt lgkmcnt(5)
buffer_store_dwordx4 a[228:231], v14, s[20:23], s74 offen offset:256 nt
v_mfma_f32_16x16x32_bf16 v[240:243], a[156:159], v[64:67], v[240:243]
v_mul_f32 v210, v210, v32
v_mul_f32 v211, v211, v32
v_mfma_f32_16x16x32_bf16 v[244:247], a[152:155], v[84:87], v[244:247]
v_cvt_pk_bf16_f32 v208, v208, v209
v_mul_f32 v212, v212, v33
v_mfma_f32_16x16x32_bf16 v[244:247], a[156:159], v[68:71], v[244:247]
v_cvt_pk_bf16_f32 v209, v210, v211
v_mul_f32 v213, v213, v33
v_mfma_f32_16x16x32_bf16 v[248:251], a[152:155], v[88:91], v[248:251]
v_mul_f32 v214, v214, v33
v_mul_f32 v215, v215, v33
v_mfma_f32_16x16x32_bf16 v[248:251], a[156:159], v[72:75], v[248:251]
s_waitcnt lgkmcnt(4)
buffer_store_dwordx4 a[244:247], v14, s[20:23], s75 offen offset:256 nt
v_mfma_f32_16x16x32_bf16 v[252:255], a[152:155], v[92:95], v[252:255]
s_waitcnt lgkmcnt(3)
buffer_store_dwordx4 a[232:235], v14, s[20:23], s76 offen offset:256 nt
s_waitcnt lgkmcnt(2)
buffer_store_dwordx4 a[248:251], v14, s[20:23], s77 offen offset:256 nt
s_waitcnt lgkmcnt(1)
buffer_store_dwordx4 a[236:239], v14, s[20:23], s78 offen offset:256 nt
s_waitcnt lgkmcnt(0)
buffer_store_dwordx4 a[252:255], v14, s[20:23], s79 offen offset:256 nt
v_cvt_pk_bf16_f32 v212, v212, v213
v_cvt_pk_bf16_f32 v213, v214, v215
v_mfma_f32_16x16x32_bf16 v[252:255], a[156:159], v[76:79], v[252:255]
ds_write2st64_b64 v15, v[192:193], v[196:197] offset0:64 offset1:66
ds_write2st64_b64 v15, v[200:201], v[204:205] offset0:68 offset1:70
v_pk_mul_f32 v[216:217], v[216:217], v[34:35] op_sel:[0,0] op_sel_hi:[1,0]
v_pk_mul_f32 v[218:219], v[218:219], v[34:35] op_sel:[0,0] op_sel_hi:[1,0]
v_cvt_pk_bf16_f32 v216, v216, v217
v_cvt_pk_bf16_f32 v217, v218, v219
ds_write2st64_b64 v37, v[208:209], v[212:213] offset0:64 offset1:66
v_pk_mul_f32 v[220:221], v[220:221], v[34:35] op_sel:[0,1] op_sel_hi:[1,1]
v_pk_mul_f32 v[222:223], v[222:223], v[34:35] op_sel:[0,1] op_sel_hi:[1,1]
v_cvt_pk_bf16_f32 v220, v220, v221
v_cvt_pk_bf16_f32 v221, v222, v223
v_pk_mul_f32 v[224:225], v[224:225], v[32:33] op_sel:[0,0] op_sel_hi:[1,0]
v_pk_mul_f32 v[226:227], v[226:227], v[32:33] op_sel:[0,0] op_sel_hi:[1,0]
v_cvt_pk_bf16_f32 v224, v224, v225
v_cvt_pk_bf16_f32 v225, v226, v227
ds_write2st64_b64 v37, v[216:217], v[220:221] offset0:68 offset1:70
v_pk_mul_f32 v[228:229], v[228:229], v[32:33] op_sel:[0,1] op_sel_hi:[1,1]
v_pk_mul_f32 v[230:231], v[230:231], v[32:33] op_sel:[0,1] op_sel_hi:[1,1]
v_cvt_pk_bf16_f32 v228, v228, v229
v_cvt_pk_bf16_f32 v229, v230, v231
v_pk_mul_f32 v[232:233], v[232:233], v[34:35] op_sel:[0,0] op_sel_hi:[1,0]
v_pk_mul_f32 v[234:235], v[234:235], v[34:35] op_sel:[0,0] op_sel_hi:[1,0]
v_cvt_pk_bf16_f32 v232, v232, v233
v_cvt_pk_bf16_f32 v233, v234, v235
ds_write2st64_b64 v38, v[224:225], v[228:229] offset0:64 offset1:66
v_pk_mul_f32 v[236:237], v[236:237], v[34:35] op_sel:[0,1] op_sel_hi:[1,1]
v_pk_mul_f32 v[238:239], v[238:239], v[34:35] op_sel:[0,1] op_sel_hi:[1,1]
v_cvt_pk_bf16_f32 v236, v236, v237
v_cvt_pk_bf16_f32 v237, v238, v239
v_pk_mul_f32 v[240:241], v[240:241], v[32:33] op_sel:[0,0] op_sel_hi:[1,0]
v_pk_mul_f32 v[242:243], v[242:243], v[32:33] op_sel:[0,0] op_sel_hi:[1,0]
v_cvt_pk_bf16_f32 v240, v240, v241
v_cvt_pk_bf16_f32 v241, v242, v243
ds_write2st64_b64 v38, v[232:233], v[236:237] offset0:68 offset1:70
v_pk_mul_f32 v[244:245], v[244:245], v[32:33] op_sel:[0,1] op_sel_hi:[1,1]
v_pk_mul_f32 v[246:247], v[246:247], v[32:33] op_sel:[0,1] op_sel_hi:[1,1]
v_cvt_pk_bf16_f32 v244, v244, v245
v_cvt_pk_bf16_f32 v245, v246, v247
v_pk_mul_f32 v[248:249], v[248:249], v[34:35] op_sel:[0,0] op_sel_hi:[1,0]
v_pk_mul_f32 v[250:251], v[250:251], v[34:35] op_sel:[0,0] op_sel_hi:[1,0]
v_cvt_pk_bf16_f32 v248, v248, v249
v_cvt_pk_bf16_f32 v249, v250, v251
ds_write2st64_b64 v39, v[240:241], v[244:245] offset0:64 offset1:66
v_pk_mul_f32 v[252:253], v[252:253], v[34:35] op_sel:[0,1] op_sel_hi:[1,1]
v_pk_mul_f32 v[254:255], v[254:255], v[34:35] op_sel:[0,1] op_sel_hi:[1,1]
v_cvt_pk_bf16_f32 v252, v252, v253
v_cvt_pk_bf16_f32 v253, v254, v255
ds_write2st64_b64 v39, v[248:249], v[252:253] offset0:68 offset1:70
ds_read2st64_b64 v[192:195], v40 offset0:64 offset1:72
ds_read2st64_b64 v[208:211], v42 offset0:65 offset1:73
ds_read2st64_b64 v[196:199], v40 offset0:66 offset1:74
ds_read2st64_b64 v[212:215], v42 offset0:67 offset1:75
ds_read2st64_b64 v[200:203], v40 offset0:68 offset1:76
ds_read2st64_b64 v[216:219], v42 offset0:69 offset1:77
ds_read2st64_b64 v[204:207], v40 offset0:70 offset1:78
ds_read2st64_b64 v[220:223], v42 offset0:71 offset1:79
s_waitcnt lgkmcnt(7)
buffer_store_dwordx4 v[192:195], v14, s[20:23], s72 offen offset:384 nt
s_waitcnt lgkmcnt(6)
buffer_store_dwordx4 v[208:211], v14, s[20:23], s73 offen offset:384 nt
s_waitcnt lgkmcnt(5)
buffer_store_dwordx4 v[196:199], v14, s[20:23], s74 offen offset:384 nt
s_waitcnt lgkmcnt(4)
buffer_store_dwordx4 v[212:215], v14, s[20:23], s75 offen offset:384 nt
s_waitcnt lgkmcnt(3)
buffer_store_dwordx4 v[200:203], v14, s[20:23], s76 offen offset:384 nt
s_waitcnt lgkmcnt(2)
buffer_store_dwordx4 v[216:219], v14, s[20:23], s77 offen offset:384 nt
s_waitcnt lgkmcnt(1)
buffer_store_dwordx4 v[204:207], v14, s[20:23], s78 offen offset:384 nt
s_waitcnt lgkmcnt(0)
buffer_store_dwordx4 v[220:223], v14, s[20:23], s79 offen offset:384 nt
s_branch L_done
L_iw4b:
s_branch L_iwb
L_i7_4:
v_mfma_f32_16x16x32_bf16 v[48:51], a[128:131], a[0:3], v[16:19]
s_add_u32 m0, s27, 0
ds_read_b128 a[152:155], v1 offset:1536
ds_read_b128 a[156:159], v1 offset:1792
v_mfma_f32_16x16x32_bf16 v[48:51], a[132:135], a[4:7], v[48:51]
v_mul_f32 v76, s35, v76
v_mul_f32 v77, s35, v77
v_mfma_f32_16x16x32_bf16 v[52:55], a[128:131], a[32:35], v[20:23]
s_sub_u32 s32, s31, 32768
v_exp_f32 v76, v76
v_mfma_f32_16x16x32_bf16 v[52:55], a[132:135], a[36:39], v[52:55]
buffer_load_dwordx4 v12, s[8:11], s42 offen offset:0 nt lds
v_mfma_f32_16x16x32_bf16 v[56:59], a[128:131], a[64:67], v[24:27]
s_add_u32 s72, s44, 0
v_exp_f32 v77, v77
v_mfma_f32_16x16x32_bf16 v[56:59], a[132:135], a[68:71], v[56:59]
s_add_u32 s73, s44, 4096
v_mul_f32 v78, s35, v78
v_mul_f32 v79, s35, v79
v_mfma_f32_16x16x32_bf16 v[60:63], a[128:131], a[96:99], v[28:31]
buffer_load_dwordx4 v12, s[8:11], s42 offen offset:2048 nt lds
v_mfma_f32_16x16x32_bf16 v[60:63], a[132:135], a[100:103], v[60:63]
s_waitcnt lgkmcnt(4)
ds_read_b64_tr_b16 a[128:129], v2 offset:32768
ds_read_b64_tr_b16 a[130:131], v2 offset:34816
v_mfma_f32_16x16x32_bf16 v[48:51], a[136:139], a[8:11], v[48:51]
s_add_u32 s74, s44, 8192
ds_read_b64_tr_b16 a[132:133], v3 offset:32768
ds_read_b64_tr_b16 a[134:135], v3 offset:34816
v_mfma_f32_16x16x32_bf16 v[48:51], a[140:143], a[12:15], v[48:51]
s_add_u32 m0, s27, 768
v_exp_f32 v78, v78
v_mfma_f32_16x16x32_bf16 v[52:55], a[136:139], a[40:43], v[52:55]
v_exp_f32 v79, v79
v_mfma_f32_16x16x32_bf16 v[52:55], a[140:143], a[44:47], v[52:55]
v_mfma_f32_16x16x32_bf16 v[56:59], a[136:139], a[72:75], v[56:59]
s_add_u32 s75, s44, 12288
v_mfma_f32_16x16x32_bf16 v[56:59], a[140:143], a[76:79], v[56:59]
v_add_f32 v9, v9, v76
v_mfma_f32_16x16x32_bf16 v[60:63], a[136:139], a[104:107], v[60:63]
buffer_load_dwordx4 v12, s[8:11], s42 offen offset:256 nt lds
v_mfma_f32_16x16x32_bf16 v[60:63], a[140:143], a[108:111], v[60:63]
s_waitcnt lgkmcnt(6)
ds_read_b64_tr_b16 a[136:137], v2 offset:33280
ds_read_b64_tr_b16 a[138:139], v2 offset:35328
v_mfma_f32_16x16x32_bf16 v[48:51], a[144:147], a[16:19], v[48:51]
s_add_u32 s76, s44, 16384
ds_read_b64_tr_b16 a[140:141], v3 offset:33280
ds_read_b64_tr_b16 a[142:143], v3 offset:35328
v_mfma_f32_16x16x32_bf16 v[48:51], a[148:151], a[20:23], v[48:51]
v_xor_b32 v37, 16, v15
v_add_f32 v9, v9, v77
v_mfma_f32_16x16x32_bf16 v[52:55], a[144:147], a[48:51], v[52:55]
v_xor_b32 v38, 32, v15
v_add_f32 v9, v9, v78
v_mfma_f32_16x16x32_bf16 v[52:55], a[148:151], a[52:55], v[52:55]
v_xor_b32 v39, 48, v15
v_mbcnt_lo_u32_b32 v40, -1, 0
v_mfma_f32_16x16x32_bf16 v[56:59], a[144:147], a[80:83], v[56:59]
v_add_f32 v9, v9, v79
v_mbcnt_hi_u32_b32 v40, -1, v40
v_mfma_f32_16x16x32_bf16 v[56:59], a[148:151], a[84:87], v[56:59]
s_add_u32 s77, s44, 20480
v_cvt_pk_bf16_f32 v76, v76, v77
v_lshl_add_u32 v40, v40, 3, s28
v_mfma_f32_16x16x32_bf16 v[60:63], a[144:147], a[112:115], v[60:63]
s_waitcnt vmcnt(42)
buffer_load_dwordx4 v12, s[8:11], s42 offen offset:2304 nt lds
v_mfma_f32_16x16x32_bf16 v[60:63], a[148:151], a[116:119], v[60:63]
s_waitcnt lgkmcnt(8)
ds_read_b64_tr_b16 a[144:145], v2 offset:40960
ds_read_b64_tr_b16 a[146:147], v2 offset:43008
v_mfma_f32_16x16x32_bf16 v[48:51], a[152:155], a[24:27], v[48:51]
s_add_u32 m0, s27, 4096
ds_read_b64_tr_b16 a[148:149], v3 offset:40960
ds_read_b64_tr_b16 a[150:151], v3 offset:43008
v_mfma_f32_16x16x32_bf16 v[48:51], a[156:159], a[28:31], v[48:51]
s_add_u32 s78, s44, 24576
v_add_u32 v11, s26, v1
v_xor_b32 v42, 32, v40
v_mfma_f32_16x16x32_bf16 v[52:55], a[152:155], a[56:59], v[52:55]
ds_read_b128 a[0:3], v11 offset:0
v_cvt_pk_bf16_f32 v77, v78, v79
v_mfma_f32_16x16x32_bf16 v[52:55], a[156:159], a[60:63], v[52:55]
ds_read_b128 a[4:7], v11 offset:256
ds_read_b128 a[8:11], v11 offset:512
v_mfma_f32_16x16x32_bf16 v[56:59], a[152:155], a[88:91], v[56:59]
ds_read_b128 a[12:15], v11 offset:768
ds_read_b128 a[16:19], v11 offset:1024
v_mfma_f32_16x16x32_bf16 v[56:59], a[156:159], a[92:95], v[56:59]
v_mul_f32 v48, s35, v48
v_mul_f32 v49, s35, v49
v_mfma_f32_16x16x32_bf16 v[60:63], a[152:155], a[120:123], v[60:63]
s_add_u32 s79, s44, 28672
v_exp_f32 v48, v48
v_mfma_f32_16x16x32_bf16 v[60:63], a[156:159], a[124:127], v[60:63]
s_waitcnt lgkmcnt(13)
ds_read_b64_tr_b16 a[152:153], v2 offset:41472
ds_read_b64_tr_b16 a[154:155], v2 offset:43520
v_mfma_f32_16x16x32_bf16 v[96:99], a[128:131], v[80:83], v[96:99]
ds_read_b64_tr_b16 a[156:157], v3 offset:41472
ds_read_b64_tr_b16 a[158:159], v3 offset:43520
v_mfma_f32_16x16x32_bf16 v[112:115], a[132:135], v[80:83], v[112:115]
v_exp_f32 v49, v49
v_mfma_f32_16x16x32_bf16 v[100:103], a[128:131], v[84:87], v[100:103]
v_mul_f32 v50, s35, v50
v_mul_f32 v51, s35, v51
v_mfma_f32_16x16x32_bf16 v[116:119], a[132:135], v[84:87], v[116:119]
v_exp_f32 v50, v50
v_mfma_f32_16x16x32_bf16 v[104:107], a[128:131], v[88:91], v[104:107]
buffer_load_dwordx4 v13, s[8:11], s42 offen offset:0 nt lds
v_mfma_f32_16x16x32_bf16 v[120:123], a[132:135], v[88:91], v[120:123]
v_exp_f32 v51, v51
v_mfma_f32_16x16x32_bf16 v[108:111], a[128:131], v[92:95], v[108:111]
ds_read_b128 a[20:23], v11 offset:1280
v_cvt_pk_bf16_f32 v66, v48, v49
v_mfma_f32_16x16x32_bf16 v[124:127], a[132:135], v[92:95], v[124:127]
s_waitcnt lgkmcnt(14)
ds_read_b64_tr_b16 a[128:129], v2 offset:36864
ds_read_b64_tr_b16 a[130:131], v2 offset:38912
v_mfma_f32_16x16x32_bf16 v[128:131], a[136:139], v[80:83], v[128:131]
ds_read_b64_tr_b16 a[132:133], v3 offset:36864
ds_read_b64_tr_b16 a[134:135], v3 offset:38912
v_mfma_f32_16x16x32_bf16 v[144:147], a[140:143], v[80:83], v[144:147]
ds_read_b128 a[24:27], v11 offset:1536
v_cvt_pk_bf16_f32 v67, v50, v51
v_mfma_f32_16x16x32_bf16 v[132:135], a[136:139], v[84:87], v[132:135]
v_mul_f32 v52, s35, v52
v_mul_f32 v53, s35, v53
v_mfma_f32_16x16x32_bf16 v[148:151], a[140:143], v[84:87], v[148:151]
v_exp_f32 v52, v52
v_mfma_f32_16x16x32_bf16 v[136:139], a[136:139], v[88:91], v[136:139]
buffer_load_dwordx4 v13, s[8:11], s42 offen offset:2048 nt lds
v_mfma_f32_16x16x32_bf16 v[152:155], a[140:143], v[88:91], v[152:155]
s_add_u32 m0, s27, 4864
ds_read_b128 a[28:31], v11 offset:1792
v_mul_f32 v54, s35, v54
v_mfma_f32_16x16x32_bf16 v[140:143], a[136:139], v[92:95], v[140:143]
v_exp_f32 v53, v53
v_mfma_f32_16x16x32_bf16 v[156:159], a[140:143], v[92:95], v[156:159]
s_waitcnt lgkmcnt(15)
ds_read_b64_tr_b16 a[136:137], v2 offset:37376
v_mul_f32 v55, s35, v55
v_mfma_f32_16x16x32_bf16 a[160:163], a[144:147], v[80:83], a[160:163]
v_exp_f32 v54, v54
v_mfma_f32_16x16x32_bf16 a[176:179], a[148:151], v[80:83], a[176:179]
v_exp_f32 v55, v55
v_mfma_f32_16x16x32_bf16 a[164:167], a[144:147], v[84:87], a[164:167]
ds_read_b64_tr_b16 a[138:139], v2 offset:39424
ds_read_b64_tr_b16 a[140:141], v3 offset:37376
v_mfma_f32_16x16x32_bf16 a[180:183], a[148:151], v[84:87], a[180:183]
ds_read_b64_tr_b16 a[142:143], v3 offset:39424
v_cvt_pk_bf16_f32 v70, v52, v53
v_mfma_f32_16x16x32_bf16 a[168:171], a[144:147], v[88:91], a[168:171]
v_cvt_pk_bf16_f32 v71, v54, v55
v_mul_f32 v56, s35, v56
v_mfma_f32_16x16x32_bf16 a[184:187], a[148:151], v[88:91], a[184:187]
v_mul_f32 v57, s35, v57
v_mul_f32 v58, s35, v58
v_mfma_f32_16x16x32_bf16 a[172:175], a[144:147], v[92:95], a[172:175]
v_exp_f32 v56, v56
v_mfma_f32_16x16x32_bf16 a[188:191], a[148:151], v[92:95], a[188:191]
s_waitcnt lgkmcnt(11)
v_exp_f32 v57, v57
v_mfma_f32_16x16x32_bf16 a[192:195], a[152:155], v[80:83], a[192:195]
buffer_load_dwordx4 v13, s[8:11], s42 offen offset:256 nt lds
v_mfma_f32_16x16x32_bf16 a[208:211], a[156:159], v[80:83], a[208:211]
ds_read_b64_tr_b16 a[144:145], v2 offset:45056
v_mul_f32 v59, s35, v59
v_mfma_f32_16x16x32_bf16 a[196:199], a[152:155], v[84:87], a[196:199]
v_exp_f32 v58, v58
v_mfma_f32_16x16x32_bf16 a[212:215], a[156:159], v[84:87], a[212:215]
v_exp_f32 v59, v59
v_mfma_f32_16x16x32_bf16 a[200:203], a[152:155], v[88:91], a[200:203]
ds_read_b64_tr_b16 a[146:147], v2 offset:47104
ds_read_b64_tr_b16 a[148:149], v3 offset:45056
v_mfma_f32_16x16x32_bf16 a[216:219], a[156:159], v[88:91], a[216:219]
ds_read_b64_tr_b16 a[150:151], v3 offset:47104
v_cvt_pk_bf16_f32 v74, v56, v57
v_mfma_f32_16x16x32_bf16 a[204:207], a[152:155], v[92:95], a[204:207]
v_cvt_pk_bf16_f32 v75, v58, v59
v_mul_f32 v60, s35, v60
v_mfma_f32_16x16x32_bf16 a[220:223], a[156:159], v[92:95], a[220:223]
s_waitcnt lgkmcnt(10)
buffer_load_dwordx4 v13, s[8:11], s42 offen offset:2304 nt lds
v_mfma_f32_16x16x32_bf16 v[96:99], a[128:131], v[64:67], v[96:99]
s_waitcnt lgkmcnt(8)
v_mul_f32 v61, s35, v61
v_mul_f32 v62, s35, v62
v_mfma_f32_16x16x32_bf16 v[112:115], a[132:135], v[64:67], v[112:115]
s_add_u32 m0, s26, 0
v_exp_f32 v60, v60
v_mfma_f32_16x16x32_bf16 v[100:103], a[128:131], v[68:71], v[100:103]
v_exp_f32 v61, v61
v_mfma_f32_16x16x32_bf16 v[116:119], a[132:135], v[68:71], v[116:119]
v_mul_f32 v63, s35, v63
v_exp_f32 v62, v62
v_exp_f32 v63, v63
v_mfma_f32_16x16x32_bf16 v[104:107], a[128:131], v[72:75], v[104:107]
v_cvt_pk_bf16_f32 v78, v60, v61
v_cvt_pk_bf16_f32 v79, v62, v63
v_mfma_f32_16x16x32_bf16 v[120:123], a[132:135], v[72:75], v[120:123]
ds_read_b64_tr_b16 a[152:153], v2 offset:45568
ds_read_b64_tr_b16 a[154:155], v2 offset:47616
ds_read_b64_tr_b16 a[156:157], v3 offset:45568
ds_read_b64_tr_b16 a[158:159], v3 offset:47616
v_mfma_f32_16x16x32_bf16 v[108:111], a[128:131], v[76:79], v[108:111]
s_waitcnt vmcnt(8)
v_add_f32 v6, v6, v48
v_add_f32 v6, v6, v49
v_mfma_f32_16x16x32_bf16 v[124:127], a[132:135], v[76:79], v[124:127]
s_waitcnt lgkmcnt(8)
ds_read_b64_tr_b16 a[128:129], v2 offset:49152
v_add_f32 v6, v6, v50
v_mfma_f32_16x16x32_bf16 v[128:131], a[136:139], v[64:67], v[128:131]
ds_read_b64_tr_b16 a[130:131], v2 offset:51200
ds_read_b64_tr_b16 a[132:133], v2 offset:53248
v_mfma_f32_16x16x32_bf16 v[144:147], a[140:143], v[64:67], v[144:147]
ds_read_b64_tr_b16 a[134:135], v2 offset:55296
v_add_f32 v6, v6, v51
v_mfma_f32_16x16x32_bf16 v[132:135], a[136:139], v[68:71], v[132:135]
v_add_f32 v7, v7, v52
v_add_u32 v10, s39, v1
v_mfma_f32_16x16x32_bf16 v[148:151], a[140:143], v[68:71], v[148:151]
v_add_f32 v7, v7, v53
v_add_f32 v7, v7, v54
v_mfma_f32_16x16x32_bf16 v[136:139], a[136:139], v[72:75], v[136:139]
buffer_load_dwordx4 v12, s[8:11], s43 offen offset:0 nt lds
v_mfma_f32_16x16x32_bf16 v[152:155], a[140:143], v[72:75], v[152:155]
ds_read_b128 a[32:35], v10 offset:0
v_add_f32 v7, v7, v55
v_mfma_f32_16x16x32_bf16 v[140:143], a[136:139], v[76:79], v[140:143]
s_mov_b32 s44, s48
ds_read_b128 a[36:39], v10 offset:256
v_add_f32 v8, v8, v56
v_mfma_f32_16x16x32_bf16 v[156:159], a[140:143], v[76:79], v[156:159]
s_waitcnt lgkmcnt(10)
ds_read_b64_tr_b16 a[136:137], v3 offset:49152
ds_read_b64_tr_b16 a[138:139], v3 offset:51200
v_mfma_f32_16x16x32_bf16 a[160:163], a[144:147], v[64:67], a[160:163]
s_add_u32 s30, s49, 262144
ds_read_b64_tr_b16 a[140:141], v3 offset:53248
ds_read_b64_tr_b16 a[142:143], v3 offset:55296
v_mfma_f32_16x16x32_bf16 a[176:179], a[148:151], v[64:67], a[176:179]
s_mov_b32 s70, s50
buffer_load_dwordx4 v12, s[8:11], s43 offen offset:2048 nt lds
v_mfma_f32_16x16x32_bf16 a[164:167], a[144:147], v[68:71], a[164:167]
s_add_u32 m0, s26, 768
ds_read_b128 a[40:43], v10 offset:512
v_add_f32 v8, v8, v57
v_mfma_f32_16x16x32_bf16 a[180:183], a[148:151], v[68:71], a[180:183]
v_add_f32 v8, v8, v58
v_add_f32 v8, v8, v59
v_mfma_f32_16x16x32_bf16 a[168:171], a[144:147], v[72:75], a[168:171]
ds_read_b128 a[44:47], v10 offset:768
v_add_f32 v9, v9, v60
v_mfma_f32_16x16x32_bf16 a[184:187], a[148:151], v[72:75], a[184:187]
s_mov_b32 s31, s53
ds_read_b128 a[48:51], v10 offset:1024
v_add_f32 v9, v9, v61
v_mfma_f32_16x16x32_bf16 a[172:175], a[144:147], v[76:79], a[172:175]
buffer_load_dwordx4 v12, s[8:11], s43 offen offset:256 nt lds
v_mfma_f32_16x16x32_bf16 a[188:191], a[148:151], v[76:79], a[188:191]
s_waitcnt lgkmcnt(13)
ds_read_b64_tr_b16 a[144:145], v2 offset:49664
ds_read_b64_tr_b16 a[146:147], v2 offset:51712
v_mfma_f32_16x16x32_bf16 a[192:195], a[152:155], v[64:67], a[192:195]
ds_read_b64_tr_b16 a[148:149], v2 offset:53760
ds_read_b64_tr_b16 a[150:151], v2 offset:55808
v_mfma_f32_16x16x32_bf16 a[208:211], a[156:159], v[64:67], a[208:211]
s_mov_b32 s94, s52
ds_read_b128 a[52:55], v10 offset:1280
v_add_f32 v9, v9, v62
v_mfma_f32_16x16x32_bf16 a[196:199], a[152:155], v[68:71], a[196:199]
ds_read_b128 a[56:59], v10 offset:1536
v_add_f32 v9, v9, v63
v_mfma_f32_16x16x32_bf16 a[212:215], a[156:159], v[68:71], a[212:215]
v_mfma_f32_16x16x32_bf16 a[200:203], a[152:155], v[72:75], a[200:203]
buffer_load_dwordx4 v12, s[8:11], s43 offen offset:2304 nt lds
v_mfma_f32_16x16x32_bf16 a[216:219], a[156:159], v[72:75], a[216:219]
s_add_u32 s41, s52, 8192
v_permlane16_swap_b32 v6, v7
v_mfma_f32_16x16x32_bf16 a[204:207], a[152:155], v[76:79], a[204:207]
v_permlane16_swap_b32 v8, v9
v_mfma_f32_16x16x32_bf16 a[220:223], a[156:159], v[76:79], a[220:223]
s_waitcnt lgkmcnt(15)
ds_read_b64_tr_b16 a[152:153], v3 offset:49664
ds_read_b64_tr_b16 a[154:155], v3 offset:51712
v_mfma_f32_16x16x32_bf16 a[224:227], a[128:131], v[80:83], a[224:227]
ds_read_b64_tr_b16 a[156:157], v3 offset:53760
ds_read_b64_tr_b16 a[158:159], v3 offset:55808
v_mfma_f32_16x16x32_bf16 a[224:227], a[132:135], v[64:67], a[224:227]
s_add_u32 m0, s26, 4096
ds_read_b128 a[60:63], v10 offset:1792
v_add_f32 v6, v6, v7
v_mfma_f32_16x16x32_bf16 a[228:231], a[128:131], v[84:87], a[228:231]
s_add_u32 s42, s52, 16384
v_add_f32 v8, v8, v9
v_mfma_f32_16x16x32_bf16 a[228:231], a[132:135], v[68:71], a[228:231]
v_mfma_f32_16x16x32_bf16 a[232:235], a[128:131], v[88:91], a[232:235]
v_permlane32_swap_b32 v6, v8
v_mfma_f32_16x16x32_bf16 a[232:235], a[132:135], v[72:75], a[232:235]
v_add_f32 v41, v6, v8
v_mfma_f32_16x16x32_bf16 a[236:239], a[128:131], v[92:95], a[236:239]
s_mov_b64 s[48:49], s[52:53]
v_rcp_f32 v32, v41
v_mfma_f32_16x16x32_bf16 a[236:239], a[132:135], v[76:79], a[236:239]
s_waitcnt lgkmcnt(14)
ds_read_b64_tr_b16 a[128:129], v2 offset:57344
ds_read_b64_tr_b16 a[130:131], v2 offset:59392
v_mfma_f32_16x16x32_bf16 a[240:243], a[136:139], v[80:83], a[240:243]
ds_read_b64_tr_b16 a[132:133], v2 offset:61440
ds_read_b64_tr_b16 a[134:135], v2 offset:63488
v_mfma_f32_16x16x32_bf16 a[240:243], a[140:143], v[64:67], a[240:243]
buffer_load_dwordx4 v13, s[8:11], s43 offen offset:0 nt lds
v_mfma_f32_16x16x32_bf16 a[244:247], a[136:139], v[84:87], a[244:247]
s_mov_b64 s[50:51], s[54:55]
v_mov_b32 v34, v32
v_mfma_f32_16x16x32_bf16 a[244:247], a[140:143], v[68:71], a[244:247]
v_mfma_f32_16x16x32_bf16 a[248:251], a[136:139], v[88:91], a[248:251]
v_permlane32_swap_b32 v32, v34
v_mfma_f32_16x16x32_bf16 a[248:251], a[140:143], v[72:75], a[248:251]
v_mov_b32 v33, v32
v_mov_b32 v35, v34
v_mfma_f32_16x16x32_bf16 a[252:255], a[136:139], v[92:95], a[252:255]
s_mov_b64 s[52:53], s[56:57]
buffer_load_dwordx4 v13, s[8:11], s43 offen offset:2048 nt lds
v_mfma_f32_16x16x32_bf16 a[252:255], a[140:143], v[76:79], a[252:255]
s_waitcnt lgkmcnt(11)
ds_read_b64_tr_b16 a[136:137], v3 offset:57344
ds_read_b64_tr_b16 a[138:139], v3 offset:59392
v_mfma_f32_16x16x32_bf16 v[160:163], a[144:147], v[80:83], v[160:163]
ds_read_b64_tr_b16 a[140:141], v3 offset:61440
ds_read_b64_tr_b16 a[142:143], v3 offset:63488
v_mfma_f32_16x16x32_bf16 v[160:163], a[148:151], v[64:67], v[160:163]
v_permlane16_swap_b32 v32, v33
v_mfma_f32_16x16x32_bf16 v[164:167], a[144:147], v[84:87], v[164:167]
s_add_u32 m0, s26, 4864
v_permlane16_swap_b32 v34, v35
v_mfma_f32_16x16x32_bf16 v[164:167], a[148:151], v[68:71], v[164:167]
s_mov_b64 s[54:55], s[58:59]
v_mfma_f32_16x16x32_bf16 v[168:171], a[144:147], v[88:91], v[168:171]
v_mfma_f32_16x16x32_bf16 v[168:171], a[148:151], v[72:75], v[168:171]
v_mul_f32 v96, v96, v32
v_mfma_f32_16x16x32_bf16 v[172:175], a[144:147], v[92:95], v[172:175]
s_mov_b64 s[56:57], s[60:61]
v_mul_f32 v97, v97, v32
v_mul_f32 v98, v98, v32
v_mfma_f32_16x16x32_bf16 v[172:175], a[148:151], v[76:79], v[172:175]
s_waitcnt lgkmcnt(9)
ds_read_b64_tr_b16 a[144:145], v2 offset:57856
ds_read_b64_tr_b16 a[146:147], v2 offset:59904
v_mfma_f32_16x16x32_bf16 v[176:179], a[152:155], v[80:83], v[176:179]
ds_read_b64_tr_b16 a[148:149], v2 offset:61952
ds_read_b64_tr_b16 a[150:151], v2 offset:64000
v_mfma_f32_16x16x32_bf16 v[176:179], a[156:159], v[64:67], v[176:179]
v_mul_f32 v99, v99, v32
v_cvt_pk_bf16_f32 v96, v96, v97
v_mfma_f32_16x16x32_bf16 v[180:183], a[152:155], v[84:87], v[180:183]
s_mov_b64 s[58:59], s[62:63]
buffer_load_dwordx4 v13, s[8:11], s43 offen offset:256 nt lds
v_mfma_f32_16x16x32_bf16 v[180:183], a[156:159], v[68:71], v[180:183]
v_cvt_pk_bf16_f32 v97, v98, v99
v_mul_f32 v100, v100, v33
v_mfma_f32_16x16x32_bf16 v[184:187], a[152:155], v[88:91], v[184:187]
v_mul_f32 v101, v101, v33
v_mul_f32 v102, v102, v33
v_mfma_f32_16x16x32_bf16 v[184:187], a[156:159], v[72:75], v[184:187]
v_mul_f32 v103, v103, v33
v_cvt_pk_bf16_f32 v100, v100, v101
v_mfma_f32_16x16x32_bf16 v[188:191], a[152:155], v[92:95], v[188:191]
v_cvt_pk_bf16_f32 v101, v102, v103
v_mul_f32 v112, v112, v32
v_mfma_f32_16x16x32_bf16 v[188:191], a[156:159], v[76:79], v[188:191]
s_waitcnt lgkmcnt(8)
ds_read_b64_tr_b16 a[152:153], v3 offset:57856
ds_read_b64_tr_b16 a[154:155], v3 offset:59904
v_mfma_f32_16x16x32_bf16 v[192:195], a[128:131], v[80:83], v[192:195]
s_mov_b32 s36, 3
ds_read_b64_tr_b16 a[156:157], v3 offset:61952
ds_read_b64_tr_b16 a[158:159], v3 offset:64000
v_mfma_f32_16x16x32_bf16 v[192:195], a[132:135], v[64:67], v[192:195]
v_mul_f32 v113, v113, v32
v_mul_f32 v114, v114, v32
v_mfma_f32_16x16x32_bf16 v[196:199], a[128:131], v[84:87], v[196:199]
v_mul_f32 v115, v115, v32
v_cvt_pk_bf16_f32 v112, v112, v113
v_mfma_f32_16x16x32_bf16 v[196:199], a[132:135], v[68:71], v[196:199]
s_mov_b32 s90, s42
buffer_load_dwordx4 v13, s[8:11], s43 offen offset:2304 nt lds
v_mfma_f32_16x16x32_bf16 v[200:203], a[128:131], v[88:91], v[200:203]
v_cvt_pk_bf16_f32 v113, v114, v115
v_mul_f32 v116, v116, v33
v_mfma_f32_16x16x32_bf16 v[200:203], a[132:135], v[72:75], v[200:203]
v_mul_f32 v117, v117, v33
v_mul_f32 v118, v118, v33
v_mfma_f32_16x16x32_bf16 v[204:207], a[128:131], v[92:95], v[204:207]
v_mul_f32 v119, v119, v33
v_cvt_pk_bf16_f32 v116, v116, v117
v_mfma_f32_16x16x32_bf16 v[204:207], a[132:135], v[76:79], v[204:207]
s_waitcnt lgkmcnt(0)
v_cvt_pk_bf16_f32 v117, v118, v119
v_mul_f32 v128, v128, v32
v_mfma_f32_16x16x32_bf16 v[208:211], a[136:139], v[80:83], v[208:211]
s_barrier
v_mfma_f32_16x16x32_bf16 v[208:211], a[140:143], v[64:67], v[208:211]
s_add_u32 s92, s34, s31
v_mul_f32 v129, v129, v32
v_mul_f32 v130, v130, v32
v_mfma_f32_16x16x32_bf16 v[212:215], a[136:139], v[84:87], v[212:215]
v_mul_f32 v131, v131, v32
v_cvt_pk_bf16_f32 v128, v128, v129
v_mfma_f32_16x16x32_bf16 v[212:215], a[140:143], v[68:71], v[212:215]
s_add_u32 s91, s92, 24576
v_accvgpr_read_b32 v48, a224
v_cvt_pk_bf16_f32 v129, v130, v131
v_mfma_f32_16x16x32_bf16 v[216:219], a[136:139], v[88:91], v[216:219]
v_accvgpr_read_b32 v49, a225
v_mul_f32 v132, v132, v33
v_mfma_f32_16x16x32_bf16 v[216:219], a[140:143], v[72:75], v[216:219]
v_mul_f32 v133, v133, v33
v_accvgpr_read_b32 v50, a226
v_mfma_f32_16x16x32_bf16 v[220:223], a[136:139], v[92:95], v[220:223]
v_mul_f32 v134, v134, v33
v_accvgpr_read_b32 v51, a227
v_mfma_f32_16x16x32_bf16 v[220:223], a[140:143], v[76:79], v[220:223]
v_mul_f32 v135, v135, v33
v_accvgpr_read_b32 v52, a228
v_mfma_f32_16x16x32_bf16 v[224:227], a[144:147], v[80:83], v[224:227]
s_mov_b32 s93, s26
v_cvt_pk_bf16_f32 v132, v132, v133
v_accvgpr_read_b32 v53, a229
v_mfma_f32_16x16x32_bf16 v[224:227], a[148:151], v[64:67], v[224:227]
v_cvt_pk_bf16_f32 v133, v134, v135
v_accvgpr_read_b32 v54, a230
v_mfma_f32_16x16x32_bf16 v[228:231], a[144:147], v[84:87], v[228:231]
v_mul_f32 v144, v144, v32
v_mul_f32 v145, v145, v32
v_mfma_f32_16x16x32_bf16 v[228:231], a[148:151], v[68:71], v[228:231]
s_mov_b32 s43, s51
v_accvgpr_read_b32 v55, a231
v_mul_f32 v146, v146, v32
v_mfma_f32_16x16x32_bf16 v[232:235], a[144:147], v[88:91], v[232:235]
v_accvgpr_read_b32 v56, a240
v_mul_f32 v147, v147, v32
v_mfma_f32_16x16x32_bf16 v[232:235], a[148:151], v[72:75], v[232:235]
v_accvgpr_read_b32 v57, a241
v_cvt_pk_bf16_f32 v144, v144, v145
v_mfma_f32_16x16x32_bf16 v[236:239], a[144:147], v[92:95], v[236:239]
v_accvgpr_read_b32 v58, a242
v_cvt_pk_bf16_f32 v145, v146, v147
v_mfma_f32_16x16x32_bf16 v[236:239], a[148:151], v[76:79], v[236:239]
v_accvgpr_read_b32 v59, a243
v_mul_f32 v148, v148, v33
v_mfma_f32_16x16x32_bf16 v[240:243], a[152:155], v[80:83], v[240:243]
v_mul_f32 v149, v149, v33
v_accvgpr_read_b32 v60, a244
v_mfma_f32_16x16x32_bf16 v[240:243], a[156:159], v[64:67], v[240:243]
v_mul_f32 v150, v150, v33
v_accvgpr_read_b32 v61, a245
v_mfma_f32_16x16x32_bf16 v[244:247], a[152:155], v[84:87], v[244:247]
v_mul_f32 v151, v151, v33
v_accvgpr_read_b32 v62, a246
v_mfma_f32_16x16x32_bf16 v[244:247], a[156:159], v[68:71], v[244:247]
v_cvt_pk_bf16_f32 v148, v148, v149
v_accvgpr_read_b32 v63, a247
v_mfma_f32_16x16x32_bf16 v[248:251], a[152:155], v[88:91], v[248:251]
v_cvt_pk_bf16_f32 v149, v150, v151
v_mul_f32 v104, v104, v34
v_mfma_f32_16x16x32_bf16 v[248:251], a[156:159], v[72:75], v[248:251]
v_mul_f32 v105, v105, v34
v_mul_f32 v106, v106, v34
v_mfma_f32_16x16x32_bf16 v[252:255], a[152:155], v[92:95], v[252:255]
v_mul_f32 v107, v107, v34
v_cvt_pk_bf16_f32 v104, v104, v105
v_mfma_f32_16x16x32_bf16 v[252:255], a[156:159], v[76:79], v[252:255]
v_cvt_pk_bf16_f32 v105, v106, v107
v_mul_f32 v108, v108, v35
v_mul_f32 v109, v109, v35
v_mul_f32 v110, v110, v35
v_mul_f32 v111, v111, v35
v_cvt_pk_bf16_f32 v108, v108, v109
v_cvt_pk_bf16_f32 v109, v110, v111
v_cmp_ngt_f32 vcc, 0x58800000, v41
ds_write2st64_b64 v15, v[96:97], v[100:101] offset0:0 offset1:2
ds_write2st64_b64 v37, v[112:113], v[116:117] offset0:0 offset1:2
s_cbranch_vccz L_noflag4
s_bitset1_b32 s38, s37
L_noflag4:
ds_write2st64_b64 v38, v[128:129], v[132:133] offset0:0 offset1:2
s_add_u32 m0, s25, 32768
s_nop 0
buffer_load_dwordx4 v4, s[12:15], s29 offen offset:0 lds
s_add_u32 m0, s25, 33536
s_nop 0
buffer_load_dwordx4 v4, s[12:15], s29 offen offset:256 lds
s_add_u32 s29, s29, 8192
ds_write2st64_b64 v39, v[144:145], v[148:149] offset0:0 offset1:2
ds_read2st64_b64 v[96:99], v40 offset0:0 offset1:8
ds_write2st64_b64 v15, v[104:105], v[108:109] offset0:4 offset1:6
v_accvgpr_read_b32 v64, a232
v_accvgpr_read_b32 v65, a233
v_pk_mul_f32 v[120:121], v[120:121], v[34:35] op_sel:[0,0] op_sel_hi:[1,0]
v_pk_mul_f32 v[122:123], v[122:123], v[34:35] op_sel:[0,0] op_sel_hi:[1,0]
v_cvt_pk_bf16_f32 v120, v120, v121
v_cvt_pk_bf16_f32 v121, v122, v123
ds_read2st64_b64 v[112:115], v42 offset0:1 offset1:9
v_accvgpr_read_b32 v66, a234
v_pk_mul_f32 v[124:125], v[124:125], v[34:35] op_sel:[0,1] op_sel_hi:[1,1]
v_pk_mul_f32 v[126:127], v[126:127], v[34:35] op_sel:[0,1] op_sel_hi:[1,1]
v_cvt_pk_bf16_f32 v124, v124, v125
v_cvt_pk_bf16_f32 v125, v126, v127
ds_write2st64_b64 v37, v[120:121], v[124:125] offset0:4 offset1:6
v_accvgpr_read_b32 v67, a235
v_accvgpr_read_b32 v68, a236
v_pk_mul_f32 v[136:137], v[136:137], v[34:35] op_sel:[0,0] op_sel_hi:[1,0]
v_pk_mul_f32 v[138:139], v[138:139], v[34:35] op_sel:[0,0] op_sel_hi:[1,0]
v_cvt_pk_bf16_f32 v136, v136, v137
v_cvt_pk_bf16_f32 v137, v138, v139
ds_read2st64_b64 v[100:103], v40 offset0:2 offset1:10
s_waitcnt lgkmcnt(4)
buffer_store_dwordx4 v[96:99], v14, s[20:23], s72 offen offset:0
v_accvgpr_read_b32 v69, a237
v_accvgpr_read_b32 v70, a238
v_pk_mul_f32 v[140:141], v[140:141], v[34:35] op_sel:[0,1] op_sel_hi:[1,1]
v_pk_mul_f32 v[142:143], v[142:143], v[34:35] op_sel:[0,1] op_sel_hi:[1,1]
v_cvt_pk_bf16_f32 v140, v140, v141
v_cvt_pk_bf16_f32 v141, v142, v143
ds_write2st64_b64 v38, v[136:137], v[140:141] offset0:4 offset1:6
v_accvgpr_read_b32 v71, a239
v_pk_mul_f32 v[152:153], v[152:153], v[34:35] op_sel:[0,0] op_sel_hi:[1,0]
v_pk_mul_f32 v[154:155], v[154:155], v[34:35] op_sel:[0,0] op_sel_hi:[1,0]
v_cvt_pk_bf16_f32 v152, v152, v153
v_cvt_pk_bf16_f32 v153, v154, v155
ds_read2st64_b64 v[116:119], v42 offset0:3 offset1:11
s_waitcnt lgkmcnt(4)
buffer_store_dwordx4 v[112:115], v14, s[20:23], s73 offen offset:0
v_accvgpr_read_b32 v72, a248
v_accvgpr_read_b32 v73, a249
v_pk_mul_f32 v[156:157], v[156:157], v[34:35] op_sel:[0,1] op_sel_hi:[1,1]
v_pk_mul_f32 v[158:159], v[158:159], v[34:35] op_sel:[0,1] op_sel_hi:[1,1]
v_cvt_pk_bf16_f32 v156, v156, v157
v_cvt_pk_bf16_f32 v157, v158, v159
ds_write2st64_b64 v39, v[152:153], v[156:157] offset0:4 offset1:6
v_accvgpr_read_b32 v74, a250
v_pk_mul_f32 v[192:193], v[192:193], v[32:33] op_sel:[0,0] op_sel_hi:[1,0]
v_pk_mul_f32 v[194:195], v[194:195], v[32:33] op_sel:[0,0] op_sel_hi:[1,0]
v_cvt_pk_bf16_f32 v192, v192, v193
v_cvt_pk_bf16_f32 v193, v194, v195
ds_read2st64_b64 v[104:107], v40 offset0:4 offset1:12
s_waitcnt lgkmcnt(4)
buffer_store_dwordx4 v[100:103], v14, s[20:23], s74 offen offset:0
v_accvgpr_read_b32 v75, a251
v_accvgpr_read_b32 v76, a252
v_pk_mul_f32 v[196:197], v[196:197], v[32:33] op_sel:[0,1] op_sel_hi:[1,1]
v_pk_mul_f32 v[198:199], v[198:199], v[32:33] op_sel:[0,1] op_sel_hi:[1,1]
v_cvt_pk_bf16_f32 v196, v196, v197
v_cvt_pk_bf16_f32 v197, v198, v199
ds_write2st64_b64 v15, v[192:193], v[196:197] offset0:0 offset1:2
ds_read_b128 a[128:131], v1 offset:8192
ds_read_b128 a[132:135], v1 offset:8448
ds_read_b128 a[136:139], v1 offset:8704
ds_read_b128 a[140:143], v1 offset:8960
ds_read_b128 a[144:147], v1 offset:9216
ds_read_b128 a[148:151], v1 offset:9472
v_accvgpr_read_b32 v77, a253
v_pk_mul_f32 v[208:209], v[208:209], v[32:33] op_sel:[0,0] op_sel_hi:[1,0]
v_pk_mul_f32 v[210:211], v[210:211], v[32:33] op_sel:[0,0] op_sel_hi:[1,0]
v_cvt_pk_bf16_f32 v208, v208, v209
v_cvt_pk_bf16_f32 v209, v210, v211
s_add_u32 m0, s25, 40960
s_nop 0
buffer_load_dwordx4 v4, s[12:15], s29 offen offset:0 lds
s_add_u32 m0, s25, 41728
s_nop 0
buffer_load_dwordx4 v4, s[12:15], s29 offen offset:256 lds
s_add_u32 s29, s29, 8192
ds_read2st64_b64 v[120:123], v42 offset0:5 offset1:13
s_waitcnt lgkmcnt(10)
buffer_store_dwordx4 v[116:119], v14, s[20:23], s75 offen offset:0
v_accvgpr_read_b32 v78, a254
v_accvgpr_read_b32 v79, a255
v_pk_mul_f32 v[212:213], v[212:213], v[32:33] op_sel:[0,1] op_sel_hi:[1,1]
v_pk_mul_f32 v[214:215], v[214:215], v[32:33] op_sel:[0,1] op_sel_hi:[1,1]
v_cvt_pk_bf16_f32 v212, v212, v213
v_cvt_pk_bf16_f32 v213, v214, v215
ds_write2st64_b64 v37, v[208:209], v[212:213] offset0:0 offset1:2
v_accvgpr_read_b32 v80, a160
v_accvgpr_read_b32 v81, a161
v_pk_mul_f32 v[224:225], v[224:225], v[32:33] op_sel:[0,0] op_sel_hi:[1,0]
v_pk_mul_f32 v[226:227], v[226:227], v[32:33] op_sel:[0,0] op_sel_hi:[1,0]
v_cvt_pk_bf16_f32 v224, v224, v225
v_cvt_pk_bf16_f32 v225, v226, v227
ds_read2st64_b64 v[108:111], v40 offset0:6 offset1:14
s_waitcnt lgkmcnt(10)
buffer_store_dwordx4 v[104:107], v14, s[20:23], s76 offen offset:0
v_accvgpr_read_b32 v82, a162
v_pk_mul_f32 v[228:229], v[228:229], v[32:33] op_sel:[0,1] op_sel_hi:[1,1]
v_pk_mul_f32 v[230:231], v[230:231], v[32:33] op_sel:[0,1] op_sel_hi:[1,1]
v_cvt_pk_bf16_f32 v228, v228, v229
v_cvt_pk_bf16_f32 v229, v230, v231
ds_write2st64_b64 v38, v[224:225], v[228:229] offset0:0 offset1:2
v_accvgpr_read_b32 v83, a163
v_accvgpr_read_b32 v84, a164
v_pk_mul_f32 v[240:241], v[240:241], v[32:33] op_sel:[0,0] op_sel_hi:[1,0]
v_pk_mul_f32 v[242:243], v[242:243], v[32:33] op_sel:[0,0] op_sel_hi:[1,0]
v_cvt_pk_bf16_f32 v240, v240, v241
v_cvt_pk_bf16_f32 v241, v242, v243
ds_read2st64_b64 v[124:127], v42 offset0:7 offset1:15
s_waitcnt lgkmcnt(4)
buffer_store_dwordx4 v[120:123], v14, s[20:23], s77 offen offset:0
v_accvgpr_read_b32 v85, a165
v_pk_mul_f32 v[244:245], v[244:245], v[32:33] op_sel:[0,1] op_sel_hi:[1,1]
v_pk_mul_f32 v[246:247], v[246:247], v[32:33] op_sel:[0,1] op_sel_hi:[1,1]
v_cvt_pk_bf16_f32 v244, v244, v245
v_cvt_pk_bf16_f32 v245, v246, v247
ds_write2st64_b64 v39, v[240:241], v[244:245] offset0:0 offset1:2
v_accvgpr_read_b32 v86, a166
v_accvgpr_read_b32 v87, a167
v_pk_mul_f32 v[200:201], v[200:201], v[34:35] op_sel:[0,0] op_sel_hi:[1,0]
v_pk_mul_f32 v[202:203], v[202:203], v[34:35] op_sel:[0,0] op_sel_hi:[1,0]
v_cvt_pk_bf16_f32 v200, v200, v201
v_cvt_pk_bf16_f32 v201, v202, v203
ds_read2st64_b64 v[192:195], v40 offset0:0 offset1:8
s_waitcnt lgkmcnt(4)
buffer_store_dwordx4 v[108:111], v14, s[20:23], s78 offen offset:0
v_accvgpr_read_b32 v88, a176
v_pk_mul_f32 v[204:205], v[204:205], v[34:35] op_sel:[0,1] op_sel_hi:[1,1]
v_pk_mul_f32 v[206:207], v[206:207], v[34:35] op_sel:[0,1] op_sel_hi:[1,1]
v_cvt_pk_bf16_f32 v204, v204, v205
v_cvt_pk_bf16_f32 v205, v206, v207
ds_write2st64_b64 v15, v[200:201], v[204:205] offset0:4 offset1:6
v_accvgpr_read_b32 v89, a177
v_accvgpr_read_b32 v90, a178
v_pk_mul_f32 v[216:217], v[216:217], v[34:35] op_sel:[0,0] op_sel_hi:[1,0]
v_pk_mul_f32 v[218:219], v[218:219], v[34:35] op_sel:[0,0] op_sel_hi:[1,0]
v_cvt_pk_bf16_f32 v216, v216, v217
v_cvt_pk_bf16_f32 v217, v218, v219
ds_read2st64_b64 v[208:211], v42 offset0:1 offset1:9
s_waitcnt lgkmcnt(4)
buffer_store_dwordx4 v[124:127], v14, s[20:23], s79 offen offset:0
v_accvgpr_read_b32 v91, a179
v_accvgpr_read_b32 v92, a180
v_pk_mul_f32 v[220:221], v[220:221], v[34:35] op_sel:[0,1] op_sel_hi:[1,1]
v_pk_mul_f32 v[222:223], v[222:223], v[34:35] op_sel:[0,1] op_sel_hi:[1,1]
v_cvt_pk_bf16_f32 v220, v220, v221
v_cvt_pk_bf16_f32 v221, v222, v223
ds_write2st64_b64 v37, v[216:217], v[220:221] offset0:4 offset1:6
v_accvgpr_read_b32 v93, a181
v_pk_mul_f32 v[232:233], v[232:233], v[34:35] op_sel:[0,0] op_sel_hi:[1,0]
v_pk_mul_f32 v[234:235], v[234:235], v[34:35] op_sel:[0,0] op_sel_hi:[1,0]
v_cvt_pk_bf16_f32 v232, v232, v233
v_cvt_pk_bf16_f32 v233, v234, v235
ds_read2st64_b64 v[196:199], v40 offset0:2 offset1:10
s_waitcnt lgkmcnt(4)
buffer_store_dwordx4 v[192:195], v14, s[20:23], s72 offen offset:384
v_accvgpr_read_b32 v94, a182
v_accvgpr_read_b32 v95, a183
v_pk_mul_f32 v[236:237], v[236:237], v[34:35] op_sel:[0,1] op_sel_hi:[1,1]
v_pk_mul_f32 v[238:239], v[238:239], v[34:35] op_sel:[0,1] op_sel_hi:[1,1]
v_cvt_pk_bf16_f32 v236, v236, v237
v_cvt_pk_bf16_f32 v237, v238, v239
ds_write2st64_b64 v38, v[232:233], v[236:237] offset0:4 offset1:6
v_pk_mul_f32 v[248:249], v[248:249], v[34:35] op_sel:[0,0] op_sel_hi:[1,0]
v_pk_mul_f32 v[250:251], v[250:251], v[34:35] op_sel:[0,0] op_sel_hi:[1,0]
v_cvt_pk_bf16_f32 v248, v248, v249
v_cvt_pk_bf16_f32 v249, v250, v251
s_add_u32 m0, s25, 49152
s_nop 0
buffer_load_dwordx4 v4, s[12:15], s29 offen offset:0 lds
s_add_u32 m0, s25, 49920
s_nop 0
buffer_load_dwordx4 v4, s[12:15], s29 offen offset:256 lds
s_add_u32 s29, s29, 8192
ds_read2st64_b64 v[212:215], v42 offset0:3 offset1:11
s_waitcnt lgkmcnt(4)
buffer_store_dwordx4 v[208:211], v14, s[20:23], s73 offen offset:384
v_pk_mul_f32 v[252:253], v[252:253], v[34:35] op_sel:[0,1] op_sel_hi:[1,1]
v_pk_mul_f32 v[254:255], v[254:255], v[34:35] op_sel:[0,1] op_sel_hi:[1,1]
v_cvt_pk_bf16_f32 v252, v252, v253
v_cvt_pk_bf16_f32 v253, v254, v255
ds_write2st64_b64 v39, v[248:249], v[252:253] offset0:4 offset1:6
v_pk_mul_f32 v[160:161], v[160:161], v[32:33] op_sel:[0,0] op_sel_hi:[1,0]
v_pk_mul_f32 v[162:163], v[162:163], v[32:33] op_sel:[0,0] op_sel_hi:[1,0]
v_cvt_pk_bf16_f32 v160, v160, v161
v_cvt_pk_bf16_f32 v161, v162, v163
ds_read2st64_b64 v[200:203], v40 offset0:4 offset1:12
s_waitcnt lgkmcnt(4)
buffer_store_dwordx4 v[196:199], v14, s[20:23], s74 offen offset:384
v_pk_mul_f32 v[164:165], v[164:165], v[32:33] op_sel:[0,1] op_sel_hi:[1,1]
v_pk_mul_f32 v[166:167], v[166:167], v[32:33] op_sel:[0,1] op_sel_hi:[1,1]
v_cvt_pk_bf16_f32 v164, v164, v165
v_cvt_pk_bf16_f32 v165, v166, v167
ds_write2st64_b64 v38, v[160:161], v[164:165] offset0:0 offset1:2
s_waitcnt vmcnt(25)
v_add_u32 v10, s27, v1
ds_read_b128 a[64:67], v10 offset:0
ds_read_b128 a[68:71], v10 offset:256
ds_read_b128 a[72:75], v10 offset:512
ds_read_b128 a[76:79], v10 offset:768
v_pk_mul_f32 v[176:177], v[176:177], v[32:33] op_sel:[0,0] op_sel_hi:[1,0]
v_pk_mul_f32 v[178:179], v[178:179], v[32:33] op_sel:[0,0] op_sel_hi:[1,0]
v_cvt_pk_bf16_f32 v176, v176, v177
v_cvt_pk_bf16_f32 v177, v178, v179
ds_read2st64_b64 v[216:219], v42 offset0:5 offset1:13
s_waitcnt lgkmcnt(8)
buffer_store_dwordx4 v[212:215], v14, s[20:23], s75 offen offset:384
v_pk_mul_f32 v[180:181], v[180:181], v[32:33] op_sel:[0,1] op_sel_hi:[1,1]
v_pk_mul_f32 v[182:183], v[182:183], v[32:33] op_sel:[0,1] op_sel_hi:[1,1]
v_cvt_pk_bf16_f32 v180, v180, v181
v_cvt_pk_bf16_f32 v181, v182, v183
ds_write2st64_b64 v39, v[176:177], v[180:181] offset0:0 offset1:2
v_pk_mul_f32 v[48:49], v[48:49], v[32:33] op_sel:[0,0] op_sel_hi:[1,0]
v_pk_mul_f32 v[50:51], v[50:51], v[32:33] op_sel:[0,0] op_sel_hi:[1,0]
v_cvt_pk_bf16_f32 v48, v48, v49
v_cvt_pk_bf16_f32 v49, v50, v51
ds_read2st64_b64 v[204:207], v40 offset0:6 offset1:14
s_waitcnt lgkmcnt(8)
buffer_store_dwordx4 v[200:203], v14, s[20:23], s76 offen offset:384
v_pk_mul_f32 v[52:53], v[52:53], v[32:33] op_sel:[0,1] op_sel_hi:[1,1]
v_pk_mul_f32 v[54:55], v[54:55], v[32:33] op_sel:[0,1] op_sel_hi:[1,1]
v_cvt_pk_bf16_f32 v52, v52, v53
v_cvt_pk_bf16_f32 v53, v54, v55
ds_write2st64_b64 v15, v[48:49], v[52:53] offset0:0 offset1:2
ds_read_b128 a[80:83], v10 offset:1024
ds_read_b128 a[84:87], v10 offset:1280
ds_read_b128 a[88:91], v10 offset:1536
ds_read_b128 a[92:95], v10 offset:1792
v_accvgpr_read_b32 v48, a192
v_accvgpr_read_b32 v49, a193
v_accvgpr_read_b32 v50, a194
v_accvgpr_read_b32 v51, a195
v_accvgpr_read_b32 v52, a196
v_accvgpr_read_b32 v53, a197
v_accvgpr_read_b32 v54, a198
v_accvgpr_read_b32 v55, a199
v_pk_mul_f32 v[56:57], v[56:57], v[32:33] op_sel:[0,0] op_sel_hi:[1,0]
v_pk_mul_f32 v[58:59], v[58:59], v[32:33] op_sel:[0,0] op_sel_hi:[1,0]
v_cvt_pk_bf16_f32 v56, v56, v57
v_cvt_pk_bf16_f32 v57, v58, v59
ds_read2st64_b64 v[220:223], v42 offset0:7 offset1:15
s_waitcnt lgkmcnt(8)
buffer_store_dwordx4 v[216:219], v14, s[20:23], s77 offen offset:384
v_pk_mul_f32 v[60:61], v[60:61], v[32:33] op_sel:[0,1] op_sel_hi:[1,1]
v_pk_mul_f32 v[62:63], v[62:63], v[32:33] op_sel:[0,1] op_sel_hi:[1,1]
v_cvt_pk_bf16_f32 v60, v60, v61
v_cvt_pk_bf16_f32 v61, v62, v63
ds_write2st64_b64 v37, v[56:57], v[60:61] offset0:0 offset1:2
v_accvgpr_read_b32 v56, a208
v_accvgpr_read_b32 v57, a209
v_accvgpr_read_b32 v58, a210
v_accvgpr_read_b32 v59, a211
v_accvgpr_read_b32 v60, a212
v_accvgpr_read_b32 v61, a213
v_accvgpr_read_b32 v62, a214
v_accvgpr_read_b32 v63, a215
v_pk_mul_f32 v[168:169], v[168:169], v[34:35] op_sel:[0,0] op_sel_hi:[1,0]
v_pk_mul_f32 v[170:171], v[170:171], v[34:35] op_sel:[0,0] op_sel_hi:[1,0]
v_cvt_pk_bf16_f32 v168, v168, v169
v_cvt_pk_bf16_f32 v169, v170, v171
ds_read2st64_b64 a[224:227], v40 offset0:0 offset1:8
s_waitcnt lgkmcnt(8)
buffer_store_dwordx4 v[204:207], v14, s[20:23], s78 offen offset:384
v_pk_mul_f32 v[172:173], v[172:173], v[34:35] op_sel:[0,1] op_sel_hi:[1,1]
v_pk_mul_f32 v[174:175], v[174:175], v[34:35] op_sel:[0,1] op_sel_hi:[1,1]
v_cvt_pk_bf16_f32 v172, v172, v173
v_cvt_pk_bf16_f32 v173, v174, v175
ds_write2st64_b64 v38, v[168:169], v[172:173] offset0:4 offset1:6
v_pk_mul_f32 v[184:185], v[184:185], v[34:35] op_sel:[0,0] op_sel_hi:[1,0]
v_pk_mul_f32 v[186:187], v[186:187], v[34:35] op_sel:[0,0] op_sel_hi:[1,0]
v_cvt_pk_bf16_f32 v184, v184, v185
v_cvt_pk_bf16_f32 v185, v186, v187
s_add_u32 s32, s32, 32768
s_add_u32 s33, s32, 4096
s_add_u32 m0, s25, 65536
s_nop 0
buffer_load_dwordx4 v5, s[16:19], s32 offen offset:0 lds
s_add_u32 m0, s25, 66560
s_nop 0
buffer_load_dwordx4 v5, s[16:19], s33 offen offset:0 lds
ds_read2st64_b64 a[240:243], v42 offset0:1 offset1:9
s_waitcnt lgkmcnt(4)
buffer_store_dwordx4 v[220:223], v14, s[20:23], s79 offen offset:384
v_pk_mul_f32 v[188:189], v[188:189], v[34:35] op_sel:[0,1] op_sel_hi:[1,1]
v_pk_mul_f32 v[190:191], v[190:191], v[34:35] op_sel:[0,1] op_sel_hi:[1,1]
v_cvt_pk_bf16_f32 v188, v188, v189
v_cvt_pk_bf16_f32 v189, v190, v191
ds_write2st64_b64 v39, v[184:185], v[188:189] offset0:4 offset1:6
v_pk_mul_f32 v[64:65], v[64:65], v[34:35] op_sel:[0,0] op_sel_hi:[1,0]
v_pk_mul_f32 v[66:67], v[66:67], v[34:35] op_sel:[0,0] op_sel_hi:[1,0]
v_cvt_pk_bf16_f32 v64, v64, v65
v_cvt_pk_bf16_f32 v65, v66, v67
ds_read2st64_b64 a[228:231], v40 offset0:2 offset1:10
s_waitcnt lgkmcnt(4)
buffer_store_dwordx4 a[224:227], v14, s[20:23], s72 offen offset:256
v_pk_mul_f32 v[68:69], v[68:69], v[34:35] op_sel:[0,1] op_sel_hi:[1,1]
v_pk_mul_f32 v[70:71], v[70:71], v[34:35] op_sel:[0,1] op_sel_hi:[1,1]
v_cvt_pk_bf16_f32 v68, v68, v69
v_cvt_pk_bf16_f32 v69, v70, v71
ds_write2st64_b64 v15, v[64:65], v[68:69] offset0:4 offset1:6
v_accvgpr_read_b32 v64, a168
v_accvgpr_read_b32 v65, a169
v_accvgpr_read_b32 v66, a170
v_accvgpr_read_b32 v67, a171
v_accvgpr_read_b32 v68, a172
v_accvgpr_read_b32 v69, a173
v_accvgpr_read_b32 v70, a174
v_accvgpr_read_b32 v71, a175
v_pk_mul_f32 v[72:73], v[72:73], v[34:35] op_sel:[0,0] op_sel_hi:[1,0]
v_pk_mul_f32 v[74:75], v[74:75], v[34:35] op_sel:[0,0] op_sel_hi:[1,0]
v_cvt_pk_bf16_f32 v72, v72, v73
v_cvt_pk_bf16_f32 v73, v74, v75
ds_read2st64_b64 a[244:247], v42 offset0:3 offset1:11
s_waitcnt lgkmcnt(4)
buffer_store_dwordx4 a[240:243], v14, s[20:23], s73 offen offset:256
v_pk_mul_f32 v[76:77], v[76:77], v[34:35] op_sel:[0,1] op_sel_hi:[1,1]
v_pk_mul_f32 v[78:79], v[78:79], v[34:35] op_sel:[0,1] op_sel_hi:[1,1]
v_cvt_pk_bf16_f32 v76, v76, v77
v_cvt_pk_bf16_f32 v77, v78, v79
ds_write2st64_b64 v37, v[72:73], v[76:77] offset0:4 offset1:6
v_accvgpr_read_b32 v72, a184
v_accvgpr_read_b32 v73, a185
v_accvgpr_read_b32 v74, a186
v_accvgpr_read_b32 v75, a187
v_accvgpr_read_b32 v76, a188
v_accvgpr_read_b32 v77, a189
v_pk_mul_f32 v[80:81], v[80:81], v[32:33] op_sel:[0,0] op_sel_hi:[1,0]
v_pk_mul_f32 v[82:83], v[82:83], v[32:33] op_sel:[0,0] op_sel_hi:[1,0]
v_cvt_pk_bf16_f32 v80, v80, v81
v_cvt_pk_bf16_f32 v81, v82, v83
ds_read2st64_b64 a[232:235], v40 offset0:4 offset1:12
s_waitcnt lgkmcnt(4)
buffer_store_dwordx4 a[228:231], v14, s[20:23], s74 offen offset:256
v_accvgpr_read_b32 v78, a190
v_pk_mul_f32 v[84:85], v[84:85], v[32:33] op_sel:[0,1] op_sel_hi:[1,1]
v_pk_mul_f32 v[86:87], v[86:87], v[32:33] op_sel:[0,1] op_sel_hi:[1,1]
v_cvt_pk_bf16_f32 v84, v84, v85
v_cvt_pk_bf16_f32 v85, v86, v87
ds_write2st64_b64 v15, v[80:81], v[84:85] offset0:0 offset1:2
s_waitcnt vmcnt(27)
v_add_u32 v11, s26, v1
ds_read_b128 a[96:99], v11 offset:0
ds_read_b128 a[100:103], v11 offset:256
ds_read_b128 a[104:107], v11 offset:512
ds_read_b128 a[108:111], v11 offset:768
v_accvgpr_read_b32 v79, a191
v_accvgpr_read_b32 v80, a200
v_pk_mul_f32 v[88:89], v[88:89], v[32:33] op_sel:[0,0] op_sel_hi:[1,0]
v_pk_mul_f32 v[90:91], v[90:91], v[32:33] op_sel:[0,0] op_sel_hi:[1,0]
v_cvt_pk_bf16_f32 v88, v88, v89
v_cvt_pk_bf16_f32 v89, v90, v91
ds_read2st64_b64 a[248:251], v42 offset0:5 offset1:13
s_waitcnt lgkmcnt(8)
buffer_store_dwordx4 a[244:247], v14, s[20:23], s75 offen offset:256
v_accvgpr_read_b32 v81, a201
v_pk_mul_f32 v[92:93], v[92:93], v[32:33] op_sel:[0,1] op_sel_hi:[1,1]
v_pk_mul_f32 v[94:95], v[94:95], v[32:33] op_sel:[0,1] op_sel_hi:[1,1]
v_cvt_pk_bf16_f32 v92, v92, v93
v_cvt_pk_bf16_f32 v93, v94, v95
ds_write2st64_b64 v37, v[88:89], v[92:93] offset0:0 offset1:2
v_accvgpr_read_b32 v82, a202
v_accvgpr_read_b32 v83, a203
v_pk_mul_f32 v[48:49], v[48:49], v[32:33] op_sel:[0,0] op_sel_hi:[1,0]
v_pk_mul_f32 v[50:51], v[50:51], v[32:33] op_sel:[0,0] op_sel_hi:[1,0]
v_cvt_pk_bf16_f32 v48, v48, v49
v_cvt_pk_bf16_f32 v49, v50, v51
ds_read2st64_b64 a[236:239], v40 offset0:6 offset1:14
s_waitcnt lgkmcnt(8)
buffer_store_dwordx4 a[232:235], v14, s[20:23], s76 offen offset:256
v_accvgpr_read_b32 v84, a204
v_pk_mul_f32 v[52:53], v[52:53], v[32:33] op_sel:[0,1] op_sel_hi:[1,1]
v_pk_mul_f32 v[54:55], v[54:55], v[32:33] op_sel:[0,1] op_sel_hi:[1,1]
v_cvt_pk_bf16_f32 v52, v52, v53
v_cvt_pk_bf16_f32 v53, v54, v55
ds_write2st64_b64 v38, v[48:49], v[52:53] offset0:0 offset1:2
ds_read_b128 a[112:115], v11 offset:1024
ds_read_b128 a[116:119], v11 offset:1280
ds_read_b128 a[120:123], v11 offset:1536
ds_read_b128 a[124:127], v11 offset:1792
v_accvgpr_read_b32 v85, a205
v_accvgpr_read_b32 v86, a206
v_pk_mul_f32 v[56:57], v[56:57], v[32:33] op_sel:[0,0] op_sel_hi:[1,0]
v_pk_mul_f32 v[58:59], v[58:59], v[32:33] op_sel:[0,0] op_sel_hi:[1,0]
v_cvt_pk_bf16_f32 v56, v56, v57
v_cvt_pk_bf16_f32 v57, v58, v59
ds_read2st64_b64 a[252:255], v42 offset0:7 offset1:15
s_waitcnt lgkmcnt(8)
buffer_store_dwordx4 a[248:251], v14, s[20:23], s77 offen offset:256
v_accvgpr_read_b32 v87, a207
v_accvgpr_read_b32 v88, a216
v_pk_mul_f32 v[60:61], v[60:61], v[32:33] op_sel:[0,1] op_sel_hi:[1,1]
v_pk_mul_f32 v[62:63], v[62:63], v[32:33] op_sel:[0,1] op_sel_hi:[1,1]
v_cvt_pk_bf16_f32 v60, v60, v61
v_cvt_pk_bf16_f32 v61, v62, v63
ds_write2st64_b64 v39, v[56:57], v[60:61] offset0:0 offset1:2
v_accvgpr_read_b32 v89, a217
v_pk_mul_f32 v[64:65], v[64:65], v[34:35] op_sel:[0,0] op_sel_hi:[1,0]
v_pk_mul_f32 v[66:67], v[66:67], v[34:35] op_sel:[0,0] op_sel_hi:[1,0]
v_cvt_pk_bf16_f32 v64, v64, v65
v_cvt_pk_bf16_f32 v65, v66, v67
ds_read2st64_b64 a[160:163], v40 offset0:0 offset1:8
s_waitcnt lgkmcnt(8)
buffer_store_dwordx4 a[236:239], v14, s[20:23], s78 offen offset:256
v_accvgpr_read_b32 v90, a218
v_accvgpr_read_b32 v91, a219
v_pk_mul_f32 v[68:69], v[68:69], v[34:35] op_sel:[0,1] op_sel_hi:[1,1]
v_pk_mul_f32 v[70:71], v[70:71], v[34:35] op_sel:[0,1] op_sel_hi:[1,1]
v_cvt_pk_bf16_f32 v68, v68, v69
v_cvt_pk_bf16_f32 v69, v70, v71
ds_write2st64_b64 v15, v[64:65], v[68:69] offset0:4 offset1:6
v_accvgpr_read_b32 v92, a220
v_pk_mul_f32 v[72:73], v[72:73], v[34:35] op_sel:[0,0] op_sel_hi:[1,0]
v_pk_mul_f32 v[74:75], v[74:75], v[34:35] op_sel:[0,0] op_sel_hi:[1,0]
v_cvt_pk_bf16_f32 v72, v72, v73
v_cvt_pk_bf16_f32 v73, v74, v75
ds_read2st64_b64 a[176:179], v42 offset0:1 offset1:9
s_waitcnt lgkmcnt(4)
buffer_store_dwordx4 a[252:255], v14, s[20:23], s79 offen offset:256
v_accvgpr_read_b32 v93, a221
v_accvgpr_read_b32 v94, a222
v_pk_mul_f32 v[76:77], v[76:77], v[34:35] op_sel:[0,1] op_sel_hi:[1,1]
v_pk_mul_f32 v[78:79], v[78:79], v[34:35] op_sel:[0,1] op_sel_hi:[1,1]
v_cvt_pk_bf16_f32 v76, v76, v77
v_cvt_pk_bf16_f32 v77, v78, v79
ds_write2st64_b64 v37, v[72:73], v[76:77] offset0:4 offset1:6
v_accvgpr_read_b32 v95, a223
v_pk_mul_f32 v[80:81], v[80:81], v[34:35] op_sel:[0,0] op_sel_hi:[1,0]
v_pk_mul_f32 v[82:83], v[82:83], v[34:35] op_sel:[0,0] op_sel_hi:[1,0]
v_cvt_pk_bf16_f32 v80, v80, v81
v_cvt_pk_bf16_f32 v81, v82, v83
ds_read2st64_b64 a[164:167], v40 offset0:2 offset1:10
s_waitcnt lgkmcnt(4)
buffer_store_dwordx4 a[160:163], v14, s[20:23], s72 offen offset:128
v_pk_mul_f32 v[84:85], v[84:85], v[34:35] op_sel:[0,1] op_sel_hi:[1,1]
v_pk_mul_f32 v[86:87], v[86:87], v[34:35] op_sel:[0,1] op_sel_hi:[1,1]
v_cvt_pk_bf16_f32 v84, v84, v85
v_cvt_pk_bf16_f32 v85, v86, v87
ds_write2st64_b64 v38, v[80:81], v[84:85] offset0:4 offset1:6
v_pk_mul_f32 v[88:89], v[88:89], v[34:35] op_sel:[0,0] op_sel_hi:[1,0]
v_pk_mul_f32 v[90:91], v[90:91], v[34:35] op_sel:[0,0] op_sel_hi:[1,0]
v_cvt_pk_bf16_f32 v88, v88, v89
v_cvt_pk_bf16_f32 v89, v90, v91
ds_read2st64_b64 a[180:183], v42 offset0:3 offset1:11
s_waitcnt lgkmcnt(4)
buffer_store_dwordx4 a[176:179], v14, s[20:23], s73 offen offset:128
v_pk_mul_f32 v[92:93], v[92:93], v[34:35] op_sel:[0,1] op_sel_hi:[1,1]
v_pk_mul_f32 v[94:95], v[94:95], v[34:35] op_sel:[0,1] op_sel_hi:[1,1]
v_cvt_pk_bf16_f32 v92, v92, v93
v_cvt_pk_bf16_f32 v93, v94, v95
ds_write2st64_b64 v39, v[88:89], v[92:93] offset0:4 offset1:6
ds_read2st64_b64 a[168:171], v40 offset0:4 offset1:12
ds_read2st64_b64 a[184:187], v42 offset0:5 offset1:13
ds_read2st64_b64 a[172:175], v40 offset0:6 offset1:14
ds_read2st64_b64 a[188:191], v42 offset0:7 offset1:15
s_waitcnt lgkmcnt(7)
buffer_store_dwordx4 a[164:167], v14, s[20:23], s74 offen offset:128
s_waitcnt lgkmcnt(5)
buffer_store_dwordx4 a[180:183], v14, s[20:23], s75 offen offset:128
s_waitcnt lgkmcnt(3)
buffer_store_dwordx4 a[168:171], v14, s[20:23], s76 offen offset:128
s_waitcnt lgkmcnt(2)
buffer_store_dwordx4 a[184:187], v14, s[20:23], s77 offen offset:128
s_waitcnt lgkmcnt(1)
buffer_store_dwordx4 a[172:175], v14, s[20:23], s78 offen offset:128
s_waitcnt lgkmcnt(0)
buffer_store_dwordx4 a[188:191], v14, s[20:23], s79 offen offset:128
s_add_u32 s37, s37, 1
s_branch L_pass
.p2align 6
L_iw0:
s_branch L_iwa
L_v3:
v_mfma_f32_16x16x32_bf16 v[32:35], a[128:131], a[0:3], 0
s_add_u32 m0, s25, 73600
ds_read_b128 a[152:155], v1 offset:9728
ds_read_b128 a[156:159], v1 offset:9984
v_mfma_f32_16x16x32_bf16 v[32:35], a[132:135], a[4:7], v[32:35]
buffer_load_dwordx4 v5, s[16:19], s32 offen offset:128 lds
v_mfma_f32_16x16x32_bf16 v[36:39], a[128:131], a[32:35], 0
s_add_u32 m0, s25, 74624
v_mov_b32 v6, 0
v_mov_b32 v7, 0
v_mfma_f32_16x16x32_bf16 v[36:39], a[132:135], a[36:39], v[36:39]
v_mov_b32 v8, 0
v_mov_b32 v9, 0
v_mfma_f32_16x16x32_bf16 v[40:43], a[128:131], a[64:67], 0
buffer_load_dwordx4 v5, s[16:19], s33 offen offset:128 lds
v_mfma_f32_16x16x32_bf16 v[40:43], a[132:135], a[68:71], v[40:43]
ds_read_b128 a[128:131], v1 offset:16384
ds_read_b128 a[132:135], v1 offset:16640
v_mfma_f32_16x16x32_bf16 v[32:35], a[136:139], a[8:11], v[32:35]
s_add_u32 m0, s25, 81664
v_mbcnt_lo_u32_b32 v11, -1, 0
v_mbcnt_hi_u32_b32 v11, -1, v11
v_mfma_f32_16x16x32_bf16 v[32:35], a[140:143], a[12:15], v[32:35]
buffer_load_dwordx4 v5, s[16:19], s32 offen offset:256 lds
v_mfma_f32_16x16x32_bf16 v[36:39], a[136:139], a[40:43], v[36:39]
s_add_u32 m0, s25, 82688
v_lshlrev_b32 v11, 5, v11
v_mfma_f32_16x16x32_bf16 v[36:39], a[140:143], a[44:47], v[36:39]
buffer_load_dwordx4 v5, s[16:19], s33 offen offset:256 lds
v_mfma_f32_16x16x32_bf16 v[40:43], a[136:139], a[72:75], v[40:43]
s_add_u32 m0, s25, 89728
v_mfma_f32_16x16x32_bf16 v[40:43], a[140:143], a[76:79], v[40:43]
ds_read_b128 a[136:139], v1 offset:16896
ds_read_b128 a[140:143], v1 offset:17152
v_mfma_f32_16x16x32_bf16 v[32:35], a[144:147], a[16:19], v[32:35]
buffer_load_dwordx4 v5, s[16:19], s32 offen offset:384 lds
v_mfma_f32_16x16x32_bf16 v[32:35], a[148:151], a[20:23], v[32:35]
s_add_u32 m0, s25, 90752
v_mfma_f32_16x16x32_bf16 v[36:39], a[144:147], a[48:51], v[36:39]
buffer_load_dwordx4 v5, s[16:19], s33 offen offset:384 lds
v_mfma_f32_16x16x32_bf16 v[36:39], a[148:151], a[52:55], v[36:39]
s_add_u32 m0, s25, 57344
v_mfma_f32_16x16x32_bf16 v[40:43], a[144:147], a[80:83], v[40:43]
buffer_load_dwordx4 v4, s[12:15], s29 offen offset:0 lds
v_mfma_f32_16x16x32_bf16 v[40:43], a[148:151], a[84:87], v[40:43]
s_waitcnt lgkmcnt(4)
ds_read_b128 a[144:147], v1 offset:17408
ds_read_b128 a[148:151], v1 offset:17664
v_mfma_f32_16x16x32_bf16 v[32:35], a[152:155], a[24:27], v[32:35]
s_add_u32 m0, s25, 58112
v_mfma_f32_16x16x32_bf16 v[32:35], a[156:159], a[28:31], v[32:35]
buffer_load_dwordx4 v4, s[12:15], s29 offen offset:256 lds
v_mfma_f32_16x16x32_bf16 v[36:39], a[152:155], a[56:59], v[36:39]
s_add_u32 s29, s29, 8192
v_mfma_f32_16x16x32_bf16 v[36:39], a[156:159], a[60:63], v[36:39]
v_mfma_f32_16x16x32_bf16 v[40:43], a[152:155], a[88:91], v[40:43]
v_mfma_f32_16x16x32_bf16 v[40:43], a[156:159], a[92:95], v[40:43]
s_waitcnt lgkmcnt(4)
ds_read_b128 a[152:155], v1 offset:17920
ds_read_b128 a[156:159], v1 offset:18176
v_mfma_f32_16x16x32_bf16 v[80:83], a[128:131], a[0:3], 0
v_max3_f32 v64, v32, v33, v34
v_max_f32 v64, v64, v35
v_mfma_f32_16x16x32_bf16 v[80:83], a[132:135], a[4:7], v[80:83]
v_max3_f32 v65, v36, v37, v38
v_max_f32 v65, v65, v39
v_mfma_f32_16x16x32_bf16 v[84:87], a[128:131], a[32:35], 0
v_mfma_f32_16x16x32_bf16 v[84:87], a[132:135], a[36:39], v[84:87]
v_max3_f32 v66, v40, v41, v42
v_max_f32 v66, v66, v43
v_mfma_f32_16x16x32_bf16 v[88:91], a[128:131], a[64:67], 0
v_mfma_f32_16x16x32_bf16 v[88:91], a[132:135], a[68:71], v[88:91]
s_waitcnt lgkmcnt(4)
v_permlane16_swap_b32 v64, v65
v_mfma_f32_16x16x32_bf16 v[80:83], a[136:139], a[8:11], v[80:83]
ds_read_b128 a[128:131], v1 offset:24576
ds_read_b128 a[132:135], v1 offset:24832
v_mfma_f32_16x16x32_bf16 v[80:83], a[140:143], a[12:15], v[80:83]
v_permlane16_swap_b32 v66, v67
v_mfma_f32_16x16x32_bf16 v[84:87], a[136:139], a[40:43], v[84:87]
v_max_f32 v64, v64, v65
v_max_f32 v66, v66, v67
v_mfma_f32_16x16x32_bf16 v[84:87], a[140:143], a[44:47], v[84:87]
v_mfma_f32_16x16x32_bf16 v[88:91], a[136:139], a[72:75], v[88:91]
v_permlane32_swap_b32 v64, v66
v_mfma_f32_16x16x32_bf16 v[88:91], a[140:143], a[76:79], v[88:91]
s_waitcnt lgkmcnt(4)
v_min_f32 v16, -v64, -v66
v_mov_b32 v24, v16
v_mfma_f32_16x16x32_bf16 v[80:83], a[144:147], a[16:19], v[80:83]
ds_read_b128 a[136:139], v1 offset:25088
ds_read_b128 a[140:143], v1 offset:25344
v_mfma_f32_16x16x32_bf16 v[80:83], a[148:151], a[20:23], v[80:83]
v_permlane32_swap_b32 v16, v24
v_mfma_f32_16x16x32_bf16 v[84:87], a[144:147], a[48:51], v[84:87]
v_mov_b32 v20, v16
v_mov_b32 v28, v24
v_mfma_f32_16x16x32_bf16 v[84:87], a[148:151], a[52:55], v[84:87]
v_mfma_f32_16x16x32_bf16 v[88:91], a[144:147], a[80:83], v[88:91]
v_permlane16_swap_b32 v16, v20
v_mfma_f32_16x16x32_bf16 v[88:91], a[148:151], a[84:87], v[88:91]
s_waitcnt lgkmcnt(4)
v_permlane16_swap_b32 v24, v28
v_mfma_f32_16x16x32_bf16 v[80:83], a[152:155], a[24:27], v[80:83]
v_mul_f32 v72, s35, v16
v_fma_f32 v32, v32, s35, v72
v_mfma_f32_16x16x32_bf16 v[80:83], a[156:159], a[28:31], v[80:83]
v_fma_f32 v33, v33, s35, v72
v_mul_f32 v73, s35, v20
v_mfma_f32_16x16x32_bf16 v[84:87], a[152:155], a[56:59], v[84:87]
v_exp_f32 v192, v32
v_mfma_f32_16x16x32_bf16 v[84:87], a[156:159], a[60:63], v[84:87]
ds_read_b128 a[144:147], v1 offset:25600
ds_read_b128 a[148:151], v1 offset:25856
v_mfma_f32_16x16x32_bf16 v[88:91], a[152:155], a[88:91], v[88:91]
v_mul_f32 v74, s35, v24
v_mov_b32 v17, v16
v_mov_b32 v18, v16
v_mov_b32 v19, v16
v_mfma_f32_16x16x32_bf16 v[88:91], a[156:159], a[92:95], v[88:91]
s_waitcnt lgkmcnt(4)
v_exp_f32 v193, v33
v_mfma_f32_16x16x32_bf16 v[48:51], a[128:131], a[0:3], v[16:19]
ds_read_b128 a[152:155], v1 offset:26112
ds_read_b128 a[156:159], v1 offset:26368
v_mov_b32 v21, v20
v_mov_b32 v22, v20
v_mov_b32 v23, v20
v_mfma_f32_16x16x32_bf16 v[48:51], a[132:135], a[4:7], v[48:51]
v_fma_f32 v34, v34, s35, v72
v_fma_f32 v35, v35, s35, v72
v_mfma_f32_16x16x32_bf16 v[52:55], a[128:131], a[32:35], v[20:23]
v_mov_b32 v25, v24
v_mov_b32 v26, v24
v_mov_b32 v27, v24
v_mfma_f32_16x16x32_bf16 v[52:55], a[132:135], a[36:39], v[52:55]
v_exp_f32 v194, v34
v_mfma_f32_16x16x32_bf16 v[56:59], a[128:131], a[64:67], v[24:27]
v_exp_f32 v195, v35
v_mfma_f32_16x16x32_bf16 v[56:59], a[132:135], a[68:71], v[56:59]
s_waitcnt lgkmcnt(4)
v_cvt_pk_bf16_f32 v32, v192, v193
v_cvt_pk_bf16_f32 v33, v194, v195
v_mfma_f32_16x16x32_bf16 v[48:51], a[136:139], a[8:11], v[48:51]
v_fma_f32 v36, v36, s35, v73
v_fma_f32 v37, v37, s35, v73
v_mfma_f32_16x16x32_bf16 v[48:51], a[140:143], a[12:15], v[48:51]
s_waitcnt vmcnt(8) lgkmcnt(0)
v_exp_f32 v196, v36
v_mfma_f32_16x16x32_bf16 v[52:55], a[136:139], a[40:43], v[52:55]
s_barrier
v_mfma_f32_16x16x32_bf16 v[52:55], a[140:143], a[44:47], v[52:55]
v_exp_f32 v197, v37
v_mfma_f32_16x16x32_bf16 v[56:59], a[136:139], a[72:75], v[56:59]
v_fma_f32 v38, v38, s35, v73
v_fma_f32 v39, v39, s35, v73
v_mfma_f32_16x16x32_bf16 v[56:59], a[140:143], a[76:79], v[56:59]
v_exp_f32 v198, v38
v_mfma_f32_16x16x32_bf16 v[48:51], a[144:147], a[16:19], v[48:51]
v_exp_f32 v199, v39
v_mfma_f32_16x16x32_bf16 v[48:51], a[148:151], a[20:23], v[48:51]
ds_read_b128 a[128:131], v1 offset:32768
ds_read_b128 a[132:135], v1 offset:33024
v_mfma_f32_16x16x32_bf16 v[52:55], a[144:147], a[48:51], v[52:55]
v_cvt_pk_bf16_f32 v36, v196, v197
v_cvt_pk_bf16_f32 v37, v198, v199
v_mfma_f32_16x16x32_bf16 v[52:55], a[148:151], a[52:55], v[52:55]
ds_read_b128 a[136:139], v1 offset:33280
ds_read_b128 a[140:143], v1 offset:33536
v_mfma_f32_16x16x32_bf16 v[56:59], a[144:147], a[80:83], v[56:59]
v_fma_f32 v40, v40, s35, v74
v_fma_f32 v41, v41, s35, v74
v_mfma_f32_16x16x32_bf16 v[56:59], a[148:151], a[84:87], v[56:59]
v_exp_f32 v200, v40
v_mfma_f32_16x16x32_bf16 v[48:51], a[152:155], a[24:27], v[48:51]
v_exp_f32 v201, v41
v_mfma_f32_16x16x32_bf16 v[48:51], a[156:159], a[28:31], v[48:51]
v_fma_f32 v42, v42, s35, v74
v_fma_f32 v43, v43, s35, v74
v_mfma_f32_16x16x32_bf16 v[52:55], a[152:155], a[56:59], v[52:55]
v_exp_f32 v202, v42
v_mfma_f32_16x16x32_bf16 v[52:55], a[156:159], a[60:63], v[52:55]
ds_read_b128 a[144:147], v1 offset:33792
ds_read_b128 a[148:151], v1 offset:34048
v_mfma_f32_16x16x32_bf16 v[56:59], a[152:155], a[88:91], v[56:59]
v_fma_f32 v80, v80, s35, v72
v_fma_f32 v81, v81, s35, v72
v_fma_f32 v82, v82, s35, v72
v_fma_f32 v83, v83, s35, v72
v_fma_f32 v84, v84, s35, v73
v_fma_f32 v85, v85, s35, v73
v_fma_f32 v86, v86, s35, v73
v_fma_f32 v87, v87, s35, v73
v_fma_f32 v88, v88, s35, v74
v_fma_f32 v89, v89, s35, v74
v_fma_f32 v90, v90, s35, v74
v_fma_f32 v91, v91, s35, v74
v_mfma_f32_16x16x32_bf16 v[56:59], a[156:159], a[92:95], v[56:59]
s_waitcnt lgkmcnt(4)
v_exp_f32 v203, v43
v_mfma_f32_16x16x32_bf16 v[64:67], a[128:131], a[0:3], v[16:19]
v_cvt_pk_bf16_f32 v40, v200, v201
v_cvt_pk_bf16_f32 v41, v202, v203
v_mfma_f32_16x16x32_bf16 v[64:67], a[132:135], a[4:7], v[64:67]
v_exp_f32 v208, v80
v_mfma_f32_16x16x32_bf16 v[68:71], a[128:131], a[32:35], v[20:23]
v_exp_f32 v209, v81
v_mfma_f32_16x16x32_bf16 v[68:71], a[132:135], a[36:39], v[68:71]
ds_read_b128 a[152:155], v1 offset:34304
ds_read_b128 a[156:159], v1 offset:34560
v_mfma_f32_16x16x32_bf16 v[72:75], a[128:131], a[64:67], v[24:27]
v_exp_f32 v210, v82
v_mfma_f32_16x16x32_bf16 v[72:75], a[132:135], a[68:71], v[72:75]
s_waitcnt lgkmcnt(4)
v_exp_f32 v211, v83
v_mfma_f32_16x16x32_bf16 v[64:67], a[136:139], a[8:11], v[64:67]
v_cvt_pk_bf16_f32 v34, v208, v209
v_cvt_pk_bf16_f32 v35, v210, v211
v_mfma_f32_16x16x32_bf16 v[64:67], a[140:143], a[12:15], v[64:67]
v_exp_f32 v212, v84
v_mfma_f32_16x16x32_bf16 v[68:71], a[136:139], a[40:43], v[68:71]
v_exp_f32 v213, v85
v_mfma_f32_16x16x32_bf16 v[68:71], a[140:143], a[44:47], v[68:71]
ds_read_b128 a[128:131], v1 offset:40960
ds_read_b128 a[132:135], v1 offset:41216
v_mfma_f32_16x16x32_bf16 v[72:75], a[136:139], a[72:75], v[72:75]
v_exp_f32 v214, v86
v_mfma_f32_16x16x32_bf16 v[72:75], a[140:143], a[76:79], v[72:75]
s_waitcnt lgkmcnt(4)
v_exp_f32 v215, v87
v_mfma_f32_16x16x32_bf16 v[64:67], a[144:147], a[16:19], v[64:67]
v_cvt_pk_bf16_f32 v38, v212, v213
v_cvt_pk_bf16_f32 v39, v214, v215
v_mfma_f32_16x16x32_bf16 v[64:67], a[148:151], a[20:23], v[64:67]
v_exp_f32 v216, v88
v_mfma_f32_16x16x32_bf16 v[68:71], a[144:147], a[48:51], v[68:71]
v_exp_f32 v217, v89
v_mfma_f32_16x16x32_bf16 v[68:71], a[148:151], a[52:55], v[68:71]
ds_read_b128 a[136:139], v1 offset:41472
ds_read_b128 a[140:143], v1 offset:41728
v_mfma_f32_16x16x32_bf16 v[72:75], a[144:147], a[80:83], v[72:75]
v_exp_f32 v218, v90
v_mfma_f32_16x16x32_bf16 v[72:75], a[148:151], a[84:87], v[72:75]
s_waitcnt lgkmcnt(4)
v_exp_f32 v219, v91
v_mfma_f32_16x16x32_bf16 v[64:67], a[152:155], a[24:27], v[64:67]
s_add_u32 m0, s25, 0
v_cvt_pk_bf16_f32 v42, v216, v217
v_cvt_pk_bf16_f32 v43, v218, v219
v_mfma_f32_16x16x32_bf16 v[64:67], a[156:159], a[28:31], v[64:67]
v_mul_f32 v48, s35, v48
v_mul_f32 v49, s35, v49
v_mfma_f32_16x16x32_bf16 v[68:71], a[152:155], a[56:59], v[68:71]
v_exp_f32 v224, v48
v_mfma_f32_16x16x32_bf16 v[68:71], a[156:159], a[60:63], v[68:71]
ds_read_b128 a[144:147], v1 offset:41984
ds_read_b128 a[148:151], v1 offset:42240
v_mfma_f32_16x16x32_bf16 v[72:75], a[152:155], a[88:91], v[72:75]
v_exp_f32 v225, v49
v_mfma_f32_16x16x32_bf16 v[72:75], a[156:159], a[92:95], v[72:75]
s_waitcnt lgkmcnt(4)
v_mul_f32 v50, s35, v50
v_mul_f32 v51, s35, v51
v_mfma_f32_16x16x32_bf16 v[80:83], a[128:131], a[0:3], v[16:19]
v_exp_f32 v226, v50
v_mfma_f32_16x16x32_bf16 v[80:83], a[132:135], a[4:7], v[80:83]
v_exp_f32 v227, v51
v_mfma_f32_16x16x32_bf16 v[84:87], a[128:131], a[32:35], v[20:23]
v_cvt_pk_bf16_f32 v48, v224, v225
v_cvt_pk_bf16_f32 v49, v226, v227
v_mfma_f32_16x16x32_bf16 v[84:87], a[132:135], a[36:39], v[84:87]
ds_read_b128 a[152:155], v1 offset:42496
ds_read_b128 a[156:159], v1 offset:42752
v_mfma_f32_16x16x32_bf16 v[88:91], a[128:131], a[64:67], v[24:27]
v_mul_f32 v52, s35, v52
v_mul_f32 v53, s35, v53
v_mfma_f32_16x16x32_bf16 v[88:91], a[132:135], a[68:71], v[88:91]
s_waitcnt lgkmcnt(4)
v_exp_f32 v228, v52
v_mfma_f32_16x16x32_bf16 v[80:83], a[136:139], a[8:11], v[80:83]
v_exp_f32 v229, v53
v_mfma_f32_16x16x32_bf16 v[80:83], a[140:143], a[12:15], v[80:83]
v_mul_f32 v54, s35, v54
v_mul_f32 v55, s35, v55
v_mfma_f32_16x16x32_bf16 v[84:87], a[136:139], a[40:43], v[84:87]
v_exp_f32 v230, v54
v_mfma_f32_16x16x32_bf16 v[84:87], a[140:143], a[44:47], v[84:87]
ds_read_b64_tr_b16 a[128:129], v2 offset:0
ds_read_b64_tr_b16 a[130:131], v2 offset:2048
ds_read_b64_tr_b16 a[132:133], v3 offset:0
ds_read_b64_tr_b16 a[134:135], v3 offset:2048
v_mfma_f32_16x16x32_bf16 v[88:91], a[136:139], a[72:75], v[88:91]
v_exp_f32 v231, v55
v_mfma_f32_16x16x32_bf16 v[88:91], a[140:143], a[76:79], v[88:91]
s_waitcnt lgkmcnt(6)
v_cvt_pk_bf16_f32 v52, v228, v229
v_cvt_pk_bf16_f32 v53, v230, v231
v_mfma_f32_16x16x32_bf16 v[80:83], a[144:147], a[16:19], v[80:83]
v_mul_f32 v56, s35, v56
v_mul_f32 v57, s35, v57
v_mfma_f32_16x16x32_bf16 v[80:83], a[148:151], a[20:23], v[80:83]
v_exp_f32 v232, v56
v_mfma_f32_16x16x32_bf16 v[84:87], a[144:147], a[48:51], v[84:87]
v_exp_f32 v233, v57
v_mfma_f32_16x16x32_bf16 v[84:87], a[148:151], a[52:55], v[84:87]
ds_read_b64_tr_b16 a[136:137], v2 offset:512
ds_read_b64_tr_b16 a[138:139], v2 offset:2560
ds_read_b64_tr_b16 a[140:141], v3 offset:512
ds_read_b64_tr_b16 a[142:143], v3 offset:2560
v_mfma_f32_16x16x32_bf16 v[88:91], a[144:147], a[80:83], v[88:91]
v_mul_f32 v58, s35, v58
v_mul_f32 v59, s35, v59
v_mfma_f32_16x16x32_bf16 v[88:91], a[148:151], a[84:87], v[88:91]
s_waitcnt lgkmcnt(8)
v_exp_f32 v234, v58
v_mfma_f32_16x16x32_bf16 v[80:83], a[152:155], a[24:27], v[80:83]
v_exp_f32 v235, v59
v_mfma_f32_16x16x32_bf16 v[80:83], a[156:159], a[28:31], v[80:83]
v_cvt_pk_bf16_f32 v56, v232, v233
v_cvt_pk_bf16_f32 v57, v234, v235
v_mfma_f32_16x16x32_bf16 v[84:87], a[152:155], a[56:59], v[84:87]
buffer_load_dwordx4 v4, s[12:15], s29 offen offset:0 lds
v_mfma_f32_16x16x32_bf16 v[84:87], a[156:159], a[60:63], v[84:87]
s_add_u32 m0, s25, 768
ds_read_b64_tr_b16 a[144:145], v2 offset:4096
ds_read_b64_tr_b16 a[146:147], v2 offset:6144
ds_read_b64_tr_b16 a[148:149], v3 offset:4096
ds_read_b64_tr_b16 a[150:151], v3 offset:6144
v_mfma_f32_16x16x32_bf16 v[88:91], a[152:155], a[88:91], v[88:91]
v_mul_f32 v64, s35, v64
v_mul_f32 v65, s35, v65
v_mfma_f32_16x16x32_bf16 v[88:91], a[156:159], a[92:95], v[88:91]
s_waitcnt lgkmcnt(8)
v_exp_f32 v64, v64
v_mfma_f32_16x16x32_bf16 v[96:99], a[128:131], v[32:35], 0
v_exp_f32 v65, v65
v_mfma_f32_16x16x32_bf16 v[112:115], a[132:135], v[32:35], 0
v_mul_f32 v66, s35, v66
v_mul_f32 v67, s35, v67
v_mfma_f32_16x16x32_bf16 v[100:103], a[128:131], v[36:39], 0
v_exp_f32 v66, v66
v_mfma_f32_16x16x32_bf16 v[116:119], a[132:135], v[36:39], 0
ds_read_b64_tr_b16 a[152:153], v2 offset:4608
ds_read_b64_tr_b16 a[154:155], v2 offset:6656
ds_read_b64_tr_b16 a[156:157], v3 offset:4608
ds_read_b64_tr_b16 a[158:159], v3 offset:6656
v_mfma_f32_16x16x32_bf16 v[104:107], a[128:131], v[40:43], 0
buffer_load_dwordx4 v4, s[12:15], s29 offen offset:256 lds
v_mfma_f32_16x16x32_bf16 v[120:123], a[132:135], v[40:43], 0
s_waitcnt lgkmcnt(8)
v_exp_f32 v67, v67
v_mfma_f32_16x16x32_bf16 v[128:131], a[136:139], v[32:35], 0
s_add_u32 s29, s29, 8192
v_cvt_pk_bf16_f32 v50, v64, v65
v_cvt_pk_bf16_f32 v51, v66, v67
v_mfma_f32_16x16x32_bf16 v[144:147], a[140:143], v[32:35], 0
s_add_u32 s32, s32, 32768
v_mul_f32 v68, s35, v68
v_mul_f32 v69, s35, v69
v_mfma_f32_16x16x32_bf16 v[132:135], a[136:139], v[36:39], 0
s_add_u32 s33, s32, 4096
v_exp_f32 v68, v68
v_mfma_f32_16x16x32_bf16 v[148:151], a[140:143], v[36:39], 0
s_add_u32 m0, s25, 98304
ds_read_b128 a[128:131], v1 offset:49152
ds_read_b128 a[132:135], v1 offset:49408
v_mfma_f32_16x16x32_bf16 v[136:139], a[136:139], v[40:43], 0
v_exp_f32 v69, v69
v_mfma_f32_16x16x32_bf16 v[152:155], a[140:143], v[40:43], 0
s_waitcnt lgkmcnt(6)
v_mul_f32 v70, s35, v70
v_mul_f32 v71, s35, v71
v_exp_f32 v70, v70
v_exp_f32 v71, v71
v_mfma_f32_16x16x32_bf16 v[96:99], a[144:147], v[48:51], v[96:99]
v_cvt_pk_bf16_f32 v54, v68, v69
v_cvt_pk_bf16_f32 v55, v70, v71
v_mfma_f32_16x16x32_bf16 v[112:115], a[148:151], v[48:51], v[112:115]
v_mul_f32 v72, s35, v72
v_mul_f32 v73, s35, v73
v_exp_f32 v72, v72
v_exp_f32 v73, v73
v_mul_f32 v74, s35, v74
v_mul_f32 v75, s35, v75
v_exp_f32 v74, v74
v_exp_f32 v75, v75
v_mfma_f32_16x16x32_bf16 v[100:103], a[144:147], v[52:55], v[100:103]
v_cvt_pk_bf16_f32 v58, v72, v73
v_cvt_pk_bf16_f32 v59, v74, v75
v_mfma_f32_16x16x32_bf16 v[116:119], a[148:151], v[52:55], v[116:119]
ds_read_b128 a[136:139], v1 offset:49664
ds_read_b128 a[140:143], v1 offset:49920
v_mfma_f32_16x16x32_bf16 v[104:107], a[144:147], v[56:59], v[104:107]
buffer_load_dwordx4 v5, s[16:19], s32 offen offset:0 lds
v_mfma_f32_16x16x32_bf16 v[120:123], a[148:151], v[56:59], v[120:123]
s_waitcnt lgkmcnt(4)
v_add_f32 v6, v6, v64
v_add_f32 v6, v6, v65
v_mfma_f32_16x16x32_bf16 v[128:131], a[152:155], v[48:51], v[128:131]
s_add_u32 m0, s25, 99328
v_add_f32 v6, v6, v66
v_mul_f32 v80, s35, v80
v_mfma_f32_16x16x32_bf16 v[144:147], a[156:159], v[48:51], v[144:147]
buffer_load_dwordx4 v5, s[16:19], s33 offen offset:0 lds
v_mfma_f32_16x16x32_bf16 v[132:135], a[152:155], v[52:55], v[132:135]
s_add_u32 m0, s25, 8192
v_add_f32 v6, v6, v67
v_mul_f32 v81, s35, v81
v_mfma_f32_16x16x32_bf16 v[148:151], a[156:159], v[52:55], v[148:151]
ds_read_b128 a[144:147], v1 offset:50176
ds_read_b128 a[148:151], v1 offset:50432
v_mfma_f32_16x16x32_bf16 v[136:139], a[152:155], v[56:59], v[136:139]
v_add_f32 v7, v7, v68
v_add_f32 v7, v7, v69
v_add_f32 v7, v7, v70
v_add_f32 v7, v7, v71
v_add_f32 v8, v8, v72
v_add_f32 v8, v8, v73
v_add_f32 v8, v8, v74
v_add_f32 v8, v8, v75
v_mfma_f32_16x16x32_bf16 v[152:155], a[156:159], v[56:59], v[152:155]
s_waitcnt lgkmcnt(4)
v_exp_f32 v80, v80
v_mfma_f32_16x16x32_bf16 v[64:67], a[128:131], a[0:3], v[16:19]
ds_read_b128 a[152:155], v1 offset:50688
ds_read_b128 a[156:159], v1 offset:50944
v_mfma_f32_16x16x32_bf16 v[64:67], a[132:135], a[4:7], v[64:67]
v_exp_f32 v81, v81
v_mfma_f32_16x16x32_bf16 v[68:71], a[128:131], a[32:35], v[20:23]
v_mul_f32 v82, s35, v82
v_mul_f32 v83, s35, v83
v_mfma_f32_16x16x32_bf16 v[68:71], a[132:135], a[36:39], v[68:71]
buffer_load_dwordx4 v4, s[12:15], s29 offen offset:0 lds
v_mfma_f32_16x16x32_bf16 v[72:75], a[128:131], a[64:67], v[24:27]
s_add_u32 m0, s25, 8960
v_exp_f32 v82, v82
v_mfma_f32_16x16x32_bf16 v[72:75], a[132:135], a[68:71], v[72:75]
s_waitcnt lgkmcnt(4)
v_exp_f32 v83, v83
v_mfma_f32_16x16x32_bf16 v[64:67], a[136:139], a[8:11], v[64:67]
v_add_f32 v6, v6, v80
v_add_f32 v6, v6, v81
v_mfma_f32_16x16x32_bf16 v[64:67], a[140:143], a[12:15], v[64:67]
s_waitcnt vmcnt(5) lgkmcnt(0)
v_add_f32 v6, v6, v82
v_add_f32 v6, v6, v83
v_mfma_f32_16x16x32_bf16 v[68:71], a[136:139], a[40:43], v[68:71]
s_barrier
v_mfma_f32_16x16x32_bf16 v[68:71], a[140:143], a[44:47], v[68:71]
v_cvt_pk_bf16_f32 v80, v80, v81
v_cvt_pk_bf16_f32 v81, v82, v83
v_mfma_f32_16x16x32_bf16 v[72:75], a[136:139], a[72:75], v[72:75]
v_mul_f32 v84, s35, v84
v_mul_f32 v85, s35, v85
v_mfma_f32_16x16x32_bf16 v[72:75], a[140:143], a[76:79], v[72:75]
buffer_load_dwordx4 v4, s[12:15], s29 offen offset:256 lds
v_mfma_f32_16x16x32_bf16 v[64:67], a[144:147], a[16:19], v[64:67]
s_add_u32 s29, s29, 8192
v_exp_f32 v84, v84
v_mfma_f32_16x16x32_bf16 v[64:67], a[148:151], a[20:23], v[64:67]
s_add_u32 m0, s25, 16384
ds_read_b64_tr_b16 a[128:129], v2 offset:8192
ds_read_b64_tr_b16 a[130:131], v2 offset:10240
ds_read_b64_tr_b16 a[132:133], v2 offset:12288
ds_read_b64_tr_b16 a[134:135], v2 offset:14336
v_mfma_f32_16x16x32_bf16 v[68:71], a[144:147], a[48:51], v[68:71]
v_exp_f32 v85, v85
v_mfma_f32_16x16x32_bf16 v[68:71], a[148:151], a[52:55], v[68:71]
ds_read_b64_tr_b16 a[136:137], v3 offset:8192
ds_read_b64_tr_b16 a[138:139], v3 offset:10240
ds_read_b64_tr_b16 a[140:141], v3 offset:12288
ds_read_b64_tr_b16 a[142:143], v3 offset:14336
v_mfma_f32_16x16x32_bf16 v[72:75], a[144:147], a[80:83], v[72:75]
v_mul_f32 v86, s35, v86
v_mul_f32 v87, s35, v87
v_mfma_f32_16x16x32_bf16 v[72:75], a[148:151], a[84:87], v[72:75]
v_exp_f32 v86, v86
v_mfma_f32_16x16x32_bf16 v[64:67], a[152:155], a[24:27], v[64:67]
v_exp_f32 v87, v87
v_mfma_f32_16x16x32_bf16 v[64:67], a[156:159], a[28:31], v[64:67]
v_add_f32 v7, v7, v84
v_add_f32 v7, v7, v85
v_mfma_f32_16x16x32_bf16 v[68:71], a[152:155], a[56:59], v[68:71]
v_add_f32 v7, v7, v86
v_add_f32 v7, v7, v87
v_mfma_f32_16x16x32_bf16 v[68:71], a[156:159], a[60:63], v[68:71]
ds_read_b64_tr_b16 a[144:145], v2 offset:8704
ds_read_b64_tr_b16 a[146:147], v2 offset:10752
ds_read_b64_tr_b16 a[148:149], v2 offset:12800
ds_read_b64_tr_b16 a[150:151], v2 offset:14848
v_mfma_f32_16x16x32_bf16 v[72:75], a[152:155], a[88:91], v[72:75]
v_cvt_pk_bf16_f32 v84, v84, v85
v_cvt_pk_bf16_f32 v85, v86, v87
v_mfma_f32_16x16x32_bf16 v[72:75], a[156:159], a[92:95], v[72:75]
s_waitcnt lgkmcnt(8)
buffer_load_dwordx4 v4, s[12:15], s29 offen offset:0 lds
v_mfma_f32_16x16x32_bf16 a[160:163], a[128:131], v[32:35], 0
s_add_u32 m0, s25, 17152
v_mul_f32 v88, s35, v88
v_mul_f32 v89, s35, v89
v_mfma_f32_16x16x32_bf16 a[160:163], a[132:135], v[48:51], a[160:163]
v_exp_f32 v88, v88
v_mfma_f32_16x16x32_bf16 a[164:167], a[128:131], v[36:39], 0
v_exp_f32 v89, v89
v_mfma_f32_16x16x32_bf16 a[164:167], a[132:135], v[52:55], a[164:167]
ds_read_b64_tr_b16 a[152:153], v3 offset:8704
ds_read_b64_tr_b16 a[154:155], v3 offset:10752
ds_read_b64_tr_b16 a[156:157], v3 offset:12800
ds_read_b64_tr_b16 a[158:159], v3 offset:14848
v_mul_f32 v90, s35, v90
v_mul_f32 v91, s35, v91
v_exp_f32 v90, v90
v_exp_f32 v91, v91
v_mfma_f32_16x16x32_bf16 a[168:171], a[128:131], v[40:43], 0
v_add_f32 v8, v8, v88
v_add_f32 v8, v8, v89
v_add_f32 v8, v8, v90
v_add_f32 v8, v8, v91
v_cvt_pk_bf16_f32 v88, v88, v89
v_cvt_pk_bf16_f32 v89, v90, v91
v_mfma_f32_16x16x32_bf16 a[168:171], a[132:135], v[56:59], a[168:171]
s_waitcnt lgkmcnt(8)
buffer_load_dwordx4 v4, s[12:15], s29 offen offset:256 lds
v_mfma_f32_16x16x32_bf16 a[176:179], a[136:139], v[32:35], 0
s_add_u32 s29, s29, 8192
v_mul_f32 v64, s35, v64
v_mul_f32 v65, s35, v65
v_mfma_f32_16x16x32_bf16 a[176:179], a[140:143], v[48:51], a[176:179]
v_exp_f32 v64, v64
v_mfma_f32_16x16x32_bf16 a[180:183], a[136:139], v[36:39], 0
s_add_u32 m0, s25, 106368
ds_read_b64_tr_b16 a[128:129], v2 offset:16384
ds_read_b64_tr_b16 a[130:131], v2 offset:18432
v_mfma_f32_16x16x32_bf16 a[180:183], a[140:143], v[52:55], a[180:183]
ds_read_b64_tr_b16 a[132:133], v2 offset:20480
ds_read_b64_tr_b16 a[134:135], v2 offset:22528
v_mfma_f32_16x16x32_bf16 a[184:187], a[136:139], v[40:43], 0
v_add_f32 v6, v6, v64
v_mul_f32 v66, s35, v66
v_mfma_f32_16x16x32_bf16 a[184:187], a[140:143], v[56:59], a[184:187]
s_waitcnt lgkmcnt(8)
v_exp_f32 v65, v65
v_mfma_f32_16x16x32_bf16 a[192:195], a[144:147], v[32:35], 0
v_mul_f32 v67, s35, v67
v_add_f32 v6, v6, v65
v_mfma_f32_16x16x32_bf16 a[192:195], a[148:151], v[48:51], a[192:195]
v_exp_f32 v66, v66
v_mfma_f32_16x16x32_bf16 a[196:199], a[144:147], v[36:39], 0
ds_read_b64_tr_b16 a[136:137], v3 offset:16384
ds_read_b64_tr_b16 a[138:139], v3 offset:18432
v_mfma_f32_16x16x32_bf16 a[196:199], a[148:151], v[52:55], a[196:199]
ds_read_b64_tr_b16 a[140:141], v3 offset:20480
ds_read_b64_tr_b16 a[142:143], v3 offset:22528
v_mfma_f32_16x16x32_bf16 a[200:203], a[144:147], v[40:43], 0
v_exp_f32 v67, v67
v_mfma_f32_16x16x32_bf16 a[200:203], a[148:151], v[56:59], a[200:203]
s_waitcnt lgkmcnt(8)
buffer_load_dwordx4 v5, s[16:19], s32 offen offset:128 lds
v_mfma_f32_16x16x32_bf16 a[208:211], a[152:155], v[32:35], 0
s_add_u32 m0, s25, 107392
v_add_f32 v6, v6, v66
v_cvt_pk_bf16_f32 v82, v64, v65
v_mfma_f32_16x16x32_bf16 a[208:211], a[156:159], v[48:51], a[208:211]
v_cvt_pk_bf16_f32 v83, v66, v67
v_add_f32 v6, v6, v67
v_mfma_f32_16x16x32_bf16 a[212:215], a[152:155], v[36:39], 0
ds_read_b64_tr_b16 a[144:145], v2 offset:16896
v_mul_f32 v68, s35, v68
v_mfma_f32_16x16x32_bf16 a[212:215], a[156:159], v[52:55], a[212:215]
ds_read_b64_tr_b16 a[146:147], v2 offset:18944
ds_read_b64_tr_b16 a[148:149], v2 offset:20992
ds_read_b64_tr_b16 a[150:151], v2 offset:23040
v_mfma_f32_16x16x32_bf16 a[216:219], a[152:155], v[40:43], 0
v_mul_f32 v69, s35, v69
v_mul_f32 v70, s35, v70
v_mfma_f32_16x16x32_bf16 a[216:219], a[156:159], v[56:59], a[216:219]
s_waitcnt lgkmcnt(8)
buffer_load_dwordx4 v5, s[16:19], s33 offen offset:128 lds
v_mfma_f32_16x16x32_bf16 a[224:227], a[128:131], v[32:35], 0
s_add_u32 m0, s25, 114432
v_exp_f32 v68, v68
v_mfma_f32_16x16x32_bf16 a[224:227], a[132:135], v[48:51], a[224:227]
ds_read_b64_tr_b16 a[152:153], v3 offset:16896
v_add_f32 v7, v7, v68
v_mfma_f32_16x16x32_bf16 a[228:231], a[128:131], v[36:39], 0
v_exp_f32 v69, v69
v_mfma_f32_16x16x32_bf16 a[228:231], a[132:135], v[52:55], a[228:231]
ds_read_b64_tr_b16 a[154:155], v3 offset:18944
ds_read_b64_tr_b16 a[156:157], v3 offset:20992
ds_read_b64_tr_b16 a[158:159], v3 offset:23040
v_mfma_f32_16x16x32_bf16 a[232:235], a[128:131], v[40:43], 0
buffer_load_dwordx4 v5, s[16:19], s32 offen offset:256 lds
v_mfma_f32_16x16x32_bf16 a[232:235], a[132:135], v[56:59], a[232:235]
s_waitcnt lgkmcnt(8)
v_add_f32 v7, v7, v69
v_mul_f32 v71, s35, v71
v_mfma_f32_16x16x32_bf16 a[240:243], a[136:139], v[32:35], 0
s_add_u32 m0, s25, 115456
v_exp_f32 v70, v70
v_mfma_f32_16x16x32_bf16 a[240:243], a[140:143], v[48:51], a[240:243]
ds_read_b128 a[128:131], v1 offset:57344
v_add_f32 v7, v7, v70
v_mfma_f32_16x16x32_bf16 a[244:247], a[136:139], v[36:39], 0
v_exp_f32 v71, v71
v_mfma_f32_16x16x32_bf16 a[244:247], a[140:143], v[52:55], a[244:247]
ds_read_b128 a[132:135], v1 offset:57600
v_cvt_pk_bf16_f32 v86, v68, v69
v_mfma_f32_16x16x32_bf16 a[248:251], a[136:139], v[40:43], 0
buffer_load_dwordx4 v5, s[16:19], s33 offen offset:256 lds
v_mfma_f32_16x16x32_bf16 a[248:251], a[140:143], v[56:59], a[248:251]
s_waitcnt lgkmcnt(6)
v_add_f32 v7, v7, v71
v_cvt_pk_bf16_f32 v87, v70, v71
v_mfma_f32_16x16x32_bf16 v[160:163], a[144:147], v[32:35], 0
s_add_u32 m0, s25, 122496
v_mul_f32 v72, s35, v72
v_mul_f32 v73, s35, v73
v_mfma_f32_16x16x32_bf16 v[160:163], a[148:151], v[48:51], v[160:163]
buffer_load_dwordx4 v5, s[16:19], s32 offen offset:384 lds
v_mfma_f32_16x16x32_bf16 v[164:167], a[144:147], v[36:39], 0
s_add_u32 m0, s25, 123520
v_exp_f32 v72, v72
v_mfma_f32_16x16x32_bf16 v[164:167], a[148:151], v[52:55], v[164:167]
ds_read_b128 a[136:139], v1 offset:57856
ds_read_b128 a[140:143], v1 offset:58112
v_mfma_f32_16x16x32_bf16 v[168:171], a[144:147], v[40:43], 0
v_add_f32 v8, v8, v72
v_mul_f32 v74, s35, v74
v_mfma_f32_16x16x32_bf16 v[168:171], a[148:151], v[56:59], v[168:171]
s_waitcnt lgkmcnt(4)
v_exp_f32 v73, v73
v_mfma_f32_16x16x32_bf16 v[176:179], a[152:155], v[32:35], 0
v_add_f32 v8, v8, v73
v_mul_f32 v75, s35, v75
v_mfma_f32_16x16x32_bf16 v[176:179], a[156:159], v[48:51], v[176:179]
buffer_load_dwordx4 v5, s[16:19], s33 offen offset:384 lds
v_mfma_f32_16x16x32_bf16 v[180:183], a[152:155], v[36:39], 0
s_add_u32 m0, s25, 24576
v_exp_f32 v74, v74
v_mfma_f32_16x16x32_bf16 v[180:183], a[156:159], v[52:55], v[180:183]
ds_read_b128 a[144:147], v1 offset:58368
ds_read_b128 a[148:151], v1 offset:58624
v_exp_f32 v75, v75
v_mfma_f32_16x16x32_bf16 v[184:187], a[152:155], v[40:43], 0
v_add_f32 v8, v8, v74
v_add_f32 v8, v8, v75
v_cvt_pk_bf16_f32 v90, v72, v73
v_cvt_pk_bf16_f32 v91, v74, v75
v_mfma_f32_16x16x32_bf16 v[184:187], a[156:159], v[56:59], v[184:187]
s_waitcnt lgkmcnt(4)
buffer_load_dwordx4 v4, s[12:15], s29 offen offset:0 lds
v_mfma_f32_16x16x32_bf16 v[64:67], a[128:131], a[0:3], v[16:19]
s_add_u32 m0, s25, 25344
v_add_f32 v6, v6, v192
v_add_f32 v6, v6, v193
v_mfma_f32_16x16x32_bf16 v[64:67], a[132:135], a[4:7], v[64:67]
v_add_f32 v6, v6, v194
v_add_f32 v6, v6, v195
v_mfma_f32_16x16x32_bf16 v[68:71], a[128:131], a[32:35], v[20:23]
v_add_f32 v7, v7, v196
v_add_f32 v7, v7, v197
v_mfma_f32_16x16x32_bf16 v[68:71], a[132:135], a[36:39], v[68:71]
ds_read_b128 a[152:155], v1 offset:58880
ds_read_b128 a[156:159], v1 offset:59136
v_mfma_f32_16x16x32_bf16 v[72:75], a[128:131], a[64:67], v[24:27]
v_add_f32 v7, v7, v198
v_add_f32 v7, v7, v199
v_mfma_f32_16x16x32_bf16 v[72:75], a[132:135], a[68:71], v[72:75]
s_waitcnt lgkmcnt(4)
v_add_f32 v8, v8, v200
v_add_f32 v8, v8, v201
v_mfma_f32_16x16x32_bf16 v[64:67], a[136:139], a[8:11], v[64:67]
buffer_load_dwordx4 v4, s[12:15], s29 offen offset:256 lds
v_mfma_f32_16x16x32_bf16 v[64:67], a[140:143], a[12:15], v[64:67]
s_add_u32 s29, s29, 8192
v_add_f32 v8, v8, v202
v_add_f32 v8, v8, v203
v_mfma_f32_16x16x32_bf16 v[68:71], a[136:139], a[40:43], v[68:71]
s_add_u32 m0, s25, 32768
v_add_f32 v6, v6, v208
v_add_f32 v6, v6, v209
v_mfma_f32_16x16x32_bf16 v[68:71], a[140:143], a[44:47], v[68:71]
ds_read_b64_tr_b16 a[128:129], v2 offset:24576
ds_read_b64_tr_b16 a[130:131], v2 offset:26624
ds_read_b64_tr_b16 a[132:133], v2 offset:28672
ds_read_b64_tr_b16 a[134:135], v2 offset:30720
v_mfma_f32_16x16x32_bf16 v[72:75], a[136:139], a[72:75], v[72:75]
v_add_f32 v6, v6, v210
v_add_f32 v6, v6, v211
v_mfma_f32_16x16x32_bf16 v[72:75], a[140:143], a[76:79], v[72:75]
s_waitcnt lgkmcnt(6)
v_add_f32 v7, v7, v212
v_add_f32 v7, v7, v213
v_mfma_f32_16x16x32_bf16 v[64:67], a[144:147], a[16:19], v[64:67]
v_add_f32 v7, v7, v214
v_add_f32 v7, v7, v215
v_mfma_f32_16x16x32_bf16 v[64:67], a[148:151], a[20:23], v[64:67]
v_add_f32 v8, v8, v216
v_add_f32 v8, v8, v217
v_mfma_f32_16x16x32_bf16 v[68:71], a[144:147], a[48:51], v[68:71]
v_add_f32 v8, v8, v218
v_add_f32 v8, v8, v219
v_mfma_f32_16x16x32_bf16 v[68:71], a[148:151], a[52:55], v[68:71]
ds_read_b64_tr_b16 a[136:137], v3 offset:24576
ds_read_b64_tr_b16 a[138:139], v3 offset:26624
ds_read_b64_tr_b16 a[140:141], v3 offset:28672
ds_read_b64_tr_b16 a[142:143], v3 offset:30720
v_mfma_f32_16x16x32_bf16 v[72:75], a[144:147], a[80:83], v[72:75]
v_add_f32 v6, v6, v224
v_add_f32 v6, v6, v225
v_mfma_f32_16x16x32_bf16 v[72:75], a[148:151], a[84:87], v[72:75]
s_waitcnt lgkmcnt(8)
buffer_load_dwordx4 v4, s[12:15], s29 offen offset:0 lds
v_mfma_f32_16x16x32_bf16 v[64:67], a[152:155], a[24:27], v[64:67]
s_add_u32 m0, s25, 33536
v_add_f32 v6, v6, v226
v_add_f32 v6, v6, v227
v_mfma_f32_16x16x32_bf16 v[64:67], a[156:159], a[28:31], v[64:67]
v_add_f32 v7, v7, v228
v_add_f32 v7, v7, v229
v_mfma_f32_16x16x32_bf16 v[68:71], a[152:155], a[56:59], v[68:71]
v_add_f32 v7, v7, v230
v_add_f32 v7, v7, v231
v_mfma_f32_16x16x32_bf16 v[68:71], a[156:159], a[60:63], v[68:71]
ds_read_b64_tr_b16 a[144:145], v2 offset:25088
ds_read_b64_tr_b16 a[146:147], v2 offset:27136
ds_read_b64_tr_b16 a[148:149], v2 offset:29184
ds_read_b64_tr_b16 a[150:151], v2 offset:31232
v_add_f32 v8, v8, v232
v_add_f32 v8, v8, v233
v_add_f32 v8, v8, v234
v_add_f32 v8, v8, v235
v_mfma_f32_16x16x32_bf16 v[72:75], a[152:155], a[88:91], v[72:75]
buffer_load_dwordx4 v4, s[12:15], s29 offen offset:256 lds
v_mfma_f32_16x16x32_bf16 v[72:75], a[156:159], a[92:95], v[72:75]
s_waitcnt lgkmcnt(8)
ds_read_b64_tr_b16 a[152:153], v3 offset:25088
ds_read_b64_tr_b16 a[154:155], v3 offset:27136
v_mfma_f32_16x16x32_bf16 v[192:195], a[128:131], v[32:35], 0
s_add_u32 s29, s29, 8192
ds_read_b64_tr_b16 a[156:157], v3 offset:29184
ds_read_b64_tr_b16 a[158:159], v3 offset:31232
v_mfma_f32_16x16x32_bf16 v[192:195], a[132:135], v[48:51], v[192:195]
s_add_u32 m0, s25, 40960
v_mul_f32 v64, s35, v64
v_mul_f32 v65, s35, v65
v_mfma_f32_16x16x32_bf16 v[196:199], a[128:131], v[36:39], 0
buffer_load_dwordx4 v4, s[12:15], s29 offen offset:0 lds
v_mfma_f32_16x16x32_bf16 v[196:199], a[132:135], v[52:55], v[196:199]
s_add_u32 m0, s25, 41728
v_exp_f32 v64, v64
v_mfma_f32_16x16x32_bf16 v[200:203], a[128:131], v[40:43], 0
buffer_load_dwordx4 v4, s[12:15], s29 offen offset:256 lds
v_mfma_f32_16x16x32_bf16 v[200:203], a[132:135], v[56:59], v[200:203]
s_waitcnt lgkmcnt(8)
v_exp_f32 v65, v65
v_mfma_f32_16x16x32_bf16 v[208:211], a[136:139], v[32:35], 0
s_add_u32 s29, s29, 8192
v_mul_f32 v66, s35, v66
v_mul_f32 v67, s35, v67
v_mfma_f32_16x16x32_bf16 v[208:211], a[140:143], v[48:51], v[208:211]
s_waitcnt vmcnt(12) lgkmcnt(0)
v_exp_f32 v66, v66
v_mfma_f32_16x16x32_bf16 v[212:215], a[136:139], v[36:39], 0
s_barrier
v_mfma_f32_16x16x32_bf16 v[212:215], a[140:143], v[52:55], v[212:215]
s_add_u32 m0, s25, 49152
v_exp_f32 v67, v67
v_mfma_f32_16x16x32_bf16 v[216:219], a[136:139], v[40:43], 0
buffer_load_dwordx4 v4, s[12:15], s29 offen offset:0 lds
v_mfma_f32_16x16x32_bf16 v[216:219], a[140:143], v[56:59], v[216:219]
ds_read_b128 a[128:131], v1 offset:0
v_add_f32 v6, v6, v64
v_mfma_f32_16x16x32_bf16 v[224:227], a[144:147], v[32:35], 0
s_add_u32 m0, s25, 49920
ds_read_b128 a[132:135], v1 offset:256
v_add_f32 v6, v6, v65
v_mfma_f32_16x16x32_bf16 v[224:227], a[148:151], v[48:51], v[224:227]
buffer_load_dwordx4 v4, s[12:15], s29 offen offset:256 lds
v_mfma_f32_16x16x32_bf16 v[228:231], a[144:147], v[36:39], 0
s_add_u32 s29, s29, 8192
v_add_f32 v6, v6, v66
v_add_f32 v6, v6, v67
v_mfma_f32_16x16x32_bf16 v[228:231], a[148:151], v[52:55], v[228:231]
s_add_u32 s32, s32, 32768
ds_read_b128 a[136:139], v1 offset:512
ds_read_b128 a[140:143], v1 offset:768
v_mfma_f32_16x16x32_bf16 v[232:235], a[144:147], v[40:43], 0
s_add_u32 s33, s32, 4096
v_cvt_pk_bf16_f32 v64, v64, v65
v_cvt_pk_bf16_f32 v65, v66, v67
v_mfma_f32_16x16x32_bf16 v[232:235], a[148:151], v[56:59], v[232:235]
v_mul_f32 v68, s35, v68
v_mul_f32 v69, s35, v69
v_mfma_f32_16x16x32_bf16 v[240:243], a[152:155], v[32:35], 0
s_add_u32 m0, s25, 65536
v_exp_f32 v68, v68
v_mfma_f32_16x16x32_bf16 v[240:243], a[156:159], v[48:51], v[240:243]
v_exp_f32 v69, v69
v_mfma_f32_16x16x32_bf16 v[244:247], a[152:155], v[36:39], 0
v_mul_f32 v70, s35, v70
v_mul_f32 v71, s35, v71
v_mfma_f32_16x16x32_bf16 v[244:247], a[156:159], v[52:55], v[244:247]
buffer_load_dwordx4 v5, s[16:19], s32 offen offset:0 lds
ds_read_b128 a[144:147], v1 offset:1024
ds_read_b128 a[148:151], v1 offset:1280
v_mfma_f32_16x16x32_bf16 v[248:251], a[152:155], v[40:43], 0
s_add_u32 m0, s25, 66560
v_exp_f32 v70, v70
v_exp_f32 v71, v71
v_mfma_f32_16x16x32_bf16 v[248:251], a[156:159], v[56:59], v[248:251]
s_waitcnt lgkmcnt(4)
buffer_load_dwordx4 v5, s[16:19], s33 offen offset:0 lds
v_add_f32 v7, v7, v68
v_add_f32 v7, v7, v69
v_add_f32 v7, v7, v70
v_add_f32 v7, v7, v71
v_cvt_pk_bf16_f32 v68, v68, v69
v_cvt_pk_bf16_f32 v69, v70, v71
L_loop3:
v_mfma_f32_16x16x32_bf16 v[48:51], a[128:131], a[0:3], v[16:19]
ds_read_b128 a[152:155], v1 offset:1536
ds_read_b128 a[156:159], v1 offset:1792
v_mfma_f32_16x16x32_bf16 v[48:51], a[132:135], a[4:7], v[48:51]
v_mul_f32 v72, s35, v72
v_mul_f32 v73, s35, v73
v_mfma_f32_16x16x32_bf16 v[52:55], a[128:131], a[32:35], v[20:23]
s_add_u32 m0, s25, 73600
v_exp_f32 v72, v72
v_mfma_f32_16x16x32_bf16 v[52:55], a[132:135], a[36:39], v[52:55]
buffer_load_dwordx4 v5, s[16:19], s32 offen offset:128 lds
v_mfma_f32_16x16x32_bf16 v[56:59], a[128:131], a[64:67], v[24:27]
s_add_u32 m0, s25, 74624
v_exp_f32 v73, v73
v_mfma_f32_16x16x32_bf16 v[56:59], a[132:135], a[68:71], v[56:59]
s_waitcnt lgkmcnt(4)
ds_read_b128 a[128:131], v1 offset:8192
ds_read_b128 a[132:135], v1 offset:8448
v_mfma_f32_16x16x32_bf16 v[48:51], a[136:139], a[8:11], v[48:51]
v_mul_f32 v74, s35, v74
v_mul_f32 v75, s35, v75
v_mfma_f32_16x16x32_bf16 v[48:51], a[140:143], a[12:15], v[48:51]
buffer_load_dwordx4 v5, s[16:19], s33 offen offset:128 lds
v_mfma_f32_16x16x32_bf16 v[52:55], a[136:139], a[40:43], v[52:55]
s_add_u32 m0, s25, 81664
v_exp_f32 v74, v74
v_mfma_f32_16x16x32_bf16 v[52:55], a[140:143], a[44:47], v[52:55]
v_exp_f32 v75, v75
v_mfma_f32_16x16x32_bf16 v[56:59], a[136:139], a[72:75], v[56:59]
buffer_load_dwordx4 v5, s[16:19], s32 offen offset:256 lds
v_mfma_f32_16x16x32_bf16 v[56:59], a[140:143], a[76:79], v[56:59]
s_waitcnt lgkmcnt(4)
ds_read_b128 a[136:139], v1 offset:8704
ds_read_b128 a[140:143], v1 offset:8960
v_mfma_f32_16x16x32_bf16 v[48:51], a[144:147], a[16:19], v[48:51]
s_add_u32 m0, s25, 82688
v_add_f32 v8, v8, v72
v_add_f32 v8, v8, v73
v_mfma_f32_16x16x32_bf16 v[48:51], a[148:151], a[20:23], v[48:51]
v_add_f32 v8, v8, v74
v_add_f32 v8, v8, v75
v_mfma_f32_16x16x32_bf16 v[52:55], a[144:147], a[48:51], v[52:55]
buffer_load_dwordx4 v5, s[16:19], s33 offen offset:256 lds
v_mfma_f32_16x16x32_bf16 v[52:55], a[148:151], a[52:55], v[52:55]
s_add_u32 m0, s25, 89728
v_cvt_pk_bf16_f32 v72, v72, v73
v_cvt_pk_bf16_f32 v73, v74, v75
v_mfma_f32_16x16x32_bf16 v[56:59], a[144:147], a[80:83], v[56:59]
buffer_load_dwordx4 v5, s[16:19], s32 offen offset:384 lds
v_mfma_f32_16x16x32_bf16 v[56:59], a[148:151], a[84:87], v[56:59]
s_waitcnt lgkmcnt(4)
ds_read_b128 a[144:147], v1 offset:9216
ds_read_b128 a[148:151], v1 offset:9472
v_mfma_f32_16x16x32_bf16 v[48:51], a[152:155], a[24:27], v[48:51]
s_add_u32 m0, s25, 90752
v_mfma_f32_16x16x32_bf16 v[48:51], a[156:159], a[28:31], v[48:51]
buffer_load_dwordx4 v5, s[16:19], s33 offen offset:384 lds
v_mfma_f32_16x16x32_bf16 v[52:55], a[152:155], a[56:59], v[52:55]
v_mfma_f32_16x16x32_bf16 v[52:55], a[156:159], a[60:63], v[52:55]
v_mfma_f32_16x16x32_bf16 v[56:59], a[152:155], a[88:91], v[56:59]
v_mfma_f32_16x16x32_bf16 v[56:59], a[156:159], a[92:95], v[56:59]
s_waitcnt lgkmcnt(4)
ds_read_b128 a[152:155], v1 offset:9728
ds_read_b128 a[156:159], v1 offset:9984
v_mfma_f32_16x16x32_bf16 v[32:35], a[128:131], a[0:3], v[16:19]
v_mul_f32 v48, s35, v48
v_mul_f32 v49, s35, v49
v_mfma_f32_16x16x32_bf16 v[32:35], a[132:135], a[4:7], v[32:35]
v_exp_f32 v48, v48
v_mfma_f32_16x16x32_bf16 v[36:39], a[128:131], a[32:35], v[20:23]
v_exp_f32 v49, v49
v_mfma_f32_16x16x32_bf16 v[36:39], a[132:135], a[36:39], v[36:39]
v_mul_f32 v50, s35, v50
v_mul_f32 v51, s35, v51
v_mfma_f32_16x16x32_bf16 v[40:43], a[128:131], a[64:67], v[24:27]
v_exp_f32 v50, v50
v_mfma_f32_16x16x32_bf16 v[40:43], a[132:135], a[68:71], v[40:43]
s_waitcnt lgkmcnt(4)
ds_read_b64_tr_b16 a[128:129], v2 offset:32768
ds_read_b64_tr_b16 a[130:131], v2 offset:34816
v_mfma_f32_16x16x32_bf16 v[32:35], a[136:139], a[8:11], v[32:35]
ds_read_b64_tr_b16 a[132:133], v3 offset:32768
ds_read_b64_tr_b16 a[134:135], v3 offset:34816
v_mfma_f32_16x16x32_bf16 v[32:35], a[140:143], a[12:15], v[32:35]
v_exp_f32 v51, v51
v_mfma_f32_16x16x32_bf16 v[36:39], a[136:139], a[40:43], v[36:39]
v_cvt_pk_bf16_f32 v66, v48, v49
v_cvt_pk_bf16_f32 v67, v50, v51
v_mfma_f32_16x16x32_bf16 v[36:39], a[140:143], a[44:47], v[36:39]
v_mul_f32 v52, s35, v52
v_mul_f32 v53, s35, v53
v_mfma_f32_16x16x32_bf16 v[40:43], a[136:139], a[72:75], v[40:43]
v_exp_f32 v52, v52
v_mfma_f32_16x16x32_bf16 v[40:43], a[140:143], a[76:79], v[40:43]
s_waitcnt lgkmcnt(6)
ds_read_b64_tr_b16 a[136:137], v2 offset:36864
ds_read_b64_tr_b16 a[138:139], v2 offset:38912
v_mfma_f32_16x16x32_bf16 v[32:35], a[144:147], a[16:19], v[32:35]
ds_read_b64_tr_b16 a[140:141], v3 offset:36864
ds_read_b64_tr_b16 a[142:143], v3 offset:38912
v_mfma_f32_16x16x32_bf16 v[32:35], a[148:151], a[20:23], v[32:35]
v_exp_f32 v53, v53
v_mfma_f32_16x16x32_bf16 v[36:39], a[144:147], a[48:51], v[36:39]
v_mul_f32 v54, s35, v54
v_mul_f32 v55, s35, v55
v_mfma_f32_16x16x32_bf16 v[36:39], a[148:151], a[52:55], v[36:39]
v_exp_f32 v54, v54
v_mfma_f32_16x16x32_bf16 v[40:43], a[144:147], a[80:83], v[40:43]
v_exp_f32 v55, v55
v_mfma_f32_16x16x32_bf16 v[40:43], a[148:151], a[84:87], v[40:43]
s_waitcnt lgkmcnt(8)
ds_read_b64_tr_b16 a[144:145], v2 offset:33280
ds_read_b64_tr_b16 a[146:147], v2 offset:35328
v_mfma_f32_16x16x32_bf16 v[32:35], a[152:155], a[24:27], v[32:35]
ds_read_b64_tr_b16 a[148:149], v2 offset:37376
ds_read_b64_tr_b16 a[150:151], v2 offset:39424
v_mfma_f32_16x16x32_bf16 v[32:35], a[156:159], a[28:31], v[32:35]
v_cvt_pk_bf16_f32 v70, v52, v53
v_cvt_pk_bf16_f32 v71, v54, v55
v_mfma_f32_16x16x32_bf16 v[36:39], a[152:155], a[56:59], v[36:39]
v_mul_f32 v56, s35, v56
v_mul_f32 v57, s35, v57
v_mfma_f32_16x16x32_bf16 v[36:39], a[156:159], a[60:63], v[36:39]
v_exp_f32 v56, v56
v_mfma_f32_16x16x32_bf16 v[40:43], a[152:155], a[88:91], v[40:43]
v_exp_f32 v57, v57
v_mfma_f32_16x16x32_bf16 v[40:43], a[156:159], a[92:95], v[40:43]
s_waitcnt lgkmcnt(8)
ds_read_b64_tr_b16 a[152:153], v3 offset:33280
ds_read_b64_tr_b16 a[154:155], v3 offset:35328
v_mfma_f32_16x16x32_bf16 v[96:99], a[128:131], v[80:83], v[96:99]
ds_read_b64_tr_b16 a[156:157], v3 offset:37376
ds_read_b64_tr_b16 a[158:159], v3 offset:39424
v_mfma_f32_16x16x32_bf16 v[112:115], a[132:135], v[80:83], v[112:115]
v_mul_f32 v58, s35, v58
v_mul_f32 v59, s35, v59
v_mfma_f32_16x16x32_bf16 v[100:103], a[128:131], v[84:87], v[100:103]
v_exp_f32 v58, v58
v_mfma_f32_16x16x32_bf16 v[116:119], a[132:135], v[84:87], v[116:119]
v_exp_f32 v59, v59
v_mfma_f32_16x16x32_bf16 v[104:107], a[128:131], v[88:91], v[104:107]
v_cvt_pk_bf16_f32 v74, v56, v57
v_cvt_pk_bf16_f32 v75, v58, v59
v_mfma_f32_16x16x32_bf16 v[120:123], a[132:135], v[88:91], v[120:123]
s_waitcnt lgkmcnt(8)
ds_read_b128 a[128:131], v1 offset:16384
ds_read_b128 a[132:135], v1 offset:16640
v_mfma_f32_16x16x32_bf16 v[96:99], a[136:139], v[64:67], v[96:99]
v_add_f32 v6, v6, v48
v_add_f32 v6, v6, v49
v_mfma_f32_16x16x32_bf16 v[112:115], a[140:143], v[64:67], v[112:115]
v_mul_f32 v32, s35, v32
v_add_f32 v6, v6, v50
v_mfma_f32_16x16x32_bf16 v[100:103], a[136:139], v[68:71], v[100:103]
v_mul_f32 v33, s35, v33
v_add_f32 v6, v6, v51
v_mfma_f32_16x16x32_bf16 v[116:119], a[140:143], v[68:71], v[116:119]
v_exp_f32 v32, v32
v_mfma_f32_16x16x32_bf16 v[104:107], a[136:139], v[72:75], v[104:107]
s_add_u32 m0, s25, 57344
v_exp_f32 v33, v33
v_mfma_f32_16x16x32_bf16 v[120:123], a[140:143], v[72:75], v[120:123]
s_waitcnt lgkmcnt(6)
ds_read_b128 a[136:139], v1 offset:16896
ds_read_b128 a[140:143], v1 offset:17152
v_mfma_f32_16x16x32_bf16 v[128:131], a[144:147], v[80:83], v[128:131]
v_add_f32 v7, v7, v52
v_add_f32 v7, v7, v53
v_mfma_f32_16x16x32_bf16 v[128:131], a[148:151], v[64:67], v[128:131]
v_mul_f32 v34, s35, v34
v_mul_f32 v35, s35, v35
v_mfma_f32_16x16x32_bf16 v[132:135], a[144:147], v[84:87], v[132:135]
v_add_f32 v7, v7, v54
v_add_f32 v7, v7, v55
v_mfma_f32_16x16x32_bf16 v[132:135], a[148:151], v[68:71], v[132:135]
v_exp_f32 v34, v34
v_mfma_f32_16x16x32_bf16 v[136:139], a[144:147], v[88:91], v[136:139]
buffer_load_dwordx4 v4, s[12:15], s29 offen offset:0 lds
v_mfma_f32_16x16x32_bf16 v[136:139], a[148:151], v[72:75], v[136:139]
s_waitcnt lgkmcnt(4)
v_exp_f32 v35, v35
v_mfma_f32_16x16x32_bf16 v[144:147], a[152:155], v[80:83], v[144:147]
s_add_u32 m0, s25, 58112
ds_read_b128 a[144:147], v1 offset:17408
v_add_f32 v8, v8, v56
v_mfma_f32_16x16x32_bf16 v[144:147], a[156:159], v[64:67], v[144:147]
ds_read_b128 a[148:151], v1 offset:17664
v_add_f32 v6, v6, v32
v_mfma_f32_16x16x32_bf16 v[148:151], a[152:155], v[84:87], v[148:151]
v_add_f32 v8, v8, v57
v_add_f32 v6, v6, v33
v_mfma_f32_16x16x32_bf16 v[148:151], a[156:159], v[68:71], v[148:151]
v_add_f32 v6, v6, v34
v_add_f32 v8, v8, v58
v_mfma_f32_16x16x32_bf16 v[152:155], a[152:155], v[88:91], v[152:155]
v_add_f32 v8, v8, v59
v_add_f32 v6, v6, v35
v_mfma_f32_16x16x32_bf16 v[152:155], a[156:159], v[72:75], v[152:155]
s_waitcnt lgkmcnt(4)
v_cvt_pk_bf16_f32 v32, v32, v33
v_cvt_pk_bf16_f32 v33, v34, v35
v_mfma_f32_16x16x32_bf16 v[48:51], a[128:131], a[0:3], v[16:19]
ds_read_b128 a[152:155], v1 offset:17920
ds_read_b128 a[156:159], v1 offset:18176
v_mfma_f32_16x16x32_bf16 v[48:51], a[132:135], a[4:7], v[48:51]
v_mul_f32 v36, s35, v36
v_mul_f32 v37, s35, v37
v_mfma_f32_16x16x32_bf16 v[52:55], a[128:131], a[32:35], v[20:23]
v_exp_f32 v36, v36
v_mfma_f32_16x16x32_bf16 v[52:55], a[132:135], a[36:39], v[52:55]
buffer_load_dwordx4 v4, s[12:15], s29 offen offset:256 lds
v_mfma_f32_16x16x32_bf16 v[56:59], a[128:131], a[64:67], v[24:27]
s_add_u32 s29, s29, 8192
v_exp_f32 v37, v37
v_mfma_f32_16x16x32_bf16 v[56:59], a[132:135], a[68:71], v[56:59]
s_waitcnt lgkmcnt(4)
v_mul_f32 v38, s35, v38
v_mul_f32 v39, s35, v39
v_mfma_f32_16x16x32_bf16 v[48:51], a[136:139], a[8:11], v[48:51]
v_exp_f32 v38, v38
v_mfma_f32_16x16x32_bf16 v[48:51], a[140:143], a[12:15], v[48:51]
s_waitcnt vmcnt(16) lgkmcnt(0)
v_exp_f32 v39, v39
v_mfma_f32_16x16x32_bf16 v[52:55], a[136:139], a[40:43], v[52:55]
s_barrier
v_mfma_f32_16x16x32_bf16 v[52:55], a[140:143], a[44:47], v[52:55]
v_add_f32 v7, v7, v36
v_add_f32 v7, v7, v37
v_mfma_f32_16x16x32_bf16 v[56:59], a[136:139], a[72:75], v[56:59]
v_add_f32 v7, v7, v38
v_add_f32 v7, v7, v39
v_mfma_f32_16x16x32_bf16 v[56:59], a[140:143], a[76:79], v[56:59]
ds_read_b64_tr_b16 a[128:129], v2 offset:40960
ds_read_b64_tr_b16 a[130:131], v2 offset:43008
v_mfma_f32_16x16x32_bf16 v[48:51], a[144:147], a[16:19], v[48:51]
ds_read_b64_tr_b16 a[132:133], v2 offset:45056
ds_read_b64_tr_b16 a[134:135], v2 offset:47104
v_mfma_f32_16x16x32_bf16 v[48:51], a[148:151], a[20:23], v[48:51]
v_cvt_pk_bf16_f32 v36, v36, v37
v_cvt_pk_bf16_f32 v37, v38, v39
v_mfma_f32_16x16x32_bf16 v[52:55], a[144:147], a[48:51], v[52:55]
ds_read_b64_tr_b16 a[136:137], v3 offset:40960
v_mul_f32 v40, s35, v40
v_mfma_f32_16x16x32_bf16 v[52:55], a[148:151], a[52:55], v[52:55]
ds_read_b64_tr_b16 a[138:139], v3 offset:43008
ds_read_b64_tr_b16 a[140:141], v3 offset:45056
ds_read_b64_tr_b16 a[142:143], v3 offset:47104
v_mfma_f32_16x16x32_bf16 v[56:59], a[144:147], a[80:83], v[56:59]
v_mul_f32 v41, s35, v41
v_mul_f32 v42, s35, v42
v_mfma_f32_16x16x32_bf16 v[56:59], a[148:151], a[84:87], v[56:59]
v_exp_f32 v40, v40
v_mfma_f32_16x16x32_bf16 v[48:51], a[152:155], a[24:27], v[48:51]
v_exp_f32 v41, v41
v_mfma_f32_16x16x32_bf16 v[48:51], a[156:159], a[28:31], v[48:51]
ds_read_b64_tr_b16 a[144:145], v2 offset:41472
v_mul_f32 v43, s35, v43
v_mfma_f32_16x16x32_bf16 v[52:55], a[152:155], a[56:59], v[52:55]
v_exp_f32 v42, v42
v_mfma_f32_16x16x32_bf16 v[52:55], a[156:159], a[60:63], v[52:55]
ds_read_b64_tr_b16 a[146:147], v2 offset:43520
ds_read_b64_tr_b16 a[148:149], v2 offset:45568
ds_read_b64_tr_b16 a[150:151], v2 offset:47616
v_mfma_f32_16x16x32_bf16 v[56:59], a[152:155], a[88:91], v[56:59]
v_exp_f32 v43, v43
v_mfma_f32_16x16x32_bf16 v[56:59], a[156:159], a[92:95], v[56:59]
s_waitcnt lgkmcnt(8)
v_add_f32 v8, v8, v40
v_add_f32 v8, v8, v41
v_mfma_f32_16x16x32_bf16 a[160:163], a[128:131], v[80:83], a[160:163]
v_add_f32 v8, v8, v42
v_add_f32 v8, v8, v43
v_mfma_f32_16x16x32_bf16 a[160:163], a[132:135], v[64:67], a[160:163]
ds_read_b64_tr_b16 a[152:153], v3 offset:41472
v_cvt_pk_bf16_f32 v40, v40, v41
v_mfma_f32_16x16x32_bf16 a[164:167], a[128:131], v[84:87], a[164:167]
ds_read_b64_tr_b16 a[154:155], v3 offset:43520
ds_read_b64_tr_b16 a[156:157], v3 offset:45568
v_mfma_f32_16x16x32_bf16 a[164:167], a[132:135], v[68:71], a[164:167]
ds_read_b64_tr_b16 a[158:159], v3 offset:47616
v_cvt_pk_bf16_f32 v41, v42, v43
v_mfma_f32_16x16x32_bf16 a[168:171], a[128:131], v[88:91], a[168:171]
v_mul_f32 v48, s35, v48
v_mul_f32 v49, s35, v49
v_mfma_f32_16x16x32_bf16 a[168:171], a[132:135], v[72:75], a[168:171]
s_waitcnt lgkmcnt(8)
v_exp_f32 v48, v48
v_mfma_f32_16x16x32_bf16 a[176:179], a[136:139], v[80:83], a[176:179]
ds_read_b64_tr_b16 a[128:129], v2 offset:49152
ds_read_b64_tr_b16 a[130:131], v2 offset:51200
v_mfma_f32_16x16x32_bf16 a[176:179], a[140:143], v[64:67], a[176:179]
ds_read_b64_tr_b16 a[132:133], v2 offset:53248
ds_read_b64_tr_b16 a[134:135], v2 offset:55296
v_mfma_f32_16x16x32_bf16 a[180:183], a[136:139], v[84:87], a[180:183]
v_add_f32 v6, v6, v48
v_mul_f32 v50, s35, v50
v_mfma_f32_16x16x32_bf16 a[180:183], a[140:143], v[68:71], a[180:183]
v_exp_f32 v49, v49
v_mfma_f32_16x16x32_bf16 a[184:187], a[136:139], v[88:91], a[184:187]
v_mul_f32 v51, s35, v51
v_add_f32 v6, v6, v49
v_mfma_f32_16x16x32_bf16 a[184:187], a[140:143], v[72:75], a[184:187]
s_waitcnt lgkmcnt(8)
v_exp_f32 v50, v50
v_mfma_f32_16x16x32_bf16 a[192:195], a[144:147], v[80:83], a[192:195]
ds_read_b64_tr_b16 a[136:137], v3 offset:49152
ds_read_b64_tr_b16 a[138:139], v3 offset:51200
v_mfma_f32_16x16x32_bf16 a[192:195], a[148:151], v[64:67], a[192:195]
ds_read_b64_tr_b16 a[140:141], v3 offset:53248
ds_read_b64_tr_b16 a[142:143], v3 offset:55296
v_mfma_f32_16x16x32_bf16 a[196:199], a[144:147], v[84:87], a[196:199]
v_exp_f32 v51, v51
v_mfma_f32_16x16x32_bf16 a[196:199], a[148:151], v[68:71], a[196:199]
v_add_f32 v6, v6, v50
v_cvt_pk_bf16_f32 v34, v48, v49
v_mfma_f32_16x16x32_bf16 a[200:203], a[144:147], v[88:91], a[200:203]
v_cvt_pk_bf16_f32 v35, v50, v51
v_add_f32 v6, v6, v51
v_mfma_f32_16x16x32_bf16 a[200:203], a[148:151], v[72:75], a[200:203]
s_waitcnt lgkmcnt(8)
buffer_load_dword v10, v11, s[96:99], s95 offen
v_mfma_f32_16x16x32_bf16 a[208:211], a[152:155], v[80:83], a[208:211]
s_add_u32 m0, s25, 0
ds_read_b64_tr_b16 a[144:145], v2 offset:49664
v_mul_f32 v52, s35, v52
v_mfma_f32_16x16x32_bf16 a[208:211], a[156:159], v[64:67], a[208:211]
ds_read_b64_tr_b16 a[146:147], v2 offset:51712
ds_read_b64_tr_b16 a[148:149], v2 offset:53760
v_mfma_f32_16x16x32_bf16 a[212:215], a[152:155], v[84:87], a[212:215]
ds_read_b64_tr_b16 a[150:151], v2 offset:55808
v_mul_f32 v53, s35, v53
v_mfma_f32_16x16x32_bf16 a[212:215], a[156:159], v[68:71], a[212:215]
v_exp_f32 v52, v52
v_mfma_f32_16x16x32_bf16 a[216:219], a[152:155], v[88:91], a[216:219]
v_add_f32 v7, v7, v52
v_mul_f32 v54, s35, v54
v_mfma_f32_16x16x32_bf16 a[216:219], a[156:159], v[72:75], a[216:219]
s_waitcnt lgkmcnt(8)
v_exp_f32 v53, v53
v_mfma_f32_16x16x32_bf16 a[224:227], a[128:131], v[80:83], a[224:227]
buffer_load_dwordx4 v4, s[12:15], s29 offen offset:0 lds
v_mfma_f32_16x16x32_bf16 a[224:227], a[132:135], v[64:67], a[224:227]
s_add_u32 m0, s25, 768
ds_read_b64_tr_b16 a[152:153], v3 offset:49664
ds_read_b64_tr_b16 a[154:155], v3 offset:51712
v_mfma_f32_16x16x32_bf16 a[228:231], a[128:131], v[84:87], a[228:231]
ds_read_b64_tr_b16 a[156:157], v3 offset:53760
ds_read_b64_tr_b16 a[158:159], v3 offset:55808
v_mfma_f32_16x16x32_bf16 a[228:231], a[132:135], v[68:71], a[228:231]
v_add_f32 v7, v7, v53
v_mul_f32 v55, s35, v55
v_mfma_f32_16x16x32_bf16 a[232:235], a[128:131], v[88:91], a[232:235]
v_exp_f32 v54, v54
v_mfma_f32_16x16x32_bf16 a[232:235], a[132:135], v[72:75], a[232:235]
s_waitcnt lgkmcnt(8)
buffer_load_dwordx4 v4, s[12:15], s29 offen offset:256 lds
v_mfma_f32_16x16x32_bf16 a[240:243], a[136:139], v[80:83], a[240:243]
s_add_u32 s29, s29, 8192
ds_read_b128 a[128:131], v1 offset:24576
v_add_f32 v7, v7, v54
v_mfma_f32_16x16x32_bf16 a[240:243], a[140:143], v[64:67], a[240:243]
s_cmp_eq_u32 s29, s30
v_exp_f32 v55, v55
v_mfma_f32_16x16x32_bf16 a[244:247], a[136:139], v[84:87], a[244:247]
s_cselect_b32 s29, s31, s29
ds_read_b128 a[132:135], v1 offset:24832
v_cvt_pk_bf16_f32 v38, v52, v53
v_mfma_f32_16x16x32_bf16 a[244:247], a[140:143], v[68:71], a[244:247]
s_add_u32 m0, s25, 8192
v_add_f32 v7, v7, v55
v_cvt_pk_bf16_f32 v39, v54, v55
v_mfma_f32_16x16x32_bf16 a[248:251], a[136:139], v[88:91], a[248:251]
v_mul_f32 v56, s35, v56
v_mul_f32 v57, s35, v57
v_mfma_f32_16x16x32_bf16 a[248:251], a[140:143], v[72:75], a[248:251]
s_waitcnt lgkmcnt(6)
v_exp_f32 v56, v56
v_mfma_f32_16x16x32_bf16 v[160:163], a[144:147], v[80:83], v[160:163]
ds_read_b128 a[136:139], v1 offset:25088
v_add_f32 v8, v8, v56
v_mfma_f32_16x16x32_bf16 v[160:163], a[148:151], v[64:67], v[160:163]
ds_read_b128 a[140:143], v1 offset:25344
v_mul_f32 v58, s35, v58
v_mfma_f32_16x16x32_bf16 v[164:167], a[144:147], v[84:87], v[164:167]
v_exp_f32 v57, v57
v_mfma_f32_16x16x32_bf16 v[164:167], a[148:151], v[68:71], v[164:167]
v_add_f32 v8, v8, v57
v_mul_f32 v59, s35, v59
v_mfma_f32_16x16x32_bf16 v[168:171], a[144:147], v[88:91], v[168:171]
buffer_load_dwordx4 v4, s[12:15], s29 offen offset:0 lds
v_mfma_f32_16x16x32_bf16 v[168:171], a[148:151], v[72:75], v[168:171]
s_waitcnt lgkmcnt(4)
v_exp_f32 v58, v58
v_mfma_f32_16x16x32_bf16 v[176:179], a[152:155], v[80:83], v[176:179]
s_add_u32 m0, s25, 8960
ds_read_b128 a[144:147], v1 offset:25600
v_add_f32 v8, v8, v58
v_mfma_f32_16x16x32_bf16 v[176:179], a[156:159], v[64:67], v[176:179]
ds_read_b128 a[148:151], v1 offset:25856
v_cvt_pk_bf16_f32 v42, v56, v57
v_mfma_f32_16x16x32_bf16 v[180:183], a[152:155], v[84:87], v[180:183]
v_exp_f32 v59, v59
v_mfma_f32_16x16x32_bf16 v[180:183], a[156:159], v[68:71], v[180:183]
buffer_load_dwordx4 v4, s[12:15], s29 offen offset:256 lds
v_mfma_f32_16x16x32_bf16 v[184:187], a[152:155], v[88:91], v[184:187]
s_add_u32 s29, s29, 8192
v_add_f32 v8, v8, v59
v_cvt_pk_bf16_f32 v43, v58, v59
v_mfma_f32_16x16x32_bf16 v[184:187], a[156:159], v[72:75], v[184:187]
s_waitcnt lgkmcnt(4)
ds_read_b128 a[152:155], v1 offset:26112
ds_read_b128 a[156:159], v1 offset:26368
v_mfma_f32_16x16x32_bf16 v[48:51], a[128:131], a[0:3], v[16:19]
buffer_load_dword v10, v11, s[12:15], s91 offen
v_mfma_f32_16x16x32_bf16 v[48:51], a[132:135], a[4:7], v[48:51]
s_add_u32 s91, s91, 24576
v_mfma_f32_16x16x32_bf16 v[52:55], a[128:131], a[32:35], v[20:23]
s_add_u32 m0, s25, 16384
v_mfma_f32_16x16x32_bf16 v[52:55], a[132:135], a[36:39], v[52:55]
buffer_load_dwordx4 v4, s[12:15], s29 offen offset:0 lds
v_mfma_f32_16x16x32_bf16 v[56:59], a[128:131], a[64:67], v[24:27]
s_add_u32 m0, s25, 17152
v_mfma_f32_16x16x32_bf16 v[56:59], a[132:135], a[68:71], v[56:59]
s_waitcnt lgkmcnt(4)
ds_read_b64_tr_b16 a[128:129], v2 offset:57344
ds_read_b64_tr_b16 a[130:131], v2 offset:59392
v_mfma_f32_16x16x32_bf16 v[48:51], a[136:139], a[8:11], v[48:51]
ds_read_b64_tr_b16 a[132:133], v2 offset:61440
ds_read_b64_tr_b16 a[134:135], v2 offset:63488
v_mfma_f32_16x16x32_bf16 v[48:51], a[140:143], a[12:15], v[48:51]
buffer_load_dwordx4 v4, s[12:15], s29 offen offset:256 lds
v_mfma_f32_16x16x32_bf16 v[52:55], a[136:139], a[40:43], v[52:55]
s_add_u32 s29, s29, 8192
v_mfma_f32_16x16x32_bf16 v[52:55], a[140:143], a[44:47], v[52:55]
buffer_load_dword v10, v11, s[16:19], s92 offen
v_mfma_f32_16x16x32_bf16 v[56:59], a[136:139], a[72:75], v[56:59]
v_mfma_f32_16x16x32_bf16 v[56:59], a[140:143], a[76:79], v[56:59]
s_waitcnt lgkmcnt(6)
ds_read_b64_tr_b16 a[136:137], v3 offset:57344
ds_read_b64_tr_b16 a[138:139], v3 offset:59392
v_mfma_f32_16x16x32_bf16 v[48:51], a[144:147], a[16:19], v[48:51]
s_add_u32 s92, s92, 24576
ds_read_b64_tr_b16 a[140:141], v3 offset:61440
ds_read_b64_tr_b16 a[142:143], v3 offset:63488
v_mfma_f32_16x16x32_bf16 v[48:51], a[148:151], a[20:23], v[48:51]
v_mfma_f32_16x16x32_bf16 v[52:55], a[144:147], a[48:51], v[52:55]
s_add_u32 s32, s32, 32768
v_mfma_f32_16x16x32_bf16 v[52:55], a[148:151], a[52:55], v[52:55]
v_mfma_f32_16x16x32_bf16 v[56:59], a[144:147], a[80:83], v[56:59]
s_add_u32 s33, s32, 4096
v_mfma_f32_16x16x32_bf16 v[56:59], a[148:151], a[84:87], v[56:59]
s_waitcnt lgkmcnt(8)
ds_read_b64_tr_b16 a[144:145], v2 offset:57856
ds_read_b64_tr_b16 a[146:147], v2 offset:59904
v_mfma_f32_16x16x32_bf16 v[48:51], a[152:155], a[24:27], v[48:51]
ds_read_b64_tr_b16 a[148:149], v2 offset:61952
ds_read_b64_tr_b16 a[150:151], v2 offset:64000
v_mfma_f32_16x16x32_bf16 v[48:51], a[156:159], a[28:31], v[48:51]
s_add_u32 m0, s25, 98304
v_mfma_f32_16x16x32_bf16 v[52:55], a[152:155], a[56:59], v[52:55]
v_mfma_f32_16x16x32_bf16 v[52:55], a[156:159], a[60:63], v[52:55]
buffer_load_dwordx4 v5, s[16:19], s32 offen offset:0 lds
v_mfma_f32_16x16x32_bf16 v[56:59], a[152:155], a[88:91], v[56:59]
v_mfma_f32_16x16x32_bf16 v[56:59], a[156:159], a[92:95], v[56:59]
s_waitcnt lgkmcnt(8)
ds_read_b64_tr_b16 a[152:153], v3 offset:57856
ds_read_b64_tr_b16 a[154:155], v3 offset:59904
v_mfma_f32_16x16x32_bf16 v[192:195], a[128:131], v[80:83], v[192:195]
s_add_u32 m0, s25, 99328
ds_read_b64_tr_b16 a[156:157], v3 offset:61952
ds_read_b64_tr_b16 a[158:159], v3 offset:64000
v_mfma_f32_16x16x32_bf16 v[192:195], a[132:135], v[64:67], v[192:195]
v_mul_f32 v48, s35, v48
v_mul_f32 v49, s35, v49
v_mfma_f32_16x16x32_bf16 v[196:199], a[128:131], v[84:87], v[196:199]
v_exp_f32 v48, v48
v_mfma_f32_16x16x32_bf16 v[196:199], a[132:135], v[68:71], v[196:199]
v_exp_f32 v49, v49
v_mfma_f32_16x16x32_bf16 v[200:203], a[128:131], v[88:91], v[200:203]
v_mul_f32 v50, s35, v50
v_mul_f32 v51, s35, v51
v_mfma_f32_16x16x32_bf16 v[200:203], a[132:135], v[72:75], v[200:203]
s_waitcnt lgkmcnt(8)
v_exp_f32 v50, v50
v_mfma_f32_16x16x32_bf16 v[208:211], a[136:139], v[80:83], v[208:211]
v_exp_f32 v51, v51
v_mfma_f32_16x16x32_bf16 v[208:211], a[140:143], v[64:67], v[208:211]
s_waitcnt vmcnt(18) lgkmcnt(0)
buffer_load_dwordx4 v5, s[16:19], s33 offen offset:0 lds
v_mfma_f32_16x16x32_bf16 v[212:215], a[136:139], v[84:87], v[212:215]
s_barrier
v_mfma_f32_16x16x32_bf16 v[212:215], a[140:143], v[68:71], v[212:215]
ds_read_b128 a[128:131], v1 offset:32768
v_add_f32 v6, v6, v48
v_mfma_f32_16x16x32_bf16 v[216:219], a[136:139], v[88:91], v[216:219]
ds_read_b128 a[132:135], v1 offset:33024
v_add_f32 v6, v6, v49
v_mfma_f32_16x16x32_bf16 v[216:219], a[140:143], v[72:75], v[216:219]
v_add_f32 v6, v6, v50
v_add_f32 v6, v6, v51
v_mfma_f32_16x16x32_bf16 v[224:227], a[144:147], v[80:83], v[224:227]
ds_read_b128 a[136:139], v1 offset:33280
ds_read_b128 a[140:143], v1 offset:33536
v_mfma_f32_16x16x32_bf16 v[224:227], a[148:151], v[64:67], v[224:227]
v_cvt_pk_bf16_f32 v48, v48, v49
v_cvt_pk_bf16_f32 v49, v50, v51
v_mfma_f32_16x16x32_bf16 v[228:231], a[144:147], v[84:87], v[228:231]
v_mul_f32 v52, s35, v52
v_mul_f32 v53, s35, v53
v_mfma_f32_16x16x32_bf16 v[228:231], a[148:151], v[68:71], v[228:231]
v_exp_f32 v52, v52
v_mfma_f32_16x16x32_bf16 v[232:235], a[144:147], v[88:91], v[232:235]
v_exp_f32 v53, v53
v_mfma_f32_16x16x32_bf16 v[232:235], a[148:151], v[72:75], v[232:235]
v_mul_f32 v54, s35, v54
v_mul_f32 v55, s35, v55
v_mfma_f32_16x16x32_bf16 v[240:243], a[152:155], v[80:83], v[240:243]
s_sub_u32 s36, s36, 1
ds_read_b128 a[144:147], v1 offset:33792
ds_read_b128 a[148:151], v1 offset:34048
v_mfma_f32_16x16x32_bf16 v[240:243], a[156:159], v[64:67], v[240:243]
s_cmp_eq_u32 s36, 0
v_exp_f32 v54, v54
v_mfma_f32_16x16x32_bf16 v[244:247], a[152:155], v[84:87], v[244:247]
v_exp_f32 v55, v55
v_mfma_f32_16x16x32_bf16 v[244:247], a[156:159], v[68:71], v[244:247]
v_add_f32 v7, v7, v52
v_add_f32 v7, v7, v53
v_mfma_f32_16x16x32_bf16 v[248:251], a[152:155], v[88:91], v[248:251]
v_add_f32 v7, v7, v54
v_add_f32 v7, v7, v55
v_mfma_f32_16x16x32_bf16 v[248:251], a[156:159], v[72:75], v[248:251]
s_waitcnt lgkmcnt(4)
v_cvt_pk_bf16_f32 v52, v52, v53
v_cvt_pk_bf16_f32 v53, v54, v55
s_cbranch_scc1 L_i6_3
v_mfma_f32_16x16x32_bf16 v[64:67], a[128:131], a[0:3], v[16:19]
ds_read_b128 a[152:155], v1 offset:34304
ds_read_b128 a[156:159], v1 offset:34560
v_mfma_f32_16x16x32_bf16 v[64:67], a[132:135], a[4:7], v[64:67]
v_mul_f32 v56, s35, v56
v_mul_f32 v57, s35, v57
v_mfma_f32_16x16x32_bf16 v[68:71], a[128:131], a[32:35], v[20:23]
s_add_u32 m0, s25, 106368
v_exp_f32 v56, v56
v_mfma_f32_16x16x32_bf16 v[68:71], a[132:135], a[36:39], v[68:71]
buffer_load_dwordx4 v5, s[16:19], s32 offen offset:128 lds
v_mfma_f32_16x16x32_bf16 v[72:75], a[128:131], a[64:67], v[24:27]
s_add_u32 m0, s25, 107392
v_exp_f32 v57, v57
v_mfma_f32_16x16x32_bf16 v[72:75], a[132:135], a[68:71], v[72:75]
s_waitcnt lgkmcnt(4)
ds_read_b128 a[128:131], v1 offset:40960
ds_read_b128 a[132:135], v1 offset:41216
v_mfma_f32_16x16x32_bf16 v[64:67], a[136:139], a[8:11], v[64:67]
v_mul_f32 v58, s35, v58
v_mul_f32 v59, s35, v59
v_mfma_f32_16x16x32_bf16 v[64:67], a[140:143], a[12:15], v[64:67]
buffer_load_dwordx4 v5, s[16:19], s33 offen offset:128 lds
v_mfma_f32_16x16x32_bf16 v[68:71], a[136:139], a[40:43], v[68:71]
s_add_u32 m0, s25, 114432
v_exp_f32 v58, v58
v_mfma_f32_16x16x32_bf16 v[68:71], a[140:143], a[44:47], v[68:71]
v_exp_f32 v59, v59
v_mfma_f32_16x16x32_bf16 v[72:75], a[136:139], a[72:75], v[72:75]
buffer_load_dwordx4 v5, s[16:19], s32 offen offset:256 lds
v_mfma_f32_16x16x32_bf16 v[72:75], a[140:143], a[76:79], v[72:75]
s_waitcnt lgkmcnt(4)
ds_read_b128 a[136:139], v1 offset:41472
ds_read_b128 a[140:143], v1 offset:41728
v_mfma_f32_16x16x32_bf16 v[64:67], a[144:147], a[16:19], v[64:67]
s_add_u32 m0, s25, 115456
v_add_f32 v8, v8, v56
v_add_f32 v8, v8, v57
v_mfma_f32_16x16x32_bf16 v[64:67], a[148:151], a[20:23], v[64:67]
v_add_f32 v8, v8, v58
v_add_f32 v8, v8, v59
v_mfma_f32_16x16x32_bf16 v[68:71], a[144:147], a[48:51], v[68:71]
buffer_load_dwordx4 v5, s[16:19], s33 offen offset:256 lds
v_mfma_f32_16x16x32_bf16 v[68:71], a[148:151], a[52:55], v[68:71]
s_add_u32 m0, s25, 122496
v_cvt_pk_bf16_f32 v56, v56, v57
v_cvt_pk_bf16_f32 v57, v58, v59
v_mfma_f32_16x16x32_bf16 v[72:75], a[144:147], a[80:83], v[72:75]
buffer_load_dwordx4 v5, s[16:19], s32 offen offset:384 lds
v_mfma_f32_16x16x32_bf16 v[72:75], a[148:151], a[84:87], v[72:75]
s_waitcnt lgkmcnt(4)
ds_read_b128 a[144:147], v1 offset:41984
ds_read_b128 a[148:151], v1 offset:42240
v_mfma_f32_16x16x32_bf16 v[64:67], a[152:155], a[24:27], v[64:67]
s_add_u32 m0, s25, 123520
v_mfma_f32_16x16x32_bf16 v[64:67], a[156:159], a[28:31], v[64:67]
buffer_load_dwordx4 v5, s[16:19], s33 offen offset:384 lds
v_mfma_f32_16x16x32_bf16 v[68:71], a[152:155], a[56:59], v[68:71]
v_mfma_f32_16x16x32_bf16 v[68:71], a[156:159], a[60:63], v[68:71]
v_mfma_f32_16x16x32_bf16 v[72:75], a[152:155], a[88:91], v[72:75]
v_mfma_f32_16x16x32_bf16 v[72:75], a[156:159], a[92:95], v[72:75]
s_waitcnt lgkmcnt(4)
ds_read_b128 a[152:155], v1 offset:42496
ds_read_b128 a[156:159], v1 offset:42752
v_mfma_f32_16x16x32_bf16 v[80:83], a[128:131], a[0:3], v[16:19]
v_mul_f32 v64, s35, v64
v_mul_f32 v65, s35, v65
v_mfma_f32_16x16x32_bf16 v[80:83], a[132:135], a[4:7], v[80:83]
v_exp_f32 v64, v64
v_mfma_f32_16x16x32_bf16 v[84:87], a[128:131], a[32:35], v[20:23]
v_exp_f32 v65, v65
v_mfma_f32_16x16x32_bf16 v[84:87], a[132:135], a[36:39], v[84:87]
v_mul_f32 v66, s35, v66
v_mul_f32 v67, s35, v67
v_mfma_f32_16x16x32_bf16 v[88:91], a[128:131], a[64:67], v[24:27]
v_exp_f32 v66, v66
v_mfma_f32_16x16x32_bf16 v[88:91], a[132:135], a[68:71], v[88:91]
s_waitcnt lgkmcnt(4)
ds_read_b64_tr_b16 a[128:129], v2 offset:0
ds_read_b64_tr_b16 a[130:131], v2 offset:2048
v_mfma_f32_16x16x32_bf16 v[80:83], a[136:139], a[8:11], v[80:83]
ds_read_b64_tr_b16 a[132:133], v3 offset:0
ds_read_b64_tr_b16 a[134:135], v3 offset:2048
v_mfma_f32_16x16x32_bf16 v[80:83], a[140:143], a[12:15], v[80:83]
v_exp_f32 v67, v67
v_mfma_f32_16x16x32_bf16 v[84:87], a[136:139], a[40:43], v[84:87]
v_cvt_pk_bf16_f32 v50, v64, v65
v_cvt_pk_bf16_f32 v51, v66, v67
v_mfma_f32_16x16x32_bf16 v[84:87], a[140:143], a[44:47], v[84:87]
v_mul_f32 v68, s35, v68
v_mul_f32 v69, s35, v69
v_mfma_f32_16x16x32_bf16 v[88:91], a[136:139], a[72:75], v[88:91]
v_exp_f32 v68, v68
v_mfma_f32_16x16x32_bf16 v[88:91], a[140:143], a[76:79], v[88:91]
s_waitcnt lgkmcnt(6)
ds_read_b64_tr_b16 a[136:137], v2 offset:4096
ds_read_b64_tr_b16 a[138:139], v2 offset:6144
v_mfma_f32_16x16x32_bf16 v[80:83], a[144:147], a[16:19], v[80:83]
ds_read_b64_tr_b16 a[140:141], v3 offset:4096
ds_read_b64_tr_b16 a[142:143], v3 offset:6144
v_mfma_f32_16x16x32_bf16 v[80:83], a[148:151], a[20:23], v[80:83]
v_exp_f32 v69, v69
v_mfma_f32_16x16x32_bf16 v[84:87], a[144:147], a[48:51], v[84:87]
v_mul_f32 v70, s35, v70
v_mul_f32 v71, s35, v71
v_mfma_f32_16x16x32_bf16 v[84:87], a[148:151], a[52:55], v[84:87]
v_exp_f32 v70, v70
v_mfma_f32_16x16x32_bf16 v[88:91], a[144:147], a[80:83], v[88:91]
v_exp_f32 v71, v71
v_mfma_f32_16x16x32_bf16 v[88:91], a[148:151], a[84:87], v[88:91]
s_waitcnt lgkmcnt(8)
ds_read_b64_tr_b16 a[144:145], v2 offset:512
ds_read_b64_tr_b16 a[146:147], v2 offset:2560
v_mfma_f32_16x16x32_bf16 v[80:83], a[152:155], a[24:27], v[80:83]
ds_read_b64_tr_b16 a[148:149], v2 offset:4608
ds_read_b64_tr_b16 a[150:151], v2 offset:6656
v_mfma_f32_16x16x32_bf16 v[80:83], a[156:159], a[28:31], v[80:83]
v_cvt_pk_bf16_f32 v54, v68, v69
v_cvt_pk_bf16_f32 v55, v70, v71
v_mfma_f32_16x16x32_bf16 v[84:87], a[152:155], a[56:59], v[84:87]
v_mul_f32 v72, s35, v72
v_mul_f32 v73, s35, v73
v_mfma_f32_16x16x32_bf16 v[84:87], a[156:159], a[60:63], v[84:87]
v_exp_f32 v72, v72
v_mfma_f32_16x16x32_bf16 v[88:91], a[152:155], a[88:91], v[88:91]
v_exp_f32 v73, v73
v_mfma_f32_16x16x32_bf16 v[88:91], a[156:159], a[92:95], v[88:91]
s_waitcnt lgkmcnt(8)
ds_read_b64_tr_b16 a[152:153], v3 offset:512
ds_read_b64_tr_b16 a[154:155], v3 offset:2560
v_mfma_f32_16x16x32_bf16 v[96:99], a[128:131], v[32:35], v[96:99]
ds_read_b64_tr_b16 a[156:157], v3 offset:4608
ds_read_b64_tr_b16 a[158:159], v3 offset:6656
v_mfma_f32_16x16x32_bf16 v[112:115], a[132:135], v[32:35], v[112:115]
v_mul_f32 v74, s35, v74
v_mul_f32 v75, s35, v75
v_mfma_f32_16x16x32_bf16 v[100:103], a[128:131], v[36:39], v[100:103]
v_exp_f32 v74, v74
v_mfma_f32_16x16x32_bf16 v[116:119], a[132:135], v[36:39], v[116:119]
v_exp_f32 v75, v75
v_mfma_f32_16x16x32_bf16 v[104:107], a[128:131], v[40:43], v[104:107]
v_cvt_pk_bf16_f32 v58, v72, v73
v_cvt_pk_bf16_f32 v59, v74, v75
v_mfma_f32_16x16x32_bf16 v[120:123], a[132:135], v[40:43], v[120:123]
s_waitcnt lgkmcnt(8)
ds_read_b128 a[128:131], v1 offset:49152
ds_read_b128 a[132:135], v1 offset:49408
v_mfma_f32_16x16x32_bf16 v[96:99], a[136:139], v[48:51], v[96:99]
v_add_f32 v6, v6, v64
v_add_f32 v6, v6, v65
v_mfma_f32_16x16x32_bf16 v[112:115], a[140:143], v[48:51], v[112:115]
v_mul_f32 v80, s35, v80
v_add_f32 v6, v6, v66
v_mfma_f32_16x16x32_bf16 v[100:103], a[136:139], v[52:55], v[100:103]
v_mul_f32 v81, s35, v81
v_add_f32 v6, v6, v67
v_mfma_f32_16x16x32_bf16 v[116:119], a[140:143], v[52:55], v[116:119]
v_exp_f32 v80, v80
v_mfma_f32_16x16x32_bf16 v[104:107], a[136:139], v[56:59], v[104:107]
s_add_u32 m0, s25, 24576
v_exp_f32 v81, v81
v_mfma_f32_16x16x32_bf16 v[120:123], a[140:143], v[56:59], v[120:123]
s_waitcnt lgkmcnt(6)
ds_read_b128 a[136:139], v1 offset:49664
ds_read_b128 a[140:143], v1 offset:49920
v_mfma_f32_16x16x32_bf16 v[128:131], a[144:147], v[32:35], v[128:131]
v_add_f32 v7, v7, v68
v_add_f32 v7, v7, v69
v_mfma_f32_16x16x32_bf16 v[128:131], a[148:151], v[48:51], v[128:131]
v_mul_f32 v82, s35, v82
v_mul_f32 v83, s35, v83
v_mfma_f32_16x16x32_bf16 v[132:135], a[144:147], v[36:39], v[132:135]
v_add_f32 v7, v7, v70
v_add_f32 v7, v7, v71
v_mfma_f32_16x16x32_bf16 v[132:135], a[148:151], v[52:55], v[132:135]
v_exp_f32 v82, v82
v_mfma_f32_16x16x32_bf16 v[136:139], a[144:147], v[40:43], v[136:139]
buffer_load_dwordx4 v4, s[12:15], s29 offen offset:0 lds
v_mfma_f32_16x16x32_bf16 v[136:139], a[148:151], v[56:59], v[136:139]
s_waitcnt lgkmcnt(4)
v_exp_f32 v83, v83
v_mfma_f32_16x16x32_bf16 v[144:147], a[152:155], v[32:35], v[144:147]
s_add_u32 m0, s25, 25344
ds_read_b128 a[144:147], v1 offset:50176
v_add_f32 v8, v8, v72
v_mfma_f32_16x16x32_bf16 v[144:147], a[156:159], v[48:51], v[144:147]
ds_read_b128 a[148:151], v1 offset:50432
v_add_f32 v6, v6, v80
v_mfma_f32_16x16x32_bf16 v[148:151], a[152:155], v[36:39], v[148:151]
v_add_f32 v8, v8, v73
v_add_f32 v6, v6, v81
v_mfma_f32_16x16x32_bf16 v[148:151], a[156:159], v[52:55], v[148:151]
v_add_f32 v6, v6, v82
v_add_f32 v8, v8, v74
v_mfma_f32_16x16x32_bf16 v[152:155], a[152:155], v[40:43], v[152:155]
v_add_f32 v8, v8, v75
v_add_f32 v6, v6, v83
v_mfma_f32_16x16x32_bf16 v[152:155], a[156:159], v[56:59], v[152:155]
s_waitcnt lgkmcnt(4)
v_cvt_pk_bf16_f32 v80, v80, v81
v_cvt_pk_bf16_f32 v81, v82, v83
v_mfma_f32_16x16x32_bf16 v[64:67], a[128:131], a[0:3], v[16:19]
ds_read_b128 a[152:155], v1 offset:50688
ds_read_b128 a[156:159], v1 offset:50944
v_mfma_f32_16x16x32_bf16 v[64:67], a[132:135], a[4:7], v[64:67]
v_mul_f32 v84, s35, v84
v_mul_f32 v85, s35, v85
v_mfma_f32_16x16x32_bf16 v[68:71], a[128:131], a[32:35], v[20:23]
v_exp_f32 v84, v84
v_mfma_f32_16x16x32_bf16 v[68:71], a[132:135], a[36:39], v[68:71]
buffer_load_dwordx4 v4, s[12:15], s29 offen offset:256 lds
v_mfma_f32_16x16x32_bf16 v[72:75], a[128:131], a[64:67], v[24:27]
s_add_u32 s29, s29, 8192
v_exp_f32 v85, v85
v_mfma_f32_16x16x32_bf16 v[72:75], a[132:135], a[68:71], v[72:75]
s_waitcnt lgkmcnt(4)
v_mul_f32 v86, s35, v86
v_mul_f32 v87, s35, v87
v_mfma_f32_16x16x32_bf16 v[64:67], a[136:139], a[8:11], v[64:67]
v_exp_f32 v86, v86
v_mfma_f32_16x16x32_bf16 v[64:67], a[140:143], a[12:15], v[64:67]
s_waitcnt vmcnt(19) lgkmcnt(0)
v_exp_f32 v87, v87
v_mfma_f32_16x16x32_bf16 v[68:71], a[136:139], a[40:43], v[68:71]
s_barrier
v_mfma_f32_16x16x32_bf16 v[68:71], a[140:143], a[44:47], v[68:71]
v_add_f32 v7, v7, v84
v_add_f32 v7, v7, v85
v_mfma_f32_16x16x32_bf16 v[72:75], a[136:139], a[72:75], v[72:75]
v_add_f32 v7, v7, v86
v_add_f32 v7, v7, v87
v_mfma_f32_16x16x32_bf16 v[72:75], a[140:143], a[76:79], v[72:75]
ds_read_b64_tr_b16 a[128:129], v2 offset:8192
ds_read_b64_tr_b16 a[130:131], v2 offset:10240
v_mfma_f32_16x16x32_bf16 v[64:67], a[144:147], a[16:19], v[64:67]
ds_read_b64_tr_b16 a[132:133], v2 offset:12288
ds_read_b64_tr_b16 a[134:135], v2 offset:14336
v_mfma_f32_16x16x32_bf16 v[64:67], a[148:151], a[20:23], v[64:67]
v_cvt_pk_bf16_f32 v84, v84, v85
v_cvt_pk_bf16_f32 v85, v86, v87
v_mfma_f32_16x16x32_bf16 v[68:71], a[144:147], a[48:51], v[68:71]
ds_read_b64_tr_b16 a[136:137], v3 offset:8192
v_mul_f32 v88, s35, v88
v_mfma_f32_16x16x32_bf16 v[68:71], a[148:151], a[52:55], v[68:71]
ds_read_b64_tr_b16 a[138:139], v3 offset:10240
ds_read_b64_tr_b16 a[140:141], v3 offset:12288
ds_read_b64_tr_b16 a[142:143], v3 offset:14336
v_mfma_f32_16x16x32_bf16 v[72:75], a[144:147], a[80:83], v[72:75]
v_mul_f32 v89, s35, v89
v_mul_f32 v90, s35, v90
v_mfma_f32_16x16x32_bf16 v[72:75], a[148:151], a[84:87], v[72:75]
v_exp_f32 v88, v88
v_mfma_f32_16x16x32_bf16 v[64:67], a[152:155], a[24:27], v[64:67]
v_exp_f32 v89, v89
v_mfma_f32_16x16x32_bf16 v[64:67], a[156:159], a[28:31], v[64:67]
ds_read_b64_tr_b16 a[144:145], v2 offset:8704
v_mul_f32 v91, s35, v91
v_mfma_f32_16x16x32_bf16 v[68:71], a[152:155], a[56:59], v[68:71]
v_exp_f32 v90, v90
v_mfma_f32_16x16x32_bf16 v[68:71], a[156:159], a[60:63], v[68:71]
ds_read_b64_tr_b16 a[146:147], v2 offset:10752
ds_read_b64_tr_b16 a[148:149], v2 offset:12800
ds_read_b64_tr_b16 a[150:151], v2 offset:14848
v_mfma_f32_16x16x32_bf16 v[72:75], a[152:155], a[88:91], v[72:75]
v_exp_f32 v91, v91
v_mfma_f32_16x16x32_bf16 v[72:75], a[156:159], a[92:95], v[72:75]
s_waitcnt lgkmcnt(8)
v_add_f32 v8, v8, v88
v_add_f32 v8, v8, v89
v_mfma_f32_16x16x32_bf16 a[160:163], a[128:131], v[32:35], a[160:163]
v_add_f32 v8, v8, v90
v_add_f32 v8, v8, v91
v_mfma_f32_16x16x32_bf16 a[160:163], a[132:135], v[48:51], a[160:163]
ds_read_b64_tr_b16 a[152:153], v3 offset:8704
v_cvt_pk_bf16_f32 v88, v88, v89
v_mfma_f32_16x16x32_bf16 a[164:167], a[128:131], v[36:39], a[164:167]
ds_read_b64_tr_b16 a[154:155], v3 offset:10752
ds_read_b64_tr_b16 a[156:157], v3 offset:12800
v_mfma_f32_16x16x32_bf16 a[164:167], a[132:135], v[52:55], a[164:167]
ds_read_b64_tr_b16 a[158:159], v3 offset:14848
v_cvt_pk_bf16_f32 v89, v90, v91
v_mfma_f32_16x16x32_bf16 a[168:171], a[128:131], v[40:43], a[168:171]
v_mul_f32 v64, s35, v64
v_mul_f32 v65, s35, v65
v_mfma_f32_16x16x32_bf16 a[168:171], a[132:135], v[56:59], a[168:171]
s_waitcnt lgkmcnt(8)
v_exp_f32 v64, v64
v_mfma_f32_16x16x32_bf16 a[176:179], a[136:139], v[32:35], a[176:179]
ds_read_b64_tr_b16 a[128:129], v2 offset:16384
ds_read_b64_tr_b16 a[130:131], v2 offset:18432
v_mfma_f32_16x16x32_bf16 a[176:179], a[140:143], v[48:51], a[176:179]
ds_read_b64_tr_b16 a[132:133], v2 offset:20480
ds_read_b64_tr_b16 a[134:135], v2 offset:22528
v_mfma_f32_16x16x32_bf16 a[180:183], a[136:139], v[36:39], a[180:183]
s_add_u32 m0, s25, 32768
v_add_f32 v6, v6, v64
v_mul_f32 v66, s35, v66
v_mfma_f32_16x16x32_bf16 a[180:183], a[140:143], v[52:55], a[180:183]
v_exp_f32 v65, v65
v_mfma_f32_16x16x32_bf16 a[184:187], a[136:139], v[40:43], a[184:187]
v_mul_f32 v67, s35, v67
v_add_f32 v6, v6, v65
v_mfma_f32_16x16x32_bf16 a[184:187], a[140:143], v[56:59], a[184:187]
s_waitcnt lgkmcnt(8)
v_exp_f32 v66, v66
v_mfma_f32_16x16x32_bf16 a[192:195], a[144:147], v[32:35], a[192:195]
ds_read_b64_tr_b16 a[136:137], v3 offset:16384
ds_read_b64_tr_b16 a[138:139], v3 offset:18432
v_mfma_f32_16x16x32_bf16 a[192:195], a[148:151], v[48:51], a[192:195]
ds_read_b64_tr_b16 a[140:141], v3 offset:20480
ds_read_b64_tr_b16 a[142:143], v3 offset:22528
v_mfma_f32_16x16x32_bf16 a[196:199], a[144:147], v[36:39], a[196:199]
v_exp_f32 v67, v67
v_mfma_f32_16x16x32_bf16 a[196:199], a[148:151], v[52:55], a[196:199]
v_add_f32 v6, v6, v66
v_cvt_pk_bf16_f32 v82, v64, v65
v_mfma_f32_16x16x32_bf16 a[200:203], a[144:147], v[40:43], a[200:203]
v_cvt_pk_bf16_f32 v83, v66, v67
v_add_f32 v6, v6, v67
v_mfma_f32_16x16x32_bf16 a[200:203], a[148:151], v[56:59], a[200:203]
s_waitcnt lgkmcnt(8)
ds_read_b64_tr_b16 a[144:145], v2 offset:16896
v_mul_f32 v68, s35, v68
v_mfma_f32_16x16x32_bf16 a[208:211], a[152:155], v[32:35], a[208:211]
ds_read_b64_tr_b16 a[146:147], v2 offset:18944
ds_read_b64_tr_b16 a[148:149], v2 offset:20992
v_mfma_f32_16x16x32_bf16 a[208:211], a[156:159], v[48:51], a[208:211]
ds_read_b64_tr_b16 a[150:151], v2 offset:23040
v_mul_f32 v69, s35, v69
v_mfma_f32_16x16x32_bf16 a[212:215], a[152:155], v[36:39], a[212:215]
buffer_load_dwordx4 v4, s[12:15], s29 offen offset:0 lds
v_mfma_f32_16x16x32_bf16 a[212:215], a[156:159], v[52:55], a[212:215]
s_add_u32 m0, s25, 33536
v_exp_f32 v68, v68
v_mfma_f32_16x16x32_bf16 a[216:219], a[152:155], v[40:43], a[216:219]
v_add_f32 v7, v7, v68
v_mul_f32 v70, s35, v70
v_mfma_f32_16x16x32_bf16 a[216:219], a[156:159], v[56:59], a[216:219]
s_waitcnt lgkmcnt(8)
v_exp_f32 v69, v69
v_mfma_f32_16x16x32_bf16 a[224:227], a[128:131], v[32:35], a[224:227]
ds_read_b64_tr_b16 a[152:153], v3 offset:16896
ds_read_b64_tr_b16 a[154:155], v3 offset:18944
v_mfma_f32_16x16x32_bf16 a[224:227], a[132:135], v[48:51], a[224:227]
ds_read_b64_tr_b16 a[156:157], v3 offset:20992
ds_read_b64_tr_b16 a[158:159], v3 offset:23040
v_mfma_f32_16x16x32_bf16 a[228:231], a[128:131], v[36:39], a[228:231]
buffer_load_dwordx4 v4, s[12:15], s29 offen offset:256 lds
v_mfma_f32_16x16x32_bf16 a[228:231], a[132:135], v[52:55], a[228:231]
s_add_u32 s29, s29, 8192
v_add_f32 v7, v7, v69
v_mul_f32 v71, s35, v71
v_mfma_f32_16x16x32_bf16 a[232:235], a[128:131], v[40:43], a[232:235]
s_add_u32 m0, s93, 0
v_exp_f32 v70, v70
v_mfma_f32_16x16x32_bf16 a[232:235], a[132:135], v[56:59], a[232:235]
s_waitcnt lgkmcnt(8)
ds_read_b128 a[128:131], v1 offset:57344
v_add_f32 v7, v7, v70
v_mfma_f32_16x16x32_bf16 a[240:243], a[136:139], v[32:35], a[240:243]
v_exp_f32 v71, v71
v_mfma_f32_16x16x32_bf16 a[240:243], a[140:143], v[48:51], a[240:243]
ds_read_b128 a[132:135], v1 offset:57600
v_cvt_pk_bf16_f32 v86, v68, v69
v_mfma_f32_16x16x32_bf16 a[244:247], a[136:139], v[36:39], a[244:247]
v_add_f32 v7, v7, v71
v_cvt_pk_bf16_f32 v87, v70, v71
v_mfma_f32_16x16x32_bf16 a[244:247], a[140:143], v[52:55], a[244:247]
buffer_load_dwordx4 v12, s[8:11], s94 offen offset:0 nt lds
v_mfma_f32_16x16x32_bf16 a[248:251], a[136:139], v[40:43], a[248:251]
v_mul_f32 v72, s35, v72
v_mul_f32 v73, s35, v73
v_mfma_f32_16x16x32_bf16 a[248:251], a[140:143], v[56:59], a[248:251]
s_waitcnt lgkmcnt(6)
buffer_load_dwordx4 v12, s[8:11], s94 offen offset:2048 nt lds
v_mfma_f32_16x16x32_bf16 v[160:163], a[144:147], v[32:35], v[160:163]
s_add_u32 m0, s25, 40960
v_exp_f32 v72, v72
v_mfma_f32_16x16x32_bf16 v[160:163], a[148:151], v[48:51], v[160:163]
ds_read_b128 a[136:139], v1 offset:57856
v_add_f32 v8, v8, v72
v_mfma_f32_16x16x32_bf16 v[164:167], a[144:147], v[36:39], v[164:167]
ds_read_b128 a[140:143], v1 offset:58112
v_mul_f32 v74, s35, v74
v_mfma_f32_16x16x32_bf16 v[164:167], a[148:151], v[52:55], v[164:167]
v_exp_f32 v73, v73
v_mfma_f32_16x16x32_bf16 v[168:171], a[144:147], v[40:43], v[168:171]
v_add_f32 v8, v8, v73
v_mul_f32 v75, s35, v75
v_mfma_f32_16x16x32_bf16 v[168:171], a[148:151], v[56:59], v[168:171]
s_waitcnt lgkmcnt(4)
buffer_load_dwordx4 v4, s[12:15], s29 offen offset:0 lds
v_mfma_f32_16x16x32_bf16 v[176:179], a[152:155], v[32:35], v[176:179]
s_add_u32 m0, s25, 41728
v_exp_f32 v74, v74
v_mfma_f32_16x16x32_bf16 v[176:179], a[156:159], v[48:51], v[176:179]
ds_read_b128 a[144:147], v1 offset:58368
v_add_f32 v8, v8, v74
v_mfma_f32_16x16x32_bf16 v[180:183], a[152:155], v[36:39], v[180:183]
ds_read_b128 a[148:151], v1 offset:58624
v_cvt_pk_bf16_f32 v90, v72, v73
v_mfma_f32_16x16x32_bf16 v[180:183], a[156:159], v[52:55], v[180:183]
v_exp_f32 v75, v75
v_mfma_f32_16x16x32_bf16 v[184:187], a[152:155], v[40:43], v[184:187]
v_add_f32 v8, v8, v75
v_cvt_pk_bf16_f32 v91, v74, v75
v_mfma_f32_16x16x32_bf16 v[184:187], a[156:159], v[56:59], v[184:187]
s_waitcnt lgkmcnt(4)
buffer_load_dwordx4 v4, s[12:15], s29 offen offset:256 lds
v_mfma_f32_16x16x32_bf16 v[64:67], a[128:131], a[0:3], v[16:19]
s_add_u32 s29, s29, 8192
ds_read_b128 a[152:155], v1 offset:58880
ds_read_b128 a[156:159], v1 offset:59136
v_mfma_f32_16x16x32_bf16 v[64:67], a[132:135], a[4:7], v[64:67]
s_add_u32 m0, s93, 4096
v_mfma_f32_16x16x32_bf16 v[68:71], a[128:131], a[32:35], v[20:23]
buffer_load_dwordx4 v13, s[8:11], s94 offen offset:0 nt lds
v_mfma_f32_16x16x32_bf16 v[68:71], a[132:135], a[36:39], v[68:71]
buffer_load_dwordx4 v13, s[8:11], s94 offen offset:2048 nt lds
v_mfma_f32_16x16x32_bf16 v[72:75], a[128:131], a[64:67], v[24:27]
s_add_u32 s93, s93, 1024
v_mfma_f32_16x16x32_bf16 v[72:75], a[132:135], a[68:71], v[72:75]
s_waitcnt lgkmcnt(4)
ds_read_b64_tr_b16 a[128:129], v2 offset:24576
ds_read_b64_tr_b16 a[130:131], v2 offset:26624
v_mfma_f32_16x16x32_bf16 v[64:67], a[136:139], a[8:11], v[64:67]
s_add_u32 s94, s94, 256
ds_read_b64_tr_b16 a[132:133], v2 offset:28672
ds_read_b64_tr_b16 a[134:135], v2 offset:30720
v_mfma_f32_16x16x32_bf16 v[64:67], a[140:143], a[12:15], v[64:67]
s_add_u32 m0, s25, 49152
v_mfma_f32_16x16x32_bf16 v[68:71], a[136:139], a[40:43], v[68:71]
buffer_load_dwordx4 v4, s[12:15], s29 offen offset:0 lds
v_mfma_f32_16x16x32_bf16 v[68:71], a[140:143], a[44:47], v[68:71]
s_add_u32 m0, s25, 49920
v_mfma_f32_16x16x32_bf16 v[72:75], a[136:139], a[72:75], v[72:75]
buffer_load_dwordx4 v4, s[12:15], s29 offen offset:256 lds
v_mfma_f32_16x16x32_bf16 v[72:75], a[140:143], a[76:79], v[72:75]
s_waitcnt lgkmcnt(6)
ds_read_b64_tr_b16 a[136:137], v3 offset:24576
ds_read_b64_tr_b16 a[138:139], v3 offset:26624
v_mfma_f32_16x16x32_bf16 v[64:67], a[144:147], a[16:19], v[64:67]
s_add_u32 s29, s29, 8192
ds_read_b64_tr_b16 a[140:141], v3 offset:28672
ds_read_b64_tr_b16 a[142:143], v3 offset:30720
v_mfma_f32_16x16x32_bf16 v[64:67], a[148:151], a[20:23], v[64:67]
v_mfma_f32_16x16x32_bf16 v[68:71], a[144:147], a[48:51], v[68:71]
s_add_u32 s32, s32, 32768
v_mfma_f32_16x16x32_bf16 v[68:71], a[148:151], a[52:55], v[68:71]
v_mfma_f32_16x16x32_bf16 v[72:75], a[144:147], a[80:83], v[72:75]
v_mfma_f32_16x16x32_bf16 v[72:75], a[148:151], a[84:87], v[72:75]
s_waitcnt lgkmcnt(8)
ds_read_b64_tr_b16 a[144:145], v2 offset:25088
ds_read_b64_tr_b16 a[146:147], v2 offset:27136
v_mfma_f32_16x16x32_bf16 v[64:67], a[152:155], a[24:27], v[64:67]
s_add_u32 s33, s32, 4096
ds_read_b64_tr_b16 a[148:149], v2 offset:29184
ds_read_b64_tr_b16 a[150:151], v2 offset:31232
v_mfma_f32_16x16x32_bf16 v[64:67], a[156:159], a[28:31], v[64:67]
s_add_u32 m0, s25, 65536
v_mfma_f32_16x16x32_bf16 v[68:71], a[152:155], a[56:59], v[68:71]
v_mfma_f32_16x16x32_bf16 v[68:71], a[156:159], a[60:63], v[68:71]
buffer_load_dwordx4 v5, s[16:19], s32 offen offset:0 lds
v_mfma_f32_16x16x32_bf16 v[72:75], a[152:155], a[88:91], v[72:75]
v_mfma_f32_16x16x32_bf16 v[72:75], a[156:159], a[92:95], v[72:75]
s_waitcnt lgkmcnt(8)
ds_read_b64_tr_b16 a[152:153], v3 offset:25088
ds_read_b64_tr_b16 a[154:155], v3 offset:27136
v_mfma_f32_16x16x32_bf16 v[192:195], a[128:131], v[32:35], v[192:195]
s_add_u32 m0, s25, 66560
ds_read_b64_tr_b16 a[156:157], v3 offset:29184
ds_read_b64_tr_b16 a[158:159], v3 offset:31232
v_mfma_f32_16x16x32_bf16 v[192:195], a[132:135], v[48:51], v[192:195]
v_mul_f32 v64, s35, v64
v_mul_f32 v65, s35, v65
v_mfma_f32_16x16x32_bf16 v[196:199], a[128:131], v[36:39], v[196:199]
v_exp_f32 v64, v64
v_mfma_f32_16x16x32_bf16 v[196:199], a[132:135], v[52:55], v[196:199]
v_exp_f32 v65, v65
v_mfma_f32_16x16x32_bf16 v[200:203], a[128:131], v[40:43], v[200:203]
v_mul_f32 v66, s35, v66
v_mul_f32 v67, s35, v67
v_mfma_f32_16x16x32_bf16 v[200:203], a[132:135], v[56:59], v[200:203]
s_waitcnt lgkmcnt(8)
v_exp_f32 v66, v66
v_mfma_f32_16x16x32_bf16 v[208:211], a[136:139], v[32:35], v[208:211]
v_exp_f32 v67, v67
v_mfma_f32_16x16x32_bf16 v[208:211], a[140:143], v[48:51], v[208:211]
s_waitcnt vmcnt(19) lgkmcnt(0)
buffer_load_dwordx4 v5, s[16:19], s33 offen offset:0 lds
v_mfma_f32_16x16x32_bf16 v[212:215], a[136:139], v[36:39], v[212:215]
s_barrier
v_mfma_f32_16x16x32_bf16 v[212:215], a[140:143], v[52:55], v[212:215]
ds_read_b128 a[128:131], v1 offset:0
v_add_f32 v6, v6, v64
v_mfma_f32_16x16x32_bf16 v[216:219], a[136:139], v[40:43], v[216:219]
ds_read_b128 a[132:135], v1 offset:256
v_add_f32 v6, v6, v65
v_mfma_f32_16x16x32_bf16 v[216:219], a[140:143], v[56:59], v[216:219]
v_add_f32 v6, v6, v66
v_add_f32 v6, v6, v67
v_mfma_f32_16x16x32_bf16 v[224:227], a[144:147], v[32:35], v[224:227]
ds_read_b128 a[136:139], v1 offset:512
ds_read_b128 a[140:143], v1 offset:768
v_mfma_f32_16x16x32_bf16 v[224:227], a[148:151], v[48:51], v[224:227]
v_cvt_pk_bf16_f32 v64, v64, v65
v_cvt_pk_bf16_f32 v65, v66, v67
v_mfma_f32_16x16x32_bf16 v[228:231], a[144:147], v[36:39], v[228:231]
v_mul_f32 v68, s35, v68
v_mul_f32 v69, s35, v69
v_mfma_f32_16x16x32_bf16 v[228:231], a[148:151], v[52:55], v[228:231]
v_exp_f32 v68, v68
v_mfma_f32_16x16x32_bf16 v[232:235], a[144:147], v[40:43], v[232:235]
v_exp_f32 v69, v69
v_mfma_f32_16x16x32_bf16 v[232:235], a[148:151], v[56:59], v[232:235]
v_mul_f32 v70, s35, v70
v_mul_f32 v71, s35, v71
v_mfma_f32_16x16x32_bf16 v[240:243], a[152:155], v[32:35], v[240:243]
ds_read_b128 a[144:147], v1 offset:1024
ds_read_b128 a[148:151], v1 offset:1280
v_mfma_f32_16x16x32_bf16 v[240:243], a[156:159], v[48:51], v[240:243]
v_exp_f32 v70, v70
v_mfma_f32_16x16x32_bf16 v[244:247], a[152:155], v[36:39], v[244:247]
v_exp_f32 v71, v71
v_mfma_f32_16x16x32_bf16 v[244:247], a[156:159], v[52:55], v[244:247]
v_add_f32 v7, v7, v68
v_add_f32 v7, v7, v69
v_mfma_f32_16x16x32_bf16 v[248:251], a[152:155], v[40:43], v[248:251]
v_add_f32 v7, v7, v70
v_add_f32 v7, v7, v71
v_mfma_f32_16x16x32_bf16 v[248:251], a[156:159], v[56:59], v[248:251]
s_waitcnt lgkmcnt(4)
v_cvt_pk_bf16_f32 v68, v68, v69
v_cvt_pk_bf16_f32 v69, v70, v71
s_branch L_loop3
L_iw3a:
s_branch L_iw3b
L_i6_3:
v_mfma_f32_16x16x32_bf16 v[64:67], a[128:131], a[0:3], v[16:19]
ds_read_b128 a[152:155], v1 offset:34304
ds_read_b128 a[156:159], v1 offset:34560
v_mfma_f32_16x16x32_bf16 v[64:67], a[132:135], a[4:7], v[64:67]
v_mul_f32 v56, s35, v56
v_mul_f32 v57, s35, v57
v_mfma_f32_16x16x32_bf16 v[68:71], a[128:131], a[32:35], v[20:23]
s_add_u32 m0, s25, 106368
v_exp_f32 v56, v56
v_mfma_f32_16x16x32_bf16 v[68:71], a[132:135], a[36:39], v[68:71]
buffer_load_dwordx4 v5, s[16:19], s32 offen offset:128 lds
v_mfma_f32_16x16x32_bf16 v[72:75], a[128:131], a[64:67], v[24:27]
s_add_u32 m0, s25, 107392
v_exp_f32 v57, v57
v_mfma_f32_16x16x32_bf16 v[72:75], a[132:135], a[68:71], v[72:75]
s_waitcnt lgkmcnt(4)
ds_read_b128 a[128:131], v1 offset:40960
ds_read_b128 a[132:135], v1 offset:41216
v_mfma_f32_16x16x32_bf16 v[64:67], a[136:139], a[8:11], v[64:67]
v_mul_f32 v58, s35, v58
v_mul_f32 v59, s35, v59
v_mfma_f32_16x16x32_bf16 v[64:67], a[140:143], a[12:15], v[64:67]
buffer_load_dwordx4 v5, s[16:19], s33 offen offset:128 lds
v_mfma_f32_16x16x32_bf16 v[68:71], a[136:139], a[40:43], v[68:71]
s_add_u32 m0, s25, 114432
v_exp_f32 v58, v58
v_mfma_f32_16x16x32_bf16 v[68:71], a[140:143], a[44:47], v[68:71]
v_exp_f32 v59, v59
v_mfma_f32_16x16x32_bf16 v[72:75], a[136:139], a[72:75], v[72:75]
buffer_load_dwordx4 v5, s[16:19], s32 offen offset:256 lds
v_mfma_f32_16x16x32_bf16 v[72:75], a[140:143], a[76:79], v[72:75]
s_waitcnt lgkmcnt(4)
ds_read_b128 a[136:139], v1 offset:41472
ds_read_b128 a[140:143], v1 offset:41728
v_mfma_f32_16x16x32_bf16 v[64:67], a[144:147], a[16:19], v[64:67]
s_add_u32 m0, s25, 115456
v_add_f32 v8, v8, v56
v_add_f32 v8, v8, v57
v_mfma_f32_16x16x32_bf16 v[64:67], a[148:151], a[20:23], v[64:67]
v_add_f32 v8, v8, v58
v_add_f32 v8, v8, v59
v_mfma_f32_16x16x32_bf16 v[68:71], a[144:147], a[48:51], v[68:71]
buffer_load_dwordx4 v5, s[16:19], s33 offen offset:256 lds
v_mfma_f32_16x16x32_bf16 v[68:71], a[148:151], a[52:55], v[68:71]
s_add_u32 m0, s25, 122496
v_cvt_pk_bf16_f32 v56, v56, v57
v_cvt_pk_bf16_f32 v57, v58, v59
v_mfma_f32_16x16x32_bf16 v[72:75], a[144:147], a[80:83], v[72:75]
buffer_load_dwordx4 v5, s[16:19], s32 offen offset:384 lds
v_mfma_f32_16x16x32_bf16 v[72:75], a[148:151], a[84:87], v[72:75]
s_waitcnt lgkmcnt(4)
ds_read_b128 a[144:147], v1 offset:41984
ds_read_b128 a[148:151], v1 offset:42240
v_mfma_f32_16x16x32_bf16 v[64:67], a[152:155], a[24:27], v[64:67]
s_add_u32 m0, s25, 123520
v_mfma_f32_16x16x32_bf16 v[64:67], a[156:159], a[28:31], v[64:67]
buffer_load_dwordx4 v5, s[16:19], s33 offen offset:384 lds
v_mfma_f32_16x16x32_bf16 v[68:71], a[152:155], a[56:59], v[68:71]
v_mfma_f32_16x16x32_bf16 v[68:71], a[156:159], a[60:63], v[68:71]
v_mfma_f32_16x16x32_bf16 v[72:75], a[152:155], a[88:91], v[72:75]
v_mfma_f32_16x16x32_bf16 v[72:75], a[156:159], a[92:95], v[72:75]
s_waitcnt lgkmcnt(4)
ds_read_b128 a[152:155], v1 offset:42496
ds_read_b128 a[156:159], v1 offset:42752
v_mfma_f32_16x16x32_bf16 v[80:83], a[128:131], a[0:3], v[16:19]
v_mul_f32 v64, s35, v64
v_mul_f32 v65, s35, v65
v_mfma_f32_16x16x32_bf16 v[80:83], a[132:135], a[4:7], v[80:83]
v_exp_f32 v64, v64
v_mfma_f32_16x16x32_bf16 v[84:87], a[128:131], a[32:35], v[20:23]
v_exp_f32 v65, v65
v_mfma_f32_16x16x32_bf16 v[84:87], a[132:135], a[36:39], v[84:87]
v_mul_f32 v66, s35, v66
v_mul_f32 v67, s35, v67
v_mfma_f32_16x16x32_bf16 v[88:91], a[128:131], a[64:67], v[24:27]
v_exp_f32 v66, v66
v_mfma_f32_16x16x32_bf16 v[88:91], a[132:135], a[68:71], v[88:91]
s_waitcnt lgkmcnt(4)
ds_read_b64_tr_b16 a[128:129], v2 offset:0
ds_read_b64_tr_b16 a[130:131], v2 offset:2048
v_mfma_f32_16x16x32_bf16 v[80:83], a[136:139], a[8:11], v[80:83]
ds_read_b64_tr_b16 a[132:133], v3 offset:0
ds_read_b64_tr_b16 a[134:135], v3 offset:2048
v_mfma_f32_16x16x32_bf16 v[80:83], a[140:143], a[12:15], v[80:83]
v_exp_f32 v67, v67
v_mfma_f32_16x16x32_bf16 v[84:87], a[136:139], a[40:43], v[84:87]
v_cvt_pk_bf16_f32 v50, v64, v65
v_cvt_pk_bf16_f32 v51, v66, v67
v_mfma_f32_16x16x32_bf16 v[84:87], a[140:143], a[44:47], v[84:87]
v_mul_f32 v68, s35, v68
v_mul_f32 v69, s35, v69
v_mfma_f32_16x16x32_bf16 v[88:91], a[136:139], a[72:75], v[88:91]
v_exp_f32 v68, v68
v_mfma_f32_16x16x32_bf16 v[88:91], a[140:143], a[76:79], v[88:91]
s_waitcnt lgkmcnt(6)
ds_read_b64_tr_b16 a[136:137], v2 offset:4096
ds_read_b64_tr_b16 a[138:139], v2 offset:6144
v_mfma_f32_16x16x32_bf16 v[80:83], a[144:147], a[16:19], v[80:83]
ds_read_b64_tr_b16 a[140:141], v3 offset:4096
ds_read_b64_tr_b16 a[142:143], v3 offset:6144
v_mfma_f32_16x16x32_bf16 v[80:83], a[148:151], a[20:23], v[80:83]
v_exp_f32 v69, v69
v_mfma_f32_16x16x32_bf16 v[84:87], a[144:147], a[48:51], v[84:87]
v_mul_f32 v70, s35, v70
v_mul_f32 v71, s35, v71
v_mfma_f32_16x16x32_bf16 v[84:87], a[148:151], a[52:55], v[84:87]
v_exp_f32 v70, v70
v_mfma_f32_16x16x32_bf16 v[88:91], a[144:147], a[80:83], v[88:91]
v_exp_f32 v71, v71
v_mfma_f32_16x16x32_bf16 v[88:91], a[148:151], a[84:87], v[88:91]
s_waitcnt lgkmcnt(8)
ds_read_b64_tr_b16 a[144:145], v2 offset:512
ds_read_b64_tr_b16 a[146:147], v2 offset:2560
v_mfma_f32_16x16x32_bf16 v[80:83], a[152:155], a[24:27], v[80:83]
ds_read_b64_tr_b16 a[148:149], v2 offset:4608
ds_read_b64_tr_b16 a[150:151], v2 offset:6656
v_mfma_f32_16x16x32_bf16 v[80:83], a[156:159], a[28:31], v[80:83]
v_cvt_pk_bf16_f32 v54, v68, v69
v_cvt_pk_bf16_f32 v55, v70, v71
v_mfma_f32_16x16x32_bf16 v[84:87], a[152:155], a[56:59], v[84:87]
v_mul_f32 v72, s35, v72
v_mul_f32 v73, s35, v73
v_mfma_f32_16x16x32_bf16 v[84:87], a[156:159], a[60:63], v[84:87]
v_exp_f32 v72, v72
v_mfma_f32_16x16x32_bf16 v[88:91], a[152:155], a[88:91], v[88:91]
v_exp_f32 v73, v73
v_mfma_f32_16x16x32_bf16 v[88:91], a[156:159], a[92:95], v[88:91]
s_waitcnt lgkmcnt(8)
ds_read_b64_tr_b16 a[152:153], v3 offset:512
ds_read_b64_tr_b16 a[154:155], v3 offset:2560
v_mfma_f32_16x16x32_bf16 v[96:99], a[128:131], v[32:35], v[96:99]
ds_read_b64_tr_b16 a[156:157], v3 offset:4608
ds_read_b64_tr_b16 a[158:159], v3 offset:6656
v_mfma_f32_16x16x32_bf16 v[112:115], a[132:135], v[32:35], v[112:115]
v_mul_f32 v74, s35, v74
v_mul_f32 v75, s35, v75
v_mfma_f32_16x16x32_bf16 v[100:103], a[128:131], v[36:39], v[100:103]
v_exp_f32 v74, v74
v_mfma_f32_16x16x32_bf16 v[116:119], a[132:135], v[36:39], v[116:119]
v_exp_f32 v75, v75
v_mfma_f32_16x16x32_bf16 v[104:107], a[128:131], v[40:43], v[104:107]
v_cvt_pk_bf16_f32 v58, v72, v73
v_cvt_pk_bf16_f32 v59, v74, v75
v_mfma_f32_16x16x32_bf16 v[120:123], a[132:135], v[40:43], v[120:123]
s_waitcnt lgkmcnt(8)
ds_read_b128 a[128:131], v1 offset:49152
ds_read_b128 a[132:135], v1 offset:49408
v_mfma_f32_16x16x32_bf16 v[96:99], a[136:139], v[48:51], v[96:99]
v_add_f32 v6, v6, v64
v_add_f32 v6, v6, v65
v_mfma_f32_16x16x32_bf16 v[112:115], a[140:143], v[48:51], v[112:115]
v_mul_f32 v80, s35, v80
v_add_f32 v6, v6, v66
v_mfma_f32_16x16x32_bf16 v[100:103], a[136:139], v[52:55], v[100:103]
v_mul_f32 v81, s35, v81
v_add_f32 v6, v6, v67
v_mfma_f32_16x16x32_bf16 v[116:119], a[140:143], v[52:55], v[116:119]
v_exp_f32 v80, v80
v_mfma_f32_16x16x32_bf16 v[104:107], a[136:139], v[56:59], v[104:107]
s_add_u32 m0, s25, 24576
v_exp_f32 v81, v81
v_mfma_f32_16x16x32_bf16 v[120:123], a[140:143], v[56:59], v[120:123]
s_waitcnt lgkmcnt(6)
ds_read_b128 a[136:139], v1 offset:49664
ds_read_b128 a[140:143], v1 offset:49920
v_mfma_f32_16x16x32_bf16 v[128:131], a[144:147], v[32:35], v[128:131]
v_add_f32 v7, v7, v68
v_add_f32 v7, v7, v69
v_mfma_f32_16x16x32_bf16 v[128:131], a[148:151], v[48:51], v[128:131]
v_mul_f32 v82, s35, v82
v_mul_f32 v83, s35, v83
v_mfma_f32_16x16x32_bf16 v[132:135], a[144:147], v[36:39], v[132:135]
v_add_f32 v7, v7, v70
v_add_f32 v7, v7, v71
v_mfma_f32_16x16x32_bf16 v[132:135], a[148:151], v[52:55], v[132:135]
v_exp_f32 v82, v82
v_mfma_f32_16x16x32_bf16 v[136:139], a[144:147], v[40:43], v[136:139]
buffer_load_dwordx4 v4, s[12:15], s29 offen offset:0 lds
v_mfma_f32_16x16x32_bf16 v[136:139], a[148:151], v[56:59], v[136:139]
s_waitcnt lgkmcnt(4)
v_exp_f32 v83, v83
v_mfma_f32_16x16x32_bf16 v[144:147], a[152:155], v[32:35], v[144:147]
s_add_u32 m0, s25, 25344
ds_read_b128 a[144:147], v1 offset:50176
v_add_f32 v8, v8, v72
v_mfma_f32_16x16x32_bf16 v[144:147], a[156:159], v[48:51], v[144:147]
ds_read_b128 a[148:151], v1 offset:50432
v_add_f32 v6, v6, v80
v_mfma_f32_16x16x32_bf16 v[148:151], a[152:155], v[36:39], v[148:151]
v_add_f32 v8, v8, v73
v_add_f32 v6, v6, v81
v_mfma_f32_16x16x32_bf16 v[148:151], a[156:159], v[52:55], v[148:151]
v_add_f32 v6, v6, v82
v_add_f32 v8, v8, v74
v_mfma_f32_16x16x32_bf16 v[152:155], a[152:155], v[40:43], v[152:155]
v_add_f32 v8, v8, v75
v_add_f32 v6, v6, v83
v_mfma_f32_16x16x32_bf16 v[152:155], a[156:159], v[56:59], v[152:155]
s_waitcnt lgkmcnt(4)
v_cvt_pk_bf16_f32 v80, v80, v81
v_cvt_pk_bf16_f32 v81, v82, v83
v_mfma_f32_16x16x32_bf16 v[64:67], a[128:131], a[0:3], v[16:19]
ds_read_b128 a[152:155], v1 offset:50688
ds_read_b128 a[156:159], v1 offset:50944
v_mfma_f32_16x16x32_bf16 v[64:67], a[132:135], a[4:7], v[64:67]
v_mul_f32 v84, s35, v84
v_mul_f32 v85, s35, v85
v_mfma_f32_16x16x32_bf16 v[68:71], a[128:131], a[32:35], v[20:23]
v_exp_f32 v84, v84
v_mfma_f32_16x16x32_bf16 v[68:71], a[132:135], a[36:39], v[68:71]
buffer_load_dwordx4 v4, s[12:15], s29 offen offset:256 lds
v_mfma_f32_16x16x32_bf16 v[72:75], a[128:131], a[64:67], v[24:27]
s_add_u32 s29, s29, 8192
v_exp_f32 v85, v85
v_mfma_f32_16x16x32_bf16 v[72:75], a[132:135], a[68:71], v[72:75]
s_waitcnt lgkmcnt(4)
v_mul_f32 v86, s35, v86
v_mul_f32 v87, s35, v87
v_mfma_f32_16x16x32_bf16 v[64:67], a[136:139], a[8:11], v[64:67]
v_exp_f32 v86, v86
v_mfma_f32_16x16x32_bf16 v[64:67], a[140:143], a[12:15], v[64:67]
s_waitcnt vmcnt(19) lgkmcnt(0)
v_exp_f32 v87, v87
v_mfma_f32_16x16x32_bf16 v[68:71], a[136:139], a[40:43], v[68:71]
s_barrier
v_mfma_f32_16x16x32_bf16 v[68:71], a[140:143], a[44:47], v[68:71]
s_add_u32 m0, s39, 0
v_add_f32 v7, v7, v84
v_add_f32 v7, v7, v85
v_mfma_f32_16x16x32_bf16 v[72:75], a[136:139], a[72:75], v[72:75]
v_add_f32 v7, v7, v86
v_add_f32 v7, v7, v87
v_mfma_f32_16x16x32_bf16 v[72:75], a[140:143], a[76:79], v[72:75]
ds_read_b64_tr_b16 a[128:129], v2 offset:8192
ds_read_b64_tr_b16 a[130:131], v2 offset:10240
v_mfma_f32_16x16x32_bf16 v[64:67], a[144:147], a[16:19], v[64:67]
ds_read_b64_tr_b16 a[132:133], v2 offset:12288
ds_read_b64_tr_b16 a[134:135], v2 offset:14336
v_mfma_f32_16x16x32_bf16 v[64:67], a[148:151], a[20:23], v[64:67]
v_cvt_pk_bf16_f32 v84, v84, v85
v_cvt_pk_bf16_f32 v85, v86, v87
v_mfma_f32_16x16x32_bf16 v[68:71], a[144:147], a[48:51], v[68:71]
ds_read_b64_tr_b16 a[136:137], v3 offset:8192
v_mul_f32 v88, s35, v88
v_mfma_f32_16x16x32_bf16 v[68:71], a[148:151], a[52:55], v[68:71]
ds_read_b64_tr_b16 a[138:139], v3 offset:10240
ds_read_b64_tr_b16 a[140:141], v3 offset:12288
ds_read_b64_tr_b16 a[142:143], v3 offset:14336
v_mfma_f32_16x16x32_bf16 v[72:75], a[144:147], a[80:83], v[72:75]
v_mul_f32 v89, s35, v89
v_mul_f32 v90, s35, v90
v_mfma_f32_16x16x32_bf16 v[72:75], a[148:151], a[84:87], v[72:75]
v_exp_f32 v88, v88
v_mfma_f32_16x16x32_bf16 v[64:67], a[152:155], a[24:27], v[64:67]
v_exp_f32 v89, v89
v_mfma_f32_16x16x32_bf16 v[64:67], a[156:159], a[28:31], v[64:67]
ds_read_b64_tr_b16 a[144:145], v2 offset:8704
v_mul_f32 v91, s35, v91
v_mfma_f32_16x16x32_bf16 v[68:71], a[152:155], a[56:59], v[68:71]
v_exp_f32 v90, v90
v_mfma_f32_16x16x32_bf16 v[68:71], a[156:159], a[60:63], v[68:71]
ds_read_b64_tr_b16 a[146:147], v2 offset:10752
ds_read_b64_tr_b16 a[148:149], v2 offset:12800
ds_read_b64_tr_b16 a[150:151], v2 offset:14848
v_mfma_f32_16x16x32_bf16 v[72:75], a[152:155], a[88:91], v[72:75]
v_exp_f32 v91, v91
v_mfma_f32_16x16x32_bf16 v[72:75], a[156:159], a[92:95], v[72:75]
s_waitcnt lgkmcnt(8)
buffer_load_dwordx4 v12, s[8:11], s41 offen offset:0 nt lds
v_mfma_f32_16x16x32_bf16 a[160:163], a[128:131], v[32:35], a[160:163]
v_add_f32 v8, v8, v88
v_add_f32 v8, v8, v89
v_mfma_f32_16x16x32_bf16 a[160:163], a[132:135], v[48:51], a[160:163]
v_add_f32 v8, v8, v90
v_add_f32 v8, v8, v91
v_mfma_f32_16x16x32_bf16 a[164:167], a[128:131], v[36:39], a[164:167]
ds_read_b64_tr_b16 a[152:153], v3 offset:8704
v_cvt_pk_bf16_f32 v88, v88, v89
v_mfma_f32_16x16x32_bf16 a[164:167], a[132:135], v[52:55], a[164:167]
ds_read_b64_tr_b16 a[154:155], v3 offset:10752
ds_read_b64_tr_b16 a[156:157], v3 offset:12800
ds_read_b64_tr_b16 a[158:159], v3 offset:14848
v_mfma_f32_16x16x32_bf16 a[168:171], a[128:131], v[40:43], a[168:171]
v_cvt_pk_bf16_f32 v89, v90, v91
v_mul_f32 v64, s35, v64
v_mfma_f32_16x16x32_bf16 a[168:171], a[132:135], v[56:59], a[168:171]
s_waitcnt lgkmcnt(8)
buffer_load_dwordx4 v12, s[8:11], s41 offen offset:2048 nt lds
v_mfma_f32_16x16x32_bf16 a[176:179], a[136:139], v[32:35], a[176:179]
s_add_u32 m0, s39, 768
ds_read_b64_tr_b16 a[128:129], v2 offset:16384
v_mul_f32 v65, s35, v65
v_mfma_f32_16x16x32_bf16 a[176:179], a[140:143], v[48:51], a[176:179]
v_exp_f32 v64, v64
v_mfma_f32_16x16x32_bf16 a[180:183], a[136:139], v[36:39], a[180:183]
ds_read_b64_tr_b16 a[130:131], v2 offset:18432
ds_read_b64_tr_b16 a[132:133], v2 offset:20480
v_mfma_f32_16x16x32_bf16 a[180:183], a[140:143], v[52:55], a[180:183]
ds_read_b64_tr_b16 a[134:135], v2 offset:22528
v_add_f32 v6, v6, v64
v_mfma_f32_16x16x32_bf16 a[184:187], a[136:139], v[40:43], a[184:187]
v_exp_f32 v65, v65
v_mfma_f32_16x16x32_bf16 a[184:187], a[140:143], v[56:59], a[184:187]
s_waitcnt lgkmcnt(8)
v_mul_f32 v66, s35, v66
v_mul_f32 v67, s35, v67
v_mfma_f32_16x16x32_bf16 a[192:195], a[144:147], v[32:35], a[192:195]
ds_read_b64_tr_b16 a[136:137], v3 offset:16384
v_add_f32 v6, v6, v65
v_mfma_f32_16x16x32_bf16 a[192:195], a[148:151], v[48:51], a[192:195]
v_exp_f32 v66, v66
v_mfma_f32_16x16x32_bf16 a[196:199], a[144:147], v[36:39], a[196:199]
ds_read_b64_tr_b16 a[138:139], v3 offset:18432
ds_read_b64_tr_b16 a[140:141], v3 offset:20480
v_mfma_f32_16x16x32_bf16 a[196:199], a[148:151], v[52:55], a[196:199]
ds_read_b64_tr_b16 a[142:143], v3 offset:22528
v_add_f32 v6, v6, v66
v_mfma_f32_16x16x32_bf16 a[200:203], a[144:147], v[40:43], a[200:203]
v_exp_f32 v67, v67
v_mfma_f32_16x16x32_bf16 a[200:203], a[148:151], v[56:59], a[200:203]
s_waitcnt lgkmcnt(8)
v_cvt_pk_bf16_f32 v82, v64, v65
v_cvt_pk_bf16_f32 v83, v66, v67
v_mfma_f32_16x16x32_bf16 a[208:211], a[152:155], v[32:35], a[208:211]
v_add_f32 v6, v6, v67
v_mul_f32 v68, s35, v68
v_mfma_f32_16x16x32_bf16 a[208:211], a[156:159], v[48:51], a[208:211]
buffer_load_dwordx4 v12, s[8:11], s41 offen offset:256 nt lds
v_mfma_f32_16x16x32_bf16 a[212:215], a[152:155], v[36:39], a[212:215]
ds_read_b64_tr_b16 a[144:145], v2 offset:16896
ds_read_b64_tr_b16 a[146:147], v2 offset:18944
v_mfma_f32_16x16x32_bf16 a[212:215], a[156:159], v[52:55], a[212:215]
ds_read_b64_tr_b16 a[148:149], v2 offset:20992
ds_read_b64_tr_b16 a[150:151], v2 offset:23040
v_mfma_f32_16x16x32_bf16 a[216:219], a[152:155], v[40:43], a[216:219]
v_mul_f32 v69, s35, v69
v_mul_f32 v70, s35, v70
v_mfma_f32_16x16x32_bf16 a[216:219], a[156:159], v[56:59], a[216:219]
s_waitcnt lgkmcnt(8)
v_exp_f32 v68, v68
v_mfma_f32_16x16x32_bf16 a[224:227], a[128:131], v[32:35], a[224:227]
ds_read_b64_tr_b16 a[152:153], v3 offset:16896
v_add_f32 v7, v7, v68
v_mfma_f32_16x16x32_bf16 a[224:227], a[132:135], v[48:51], a[224:227]
v_exp_f32 v69, v69
v_mfma_f32_16x16x32_bf16 a[228:231], a[128:131], v[36:39], a[228:231]
ds_read_b64_tr_b16 a[154:155], v3 offset:18944
ds_read_b64_tr_b16 a[156:157], v3 offset:20992
v_mfma_f32_16x16x32_bf16 a[228:231], a[132:135], v[52:55], a[228:231]
ds_read_b64_tr_b16 a[158:159], v3 offset:23040
v_add_f32 v7, v7, v69
v_mfma_f32_16x16x32_bf16 a[232:235], a[128:131], v[40:43], a[232:235]
buffer_load_dwordx4 v12, s[8:11], s41 offen offset:2304 nt lds
v_mfma_f32_16x16x32_bf16 a[232:235], a[132:135], v[56:59], a[232:235]
s_waitcnt lgkmcnt(8)
ds_read_b128 a[128:131], v1 offset:57344
v_mul_f32 v71, s35, v71
v_mfma_f32_16x16x32_bf16 a[240:243], a[136:139], v[32:35], a[240:243]
s_add_u32 m0, s39, 4096
v_exp_f32 v70, v70
v_mfma_f32_16x16x32_bf16 a[240:243], a[140:143], v[48:51], a[240:243]
ds_read_b128 a[132:135], v1 offset:57600
v_add_f32 v7, v7, v70
v_mfma_f32_16x16x32_bf16 a[244:247], a[136:139], v[36:39], a[244:247]
v_exp_f32 v71, v71
v_mfma_f32_16x16x32_bf16 a[244:247], a[140:143], v[52:55], a[244:247]
v_cvt_pk_bf16_f32 v86, v68, v69
v_add_f32 v7, v7, v71
v_mfma_f32_16x16x32_bf16 a[248:251], a[136:139], v[40:43], a[248:251]
v_cvt_pk_bf16_f32 v87, v70, v71
v_mul_f32 v72, s35, v72
v_mfma_f32_16x16x32_bf16 a[248:251], a[140:143], v[56:59], a[248:251]
s_waitcnt lgkmcnt(6)
ds_read_b128 a[136:139], v1 offset:57856
v_mul_f32 v73, s35, v73
v_mfma_f32_16x16x32_bf16 v[160:163], a[144:147], v[32:35], v[160:163]
v_exp_f32 v72, v72
v_mfma_f32_16x16x32_bf16 v[160:163], a[148:151], v[48:51], v[160:163]
ds_read_b128 a[140:143], v1 offset:58112
v_add_f32 v8, v8, v72
v_mfma_f32_16x16x32_bf16 v[164:167], a[144:147], v[36:39], v[164:167]
v_exp_f32 v73, v73
v_mfma_f32_16x16x32_bf16 v[164:167], a[148:151], v[52:55], v[164:167]
v_add_f32 v8, v8, v73
v_mul_f32 v74, s35, v74
v_mfma_f32_16x16x32_bf16 v[168:171], a[144:147], v[40:43], v[168:171]
buffer_load_dwordx4 v13, s[8:11], s41 offen offset:0 nt lds
v_mfma_f32_16x16x32_bf16 v[168:171], a[148:151], v[56:59], v[168:171]
s_waitcnt lgkmcnt(4)
ds_read_b128 a[144:147], v1 offset:58368
v_mul_f32 v75, s35, v75
v_mfma_f32_16x16x32_bf16 v[176:179], a[152:155], v[32:35], v[176:179]
v_exp_f32 v74, v74
v_mfma_f32_16x16x32_bf16 v[176:179], a[156:159], v[48:51], v[176:179]
ds_read_b128 a[148:151], v1 offset:58624
v_add_f32 v8, v8, v74
v_mfma_f32_16x16x32_bf16 v[180:183], a[152:155], v[36:39], v[180:183]
v_exp_f32 v75, v75
v_mfma_f32_16x16x32_bf16 v[180:183], a[156:159], v[52:55], v[180:183]
v_add_f32 v8, v8, v75
v_cvt_pk_bf16_f32 v90, v72, v73
v_mfma_f32_16x16x32_bf16 v[184:187], a[152:155], v[40:43], v[184:187]
v_cvt_pk_bf16_f32 v91, v74, v75
v_mfma_f32_16x16x32_bf16 v[184:187], a[156:159], v[56:59], v[184:187]
s_waitcnt lgkmcnt(4)
buffer_load_dwordx4 v13, s[8:11], s41 offen offset:2048 nt lds
v_mfma_f32_16x16x32_bf16 v[64:67], a[128:131], a[0:3], v[16:19]
s_add_u32 m0, s39, 4864
ds_read_b128 a[152:155], v1 offset:58880
ds_read_b128 a[156:159], v1 offset:59136
v_mfma_f32_16x16x32_bf16 v[64:67], a[132:135], a[4:7], v[64:67]
v_mfma_f32_16x16x32_bf16 v[68:71], a[128:131], a[32:35], v[20:23]
v_mfma_f32_16x16x32_bf16 v[68:71], a[132:135], a[36:39], v[68:71]
v_mfma_f32_16x16x32_bf16 v[72:75], a[128:131], a[64:67], v[24:27]
buffer_load_dwordx4 v13, s[8:11], s41 offen offset:256 nt lds
v_mfma_f32_16x16x32_bf16 v[72:75], a[132:135], a[68:71], v[72:75]
s_waitcnt lgkmcnt(4)
ds_read_b64_tr_b16 a[128:129], v2 offset:24576
ds_read_b64_tr_b16 a[130:131], v2 offset:26624
v_mfma_f32_16x16x32_bf16 v[64:67], a[136:139], a[8:11], v[64:67]
ds_read_b64_tr_b16 a[132:133], v2 offset:28672
ds_read_b64_tr_b16 a[134:135], v2 offset:30720
v_mfma_f32_16x16x32_bf16 v[64:67], a[140:143], a[12:15], v[64:67]
v_mfma_f32_16x16x32_bf16 v[68:71], a[136:139], a[40:43], v[68:71]
v_mfma_f32_16x16x32_bf16 v[68:71], a[140:143], a[44:47], v[68:71]
v_mfma_f32_16x16x32_bf16 v[72:75], a[136:139], a[72:75], v[72:75]
v_mfma_f32_16x16x32_bf16 v[72:75], a[140:143], a[76:79], v[72:75]
s_waitcnt lgkmcnt(6)
ds_read_b64_tr_b16 a[136:137], v3 offset:24576
ds_read_b64_tr_b16 a[138:139], v3 offset:26624
v_mfma_f32_16x16x32_bf16 v[64:67], a[144:147], a[16:19], v[64:67]
ds_read_b64_tr_b16 a[140:141], v3 offset:28672
ds_read_b64_tr_b16 a[142:143], v3 offset:30720
v_mfma_f32_16x16x32_bf16 v[64:67], a[148:151], a[20:23], v[64:67]
buffer_load_dwordx4 v13, s[8:11], s41 offen offset:2304 nt lds
v_mfma_f32_16x16x32_bf16 v[68:71], a[144:147], a[48:51], v[68:71]
v_mfma_f32_16x16x32_bf16 v[68:71], a[148:151], a[52:55], v[68:71]
v_mfma_f32_16x16x32_bf16 v[72:75], a[144:147], a[80:83], v[72:75]
v_mfma_f32_16x16x32_bf16 v[72:75], a[148:151], a[84:87], v[72:75]
s_waitcnt lgkmcnt(8)
ds_read_b64_tr_b16 a[144:145], v2 offset:25088
ds_read_b64_tr_b16 a[146:147], v2 offset:27136
v_mfma_f32_16x16x32_bf16 v[64:67], a[152:155], a[24:27], v[64:67]
ds_read_b64_tr_b16 a[148:149], v2 offset:29184
ds_read_b64_tr_b16 a[150:151], v2 offset:31232
v_mfma_f32_16x16x32_bf16 v[64:67], a[156:159], a[28:31], v[64:67]
v_mfma_f32_16x16x32_bf16 v[68:71], a[152:155], a[56:59], v[68:71]
v_mfma_f32_16x16x32_bf16 v[68:71], a[156:159], a[60:63], v[68:71]
v_mfma_f32_16x16x32_bf16 v[72:75], a[152:155], a[88:91], v[72:75]
v_mfma_f32_16x16x32_bf16 v[72:75], a[156:159], a[92:95], v[72:75]
s_waitcnt lgkmcnt(8)
ds_read_b64_tr_b16 a[152:153], v3 offset:25088
ds_read_b64_tr_b16 a[154:155], v3 offset:27136
v_mfma_f32_16x16x32_bf16 v[192:195], a[128:131], v[32:35], v[192:195]
ds_read_b64_tr_b16 a[156:157], v3 offset:29184
ds_read_b64_tr_b16 a[158:159], v3 offset:31232
v_mfma_f32_16x16x32_bf16 v[192:195], a[132:135], v[48:51], v[192:195]
v_mul_f32 v64, s35, v64
v_mul_f32 v65, s35, v65
v_mfma_f32_16x16x32_bf16 v[196:199], a[128:131], v[36:39], v[196:199]
v_exp_f32 v64, v64
v_mfma_f32_16x16x32_bf16 v[196:199], a[132:135], v[52:55], v[196:199]
v_exp_f32 v65, v65
v_mfma_f32_16x16x32_bf16 v[200:203], a[128:131], v[40:43], v[200:203]
v_mul_f32 v66, s35, v66
v_mul_f32 v67, s35, v67
v_mfma_f32_16x16x32_bf16 v[200:203], a[132:135], v[56:59], v[200:203]
s_waitcnt lgkmcnt(8)
v_exp_f32 v66, v66
v_mfma_f32_16x16x32_bf16 v[208:211], a[136:139], v[32:35], v[208:211]
v_exp_f32 v67, v67
v_mfma_f32_16x16x32_bf16 v[208:211], a[140:143], v[48:51], v[208:211]
s_waitcnt vmcnt(8) lgkmcnt(0)
v_add_f32 v6, v6, v64
v_add_f32 v6, v6, v65
v_mfma_f32_16x16x32_bf16 v[212:215], a[136:139], v[36:39], v[212:215]
s_barrier
v_mfma_f32_16x16x32_bf16 v[212:215], a[140:143], v[52:55], v[212:215]
ds_read_b128 a[128:131], v1 offset:0
ds_read_b128 a[132:135], v1 offset:256
v_mfma_f32_16x16x32_bf16 v[216:219], a[136:139], v[40:43], v[216:219]
v_add_f32 v6, v6, v66
v_add_f32 v6, v6, v67
v_mfma_f32_16x16x32_bf16 v[216:219], a[140:143], v[56:59], v[216:219]
ds_read_b128 a[136:139], v1 offset:512
ds_read_b128 a[140:143], v1 offset:768
v_mfma_f32_16x16x32_bf16 v[224:227], a[144:147], v[32:35], v[224:227]
v_cvt_pk_bf16_f32 v64, v64, v65
v_cvt_pk_bf16_f32 v65, v66, v67
v_mfma_f32_16x16x32_bf16 v[224:227], a[148:151], v[48:51], v[224:227]
v_mul_f32 v68, s35, v68
v_mul_f32 v69, s35, v69
v_mfma_f32_16x16x32_bf16 v[228:231], a[144:147], v[36:39], v[228:231]
v_exp_f32 v68, v68
v_mfma_f32_16x16x32_bf16 v[228:231], a[148:151], v[52:55], v[228:231]
v_exp_f32 v69, v69
v_mfma_f32_16x16x32_bf16 v[232:235], a[144:147], v[40:43], v[232:235]
v_mul_f32 v70, s35, v70
v_mul_f32 v71, s35, v71
v_mfma_f32_16x16x32_bf16 v[232:235], a[148:151], v[56:59], v[232:235]
ds_read_b128 a[144:147], v1 offset:1024
ds_read_b128 a[148:151], v1 offset:1280
v_mfma_f32_16x16x32_bf16 v[240:243], a[152:155], v[32:35], v[240:243]
v_exp_f32 v70, v70
v_mfma_f32_16x16x32_bf16 v[240:243], a[156:159], v[48:51], v[240:243]
v_exp_f32 v71, v71
v_mfma_f32_16x16x32_bf16 v[244:247], a[152:155], v[36:39], v[244:247]
v_add_f32 v7, v7, v68
v_add_f32 v7, v7, v69
v_mfma_f32_16x16x32_bf16 v[244:247], a[156:159], v[52:55], v[244:247]
v_add_f32 v7, v7, v70
v_add_f32 v7, v7, v71
v_mfma_f32_16x16x32_bf16 v[248:251], a[152:155], v[40:43], v[248:251]
v_cvt_pk_bf16_f32 v68, v68, v69
v_cvt_pk_bf16_f32 v69, v70, v71
v_mfma_f32_16x16x32_bf16 v[248:251], a[156:159], v[56:59], v[248:251]
s_waitcnt lgkmcnt(4)
s_cmp_lt_u32 s37, 2
s_cbranch_scc1 L_i7_3
v_mfma_f32_16x16x32_bf16 v[48:51], a[128:131], a[0:3], v[16:19]
ds_read_b128 a[152:155], v1 offset:1536
ds_read_b128 a[156:159], v1 offset:1792
v_mfma_f32_16x16x32_bf16 v[48:51], a[132:135], a[4:7], v[48:51]
v_mul_f32 v72, s35, v72
v_mul_f32 v73, s35, v73
v_mfma_f32_16x16x32_bf16 v[52:55], a[128:131], a[32:35], v[20:23]
s_add_u32 s72, s44, 0
v_exp_f32 v72, v72
v_mfma_f32_16x16x32_bf16 v[52:55], a[132:135], a[36:39], v[52:55]
s_add_u32 s73, s44, 4096
v_exp_f32 v73, v73
v_mfma_f32_16x16x32_bf16 v[56:59], a[128:131], a[64:67], v[24:27]
s_add_u32 s74, s44, 8192
v_mul_f32 v74, s35, v74
v_mul_f32 v75, s35, v75
v_mfma_f32_16x16x32_bf16 v[56:59], a[132:135], a[68:71], v[56:59]
s_waitcnt lgkmcnt(4)
ds_read_b64_tr_b16 a[128:129], v2 offset:32768
ds_read_b64_tr_b16 a[130:131], v2 offset:34816
v_mfma_f32_16x16x32_bf16 v[48:51], a[136:139], a[8:11], v[48:51]
ds_read_b64_tr_b16 a[132:133], v3 offset:32768
ds_read_b64_tr_b16 a[134:135], v3 offset:34816
v_mfma_f32_16x16x32_bf16 v[48:51], a[140:143], a[12:15], v[48:51]
s_add_u32 s75, s44, 12288
v_exp_f32 v74, v74
v_mfma_f32_16x16x32_bf16 v[52:55], a[136:139], a[40:43], v[52:55]
v_xor_b32 v37, 16, v15
v_xor_b32 v38, 32, v15
v_mfma_f32_16x16x32_bf16 v[52:55], a[140:143], a[44:47], v[52:55]
v_exp_f32 v75, v75
v_mfma_f32_16x16x32_bf16 v[56:59], a[136:139], a[72:75], v[56:59]
v_xor_b32 v39, 48, v15
v_add_f32 v8, v8, v72
v_mfma_f32_16x16x32_bf16 v[56:59], a[140:143], a[76:79], v[56:59]
s_waitcnt lgkmcnt(6)
ds_read_b64_tr_b16 a[136:137], v2 offset:33280
ds_read_b64_tr_b16 a[138:139], v2 offset:35328
v_mfma_f32_16x16x32_bf16 v[48:51], a[144:147], a[16:19], v[48:51]
s_add_u32 s76, s44, 16384
ds_read_b64_tr_b16 a[140:141], v3 offset:33280
ds_read_b64_tr_b16 a[142:143], v3 offset:35328
v_mfma_f32_16x16x32_bf16 v[48:51], a[148:151], a[20:23], v[48:51]
v_mbcnt_lo_u32_b32 v40, -1, 0
v_add_f32 v8, v8, v73
v_mfma_f32_16x16x32_bf16 v[52:55], a[144:147], a[48:51], v[52:55]
v_mbcnt_hi_u32_b32 v40, -1, v40
v_add_f32 v8, v8, v74
v_mfma_f32_16x16x32_bf16 v[52:55], a[148:151], a[52:55], v[52:55]
s_add_u32 s77, s44, 20480
v_lshl_add_u32 v40, v40, 3, s28
v_add_f32 v8, v8, v75
v_mfma_f32_16x16x32_bf16 v[56:59], a[144:147], a[80:83], v[56:59]
v_xor_b32 v42, 32, v40
v_cvt_pk_bf16_f32 v72, v72, v73
v_mfma_f32_16x16x32_bf16 v[56:59], a[148:151], a[84:87], v[56:59]
s_waitcnt lgkmcnt(8)
ds_read_b64_tr_b16 a[144:145], v2 offset:36864
ds_read_b64_tr_b16 a[146:147], v2 offset:38912
v_mfma_f32_16x16x32_bf16 v[48:51], a[152:155], a[24:27], v[48:51]
ds_read_b64_tr_b16 a[148:149], v3 offset:36864
ds_read_b64_tr_b16 a[150:151], v3 offset:38912
v_mfma_f32_16x16x32_bf16 v[48:51], a[156:159], a[28:31], v[48:51]
v_cvt_pk_bf16_f32 v73, v74, v75
v_mfma_f32_16x16x32_bf16 v[52:55], a[152:155], a[56:59], v[52:55]
v_mfma_f32_16x16x32_bf16 v[52:55], a[156:159], a[60:63], v[52:55]
v_mfma_f32_16x16x32_bf16 v[56:59], a[152:155], a[88:91], v[56:59]
v_mfma_f32_16x16x32_bf16 v[56:59], a[156:159], a[92:95], v[56:59]
s_waitcnt lgkmcnt(8)
ds_read_b64_tr_b16 a[152:153], v2 offset:37376
ds_read_b64_tr_b16 a[154:155], v2 offset:39424
v_mfma_f32_16x16x32_bf16 v[96:99], a[128:131], v[80:83], v[96:99]
ds_read_b64_tr_b16 a[156:157], v3 offset:37376
ds_read_b64_tr_b16 a[158:159], v3 offset:39424
v_mfma_f32_16x16x32_bf16 v[112:115], a[132:135], v[80:83], v[112:115]
v_mul_f32 v48, s35, v48
v_mul_f32 v49, s35, v49
v_mfma_f32_16x16x32_bf16 v[100:103], a[128:131], v[84:87], v[100:103]
v_exp_f32 v48, v48
v_mfma_f32_16x16x32_bf16 v[116:119], a[132:135], v[84:87], v[116:119]
v_exp_f32 v49, v49
v_mfma_f32_16x16x32_bf16 v[104:107], a[128:131], v[88:91], v[104:107]
v_mul_f32 v50, s35, v50
v_mul_f32 v51, s35, v51
v_mfma_f32_16x16x32_bf16 v[120:123], a[132:135], v[88:91], v[120:123]
s_waitcnt lgkmcnt(8)
v_exp_f32 v50, v50
v_mfma_f32_16x16x32_bf16 v[128:131], a[136:139], v[80:83], v[128:131]
v_exp_f32 v51, v51
v_mfma_f32_16x16x32_bf16 v[144:147], a[140:143], v[80:83], v[144:147]
v_cvt_pk_bf16_f32 v66, v48, v49
v_cvt_pk_bf16_f32 v67, v50, v51
v_mfma_f32_16x16x32_bf16 v[132:135], a[136:139], v[84:87], v[132:135]
v_mul_f32 v52, s35, v52
v_mul_f32 v53, s35, v53
v_mfma_f32_16x16x32_bf16 v[148:151], a[140:143], v[84:87], v[148:151]
ds_read_b64_tr_b16 a[128:129], v2 offset:40960
ds_read_b64_tr_b16 a[130:131], v2 offset:43008
ds_read_b64_tr_b16 a[132:133], v2 offset:45056
ds_read_b64_tr_b16 a[134:135], v2 offset:47104
v_mfma_f32_16x16x32_bf16 v[136:139], a[136:139], v[88:91], v[136:139]
v_exp_f32 v52, v52
v_mfma_f32_16x16x32_bf16 v[152:155], a[140:143], v[88:91], v[152:155]
s_waitcnt lgkmcnt(8)
v_exp_f32 v53, v53
v_mul_f32 v54, s35, v54
v_mul_f32 v55, s35, v55
v_exp_f32 v54, v54
v_exp_f32 v55, v55
v_mfma_f32_16x16x32_bf16 v[96:99], a[144:147], v[64:67], v[96:99]
v_cvt_pk_bf16_f32 v70, v52, v53
v_cvt_pk_bf16_f32 v71, v54, v55
v_mfma_f32_16x16x32_bf16 v[112:115], a[148:151], v[64:67], v[112:115]
v_mul_f32 v56, s35, v56
v_mul_f32 v57, s35, v57
v_exp_f32 v56, v56
v_exp_f32 v57, v57
v_mul_f32 v58, s35, v58
v_mul_f32 v59, s35, v59
v_exp_f32 v58, v58
v_exp_f32 v59, v59
v_mfma_f32_16x16x32_bf16 v[100:103], a[144:147], v[68:71], v[100:103]
v_cvt_pk_bf16_f32 v74, v56, v57
v_cvt_pk_bf16_f32 v75, v58, v59
v_mfma_f32_16x16x32_bf16 v[116:119], a[148:151], v[68:71], v[116:119]
ds_read_b64_tr_b16 a[136:137], v3 offset:40960
ds_read_b64_tr_b16 a[138:139], v3 offset:43008
ds_read_b64_tr_b16 a[140:141], v3 offset:45056
ds_read_b64_tr_b16 a[142:143], v3 offset:47104
v_mfma_f32_16x16x32_bf16 v[104:107], a[144:147], v[72:75], v[104:107]
v_add_f32 v6, v6, v48
v_add_f32 v6, v6, v49
v_mfma_f32_16x16x32_bf16 v[120:123], a[148:151], v[72:75], v[120:123]
s_waitcnt lgkmcnt(8)
v_add_f32 v6, v6, v50
v_add_f32 v6, v6, v51
v_mfma_f32_16x16x32_bf16 v[128:131], a[152:155], v[64:67], v[128:131]
v_add_f32 v7, v7, v52
v_add_f32 v7, v7, v53
v_mfma_f32_16x16x32_bf16 v[144:147], a[156:159], v[64:67], v[144:147]
ds_read_b64_tr_b16 a[144:145], v2 offset:41472
v_add_f32 v7, v7, v54
v_mfma_f32_16x16x32_bf16 v[132:135], a[152:155], v[68:71], v[132:135]
ds_read_b64_tr_b16 a[146:147], v2 offset:43520
ds_read_b64_tr_b16 a[148:149], v2 offset:45568
v_mfma_f32_16x16x32_bf16 v[148:151], a[156:159], v[68:71], v[148:151]
ds_read_b64_tr_b16 a[150:151], v2 offset:47616
v_add_f32 v7, v7, v55
v_mfma_f32_16x16x32_bf16 v[136:139], a[152:155], v[72:75], v[136:139]
v_add_f32 v8, v8, v56
v_add_f32 v8, v8, v57
v_mfma_f32_16x16x32_bf16 v[152:155], a[156:159], v[72:75], v[152:155]
s_waitcnt lgkmcnt(8)
v_add_f32 v8, v8, v58
v_add_f32 v8, v8, v59
v_mfma_f32_16x16x32_bf16 a[160:163], a[128:131], v[80:83], a[160:163]
ds_read_b64_tr_b16 a[152:153], v3 offset:41472
ds_read_b64_tr_b16 a[154:155], v3 offset:43520
v_mfma_f32_16x16x32_bf16 a[160:163], a[132:135], v[64:67], a[160:163]
v_permlane16_swap_b32 v6, v7
v_mfma_f32_16x16x32_bf16 a[164:167], a[128:131], v[84:87], a[164:167]
v_permlane16_swap_b32 v8, v9
v_mfma_f32_16x16x32_bf16 a[164:167], a[132:135], v[68:71], a[164:167]
ds_read_b64_tr_b16 a[156:157], v3 offset:45568
ds_read_b64_tr_b16 a[158:159], v3 offset:47616
v_mfma_f32_16x16x32_bf16 a[168:171], a[128:131], v[88:91], a[168:171]
v_add_f32 v6, v6, v7
v_add_f32 v8, v8, v9
v_mfma_f32_16x16x32_bf16 a[168:171], a[132:135], v[72:75], a[168:171]
s_waitcnt lgkmcnt(8)
ds_read_b64_tr_b16 a[128:129], v2 offset:49152
ds_read_b64_tr_b16 a[130:131], v2 offset:51200
v_mfma_f32_16x16x32_bf16 a[176:179], a[136:139], v[80:83], a[176:179]
v_permlane32_swap_b32 v6, v8
v_add_f32 v41, v6, v8
v_rcp_f32 v32, v41
v_mfma_f32_16x16x32_bf16 a[176:179], a[140:143], v[64:67], a[176:179]
ds_read_b64_tr_b16 a[132:133], v2 offset:53248
v_mov_b32 v34, v32
v_mfma_f32_16x16x32_bf16 a[180:183], a[136:139], v[84:87], a[180:183]
ds_read_b64_tr_b16 a[134:135], v2 offset:55296
v_mfma_f32_16x16x32_bf16 a[180:183], a[140:143], v[68:71], a[180:183]
v_permlane32_swap_b32 v32, v34
v_mov_b32 v33, v32
v_mov_b32 v35, v34
v_mfma_f32_16x16x32_bf16 a[184:187], a[136:139], v[88:91], a[184:187]
v_mfma_f32_16x16x32_bf16 a[184:187], a[140:143], v[72:75], a[184:187]
s_waitcnt lgkmcnt(8)
v_permlane16_swap_b32 v32, v33
v_permlane16_swap_b32 v34, v35
v_cmp_ngt_f32 vcc, 0x58800000, v41
v_pk_mul_f32 v[96:97], v[96:97], v[32:33] op_sel:[0,0] op_sel_hi:[1,0]
v_pk_mul_f32 v[98:99], v[98:99], v[32:33] op_sel:[0,0] op_sel_hi:[1,0]
v_cvt_pk_bf16_f32 v96, v96, v97
v_cvt_pk_bf16_f32 v97, v98, v99
v_pk_mul_f32 v[100:101], v[100:101], v[32:33] op_sel:[0,1] op_sel_hi:[1,1]
v_pk_mul_f32 v[102:103], v[102:103], v[32:33] op_sel:[0,1] op_sel_hi:[1,1]
v_cvt_pk_bf16_f32 v100, v100, v101
v_cvt_pk_bf16_f32 v101, v102, v103
v_pk_mul_f32 v[104:105], v[104:105], v[34:35] op_sel:[0,0] op_sel_hi:[1,0]
v_pk_mul_f32 v[106:107], v[106:107], v[34:35] op_sel:[0,0] op_sel_hi:[1,0]
v_cvt_pk_bf16_f32 v104, v104, v105
v_cvt_pk_bf16_f32 v105, v106, v107
ds_write2st64_b64 v15, v[96:97], v[100:101] offset0:64 offset1:66
s_cbranch_vccz L_noflag3g
s_bitset1_b32 s38, s37
L_noflag3g:
v_pk_mul_f32 v[112:113], v[112:113], v[32:33] op_sel:[0,0] op_sel_hi:[1,0]
v_pk_mul_f32 v[114:115], v[114:115], v[32:33] op_sel:[0,0] op_sel_hi:[1,0]
v_cvt_pk_bf16_f32 v112, v112, v113
v_cvt_pk_bf16_f32 v113, v114, v115
ds_write_b64 v15, v[104:105] offset:34816
v_pk_mul_f32 v[116:117], v[116:117], v[32:33] op_sel:[0,1] op_sel_hi:[1,1]
v_pk_mul_f32 v[118:119], v[118:119], v[32:33] op_sel:[0,1] op_sel_hi:[1,1]
v_cvt_pk_bf16_f32 v116, v116, v117
v_cvt_pk_bf16_f32 v117, v118, v119
v_pk_mul_f32 v[120:121], v[120:121], v[34:35] op_sel:[0,0] op_sel_hi:[1,0]
v_pk_mul_f32 v[122:123], v[122:123], v[34:35] op_sel:[0,0] op_sel_hi:[1,0]
v_cvt_pk_bf16_f32 v120, v120, v121
v_cvt_pk_bf16_f32 v121, v122, v123
ds_write2st64_b64 v37, v[112:113], v[116:117] offset0:64 offset1:66
v_pk_mul_f32 v[128:129], v[128:129], v[32:33] op_sel:[0,0] op_sel_hi:[1,0]
v_pk_mul_f32 v[130:131], v[130:131], v[32:33] op_sel:[0,0] op_sel_hi:[1,0]
v_cvt_pk_bf16_f32 v128, v128, v129
v_cvt_pk_bf16_f32 v129, v130, v131
ds_write_b64 v37, v[120:121] offset:34816
v_pk_mul_f32 v[132:133], v[132:133], v[32:33] op_sel:[0,1] op_sel_hi:[1,1]
v_pk_mul_f32 v[134:135], v[134:135], v[32:33] op_sel:[0,1] op_sel_hi:[1,1]
v_cvt_pk_bf16_f32 v132, v132, v133
v_cvt_pk_bf16_f32 v133, v134, v135
v_pk_mul_f32 v[136:137], v[136:137], v[34:35] op_sel:[0,0] op_sel_hi:[1,0]
v_pk_mul_f32 v[138:139], v[138:139], v[34:35] op_sel:[0,0] op_sel_hi:[1,0]
v_cvt_pk_bf16_f32 v136, v136, v137
v_cvt_pk_bf16_f32 v137, v138, v139
ds_write2st64_b64 v38, v[128:129], v[132:133] offset0:64 offset1:66
v_pk_mul_f32 v[144:145], v[144:145], v[32:33] op_sel:[0,0] op_sel_hi:[1,0]
v_pk_mul_f32 v[146:147], v[146:147], v[32:33] op_sel:[0,0] op_sel_hi:[1,0]
v_cvt_pk_bf16_f32 v144, v144, v145
v_cvt_pk_bf16_f32 v145, v146, v147
ds_write_b64 v38, v[136:137] offset:34816
v_pk_mul_f32 v[148:149], v[148:149], v[32:33] op_sel:[0,1] op_sel_hi:[1,1]
v_pk_mul_f32 v[150:151], v[150:151], v[32:33] op_sel:[0,1] op_sel_hi:[1,1]
v_cvt_pk_bf16_f32 v148, v148, v149
v_cvt_pk_bf16_f32 v149, v150, v151
v_pk_mul_f32 v[152:153], v[152:153], v[34:35] op_sel:[0,0] op_sel_hi:[1,0]
v_pk_mul_f32 v[154:155], v[154:155], v[34:35] op_sel:[0,0] op_sel_hi:[1,0]
v_cvt_pk_bf16_f32 v152, v152, v153
v_cvt_pk_bf16_f32 v153, v154, v155
ds_write2st64_b64 v39, v[144:145], v[148:149] offset0:64 offset1:66
ds_write_b64 v39, v[152:153] offset:34816
v_mfma_f32_16x16x32_bf16 a[192:195], a[144:147], v[80:83], a[192:195]
ds_read_b64_tr_b16 a[136:137], v3 offset:49152
ds_read_b64_tr_b16 a[138:139], v3 offset:51200
v_mfma_f32_16x16x32_bf16 a[192:195], a[148:151], v[64:67], a[192:195]
ds_read_b64_tr_b16 a[140:141], v3 offset:53248
ds_read_b64_tr_b16 a[142:143], v3 offset:55296
v_mfma_f32_16x16x32_bf16 a[196:199], a[144:147], v[84:87], a[196:199]
ds_read2st64_b64 v[96:99], v40 offset0:64 offset1:72
v_accvgpr_read_b32 v48, a160
v_mfma_f32_16x16x32_bf16 a[196:199], a[148:151], v[68:71], a[196:199]
v_accvgpr_read_b32 v52, a164
v_accvgpr_read_b32 v56, a168
v_mfma_f32_16x16x32_bf16 a[200:203], a[144:147], v[88:91], a[200:203]
v_accvgpr_read_b32 v60, a176
v_accvgpr_read_b32 v49, a161
v_mfma_f32_16x16x32_bf16 a[200:203], a[148:151], v[72:75], a[200:203]
s_waitcnt lgkmcnt(15)
v_accvgpr_read_b32 v53, a165
v_accvgpr_read_b32 v57, a169
v_mfma_f32_16x16x32_bf16 a[208:211], a[152:155], v[80:83], a[208:211]
ds_read2st64_b64 v[112:115], v42 offset0:65 offset1:73
v_accvgpr_read_b32 v61, a177
v_mfma_f32_16x16x32_bf16 a[208:211], a[156:159], v[64:67], a[208:211]
v_accvgpr_read_b32 v50, a162
v_accvgpr_read_b32 v54, a166
v_mfma_f32_16x16x32_bf16 a[212:215], a[152:155], v[84:87], a[212:215]
v_accvgpr_read_b32 v58, a170
v_accvgpr_read_b32 v62, a178
v_mfma_f32_16x16x32_bf16 a[212:215], a[156:159], v[68:71], a[212:215]
ds_read2st64_b64 v[100:103], v40 offset0:66 offset1:74
ds_read_b64_tr_b16 a[144:145], v2 offset:49664
ds_read_b64_tr_b16 a[146:147], v2 offset:51712
ds_read_b64_tr_b16 a[148:149], v2 offset:53760
ds_read_b64_tr_b16 a[150:151], v2 offset:55808
ds_read2st64_b64 v[116:119], v42 offset0:67 offset1:75
ds_read2st64_b64 v[104:107], v40 offset0:68 offset1:76
ds_read2st64_b64 v[120:123], v42 offset0:69 offset1:77
v_mfma_f32_16x16x32_bf16 a[216:219], a[152:155], v[88:91], a[216:219]
v_accvgpr_read_b32 v51, a163
v_accvgpr_read_b32 v55, a167
v_mfma_f32_16x16x32_bf16 a[216:219], a[156:159], v[72:75], a[216:219]
s_waitcnt lgkmcnt(15)
v_accvgpr_read_b32 v59, a171
v_accvgpr_read_b32 v63, a179
v_mfma_f32_16x16x32_bf16 a[224:227], a[128:131], v[80:83], a[224:227]
v_accvgpr_read_b32 v128, a180
v_accvgpr_read_b32 v129, a181
v_mfma_f32_16x16x32_bf16 a[224:227], a[132:135], v[64:67], a[224:227]
v_accvgpr_read_b32 v130, a182
v_accvgpr_read_b32 v131, a183
v_mfma_f32_16x16x32_bf16 a[228:231], a[128:131], v[84:87], a[228:231]
s_waitcnt lgkmcnt(9)
buffer_store_dwordx4 v[96:99], v14, s[20:23], s72 offen offset:0 nt
s_waitcnt lgkmcnt(8)
buffer_store_dwordx4 v[112:115], v14, s[20:23], s73 offen offset:0 nt
s_waitcnt lgkmcnt(7)
buffer_store_dwordx4 v[100:103], v14, s[20:23], s74 offen offset:0 nt
s_waitcnt lgkmcnt(2)
buffer_store_dwordx4 v[116:119], v14, s[20:23], s75 offen offset:0 nt
s_waitcnt lgkmcnt(1)
buffer_store_dwordx4 v[104:107], v14, s[20:23], s76 offen offset:0 nt
s_waitcnt lgkmcnt(0)
buffer_store_dwordx4 v[120:123], v14, s[20:23], s77 offen offset:0 nt
v_accvgpr_read_b32 v132, a184
v_accvgpr_read_b32 v133, a185
v_accvgpr_read_b32 v134, a186
v_accvgpr_read_b32 v135, a187
v_mfma_f32_16x16x32_bf16 a[228:231], a[132:135], v[68:71], a[228:231]
ds_read_b64_tr_b16 a[152:153], v3 offset:49664
ds_read_b64_tr_b16 a[154:155], v3 offset:51712
ds_read_b64_tr_b16 a[156:157], v3 offset:53760
ds_read_b64_tr_b16 a[158:159], v3 offset:55808
v_pk_mul_f32 v[48:49], v[48:49], v[32:33] op_sel:[0,0] op_sel_hi:[1,0]
v_pk_mul_f32 v[50:51], v[50:51], v[32:33] op_sel:[0,0] op_sel_hi:[1,0]
v_cvt_pk_bf16_f32 v48, v48, v49
v_cvt_pk_bf16_f32 v49, v50, v51
v_pk_mul_f32 v[52:53], v[52:53], v[32:33] op_sel:[0,1] op_sel_hi:[1,1]
v_pk_mul_f32 v[54:55], v[54:55], v[32:33] op_sel:[0,1] op_sel_hi:[1,1]
v_cvt_pk_bf16_f32 v52, v52, v53
v_cvt_pk_bf16_f32 v53, v54, v55
v_pk_mul_f32 v[56:57], v[56:57], v[34:35] op_sel:[0,0] op_sel_hi:[1,0]
v_pk_mul_f32 v[58:59], v[58:59], v[34:35] op_sel:[0,0] op_sel_hi:[1,0]
v_cvt_pk_bf16_f32 v56, v56, v57
v_cvt_pk_bf16_f32 v57, v58, v59
ds_write2st64_b64 v15, v[48:49], v[52:53] offset0:64 offset1:66
v_pk_mul_f32 v[60:61], v[60:61], v[32:33] op_sel:[0,0] op_sel_hi:[1,0]
v_pk_mul_f32 v[62:63], v[62:63], v[32:33] op_sel:[0,0] op_sel_hi:[1,0]
v_cvt_pk_bf16_f32 v60, v60, v61
v_cvt_pk_bf16_f32 v61, v62, v63
ds_write_b64 v15, v[56:57] offset:34816
v_pk_mul_f32 v[128:129], v[128:129], v[32:33] op_sel:[0,1] op_sel_hi:[1,1]
v_pk_mul_f32 v[130:131], v[130:131], v[32:33] op_sel:[0,1] op_sel_hi:[1,1]
v_cvt_pk_bf16_f32 v128, v128, v129
v_cvt_pk_bf16_f32 v129, v130, v131
v_pk_mul_f32 v[132:133], v[132:133], v[34:35] op_sel:[0,0] op_sel_hi:[1,0]
v_pk_mul_f32 v[134:135], v[134:135], v[34:35] op_sel:[0,0] op_sel_hi:[1,0]
v_cvt_pk_bf16_f32 v132, v132, v133
v_cvt_pk_bf16_f32 v133, v134, v135
ds_write2st64_b64 v37, v[60:61], v[128:129] offset0:64 offset1:66
v_accvgpr_read_b32 v136, a192
v_accvgpr_read_b32 v137, a193
v_accvgpr_read_b32 v138, a194
v_accvgpr_read_b32 v139, a195
v_pk_mul_f32 v[136:137], v[136:137], v[32:33] op_sel:[0,0] op_sel_hi:[1,0]
v_pk_mul_f32 v[138:139], v[138:139], v[32:33] op_sel:[0,0] op_sel_hi:[1,0]
v_cvt_pk_bf16_f32 v136, v136, v137
v_cvt_pk_bf16_f32 v137, v138, v139
ds_write_b64 v37, v[132:133] offset:34816
v_accvgpr_read_b32 v140, a196
v_accvgpr_read_b32 v141, a197
v_accvgpr_read_b32 v142, a198
v_accvgpr_read_b32 v143, a199
v_pk_mul_f32 v[140:141], v[140:141], v[32:33] op_sel:[0,1] op_sel_hi:[1,1]
v_pk_mul_f32 v[142:143], v[142:143], v[32:33] op_sel:[0,1] op_sel_hi:[1,1]
v_cvt_pk_bf16_f32 v140, v140, v141
v_cvt_pk_bf16_f32 v141, v142, v143
v_accvgpr_read_b32 v144, a200
v_accvgpr_read_b32 v145, a201
v_accvgpr_read_b32 v146, a202
v_accvgpr_read_b32 v147, a203
v_pk_mul_f32 v[144:145], v[144:145], v[34:35] op_sel:[0,0] op_sel_hi:[1,0]
v_pk_mul_f32 v[146:147], v[146:147], v[34:35] op_sel:[0,0] op_sel_hi:[1,0]
v_cvt_pk_bf16_f32 v144, v144, v145
v_cvt_pk_bf16_f32 v145, v146, v147
ds_write2st64_b64 v38, v[136:137], v[140:141] offset0:64 offset1:66
v_accvgpr_read_b32 v148, a208
v_accvgpr_read_b32 v149, a209
v_accvgpr_read_b32 v150, a210
v_accvgpr_read_b32 v151, a211
v_pk_mul_f32 v[148:149], v[148:149], v[32:33] op_sel:[0,0] op_sel_hi:[1,0]
v_pk_mul_f32 v[150:151], v[150:151], v[32:33] op_sel:[0,0] op_sel_hi:[1,0]
v_cvt_pk_bf16_f32 v148, v148, v149
v_cvt_pk_bf16_f32 v149, v150, v151
ds_write_b64 v38, v[144:145] offset:34816
v_accvgpr_read_b32 v152, a212
v_accvgpr_read_b32 v153, a213
v_accvgpr_read_b32 v154, a214
v_accvgpr_read_b32 v155, a215
v_pk_mul_f32 v[152:153], v[152:153], v[32:33] op_sel:[0,1] op_sel_hi:[1,1]
v_pk_mul_f32 v[154:155], v[154:155], v[32:33] op_sel:[0,1] op_sel_hi:[1,1]
v_cvt_pk_bf16_f32 v152, v152, v153
v_cvt_pk_bf16_f32 v153, v154, v155
v_accvgpr_read_b32 v156, a216
v_accvgpr_read_b32 v157, a217
v_accvgpr_read_b32 v158, a218
v_accvgpr_read_b32 v159, a219
v_pk_mul_f32 v[156:157], v[156:157], v[34:35] op_sel:[0,0] op_sel_hi:[1,0]
v_pk_mul_f32 v[158:159], v[158:159], v[34:35] op_sel:[0,0] op_sel_hi:[1,0]
v_cvt_pk_bf16_f32 v156, v156, v157
v_cvt_pk_bf16_f32 v157, v158, v159
ds_write2st64_b64 v39, v[148:149], v[152:153] offset0:64 offset1:66
ds_write_b64 v39, v[156:157] offset:34816
v_mfma_f32_16x16x32_bf16 a[232:235], a[128:131], v[88:91], a[232:235]
ds_read2st64_b64 a[160:163], v40 offset0:64 offset1:72
ds_read2st64_b64 a[176:179], v42 offset0:65 offset1:73
v_mfma_f32_16x16x32_bf16 a[232:235], a[132:135], v[72:75], a[232:235]
ds_read_b64_tr_b16 a[128:129], v2 offset:57344
ds_read_b64_tr_b16 a[130:131], v2 offset:59392
v_mfma_f32_16x16x32_bf16 a[240:243], a[136:139], v[80:83], a[240:243]
ds_read_b64_tr_b16 a[132:133], v2 offset:61440
ds_read_b64_tr_b16 a[134:135], v2 offset:63488
v_mfma_f32_16x16x32_bf16 a[240:243], a[140:143], v[64:67], a[240:243]
ds_read2st64_b64 a[164:167], v40 offset0:66 offset1:74
v_accvgpr_read_b32 v48, a224
v_mfma_f32_16x16x32_bf16 a[244:247], a[136:139], v[84:87], a[244:247]
ds_read2st64_b64 a[180:183], v42 offset0:67 offset1:75
v_accvgpr_read_b32 v49, a225
v_mfma_f32_16x16x32_bf16 a[244:247], a[140:143], v[68:71], a[244:247]
v_accvgpr_read_b32 v50, a226
v_accvgpr_read_b32 v51, a227
v_mfma_f32_16x16x32_bf16 a[248:251], a[136:139], v[88:91], a[248:251]
ds_read2st64_b64 a[168:171], v40 offset0:68 offset1:76
v_accvgpr_read_b32 v52, a228
v_mfma_f32_16x16x32_bf16 a[248:251], a[140:143], v[72:75], a[248:251]
ds_read_b64_tr_b16 a[136:137], v3 offset:57344
v_accvgpr_read_b32 v53, a229
v_mfma_f32_16x16x32_bf16 v[160:163], a[144:147], v[80:83], v[160:163]
ds_read_b64_tr_b16 a[138:139], v3 offset:59392
ds_read_b64_tr_b16 a[140:141], v3 offset:61440
v_mfma_f32_16x16x32_bf16 v[160:163], a[148:151], v[64:67], v[160:163]
ds_read_b64_tr_b16 a[142:143], v3 offset:63488
ds_read2st64_b64 a[184:187], v42 offset0:69 offset1:77
v_mfma_f32_16x16x32_bf16 v[164:167], a[144:147], v[84:87], v[164:167]
v_accvgpr_read_b32 v54, a230
v_accvgpr_read_b32 v55, a231
v_mfma_f32_16x16x32_bf16 v[164:167], a[148:151], v[68:71], v[164:167]
s_waitcnt lgkmcnt(13)
buffer_store_dwordx4 a[160:163], v14, s[20:23], s72 offen offset:128 nt
v_mfma_f32_16x16x32_bf16 v[168:171], a[144:147], v[88:91], v[168:171]
v_accvgpr_read_b32 v56, a232
v_accvgpr_read_b32 v57, a233
v_mfma_f32_16x16x32_bf16 v[168:171], a[148:151], v[72:75], v[168:171]
v_accvgpr_read_b32 v58, a234
v_accvgpr_read_b32 v59, a235
v_mfma_f32_16x16x32_bf16 v[176:179], a[152:155], v[80:83], v[176:179]
v_accvgpr_read_b32 v60, a240
v_accvgpr_read_b32 v61, a241
v_mfma_f32_16x16x32_bf16 v[176:179], a[156:159], v[64:67], v[176:179]
s_waitcnt lgkmcnt(12)
buffer_store_dwordx4 a[176:179], v14, s[20:23], s73 offen offset:128 nt
v_mfma_f32_16x16x32_bf16 v[180:183], a[152:155], v[84:87], v[180:183]
v_accvgpr_read_b32 v62, a242
v_accvgpr_read_b32 v63, a243
v_mfma_f32_16x16x32_bf16 v[180:183], a[156:159], v[68:71], v[180:183]
ds_read_b64_tr_b16 a[144:145], v2 offset:57856
ds_read_b64_tr_b16 a[146:147], v2 offset:59904
ds_read_b64_tr_b16 a[148:149], v2 offset:61952
ds_read_b64_tr_b16 a[150:151], v2 offset:64000
v_mfma_f32_16x16x32_bf16 v[184:187], a[152:155], v[88:91], v[184:187]
v_accvgpr_read_b32 v128, a244
v_accvgpr_read_b32 v129, a245
v_mfma_f32_16x16x32_bf16 v[184:187], a[156:159], v[72:75], v[184:187]
s_waitcnt lgkmcnt(12)
s_waitcnt lgkmcnt(11)
buffer_store_dwordx4 a[164:167], v14, s[20:23], s74 offen offset:128 nt
v_mfma_f32_16x16x32_bf16 v[192:195], a[128:131], v[80:83], v[192:195]
v_accvgpr_read_b32 v130, a246
v_accvgpr_read_b32 v131, a247
v_mfma_f32_16x16x32_bf16 v[192:195], a[132:135], v[64:67], v[192:195]
v_accvgpr_read_b32 v132, a248
v_accvgpr_read_b32 v133, a249
v_mfma_f32_16x16x32_bf16 v[196:199], a[128:131], v[84:87], v[196:199]
s_waitcnt lgkmcnt(10)
buffer_store_dwordx4 a[180:183], v14, s[20:23], s75 offen offset:128 nt
s_waitcnt lgkmcnt(9)
buffer_store_dwordx4 a[168:171], v14, s[20:23], s76 offen offset:128 nt
s_waitcnt lgkmcnt(4)
buffer_store_dwordx4 a[184:187], v14, s[20:23], s77 offen offset:128 nt
v_accvgpr_read_b32 v134, a250
v_accvgpr_read_b32 v135, a251
v_mfma_f32_16x16x32_bf16 v[196:199], a[132:135], v[68:71], v[196:199]
ds_read_b64_tr_b16 a[152:153], v3 offset:57856
ds_read_b64_tr_b16 a[154:155], v3 offset:59904
ds_read_b64_tr_b16 a[156:157], v3 offset:61952
ds_read_b64_tr_b16 a[158:159], v3 offset:64000
v_pk_mul_f32 v[48:49], v[48:49], v[32:33] op_sel:[0,0] op_sel_hi:[1,0]
v_pk_mul_f32 v[50:51], v[50:51], v[32:33] op_sel:[0,0] op_sel_hi:[1,0]
v_cvt_pk_bf16_f32 v48, v48, v49
v_cvt_pk_bf16_f32 v49, v50, v51
v_pk_mul_f32 v[52:53], v[52:53], v[32:33] op_sel:[0,1] op_sel_hi:[1,1]
v_pk_mul_f32 v[54:55], v[54:55], v[32:33] op_sel:[0,1] op_sel_hi:[1,1]
v_cvt_pk_bf16_f32 v52, v52, v53
v_cvt_pk_bf16_f32 v53, v54, v55
v_pk_mul_f32 v[56:57], v[56:57], v[34:35] op_sel:[0,0] op_sel_hi:[1,0]
v_pk_mul_f32 v[58:59], v[58:59], v[34:35] op_sel:[0,0] op_sel_hi:[1,0]
v_cvt_pk_bf16_f32 v56, v56, v57
v_cvt_pk_bf16_f32 v57, v58, v59
ds_write2st64_b64 v15, v[48:49], v[52:53] offset0:64 offset1:66
v_pk_mul_f32 v[60:61], v[60:61], v[32:33] op_sel:[0,0] op_sel_hi:[1,0]
v_pk_mul_f32 v[62:63], v[62:63], v[32:33] op_sel:[0,0] op_sel_hi:[1,0]
v_cvt_pk_bf16_f32 v60, v60, v61
v_cvt_pk_bf16_f32 v61, v62, v63
ds_write_b64 v15, v[56:57] offset:34816
v_pk_mul_f32 v[128:129], v[128:129], v[32:33] op_sel:[0,1] op_sel_hi:[1,1]
v_pk_mul_f32 v[130:131], v[130:131], v[32:33] op_sel:[0,1] op_sel_hi:[1,1]
v_cvt_pk_bf16_f32 v128, v128, v129
v_cvt_pk_bf16_f32 v129, v130, v131
v_pk_mul_f32 v[132:133], v[132:133], v[34:35] op_sel:[0,0] op_sel_hi:[1,0]
v_pk_mul_f32 v[134:135], v[134:135], v[34:35] op_sel:[0,0] op_sel_hi:[1,0]
v_cvt_pk_bf16_f32 v132, v132, v133
v_cvt_pk_bf16_f32 v133, v134, v135
ds_write2st64_b64 v37, v[60:61], v[128:129] offset0:64 offset1:66
v_pk_mul_f32 v[160:161], v[160:161], v[32:33] op_sel:[0,0] op_sel_hi:[1,0]
v_pk_mul_f32 v[162:163], v[162:163], v[32:33] op_sel:[0,0] op_sel_hi:[1,0]
v_cvt_pk_bf16_f32 v160, v160, v161
v_cvt_pk_bf16_f32 v161, v162, v163
ds_write_b64 v37, v[132:133] offset:34816
v_pk_mul_f32 v[164:165], v[164:165], v[32:33] op_sel:[0,1] op_sel_hi:[1,1]
v_pk_mul_f32 v[166:167], v[166:167], v[32:33] op_sel:[0,1] op_sel_hi:[1,1]
v_cvt_pk_bf16_f32 v164, v164, v165
v_cvt_pk_bf16_f32 v165, v166, v167
v_pk_mul_f32 v[168:169], v[168:169], v[34:35] op_sel:[0,0] op_sel_hi:[1,0]
v_pk_mul_f32 v[170:171], v[170:171], v[34:35] op_sel:[0,0] op_sel_hi:[1,0]
v_cvt_pk_bf16_f32 v168, v168, v169
v_cvt_pk_bf16_f32 v169, v170, v171
ds_write2st64_b64 v38, v[160:161], v[164:165] offset0:64 offset1:66
v_pk_mul_f32 v[176:177], v[176:177], v[32:33] op_sel:[0,0] op_sel_hi:[1,0]
v_pk_mul_f32 v[178:179], v[178:179], v[32:33] op_sel:[0,0] op_sel_hi:[1,0]
v_cvt_pk_bf16_f32 v176, v176, v177
v_cvt_pk_bf16_f32 v177, v178, v179
ds_write_b64 v38, v[168:169] offset:34816
v_pk_mul_f32 v[180:181], v[180:181], v[32:33] op_sel:[0,1] op_sel_hi:[1,1]
v_pk_mul_f32 v[182:183], v[182:183], v[32:33] op_sel:[0,1] op_sel_hi:[1,1]
v_cvt_pk_bf16_f32 v180, v180, v181
v_cvt_pk_bf16_f32 v181, v182, v183
v_pk_mul_f32 v[184:185], v[184:185], v[34:35] op_sel:[0,0] op_sel_hi:[1,0]
v_pk_mul_f32 v[186:187], v[186:187], v[34:35] op_sel:[0,0] op_sel_hi:[1,0]
v_cvt_pk_bf16_f32 v184, v184, v185
v_cvt_pk_bf16_f32 v185, v186, v187
ds_write2st64_b64 v39, v[176:177], v[180:181] offset0:64 offset1:66
ds_write_b64 v39, v[184:185] offset:34816
v_mfma_f32_16x16x32_bf16 v[200:203], a[128:131], v[88:91], v[200:203]
ds_read2st64_b64 a[224:227], v40 offset0:64 offset1:72
ds_read2st64_b64 a[240:243], v42 offset0:65 offset1:73
v_mfma_f32_16x16x32_bf16 v[200:203], a[132:135], v[72:75], v[200:203]
ds_read2st64_b64 a[228:231], v40 offset0:66 offset1:74
ds_read2st64_b64 a[244:247], v42 offset0:67 offset1:75
v_mfma_f32_16x16x32_bf16 v[208:211], a[136:139], v[80:83], v[208:211]
v_mul_f32 v192, v192, v32
v_mul_f32 v193, v193, v32
v_mfma_f32_16x16x32_bf16 v[208:211], a[140:143], v[64:67], v[208:211]
v_mul_f32 v194, v194, v32
v_mul_f32 v195, v195, v32
v_mfma_f32_16x16x32_bf16 v[212:215], a[136:139], v[84:87], v[212:215]
ds_read2st64_b64 a[232:235], v40 offset0:68 offset1:76
v_cvt_pk_bf16_f32 v192, v192, v193
v_mfma_f32_16x16x32_bf16 v[212:215], a[140:143], v[68:71], v[212:215]
v_mul_f32 v196, v196, v33
v_cvt_pk_bf16_f32 v193, v194, v195
v_mfma_f32_16x16x32_bf16 v[216:219], a[136:139], v[88:91], v[216:219]
ds_read2st64_b64 a[248:251], v42 offset0:69 offset1:77
v_mul_f32 v197, v197, v33
v_mfma_f32_16x16x32_bf16 v[216:219], a[140:143], v[72:75], v[216:219]
s_waitcnt lgkmcnt(15)
v_mul_f32 v198, v198, v33
v_mul_f32 v199, v199, v33
v_mfma_f32_16x16x32_bf16 v[224:227], a[144:147], v[80:83], v[224:227]
s_waitcnt lgkmcnt(5)
buffer_store_dwordx4 a[224:227], v14, s[20:23], s72 offen offset:256 nt
v_mfma_f32_16x16x32_bf16 v[224:227], a[148:151], v[64:67], v[224:227]
v_cvt_pk_bf16_f32 v196, v196, v197
v_mul_f32 v200, v200, v34
v_mfma_f32_16x16x32_bf16 v[228:231], a[144:147], v[84:87], v[228:231]
v_cvt_pk_bf16_f32 v197, v198, v199
v_mul_f32 v201, v201, v34
v_mfma_f32_16x16x32_bf16 v[228:231], a[148:151], v[68:71], v[228:231]
v_mul_f32 v202, v202, v34
v_mul_f32 v203, v203, v34
v_mfma_f32_16x16x32_bf16 v[232:235], a[144:147], v[88:91], v[232:235]
s_waitcnt lgkmcnt(4)
buffer_store_dwordx4 a[240:243], v14, s[20:23], s73 offen offset:256 nt
v_mfma_f32_16x16x32_bf16 v[232:235], a[148:151], v[72:75], v[232:235]
v_cvt_pk_bf16_f32 v200, v200, v201
v_mul_f32 v208, v208, v32
v_mfma_f32_16x16x32_bf16 v[240:243], a[152:155], v[80:83], v[240:243]
v_cvt_pk_bf16_f32 v201, v202, v203
v_mul_f32 v209, v209, v32
v_mfma_f32_16x16x32_bf16 v[240:243], a[156:159], v[64:67], v[240:243]
v_mul_f32 v210, v210, v32
v_mul_f32 v211, v211, v32
v_mfma_f32_16x16x32_bf16 v[244:247], a[152:155], v[84:87], v[244:247]
s_waitcnt lgkmcnt(3)
buffer_store_dwordx4 a[228:231], v14, s[20:23], s74 offen offset:256 nt
v_mfma_f32_16x16x32_bf16 v[244:247], a[156:159], v[68:71], v[244:247]
v_cvt_pk_bf16_f32 v208, v208, v209
v_cvt_pk_bf16_f32 v209, v210, v211
v_mfma_f32_16x16x32_bf16 v[248:251], a[152:155], v[88:91], v[248:251]
s_waitcnt lgkmcnt(2)
buffer_store_dwordx4 a[244:247], v14, s[20:23], s75 offen offset:256 nt
s_waitcnt lgkmcnt(1)
buffer_store_dwordx4 a[232:235], v14, s[20:23], s76 offen offset:256 nt
s_waitcnt lgkmcnt(0)
buffer_store_dwordx4 a[248:251], v14, s[20:23], s77 offen offset:256 nt
v_mfma_f32_16x16x32_bf16 v[248:251], a[156:159], v[72:75], v[248:251]
ds_write2st64_b64 v15, v[192:193], v[196:197] offset0:64 offset1:66
ds_write_b64 v15, v[200:201] offset:34816
v_pk_mul_f32 v[212:213], v[212:213], v[32:33] op_sel:[0,1] op_sel_hi:[1,1]
v_pk_mul_f32 v[214:215], v[214:215], v[32:33] op_sel:[0,1] op_sel_hi:[1,1]
v_cvt_pk_bf16_f32 v212, v212, v213
v_cvt_pk_bf16_f32 v213, v214, v215
v_pk_mul_f32 v[216:217], v[216:217], v[34:35] op_sel:[0,0] op_sel_hi:[1,0]
v_pk_mul_f32 v[218:219], v[218:219], v[34:35] op_sel:[0,0] op_sel_hi:[1,0]
v_cvt_pk_bf16_f32 v216, v216, v217
v_cvt_pk_bf16_f32 v217, v218, v219
ds_write2st64_b64 v37, v[208:209], v[212:213] offset0:64 offset1:66
v_pk_mul_f32 v[224:225], v[224:225], v[32:33] op_sel:[0,0] op_sel_hi:[1,0]
v_pk_mul_f32 v[226:227], v[226:227], v[32:33] op_sel:[0,0] op_sel_hi:[1,0]
v_cvt_pk_bf16_f32 v224, v224, v225
v_cvt_pk_bf16_f32 v225, v226, v227
ds_write_b64 v37, v[216:217] offset:34816
v_pk_mul_f32 v[228:229], v[228:229], v[32:33] op_sel:[0,1] op_sel_hi:[1,1]
v_pk_mul_f32 v[230:231], v[230:231], v[32:33] op_sel:[0,1] op_sel_hi:[1,1]
v_cvt_pk_bf16_f32 v228, v228, v229
v_cvt_pk_bf16_f32 v229, v230, v231
v_pk_mul_f32 v[232:233], v[232:233], v[34:35] op_sel:[0,0] op_sel_hi:[1,0]
v_pk_mul_f32 v[234:235], v[234:235], v[34:35] op_sel:[0,0] op_sel_hi:[1,0]
v_cvt_pk_bf16_f32 v232, v232, v233
v_cvt_pk_bf16_f32 v233, v234, v235
ds_write2st64_b64 v38, v[224:225], v[228:229] offset0:64 offset1:66
v_pk_mul_f32 v[240:241], v[240:241], v[32:33] op_sel:[0,0] op_sel_hi:[1,0]
v_pk_mul_f32 v[242:243], v[242:243], v[32:33] op_sel:[0,0] op_sel_hi:[1,0]
v_cvt_pk_bf16_f32 v240, v240, v241
v_cvt_pk_bf16_f32 v241, v242, v243
ds_write_b64 v38, v[232:233] offset:34816
v_pk_mul_f32 v[244:245], v[244:245], v[32:33] op_sel:[0,1] op_sel_hi:[1,1]
v_pk_mul_f32 v[246:247], v[246:247], v[32:33] op_sel:[0,1] op_sel_hi:[1,1]
v_cvt_pk_bf16_f32 v244, v244, v245
v_cvt_pk_bf16_f32 v245, v246, v247
v_pk_mul_f32 v[248:249], v[248:249], v[34:35] op_sel:[0,0] op_sel_hi:[1,0]
v_pk_mul_f32 v[250:251], v[250:251], v[34:35] op_sel:[0,0] op_sel_hi:[1,0]
v_cvt_pk_bf16_f32 v248, v248, v249
v_cvt_pk_bf16_f32 v249, v250, v251
ds_write2st64_b64 v39, v[240:241], v[244:245] offset0:64 offset1:66
ds_write_b64 v39, v[248:249] offset:34816
ds_read2st64_b64 v[192:195], v40 offset0:64 offset1:72
ds_read2st64_b64 v[208:211], v42 offset0:65 offset1:73
ds_read2st64_b64 v[196:199], v40 offset0:66 offset1:74
ds_read2st64_b64 v[212:215], v42 offset0:67 offset1:75
ds_read2st64_b64 v[200:203], v40 offset0:68 offset1:76
ds_read2st64_b64 v[216:219], v42 offset0:69 offset1:77
s_waitcnt lgkmcnt(5)
buffer_store_dwordx4 v[192:195], v14, s[20:23], s72 offen offset:384 nt
s_waitcnt lgkmcnt(4)
buffer_store_dwordx4 v[208:211], v14, s[20:23], s73 offen offset:384 nt
s_waitcnt lgkmcnt(3)
buffer_store_dwordx4 v[196:199], v14, s[20:23], s74 offen offset:384 nt
s_waitcnt lgkmcnt(2)
buffer_store_dwordx4 v[212:215], v14, s[20:23], s75 offen offset:384 nt
s_waitcnt lgkmcnt(1)
buffer_store_dwordx4 v[200:203], v14, s[20:23], s76 offen offset:384 nt
s_waitcnt lgkmcnt(0)
buffer_store_dwordx4 v[216:219], v14, s[20:23], s77 offen offset:384 nt
s_branch L_done
L_iw3b:
s_branch L_iw4a
L_i7_3:
v_mfma_f32_16x16x32_bf16 v[48:51], a[128:131], a[0:3], v[16:19]
s_add_u32 m0, s27, 0
ds_read_b128 a[152:155], v1 offset:1536
ds_read_b128 a[156:159], v1 offset:1792
v_mfma_f32_16x16x32_bf16 v[48:51], a[132:135], a[4:7], v[48:51]
v_mul_f32 v72, s35, v72
v_mul_f32 v73, s35, v73
v_mfma_f32_16x16x32_bf16 v[52:55], a[128:131], a[32:35], v[20:23]
s_sub_u32 s32, s31, 32768
v_exp_f32 v72, v72
v_mfma_f32_16x16x32_bf16 v[52:55], a[132:135], a[36:39], v[52:55]
buffer_load_dwordx4 v12, s[8:11], s42 offen offset:0 nt lds
v_mfma_f32_16x16x32_bf16 v[56:59], a[128:131], a[64:67], v[24:27]
s_add_u32 s72, s44, 0
v_exp_f32 v73, v73
v_mfma_f32_16x16x32_bf16 v[56:59], a[132:135], a[68:71], v[56:59]
s_waitcnt lgkmcnt(4)
ds_read_b64_tr_b16 a[128:129], v2 offset:32768
ds_read_b64_tr_b16 a[130:131], v2 offset:34816
v_mfma_f32_16x16x32_bf16 v[48:51], a[136:139], a[8:11], v[48:51]
s_add_u32 s73, s44, 4096
ds_read_b64_tr_b16 a[132:133], v3 offset:32768
ds_read_b64_tr_b16 a[134:135], v3 offset:34816
v_mfma_f32_16x16x32_bf16 v[48:51], a[140:143], a[12:15], v[48:51]
s_add_u32 s74, s44, 8192
v_mul_f32 v74, s35, v74
v_mul_f32 v75, s35, v75
v_mfma_f32_16x16x32_bf16 v[52:55], a[136:139], a[40:43], v[52:55]
buffer_load_dwordx4 v12, s[8:11], s42 offen offset:2048 nt lds
v_mfma_f32_16x16x32_bf16 v[52:55], a[140:143], a[44:47], v[52:55]
s_add_u32 m0, s27, 768
v_exp_f32 v74, v74
v_mfma_f32_16x16x32_bf16 v[56:59], a[136:139], a[72:75], v[56:59]
s_add_u32 s75, s44, 12288
v_exp_f32 v75, v75
v_mfma_f32_16x16x32_bf16 v[56:59], a[140:143], a[76:79], v[56:59]
s_waitcnt lgkmcnt(6)
ds_read_b64_tr_b16 a[136:137], v2 offset:33280
ds_read_b64_tr_b16 a[138:139], v2 offset:35328
v_mfma_f32_16x16x32_bf16 v[48:51], a[144:147], a[16:19], v[48:51]
s_add_u32 s76, s44, 16384
ds_read_b64_tr_b16 a[140:141], v3 offset:33280
ds_read_b64_tr_b16 a[142:143], v3 offset:35328
v_mfma_f32_16x16x32_bf16 v[48:51], a[148:151], a[20:23], v[48:51]
v_xor_b32 v37, 16, v15
v_xor_b32 v38, 32, v15
v_mfma_f32_16x16x32_bf16 v[52:55], a[144:147], a[48:51], v[52:55]
s_waitcnt vmcnt(41)
v_add_f32 v8, v8, v72
v_xor_b32 v39, 48, v15
v_mfma_f32_16x16x32_bf16 v[52:55], a[148:151], a[52:55], v[52:55]
v_add_f32 v8, v8, v73
v_mbcnt_lo_u32_b32 v40, -1, 0
v_mfma_f32_16x16x32_bf16 v[56:59], a[144:147], a[80:83], v[56:59]
s_add_u32 s77, s44, 20480
buffer_load_dwordx4 v12, s[8:11], s42 offen offset:256 nt lds
v_mfma_f32_16x16x32_bf16 v[56:59], a[148:151], a[84:87], v[56:59]
s_waitcnt lgkmcnt(8)
ds_read_b64_tr_b16 a[144:145], v2 offset:40960
ds_read_b64_tr_b16 a[146:147], v2 offset:43008
v_mfma_f32_16x16x32_bf16 v[48:51], a[152:155], a[24:27], v[48:51]
ds_read_b64_tr_b16 a[148:149], v3 offset:40960
ds_read_b64_tr_b16 a[150:151], v3 offset:43008
v_mfma_f32_16x16x32_bf16 v[48:51], a[156:159], a[28:31], v[48:51]
s_mov_b32 s78, 0x7fff0000
v_add_f32 v8, v8, v74
v_add_u32 v11, s26, v1
v_mfma_f32_16x16x32_bf16 v[52:55], a[152:155], a[56:59], v[52:55]
v_mbcnt_hi_u32_b32 v40, -1, v40
v_add_f32 v8, v8, v75
v_mfma_f32_16x16x32_bf16 v[52:55], a[156:159], a[60:63], v[52:55]
v_lshl_add_u32 v40, v40, 3, s28
v_cvt_pk_bf16_f32 v72, v72, v73
v_mfma_f32_16x16x32_bf16 v[56:59], a[152:155], a[88:91], v[56:59]
ds_read_b128 a[0:3], v11 offset:0
v_xor_b32 v42, 32, v40
v_mfma_f32_16x16x32_bf16 v[56:59], a[156:159], a[92:95], v[56:59]
s_waitcnt lgkmcnt(9)
buffer_load_dwordx4 v12, s[8:11], s42 offen offset:2304 nt lds
v_mfma_f32_16x16x32_bf16 v[96:99], a[128:131], v[80:83], v[96:99]
s_add_u32 m0, s27, 4096
ds_read_b128 a[4:7], v11 offset:256
v_cvt_pk_bf16_f32 v73, v74, v75
v_mfma_f32_16x16x32_bf16 v[112:115], a[132:135], v[80:83], v[112:115]
s_mov_b32 s79, 0x7fff0000
ds_read_b64_tr_b16 a[152:153], v2 offset:41472
ds_read_b64_tr_b16 a[154:155], v2 offset:43520
v_mfma_f32_16x16x32_bf16 v[100:103], a[128:131], v[84:87], v[100:103]
ds_read_b64_tr_b16 a[156:157], v3 offset:41472
ds_read_b64_tr_b16 a[158:159], v3 offset:43520
v_mfma_f32_16x16x32_bf16 v[116:119], a[132:135], v[84:87], v[116:119]
ds_read_b128 a[8:11], v11 offset:512
v_mul_f32 v48, s35, v48
v_mfma_f32_16x16x32_bf16 v[104:107], a[128:131], v[88:91], v[104:107]
ds_read_b128 a[12:15], v11 offset:768
v_mul_f32 v49, s35, v49
v_mfma_f32_16x16x32_bf16 v[120:123], a[132:135], v[88:91], v[120:123]
s_waitcnt lgkmcnt(12)
v_exp_f32 v48, v48
v_mfma_f32_16x16x32_bf16 v[128:131], a[136:139], v[80:83], v[128:131]
v_exp_f32 v49, v49
v_mfma_f32_16x16x32_bf16 v[144:147], a[140:143], v[80:83], v[144:147]
ds_read_b128 a[16:19], v11 offset:1024
v_mul_f32 v50, s35, v50
v_mfma_f32_16x16x32_bf16 v[132:135], a[136:139], v[84:87], v[132:135]
buffer_load_dwordx4 v13, s[8:11], s42 offen offset:0 nt lds
v_mfma_f32_16x16x32_bf16 v[148:151], a[140:143], v[84:87], v[148:151]
ds_read_b64_tr_b16 a[128:129], v2 offset:36864
ds_read_b64_tr_b16 a[130:131], v2 offset:38912
ds_read_b64_tr_b16 a[132:133], v3 offset:36864
ds_read_b64_tr_b16 a[134:135], v3 offset:38912
v_mfma_f32_16x16x32_bf16 v[136:139], a[136:139], v[88:91], v[136:139]
ds_read_b128 a[20:23], v11 offset:1280
v_mul_f32 v51, s35, v51
v_mfma_f32_16x16x32_bf16 v[152:155], a[140:143], v[88:91], v[152:155]
s_waitcnt lgkmcnt(14)
v_exp_f32 v50, v50
v_mfma_f32_16x16x32_bf16 a[160:163], a[144:147], v[80:83], a[160:163]
v_exp_f32 v51, v51
v_mfma_f32_16x16x32_bf16 a[176:179], a[148:151], v[80:83], a[176:179]
v_cvt_pk_bf16_f32 v66, v48, v49
v_cvt_pk_bf16_f32 v67, v50, v51
v_mfma_f32_16x16x32_bf16 a[164:167], a[144:147], v[84:87], a[164:167]
buffer_load_dwordx4 v13, s[8:11], s42 offen offset:2048 nt lds
v_mfma_f32_16x16x32_bf16 a[180:183], a[148:151], v[84:87], a[180:183]
s_add_u32 m0, s27, 4864
ds_read_b64_tr_b16 a[136:137], v2 offset:37376
ds_read_b64_tr_b16 a[138:139], v2 offset:39424
ds_read_b64_tr_b16 a[140:141], v3 offset:37376
ds_read_b64_tr_b16 a[142:143], v3 offset:39424
v_mfma_f32_16x16x32_bf16 a[168:171], a[144:147], v[88:91], a[168:171]
ds_read_b128 a[24:27], v11 offset:1536
v_mul_f32 v52, s35, v52
v_mfma_f32_16x16x32_bf16 a[184:187], a[148:151], v[88:91], a[184:187]
s_waitcnt lgkmcnt(13)
ds_read_b128 a[28:31], v11 offset:1792
v_mul_f32 v53, s35, v53
v_mfma_f32_16x16x32_bf16 a[192:195], a[152:155], v[80:83], a[192:195]
v_exp_f32 v52, v52
v_mfma_f32_16x16x32_bf16 a[208:211], a[156:159], v[80:83], a[208:211]
v_exp_f32 v53, v53
v_mfma_f32_16x16x32_bf16 a[196:199], a[152:155], v[84:87], a[196:199]
v_mul_f32 v54, s35, v54
v_mul_f32 v55, s35, v55
v_mfma_f32_16x16x32_bf16 a[212:215], a[156:159], v[84:87], a[212:215]
ds_read_b64_tr_b16 a[144:145], v2 offset:45056
ds_read_b64_tr_b16 a[146:147], v2 offset:47104
ds_read_b64_tr_b16 a[148:149], v3 offset:45056
ds_read_b64_tr_b16 a[150:151], v3 offset:47104
v_mfma_f32_16x16x32_bf16 a[200:203], a[152:155], v[88:91], a[200:203]
v_exp_f32 v54, v54
v_mfma_f32_16x16x32_bf16 a[216:219], a[156:159], v[88:91], a[216:219]
s_waitcnt lgkmcnt(11)
v_exp_f32 v55, v55
v_mfma_f32_16x16x32_bf16 v[96:99], a[128:131], v[64:67], v[96:99]
v_cvt_pk_bf16_f32 v70, v52, v53
v_cvt_pk_bf16_f32 v71, v54, v55
v_mfma_f32_16x16x32_bf16 v[112:115], a[132:135], v[64:67], v[112:115]
v_mul_f32 v56, s35, v56
v_mul_f32 v57, s35, v57
v_exp_f32 v56, v56
v_exp_f32 v57, v57
v_mul_f32 v58, s35, v58
v_mul_f32 v59, s35, v59
v_exp_f32 v58, v58
v_exp_f32 v59, v59
v_mfma_f32_16x16x32_bf16 v[100:103], a[128:131], v[68:71], v[100:103]
v_cvt_pk_bf16_f32 v74, v56, v57
v_cvt_pk_bf16_f32 v75, v58, v59
v_mfma_f32_16x16x32_bf16 v[116:119], a[132:135], v[68:71], v[116:119]
ds_read_b64_tr_b16 a[152:153], v2 offset:45568
ds_read_b64_tr_b16 a[154:155], v2 offset:47616
ds_read_b64_tr_b16 a[156:157], v3 offset:45568
ds_read_b64_tr_b16 a[158:159], v3 offset:47616
v_mfma_f32_16x16x32_bf16 v[104:107], a[128:131], v[72:75], v[104:107]
buffer_load_dwordx4 v13, s[8:11], s42 offen offset:256 nt lds
v_mfma_f32_16x16x32_bf16 v[120:123], a[132:135], v[72:75], v[120:123]
s_waitcnt lgkmcnt(10)
buffer_load_dwordx4 v13, s[8:11], s42 offen offset:2304 nt lds
v_mfma_f32_16x16x32_bf16 v[128:131], a[136:139], v[64:67], v[128:131]
s_waitcnt lgkmcnt(8)
v_add_f32 v6, v6, v48
v_add_f32 v6, v6, v49
v_mfma_f32_16x16x32_bf16 v[144:147], a[140:143], v[64:67], v[144:147]
s_add_u32 m0, s26, 0
ds_read_b64_tr_b16 a[128:129], v2 offset:49152
ds_read_b64_tr_b16 a[130:131], v2 offset:51200
v_mfma_f32_16x16x32_bf16 v[132:135], a[136:139], v[68:71], v[132:135]
s_waitcnt vmcnt(8)
ds_read_b64_tr_b16 a[132:133], v2 offset:53248
ds_read_b64_tr_b16 a[134:135], v2 offset:55296
v_mfma_f32_16x16x32_bf16 v[148:151], a[140:143], v[68:71], v[148:151]
v_add_f32 v6, v6, v50
v_add_f32 v6, v6, v51
v_mfma_f32_16x16x32_bf16 v[136:139], a[136:139], v[72:75], v[136:139]
v_add_f32 v7, v7, v52
v_add_u32 v10, s39, v1
v_mfma_f32_16x16x32_bf16 v[152:155], a[140:143], v[72:75], v[152:155]
s_waitcnt lgkmcnt(8)
buffer_load_dwordx4 v12, s[8:11], s43 offen offset:0 nt lds
v_mfma_f32_16x16x32_bf16 a[160:163], a[144:147], v[64:67], a[160:163]
ds_read_b64_tr_b16 a[136:137], v3 offset:49152
ds_read_b64_tr_b16 a[138:139], v3 offset:51200
v_mfma_f32_16x16x32_bf16 a[176:179], a[148:151], v[64:67], a[176:179]
ds_read_b64_tr_b16 a[140:141], v3 offset:53248
ds_read_b64_tr_b16 a[142:143], v3 offset:55296
v_mfma_f32_16x16x32_bf16 a[164:167], a[144:147], v[68:71], a[164:167]
s_mov_b32 s44, s48
ds_read_b128 a[32:35], v10 offset:0
v_add_f32 v7, v7, v53
v_mfma_f32_16x16x32_bf16 a[180:183], a[148:151], v[68:71], a[180:183]
s_add_u32 s30, s49, 262144
ds_read_b128 a[36:39], v10 offset:256
v_add_f32 v7, v7, v54
v_mfma_f32_16x16x32_bf16 a[168:171], a[144:147], v[72:75], a[168:171]
s_mov_b32 s70, s50
buffer_load_dwordx4 v12, s[8:11], s43 offen offset:2048 nt lds
v_mfma_f32_16x16x32_bf16 a[184:187], a[148:151], v[72:75], a[184:187]
s_waitcnt lgkmcnt(10)
ds_read_b64_tr_b16 a[144:145], v2 offset:49664
v_add_f32 v7, v7, v55
v_mfma_f32_16x16x32_bf16 a[192:195], a[152:155], v[64:67], a[192:195]
s_add_u32 m0, s26, 768
ds_read_b64_tr_b16 a[146:147], v2 offset:51712
ds_read_b64_tr_b16 a[148:149], v2 offset:53760
v_mfma_f32_16x16x32_bf16 a[208:211], a[156:159], v[64:67], a[208:211]
s_mov_b32 s31, s53
ds_read_b64_tr_b16 a[150:151], v2 offset:55808
ds_read_b128 a[40:43], v10 offset:512
v_mfma_f32_16x16x32_bf16 a[196:199], a[152:155], v[68:71], a[196:199]
s_mov_b32 s94, s52
v_add_f32 v8, v8, v56
v_add_f32 v8, v8, v57
v_mfma_f32_16x16x32_bf16 a[212:215], a[156:159], v[68:71], a[212:215]
ds_read_b128 a[44:47], v10 offset:768
v_add_f32 v8, v8, v58
v_mfma_f32_16x16x32_bf16 a[200:203], a[152:155], v[72:75], a[200:203]
ds_read_b128 a[48:51], v10 offset:1024
v_add_f32 v8, v8, v59
v_mfma_f32_16x16x32_bf16 a[216:219], a[156:159], v[72:75], a[216:219]
s_waitcnt lgkmcnt(13)
ds_read_b64_tr_b16 a[152:153], v3 offset:49664
ds_read_b64_tr_b16 a[154:155], v3 offset:51712
v_mfma_f32_16x16x32_bf16 a[224:227], a[128:131], v[80:83], a[224:227]
s_add_u32 s41, s52, 8192
ds_read_b64_tr_b16 a[156:157], v3 offset:53760
ds_read_b64_tr_b16 a[158:159], v3 offset:55808
v_mfma_f32_16x16x32_bf16 a[224:227], a[132:135], v[64:67], a[224:227]
buffer_load_dwordx4 v12, s[8:11], s43 offen offset:256 nt lds
v_mfma_f32_16x16x32_bf16 a[228:231], a[128:131], v[84:87], a[228:231]
s_add_u32 s42, s52, 16384
ds_read_b128 a[52:55], v10 offset:1280
ds_read_b128 a[56:59], v10 offset:1536
v_mfma_f32_16x16x32_bf16 a[228:231], a[132:135], v[68:71], a[228:231]
buffer_load_dwordx4 v12, s[8:11], s43 offen offset:2304 nt lds
v_mfma_f32_16x16x32_bf16 a[232:235], a[128:131], v[88:91], a[232:235]
s_add_u32 m0, s26, 4096
v_permlane16_swap_b32 v6, v7
v_mfma_f32_16x16x32_bf16 a[232:235], a[132:135], v[72:75], a[232:235]
s_waitcnt lgkmcnt(15)
ds_read_b64_tr_b16 a[128:129], v2 offset:57344
ds_read_b64_tr_b16 a[130:131], v2 offset:59392
v_mfma_f32_16x16x32_bf16 a[240:243], a[136:139], v[80:83], a[240:243]
s_mov_b64 s[48:49], s[52:53]
ds_read_b64_tr_b16 a[132:133], v2 offset:61440
ds_read_b64_tr_b16 a[134:135], v2 offset:63488
v_mfma_f32_16x16x32_bf16 a[240:243], a[140:143], v[64:67], a[240:243]
v_permlane16_swap_b32 v8, v9
v_mfma_f32_16x16x32_bf16 a[244:247], a[136:139], v[84:87], a[244:247]
s_mov_b64 s[50:51], s[54:55]
ds_read_b128 a[60:63], v10 offset:1792
v_add_f32 v6, v6, v7
v_mfma_f32_16x16x32_bf16 a[244:247], a[140:143], v[68:71], a[244:247]
buffer_load_dwordx4 v13, s[8:11], s43 offen offset:0 nt lds
v_mfma_f32_16x16x32_bf16 a[248:251], a[136:139], v[88:91], a[248:251]
buffer_load_dwordx4 v13, s[8:11], s43 offen offset:2048 nt lds
v_mfma_f32_16x16x32_bf16 a[248:251], a[140:143], v[72:75], a[248:251]
s_waitcnt lgkmcnt(14)
ds_read_b64_tr_b16 a[136:137], v3 offset:57344
v_add_f32 v8, v8, v9
v_mfma_f32_16x16x32_bf16 v[160:163], a[144:147], v[80:83], v[160:163]
s_mov_b64 s[52:53], s[56:57]
ds_read_b64_tr_b16 a[138:139], v3 offset:59392
ds_read_b64_tr_b16 a[140:141], v3 offset:61440
v_mfma_f32_16x16x32_bf16 v[160:163], a[148:151], v[64:67], v[160:163]
s_mov_b64 s[54:55], s[58:59]
v_permlane32_swap_b32 v6, v8
v_mfma_f32_16x16x32_bf16 v[164:167], a[144:147], v[84:87], v[164:167]
s_add_u32 m0, s26, 4864
ds_read_b64_tr_b16 a[142:143], v3 offset:63488
v_add_f32 v41, v6, v8
v_mfma_f32_16x16x32_bf16 v[164:167], a[148:151], v[68:71], v[164:167]
v_rcp_f32 v32, v41
v_mfma_f32_16x16x32_bf16 v[168:171], a[144:147], v[88:91], v[168:171]
s_mov_b64 s[56:57], s[60:61]
v_mov_b32 v34, v32
v_mfma_f32_16x16x32_bf16 v[168:171], a[148:151], v[72:75], v[168:171]
s_waitcnt lgkmcnt(11)
ds_read_b64_tr_b16 a[144:145], v2 offset:57856
ds_read_b64_tr_b16 a[146:147], v2 offset:59904
v_mfma_f32_16x16x32_bf16 v[176:179], a[152:155], v[80:83], v[176:179]
v_permlane32_swap_b32 v32, v34
v_mfma_f32_16x16x32_bf16 v[176:179], a[156:159], v[64:67], v[176:179]
s_mov_b64 s[58:59], s[62:63]
ds_read_b64_tr_b16 a[148:149], v2 offset:61952
ds_read_b64_tr_b16 a[150:151], v2 offset:64000
v_mfma_f32_16x16x32_bf16 v[180:183], a[152:155], v[84:87], v[180:183]
v_mov_b32 v33, v32
v_mov_b32 v35, v34
v_mfma_f32_16x16x32_bf16 v[180:183], a[156:159], v[68:71], v[180:183]
buffer_load_dwordx4 v13, s[8:11], s43 offen offset:256 nt lds
v_mfma_f32_16x16x32_bf16 v[184:187], a[152:155], v[88:91], v[184:187]
s_mov_b32 s36, 3
v_permlane16_swap_b32 v32, v33
v_mfma_f32_16x16x32_bf16 v[184:187], a[156:159], v[72:75], v[184:187]
s_waitcnt lgkmcnt(9)
v_permlane16_swap_b32 v34, v35
v_mfma_f32_16x16x32_bf16 v[192:195], a[128:131], v[80:83], v[192:195]
ds_read_b64_tr_b16 a[152:153], v3 offset:57856
ds_read_b64_tr_b16 a[154:155], v3 offset:59904
ds_read_b64_tr_b16 a[156:157], v3 offset:61952
ds_read_b64_tr_b16 a[158:159], v3 offset:64000
v_mfma_f32_16x16x32_bf16 v[192:195], a[132:135], v[64:67], v[192:195]
s_mov_b32 s90, s42
v_mul_f32 v96, v96, v32
v_mul_f32 v97, v97, v32
v_mfma_f32_16x16x32_bf16 v[196:199], a[128:131], v[84:87], v[196:199]
v_mul_f32 v98, v98, v32
v_mul_f32 v99, v99, v32
v_mfma_f32_16x16x32_bf16 v[196:199], a[132:135], v[68:71], v[196:199]
v_cvt_pk_bf16_f32 v96, v96, v97
v_cvt_pk_bf16_f32 v97, v98, v99
v_mfma_f32_16x16x32_bf16 v[200:203], a[128:131], v[88:91], v[200:203]
s_add_u32 s92, s34, s31
v_mul_f32 v100, v100, v33
v_mul_f32 v101, v101, v33
v_mfma_f32_16x16x32_bf16 v[200:203], a[132:135], v[72:75], v[200:203]
s_waitcnt lgkmcnt(8)
v_mul_f32 v102, v102, v33
v_mul_f32 v103, v103, v33
v_mfma_f32_16x16x32_bf16 v[208:211], a[136:139], v[80:83], v[208:211]
v_cvt_pk_bf16_f32 v100, v100, v101
v_cvt_pk_bf16_f32 v101, v102, v103
v_mfma_f32_16x16x32_bf16 v[208:211], a[140:143], v[64:67], v[208:211]
s_waitcnt lgkmcnt(0)
v_mul_f32 v112, v112, v32
v_mul_f32 v113, v113, v32
v_mfma_f32_16x16x32_bf16 v[212:215], a[136:139], v[84:87], v[212:215]
s_barrier
v_mfma_f32_16x16x32_bf16 v[212:215], a[140:143], v[68:71], v[212:215]
s_add_u32 s91, s92, 24576
v_mul_f32 v114, v114, v32
v_mul_f32 v115, v115, v32
v_mfma_f32_16x16x32_bf16 v[216:219], a[136:139], v[88:91], v[216:219]
s_mov_b32 s93, s26
v_cvt_pk_bf16_f32 v112, v112, v113
v_cvt_pk_bf16_f32 v113, v114, v115
v_mfma_f32_16x16x32_bf16 v[216:219], a[140:143], v[72:75], v[216:219]
v_mul_f32 v116, v116, v33
v_mul_f32 v117, v117, v33
v_mfma_f32_16x16x32_bf16 v[224:227], a[144:147], v[80:83], v[224:227]
v_mul_f32 v118, v118, v33
v_mul_f32 v119, v119, v33
v_mfma_f32_16x16x32_bf16 v[224:227], a[148:151], v[64:67], v[224:227]
v_cvt_pk_bf16_f32 v116, v116, v117
v_cvt_pk_bf16_f32 v117, v118, v119
v_mfma_f32_16x16x32_bf16 v[228:231], a[144:147], v[84:87], v[228:231]
buffer_load_dwordx4 v13, s[8:11], s43 offen offset:2304 nt lds
v_mfma_f32_16x16x32_bf16 v[228:231], a[148:151], v[68:71], v[228:231]
s_mov_b32 s43, s51
v_accvgpr_read_b32 v48, a224
v_accvgpr_read_b32 v49, a225
v_mfma_f32_16x16x32_bf16 v[232:235], a[144:147], v[88:91], v[232:235]
v_accvgpr_read_b32 v50, a226
v_accvgpr_read_b32 v51, a227
v_mfma_f32_16x16x32_bf16 v[232:235], a[148:151], v[72:75], v[232:235]
v_accvgpr_read_b32 v52, a228
v_accvgpr_read_b32 v53, a229
v_mfma_f32_16x16x32_bf16 v[240:243], a[152:155], v[80:83], v[240:243]
v_accvgpr_read_b32 v54, a230
v_accvgpr_read_b32 v55, a231
v_mfma_f32_16x16x32_bf16 v[240:243], a[156:159], v[64:67], v[240:243]
v_accvgpr_read_b32 v56, a240
v_accvgpr_read_b32 v57, a241
v_mfma_f32_16x16x32_bf16 v[244:247], a[152:155], v[84:87], v[244:247]
v_accvgpr_read_b32 v58, a242
v_accvgpr_read_b32 v59, a243
v_mfma_f32_16x16x32_bf16 v[244:247], a[156:159], v[68:71], v[244:247]
v_mfma_f32_16x16x32_bf16 v[248:251], a[152:155], v[88:91], v[248:251]
v_mfma_f32_16x16x32_bf16 v[248:251], a[156:159], v[72:75], v[248:251]
v_cmp_ngt_f32 vcc, 0x58800000, v41
ds_write2st64_b64 v15, v[96:97], v[100:101] offset0:0 offset1:2
ds_write2st64_b64 v37, v[112:113], v[116:117] offset0:0 offset1:2
v_pk_mul_f32 v[128:129], v[128:129], v[32:33] op_sel:[0,0] op_sel_hi:[1,0]
v_pk_mul_f32 v[130:131], v[130:131], v[32:33] op_sel:[0,0] op_sel_hi:[1,0]
v_cvt_pk_bf16_f32 v128, v128, v129
v_cvt_pk_bf16_f32 v129, v130, v131
s_cbranch_vccz L_noflag3
s_bitset1_b32 s38, s37
L_noflag3:
v_pk_mul_f32 v[132:133], v[132:133], v[32:33] op_sel:[0,1] op_sel_hi:[1,1]
v_pk_mul_f32 v[134:135], v[134:135], v[32:33] op_sel:[0,1] op_sel_hi:[1,1]
v_cvt_pk_bf16_f32 v132, v132, v133
v_cvt_pk_bf16_f32 v133, v134, v135
ds_write2st64_b64 v38, v[128:129], v[132:133] offset0:0 offset1:2
v_pk_mul_f32 v[144:145], v[144:145], v[32:33] op_sel:[0,0] op_sel_hi:[1,0]
v_pk_mul_f32 v[146:147], v[146:147], v[32:33] op_sel:[0,0] op_sel_hi:[1,0]
v_cvt_pk_bf16_f32 v144, v144, v145
v_cvt_pk_bf16_f32 v145, v146, v147
s_add_u32 m0, s25, 32768
s_nop 0
buffer_load_dwordx4 v4, s[12:15], s29 offen offset:0 lds
s_add_u32 m0, s25, 33536
s_nop 0
buffer_load_dwordx4 v4, s[12:15], s29 offen offset:256 lds
s_add_u32 s29, s29, 8192
v_accvgpr_read_b32 v60, a244
v_pk_mul_f32 v[148:149], v[148:149], v[32:33] op_sel:[0,1] op_sel_hi:[1,1]
v_pk_mul_f32 v[150:151], v[150:151], v[32:33] op_sel:[0,1] op_sel_hi:[1,1]
v_cvt_pk_bf16_f32 v148, v148, v149
v_cvt_pk_bf16_f32 v149, v150, v151
ds_write2st64_b64 v39, v[144:145], v[148:149] offset0:0 offset1:2
v_accvgpr_read_b32 v61, a245
v_accvgpr_read_b32 v62, a246
v_pk_mul_f32 v[104:105], v[104:105], v[34:35] op_sel:[0,0] op_sel_hi:[1,0]
v_pk_mul_f32 v[106:107], v[106:107], v[34:35] op_sel:[0,0] op_sel_hi:[1,0]
v_cvt_pk_bf16_f32 v104, v104, v105
v_cvt_pk_bf16_f32 v105, v106, v107
ds_write_b64 v15, v[104:105] offset:2048
ds_read2st64_b64 v[96:99], v40 offset0:0 offset1:8
v_accvgpr_read_b32 v63, a247
v_pk_mul_f32 v[120:121], v[120:121], v[34:35] op_sel:[0,0] op_sel_hi:[1,0]
v_pk_mul_f32 v[122:123], v[122:123], v[34:35] op_sel:[0,0] op_sel_hi:[1,0]
v_cvt_pk_bf16_f32 v120, v120, v121
v_cvt_pk_bf16_f32 v121, v122, v123
ds_write_b64 v37, v[120:121] offset:2048
ds_read2st64_b64 v[112:115], v42 offset0:1 offset1:9
v_accvgpr_read_b32 v64, a232
v_accvgpr_read_b32 v65, a233
v_pk_mul_f32 v[136:137], v[136:137], v[34:35] op_sel:[0,0] op_sel_hi:[1,0]
v_pk_mul_f32 v[138:139], v[138:139], v[34:35] op_sel:[0,0] op_sel_hi:[1,0]
v_cvt_pk_bf16_f32 v136, v136, v137
v_cvt_pk_bf16_f32 v137, v138, v139
ds_write_b64 v38, v[136:137] offset:2048
ds_read2st64_b64 v[100:103], v40 offset0:2 offset1:10
v_accvgpr_read_b32 v66, a234
v_accvgpr_read_b32 v67, a235
v_pk_mul_f32 v[152:153], v[152:153], v[34:35] op_sel:[0,0] op_sel_hi:[1,0]
v_pk_mul_f32 v[154:155], v[154:155], v[34:35] op_sel:[0,0] op_sel_hi:[1,0]
v_cvt_pk_bf16_f32 v152, v152, v153
v_cvt_pk_bf16_f32 v153, v154, v155
ds_write_b64 v39, v[152:153] offset:2048
ds_read2st64_b64 v[116:119], v42 offset0:3 offset1:11
v_accvgpr_read_b32 v68, a248
v_pk_mul_f32 v[192:193], v[192:193], v[32:33] op_sel:[0,0] op_sel_hi:[1,0]
v_pk_mul_f32 v[194:195], v[194:195], v[32:33] op_sel:[0,0] op_sel_hi:[1,0]
v_cvt_pk_bf16_f32 v192, v192, v193
v_cvt_pk_bf16_f32 v193, v194, v195
ds_read2st64_b64 v[104:107], v40 offset0:4 offset1:12
s_waitcnt lgkmcnt(7)
buffer_store_dwordx4 v[96:99], v14, s[20:23], s72 offen offset:0
v_accvgpr_read_b32 v69, a249
v_accvgpr_read_b32 v70, a250
v_pk_mul_f32 v[196:197], v[196:197], v[32:33] op_sel:[0,1] op_sel_hi:[1,1]
v_pk_mul_f32 v[198:199], v[198:199], v[32:33] op_sel:[0,1] op_sel_hi:[1,1]
v_cvt_pk_bf16_f32 v196, v196, v197
v_cvt_pk_bf16_f32 v197, v198, v199
ds_write2st64_b64 v15, v[192:193], v[196:197] offset0:0 offset1:2
ds_read_b128 a[128:131], v1 offset:8192
ds_read_b128 a[132:135], v1 offset:8448
ds_read_b128 a[136:139], v1 offset:8704
ds_read_b128 a[140:143], v1 offset:8960
ds_read_b128 a[144:147], v1 offset:9216
ds_read_b128 a[148:151], v1 offset:9472
v_accvgpr_read_b32 v71, a251
v_pk_mul_f32 v[208:209], v[208:209], v[32:33] op_sel:[0,0] op_sel_hi:[1,0]
v_pk_mul_f32 v[210:211], v[210:211], v[32:33] op_sel:[0,0] op_sel_hi:[1,0]
v_cvt_pk_bf16_f32 v208, v208, v209
v_cvt_pk_bf16_f32 v209, v210, v211
ds_read2st64_b64 v[120:123], v42 offset0:5 offset1:13
s_waitcnt lgkmcnt(13)
buffer_store_dwordx4 v[112:115], v14, s[20:23], s73 offen offset:0
v_accvgpr_read_b32 v72, a160
v_accvgpr_read_b32 v73, a161
v_pk_mul_f32 v[212:213], v[212:213], v[32:33] op_sel:[0,1] op_sel_hi:[1,1]
v_pk_mul_f32 v[214:215], v[214:215], v[32:33] op_sel:[0,1] op_sel_hi:[1,1]
v_cvt_pk_bf16_f32 v212, v212, v213
v_cvt_pk_bf16_f32 v213, v214, v215
s_add_u32 m0, s25, 40960
s_nop 0
buffer_load_dwordx4 v4, s[12:15], s29 offen offset:0 lds
s_add_u32 m0, s25, 41728
s_nop 0
buffer_load_dwordx4 v4, s[12:15], s29 offen offset:256 lds
s_add_u32 s29, s29, 8192
ds_write2st64_b64 v37, v[208:209], v[212:213] offset0:0 offset1:2
v_accvgpr_read_b32 v74, a162
v_accvgpr_read_b32 v75, a163
v_pk_mul_f32 v[224:225], v[224:225], v[32:33] op_sel:[0,0] op_sel_hi:[1,0]
v_pk_mul_f32 v[226:227], v[226:227], v[32:33] op_sel:[0,0] op_sel_hi:[1,0]
v_cvt_pk_bf16_f32 v224, v224, v225
v_cvt_pk_bf16_f32 v225, v226, v227
s_waitcnt lgkmcnt(12)
buffer_store_dwordx4 v[100:103], v14, s[20:23], s74 offen offset:0
v_accvgpr_read_b32 v76, a164
v_pk_mul_f32 v[228:229], v[228:229], v[32:33] op_sel:[0,1] op_sel_hi:[1,1]
v_pk_mul_f32 v[230:231], v[230:231], v[32:33] op_sel:[0,1] op_sel_hi:[1,1]
v_cvt_pk_bf16_f32 v228, v228, v229
v_cvt_pk_bf16_f32 v229, v230, v231
ds_write2st64_b64 v38, v[224:225], v[228:229] offset0:0 offset1:2
v_accvgpr_read_b32 v77, a165
v_accvgpr_read_b32 v78, a166
v_pk_mul_f32 v[240:241], v[240:241], v[32:33] op_sel:[0,0] op_sel_hi:[1,0]
v_pk_mul_f32 v[242:243], v[242:243], v[32:33] op_sel:[0,0] op_sel_hi:[1,0]
v_cvt_pk_bf16_f32 v240, v240, v241
v_cvt_pk_bf16_f32 v241, v242, v243
s_waitcnt lgkmcnt(11)
buffer_store_dwordx4 v[116:119], v14, s[20:23], s75 offen offset:0
v_accvgpr_read_b32 v79, a167
v_pk_mul_f32 v[244:245], v[244:245], v[32:33] op_sel:[0,1] op_sel_hi:[1,1]
v_pk_mul_f32 v[246:247], v[246:247], v[32:33] op_sel:[0,1] op_sel_hi:[1,1]
v_cvt_pk_bf16_f32 v244, v244, v245
v_cvt_pk_bf16_f32 v245, v246, v247
ds_write2st64_b64 v39, v[240:241], v[244:245] offset0:0 offset1:2
v_accvgpr_read_b32 v80, a176
v_accvgpr_read_b32 v81, a177
v_pk_mul_f32 v[200:201], v[200:201], v[34:35] op_sel:[0,0] op_sel_hi:[1,0]
v_pk_mul_f32 v[202:203], v[202:203], v[34:35] op_sel:[0,0] op_sel_hi:[1,0]
v_cvt_pk_bf16_f32 v200, v200, v201
v_cvt_pk_bf16_f32 v201, v202, v203
ds_write_b64 v15, v[200:201] offset:2048
ds_read2st64_b64 v[192:195], v40 offset0:0 offset1:8
s_waitcnt lgkmcnt(13)
buffer_store_dwordx4 v[104:107], v14, s[20:23], s76 offen offset:0
v_accvgpr_read_b32 v82, a178
v_accvgpr_read_b32 v83, a179
v_pk_mul_f32 v[216:217], v[216:217], v[34:35] op_sel:[0,0] op_sel_hi:[1,0]
v_pk_mul_f32 v[218:219], v[218:219], v[34:35] op_sel:[0,0] op_sel_hi:[1,0]
v_cvt_pk_bf16_f32 v216, v216, v217
v_cvt_pk_bf16_f32 v217, v218, v219
ds_write_b64 v37, v[216:217] offset:2048
ds_read2st64_b64 v[208:211], v42 offset0:1 offset1:9
v_accvgpr_read_b32 v84, a180
v_pk_mul_f32 v[232:233], v[232:233], v[34:35] op_sel:[0,0] op_sel_hi:[1,0]
v_pk_mul_f32 v[234:235], v[234:235], v[34:35] op_sel:[0,0] op_sel_hi:[1,0]
v_cvt_pk_bf16_f32 v232, v232, v233
v_cvt_pk_bf16_f32 v233, v234, v235
ds_write_b64 v38, v[232:233] offset:2048
ds_read2st64_b64 v[196:199], v40 offset0:2 offset1:10
s_waitcnt lgkmcnt(9)
buffer_store_dwordx4 v[120:123], v14, s[20:23], s77 offen offset:0
v_accvgpr_read_b32 v85, a181
v_accvgpr_read_b32 v86, a182
v_pk_mul_f32 v[248:249], v[248:249], v[34:35] op_sel:[0,0] op_sel_hi:[1,0]
v_pk_mul_f32 v[250:251], v[250:251], v[34:35] op_sel:[0,0] op_sel_hi:[1,0]
v_cvt_pk_bf16_f32 v248, v248, v249
v_cvt_pk_bf16_f32 v249, v250, v251
ds_write_b64 v39, v[248:249] offset:2048
ds_read2st64_b64 v[212:215], v42 offset0:3 offset1:11
v_accvgpr_read_b32 v87, a183
v_pk_mul_f32 v[160:161], v[160:161], v[32:33] op_sel:[0,0] op_sel_hi:[1,0]
v_pk_mul_f32 v[162:163], v[162:163], v[32:33] op_sel:[0,0] op_sel_hi:[1,0]
v_cvt_pk_bf16_f32 v160, v160, v161
v_cvt_pk_bf16_f32 v161, v162, v163
s_add_u32 m0, s25, 49152
s_nop 0
buffer_load_dwordx4 v4, s[12:15], s29 offen offset:0 lds
s_add_u32 m0, s25, 49920
s_nop 0
buffer_load_dwordx4 v4, s[12:15], s29 offen offset:256 lds
s_add_u32 s29, s29, 8192
ds_read2st64_b64 v[200:203], v40 offset0:4 offset1:12
s_waitcnt lgkmcnt(7)
buffer_store_dwordx4 v[192:195], v14, s[20:23], s72 offen offset:384
v_accvgpr_read_b32 v88, a192
v_accvgpr_read_b32 v89, a193
v_pk_mul_f32 v[164:165], v[164:165], v[32:33] op_sel:[0,1] op_sel_hi:[1,1]
v_pk_mul_f32 v[166:167], v[166:167], v[32:33] op_sel:[0,1] op_sel_hi:[1,1]
v_cvt_pk_bf16_f32 v164, v164, v165
v_cvt_pk_bf16_f32 v165, v166, v167
ds_write2st64_b64 v38, v[160:161], v[164:165] offset0:0 offset1:2
s_waitcnt vmcnt(21)
v_add_u32 v10, s27, v1
ds_read_b128 a[64:67], v10 offset:0
ds_read_b128 a[68:71], v10 offset:256
ds_read_b128 a[72:75], v10 offset:512
ds_read_b128 a[76:79], v10 offset:768
v_accvgpr_read_b32 v90, a194
v_accvgpr_read_b32 v91, a195
v_pk_mul_f32 v[176:177], v[176:177], v[32:33] op_sel:[0,0] op_sel_hi:[1,0]
v_pk_mul_f32 v[178:179], v[178:179], v[32:33] op_sel:[0,0] op_sel_hi:[1,0]
v_cvt_pk_bf16_f32 v176, v176, v177
v_cvt_pk_bf16_f32 v177, v178, v179
ds_read2st64_b64 v[216:219], v42 offset0:5 offset1:13
s_waitcnt lgkmcnt(11)
buffer_store_dwordx4 v[208:211], v14, s[20:23], s73 offen offset:384
v_accvgpr_read_b32 v92, a196
v_pk_mul_f32 v[180:181], v[180:181], v[32:33] op_sel:[0,1] op_sel_hi:[1,1]
v_pk_mul_f32 v[182:183], v[182:183], v[32:33] op_sel:[0,1] op_sel_hi:[1,1]
v_cvt_pk_bf16_f32 v180, v180, v181
v_cvt_pk_bf16_f32 v181, v182, v183
ds_write2st64_b64 v39, v[176:177], v[180:181] offset0:0 offset1:2
v_accvgpr_read_b32 v93, a197
v_accvgpr_read_b32 v94, a198
v_pk_mul_f32 v[48:49], v[48:49], v[32:33] op_sel:[0,0] op_sel_hi:[1,0]
v_pk_mul_f32 v[50:51], v[50:51], v[32:33] op_sel:[0,0] op_sel_hi:[1,0]
v_cvt_pk_bf16_f32 v48, v48, v49
v_cvt_pk_bf16_f32 v49, v50, v51
s_waitcnt lgkmcnt(10)
buffer_store_dwordx4 v[196:199], v14, s[20:23], s74 offen offset:384
v_accvgpr_read_b32 v95, a199
v_pk_mul_f32 v[52:53], v[52:53], v[32:33] op_sel:[0,1] op_sel_hi:[1,1]
v_pk_mul_f32 v[54:55], v[54:55], v[32:33] op_sel:[0,1] op_sel_hi:[1,1]
v_cvt_pk_bf16_f32 v52, v52, v53
v_cvt_pk_bf16_f32 v53, v54, v55
ds_write2st64_b64 v15, v[48:49], v[52:53] offset0:0 offset1:2
ds_read_b128 a[80:83], v10 offset:1024
ds_read_b128 a[84:87], v10 offset:1280
ds_read_b128 a[88:91], v10 offset:1536
ds_read_b128 a[92:95], v10 offset:1792
v_accvgpr_read_b32 v48, a208
v_accvgpr_read_b32 v49, a209
v_pk_mul_f32 v[56:57], v[56:57], v[32:33] op_sel:[0,0] op_sel_hi:[1,0]
v_pk_mul_f32 v[58:59], v[58:59], v[32:33] op_sel:[0,0] op_sel_hi:[1,0]
v_cvt_pk_bf16_f32 v56, v56, v57
v_cvt_pk_bf16_f32 v57, v58, v59
s_waitcnt lgkmcnt(13)
buffer_store_dwordx4 v[212:215], v14, s[20:23], s75 offen offset:384
v_accvgpr_read_b32 v50, a210
v_accvgpr_read_b32 v51, a211
v_pk_mul_f32 v[60:61], v[60:61], v[32:33] op_sel:[0,1] op_sel_hi:[1,1]
v_pk_mul_f32 v[62:63], v[62:63], v[32:33] op_sel:[0,1] op_sel_hi:[1,1]
v_cvt_pk_bf16_f32 v60, v60, v61
v_cvt_pk_bf16_f32 v61, v62, v63
ds_write2st64_b64 v37, v[56:57], v[60:61] offset0:0 offset1:2
v_accvgpr_read_b32 v52, a212
v_pk_mul_f32 v[168:169], v[168:169], v[34:35] op_sel:[0,0] op_sel_hi:[1,0]
v_pk_mul_f32 v[170:171], v[170:171], v[34:35] op_sel:[0,0] op_sel_hi:[1,0]
v_cvt_pk_bf16_f32 v168, v168, v169
v_cvt_pk_bf16_f32 v169, v170, v171
ds_write_b64 v38, v[168:169] offset:2048
ds_read2st64_b64 a[224:227], v40 offset0:0 offset1:8
s_waitcnt lgkmcnt(15)
buffer_store_dwordx4 v[200:203], v14, s[20:23], s76 offen offset:384
v_accvgpr_read_b32 v53, a213
v_accvgpr_read_b32 v54, a214
v_pk_mul_f32 v[184:185], v[184:185], v[34:35] op_sel:[0,0] op_sel_hi:[1,0]
v_pk_mul_f32 v[186:187], v[186:187], v[34:35] op_sel:[0,0] op_sel_hi:[1,0]
v_cvt_pk_bf16_f32 v184, v184, v185
v_cvt_pk_bf16_f32 v185, v186, v187
s_add_u32 s32, s32, 32768
s_add_u32 s33, s32, 4096
s_add_u32 m0, s25, 65536
s_nop 0
buffer_load_dwordx4 v5, s[16:19], s32 offen offset:0 lds
s_add_u32 m0, s25, 66560
s_nop 0
buffer_load_dwordx4 v5, s[16:19], s33 offen offset:0 lds
ds_write_b64 v39, v[184:185] offset:2048
ds_read2st64_b64 a[240:243], v42 offset0:1 offset1:9
v_accvgpr_read_b32 v55, a215
v_pk_mul_f32 v[64:65], v[64:65], v[34:35] op_sel:[0,0] op_sel_hi:[1,0]
v_pk_mul_f32 v[66:67], v[66:67], v[34:35] op_sel:[0,0] op_sel_hi:[1,0]
v_cvt_pk_bf16_f32 v64, v64, v65
v_cvt_pk_bf16_f32 v65, v66, v67
ds_write_b64 v15, v[64:65] offset:2048
ds_read2st64_b64 a[228:231], v40 offset0:2 offset1:10
s_waitcnt lgkmcnt(13)
buffer_store_dwordx4 v[216:219], v14, s[20:23], s77 offen offset:384
v_accvgpr_read_b32 v56, a168
v_accvgpr_read_b32 v57, a169
v_pk_mul_f32 v[68:69], v[68:69], v[34:35] op_sel:[0,0] op_sel_hi:[1,0]
v_pk_mul_f32 v[70:71], v[70:71], v[34:35] op_sel:[0,0] op_sel_hi:[1,0]
v_cvt_pk_bf16_f32 v68, v68, v69
v_cvt_pk_bf16_f32 v69, v70, v71
ds_write_b64 v37, v[68:69] offset:2048
ds_read2st64_b64 a[244:247], v42 offset0:3 offset1:11
v_accvgpr_read_b32 v58, a170
v_accvgpr_read_b32 v59, a171
v_pk_mul_f32 v[72:73], v[72:73], v[32:33] op_sel:[0,0] op_sel_hi:[1,0]
v_pk_mul_f32 v[74:75], v[74:75], v[32:33] op_sel:[0,0] op_sel_hi:[1,0]
v_cvt_pk_bf16_f32 v72, v72, v73
v_cvt_pk_bf16_f32 v73, v74, v75
ds_read2st64_b64 a[232:235], v40 offset0:4 offset1:12
s_waitcnt lgkmcnt(7)
buffer_store_dwordx4 a[224:227], v14, s[20:23], s72 offen offset:256
v_accvgpr_read_b32 v60, a184
v_pk_mul_f32 v[76:77], v[76:77], v[32:33] op_sel:[0,1] op_sel_hi:[1,1]
v_pk_mul_f32 v[78:79], v[78:79], v[32:33] op_sel:[0,1] op_sel_hi:[1,1]
v_cvt_pk_bf16_f32 v76, v76, v77
v_cvt_pk_bf16_f32 v77, v78, v79
ds_write2st64_b64 v15, v[72:73], v[76:77] offset0:0 offset1:2
s_waitcnt vmcnt(21)
v_add_u32 v11, s26, v1
ds_read_b128 a[96:99], v11 offset:0
ds_read_b128 a[100:103], v11 offset:256
ds_read_b128 a[104:107], v11 offset:512
ds_read_b128 a[108:111], v11 offset:768
v_accvgpr_read_b32 v61, a185
v_accvgpr_read_b32 v62, a186
v_pk_mul_f32 v[80:81], v[80:81], v[32:33] op_sel:[0,0] op_sel_hi:[1,0]
v_pk_mul_f32 v[82:83], v[82:83], v[32:33] op_sel:[0,0] op_sel_hi:[1,0]
v_cvt_pk_bf16_f32 v80, v80, v81
v_cvt_pk_bf16_f32 v81, v82, v83
ds_read2st64_b64 a[248:251], v42 offset0:5 offset1:13
s_waitcnt lgkmcnt(11)
buffer_store_dwordx4 a[240:243], v14, s[20:23], s73 offen offset:256
v_accvgpr_read_b32 v63, a187
v_pk_mul_f32 v[84:85], v[84:85], v[32:33] op_sel:[0,1] op_sel_hi:[1,1]
v_pk_mul_f32 v[86:87], v[86:87], v[32:33] op_sel:[0,1] op_sel_hi:[1,1]
v_cvt_pk_bf16_f32 v84, v84, v85
v_cvt_pk_bf16_f32 v85, v86, v87
ds_write2st64_b64 v37, v[80:81], v[84:85] offset0:0 offset1:2
v_accvgpr_read_b32 v64, a200
v_accvgpr_read_b32 v65, a201
v_pk_mul_f32 v[88:89], v[88:89], v[32:33] op_sel:[0,0] op_sel_hi:[1,0]
v_pk_mul_f32 v[90:91], v[90:91], v[32:33] op_sel:[0,0] op_sel_hi:[1,0]
v_cvt_pk_bf16_f32 v88, v88, v89
v_cvt_pk_bf16_f32 v89, v90, v91
s_waitcnt lgkmcnt(10)
buffer_store_dwordx4 a[228:231], v14, s[20:23], s74 offen offset:256
v_accvgpr_read_b32 v66, a202
v_accvgpr_read_b32 v67, a203
v_pk_mul_f32 v[92:93], v[92:93], v[32:33] op_sel:[0,1] op_sel_hi:[1,1]
v_pk_mul_f32 v[94:95], v[94:95], v[32:33] op_sel:[0,1] op_sel_hi:[1,1]
v_cvt_pk_bf16_f32 v92, v92, v93
v_cvt_pk_bf16_f32 v93, v94, v95
ds_write2st64_b64 v38, v[88:89], v[92:93] offset0:0 offset1:2
ds_read_b128 a[112:115], v11 offset:1024
ds_read_b128 a[116:119], v11 offset:1280
ds_read_b128 a[120:123], v11 offset:1536
ds_read_b128 a[124:127], v11 offset:1792
v_accvgpr_read_b32 v68, a216
v_pk_mul_f32 v[48:49], v[48:49], v[32:33] op_sel:[0,0] op_sel_hi:[1,0]
v_pk_mul_f32 v[50:51], v[50:51], v[32:33] op_sel:[0,0] op_sel_hi:[1,0]
v_cvt_pk_bf16_f32 v48, v48, v49
v_cvt_pk_bf16_f32 v49, v50, v51
s_waitcnt lgkmcnt(13)
buffer_store_dwordx4 a[244:247], v14, s[20:23], s75 offen offset:256
v_accvgpr_read_b32 v69, a217
v_accvgpr_read_b32 v70, a218
v_pk_mul_f32 v[52:53], v[52:53], v[32:33] op_sel:[0,1] op_sel_hi:[1,1]
v_pk_mul_f32 v[54:55], v[54:55], v[32:33] op_sel:[0,1] op_sel_hi:[1,1]
v_cvt_pk_bf16_f32 v52, v52, v53
v_cvt_pk_bf16_f32 v53, v54, v55
ds_write2st64_b64 v39, v[48:49], v[52:53] offset0:0 offset1:2
v_accvgpr_read_b32 v71, a219
v_pk_mul_f32 v[56:57], v[56:57], v[34:35] op_sel:[0,0] op_sel_hi:[1,0]
v_pk_mul_f32 v[58:59], v[58:59], v[34:35] op_sel:[0,0] op_sel_hi:[1,0]
v_cvt_pk_bf16_f32 v56, v56, v57
v_cvt_pk_bf16_f32 v57, v58, v59
ds_write_b64 v15, v[56:57] offset:2048
ds_read2st64_b64 a[160:163], v40 offset0:0 offset1:8
s_waitcnt lgkmcnt(15)
buffer_store_dwordx4 a[232:235], v14, s[20:23], s76 offen offset:256
v_pk_mul_f32 v[60:61], v[60:61], v[34:35] op_sel:[0,0] op_sel_hi:[1,0]
v_pk_mul_f32 v[62:63], v[62:63], v[34:35] op_sel:[0,0] op_sel_hi:[1,0]
v_cvt_pk_bf16_f32 v60, v60, v61
v_cvt_pk_bf16_f32 v61, v62, v63
ds_write_b64 v37, v[60:61] offset:2048
ds_read2st64_b64 a[176:179], v42 offset0:1 offset1:9
v_pk_mul_f32 v[64:65], v[64:65], v[34:35] op_sel:[0,0] op_sel_hi:[1,0]
v_pk_mul_f32 v[66:67], v[66:67], v[34:35] op_sel:[0,0] op_sel_hi:[1,0]
v_cvt_pk_bf16_f32 v64, v64, v65
v_cvt_pk_bf16_f32 v65, v66, v67
ds_write_b64 v38, v[64:65] offset:2048
ds_read2st64_b64 a[164:167], v40 offset0:2 offset1:10
s_waitcnt lgkmcnt(13)
buffer_store_dwordx4 a[248:251], v14, s[20:23], s77 offen offset:256
v_pk_mul_f32 v[68:69], v[68:69], v[34:35] op_sel:[0,0] op_sel_hi:[1,0]
v_pk_mul_f32 v[70:71], v[70:71], v[34:35] op_sel:[0,0] op_sel_hi:[1,0]
v_cvt_pk_bf16_f32 v68, v68, v69
v_cvt_pk_bf16_f32 v69, v70, v71
ds_write_b64 v39, v[68:69] offset:2048
ds_read2st64_b64 a[180:183], v42 offset0:3 offset1:11
ds_read2st64_b64 a[168:171], v40 offset0:4 offset1:12
ds_read2st64_b64 a[184:187], v42 offset0:5 offset1:13
s_waitcnt lgkmcnt(8)
buffer_store_dwordx4 a[160:163], v14, s[20:23], s72 offen offset:128
s_waitcnt lgkmcnt(6)
buffer_store_dwordx4 a[176:179], v14, s[20:23], s73 offen offset:128
s_waitcnt lgkmcnt(4)
buffer_store_dwordx4 a[164:167], v14, s[20:23], s74 offen offset:128
s_waitcnt lgkmcnt(2)
buffer_store_dwordx4 a[180:183], v14, s[20:23], s75 offen offset:128
s_waitcnt lgkmcnt(1)
buffer_store_dwordx4 a[168:171], v14, s[20:23], s76 offen offset:128
s_waitcnt lgkmcnt(0)
buffer_store_dwordx4 a[184:187], v14, s[20:23], s77 offen offset:128
s_add_u32 s37, s37, 1
s_branch L_pass
L_done:
s_cmp_lg_u32 s38, 0
s_cbranch_scc1 L_repair
L_fin:
L_exit:
s_endpgm
L_warm_end:
L_repair:
s_waitcnt vmcnt(0) lgkmcnt(0)
v_mbcnt_lo_u32_b32 v8, -1, 0
v_mbcnt_hi_u32_b32 v8, -1, v8
v_and_b32 v9, 15, v8
v_lshrrev_b32 v8, 4, v8
v_lshlrev_b32 v48, 9, v9
v_lshl_add_u32 v52, v8, 3, v48
v_lshl_add_u32 v48, v8, 4, v48
s_sub_u32 s45, s26, 65536
v_add_u32 v49, s45, v2
v_add_u32 v50, s45, v3
s_lshl_b32 s45, s24, 13
v_subrev_u32 v51, s45, v5
s_mov_b32 s90, 0
L_rp:
s_bitcmp1_b32 s38, s90
s_cbranch_scc0 L_rp_next
s_mov_b32 s91, 0
L_rb:
s_lshl_b32 s93, s91, 13
s_add_u32 s93, s93, s80
buffer_load_dwordx4 v[96:99], v48, s[8:11], s93 offen offset:0
buffer_load_dwordx4 v[100:103], v48, s[8:11], s93 offen offset:64
buffer_load_dwordx4 v[104:107], v48, s[8:11], s93 offen offset:128
buffer_load_dwordx4 v[108:111], v48, s[8:11], s93 offen offset:192
buffer_load_dwordx4 v[112:115], v48, s[8:11], s93 offen offset:256
buffer_load_dwordx4 v[116:119], v48, s[8:11], s93 offen offset:320
buffer_load_dwordx4 v[120:123], v48, s[8:11], s93 offen offset:384
buffer_load_dwordx4 v[124:127], v48, s[8:11], s93 offen offset:448
v_mov_b32 v6, 0xff800000
v_mov_b32 v7, 0
v_mov_b32 v160, 0
v_mov_b32 v161, 0
v_mov_b32 v162, 0
v_mov_b32 v163, 0
v_mov_b32 v164, 0
v_mov_b32 v165, 0
v_mov_b32 v166, 0
v_mov_b32 v167, 0
v_mov_b32 v168, 0
v_mov_b32 v169, 0
v_mov_b32 v170, 0
v_mov_b32 v171, 0
v_mov_b32 v172, 0
v_mov_b32 v173, 0
v_mov_b32 v174, 0
v_mov_b32 v175, 0
v_mov_b32 v176, 0
v_mov_b32 v177, 0
v_mov_b32 v178, 0
v_mov_b32 v179, 0
v_mov_b32 v180, 0
v_mov_b32 v181, 0
v_mov_b32 v182, 0
v_mov_b32 v183, 0
v_mov_b32 v184, 0
v_mov_b32 v185, 0
v_mov_b32 v186, 0
v_mov_b32 v187, 0
v_mov_b32 v188, 0
v_mov_b32 v189, 0
v_mov_b32 v190, 0
v_mov_b32 v191, 0
v_mov_b32 v192, 0
v_mov_b32 v193, 0
v_mov_b32 v194, 0
v_mov_b32 v195, 0
v_mov_b32 v196, 0
v_mov_b32 v197, 0
v_mov_b32 v198, 0
v_mov_b32 v199, 0
v_mov_b32 v200, 0
v_mov_b32 v201, 0
v_mov_b32 v202, 0
v_mov_b32 v203, 0
v_mov_b32 v204, 0
v_mov_b32 v205, 0
v_mov_b32 v206, 0
v_mov_b32 v207, 0
v_mov_b32 v208, 0
v_mov_b32 v209, 0
v_mov_b32 v210, 0
v_mov_b32 v211, 0
v_mov_b32 v212, 0
v_mov_b32 v213, 0
v_mov_b32 v214, 0
v_mov_b32 v215, 0
v_mov_b32 v216, 0
v_mov_b32 v217, 0
v_mov_b32 v218, 0
v_mov_b32 v219, 0
v_mov_b32 v220, 0
v_mov_b32 v221, 0
v_mov_b32 v222, 0
v_mov_b32 v223, 0
s_mov_b32 s94, s81
s_mov_b32 s95, s81
s_mov_b32 s92, 0
L_rj:
buffer_load_dwordx4 v[128:131], v48, s[12:15], s94 offen offset:0
buffer_load_dwordx4 v[132:135], v48, s[12:15], s94 offen offset:64
buffer_load_dwordx4 v[136:139], v48, s[12:15], s94 offen offset:128
buffer_load_dwordx4 v[140:143], v48, s[12:15], s94 offen offset:192
buffer_load_dwordx4 v[144:147], v48, s[12:15], s94 offen offset:256
buffer_load_dwordx4 v[148:151], v48, s[12:15], s94 offen offset:320
buffer_load_dwordx4 v[152:155], v48, s[12:15], s94 offen offset:384
buffer_load_dwordx4 v[156:159], v48, s[12:15], s94 offen offset:448
s_add_u32 s94, s94, 8192
s_waitcnt vmcnt(0)
v_mfma_f32_16x16x32_bf16 v[32:35], v[128:131], v[96:99], 0
v_mfma_f32_16x16x32_bf16 v[32:35], v[132:135], v[100:103], v[32:35]
v_mfma_f32_16x16x32_bf16 v[32:35], v[136:139], v[104:107], v[32:35]
v_mfma_f32_16x16x32_bf16 v[32:35], v[140:143], v[108:111], v[32:35]
v_mfma_f32_16x16x32_bf16 v[32:35], v[144:147], v[112:115], v[32:35]
v_mfma_f32_16x16x32_bf16 v[32:35], v[148:151], v[116:119], v[32:35]
v_mfma_f32_16x16x32_bf16 v[32:35], v[152:155], v[120:123], v[32:35]
v_mfma_f32_16x16x32_bf16 v[32:35], v[156:159], v[124:127], v[32:35]
buffer_load_dwordx4 v[128:131], v48, s[12:15], s94 offen offset:0
buffer_load_dwordx4 v[132:135], v48, s[12:15], s94 offen offset:64
buffer_load_dwordx4 v[136:139], v48, s[12:15], s94 offen offset:128
buffer_load_dwordx4 v[140:143], v48, s[12:15], s94 offen offset:192
buffer_load_dwordx4 v[144:147], v48, s[12:15], s94 offen offset:256
buffer_load_dwordx4 v[148:151], v48, s[12:15], s94 offen offset:320
buffer_load_dwordx4 v[152:155], v48, s[12:15], s94 offen offset:384
buffer_load_dwordx4 v[156:159], v48, s[12:15], s94 offen offset:448
s_add_u32 s94, s94, 8192
s_waitcnt vmcnt(0)
v_mfma_f32_16x16x32_bf16 v[36:39], v[128:131], v[96:99], 0
v_mfma_f32_16x16x32_bf16 v[36:39], v[132:135], v[100:103], v[36:39]
v_mfma_f32_16x16x32_bf16 v[36:39], v[136:139], v[104:107], v[36:39]
v_mfma_f32_16x16x32_bf16 v[36:39], v[140:143], v[108:111], v[36:39]
v_mfma_f32_16x16x32_bf16 v[36:39], v[144:147], v[112:115], v[36:39]
v_mfma_f32_16x16x32_bf16 v[36:39], v[148:151], v[116:119], v[36:39]
v_mfma_f32_16x16x32_bf16 v[36:39], v[152:155], v[120:123], v[36:39]
v_mfma_f32_16x16x32_bf16 v[36:39], v[156:159], v[124:127], v[36:39]
buffer_load_dwordx4 v[128:131], v48, s[12:15], s94 offen offset:0
buffer_load_dwordx4 v[132:135], v48, s[12:15], s94 offen offset:64
buffer_load_dwordx4 v[136:139], v48, s[12:15], s94 offen offset:128
buffer_load_dwordx4 v[140:143], v48, s[12:15], s94 offen offset:192
buffer_load_dwordx4 v[144:147], v48, s[12:15], s94 offen offset:256
buffer_load_dwordx4 v[148:151], v48, s[12:15], s94 offen offset:320
buffer_load_dwordx4 v[152:155], v48, s[12:15], s94 offen offset:384
buffer_load_dwordx4 v[156:159], v48, s[12:15], s94 offen offset:448
s_add_u32 s94, s94, 8192
s_waitcnt vmcnt(0)
v_mfma_f32_16x16x32_bf16 v[40:43], v[128:131], v[96:99], 0
v_mfma_f32_16x16x32_bf16 v[40:43], v[132:135], v[100:103], v[40:43]
v_mfma_f32_16x16x32_bf16 v[40:43], v[136:139], v[104:107], v[40:43]
v_mfma_f32_16x16x32_bf16 v[40:43], v[140:143], v[108:111], v[40:43]
v_mfma_f32_16x16x32_bf16 v[40:43], v[144:147], v[112:115], v[40:43]
v_mfma_f32_16x16x32_bf16 v[40:43], v[148:151], v[116:119], v[40:43]
v_mfma_f32_16x16x32_bf16 v[40:43], v[152:155], v[120:123], v[40:43]
v_mfma_f32_16x16x32_bf16 v[40:43], v[156:159], v[124:127], v[40:43]
buffer_load_dwordx4 v[128:131], v48, s[12:15], s94 offen offset:0
buffer_load_dwordx4 v[132:135], v48, s[12:15], s94 offen offset:64
buffer_load_dwordx4 v[136:139], v48, s[12:15], s94 offen offset:128
buffer_load_dwordx4 v[140:143], v48, s[12:15], s94 offen offset:192
buffer_load_dwordx4 v[144:147], v48, s[12:15], s94 offen offset:256
buffer_load_dwordx4 v[148:151], v48, s[12:15], s94 offen offset:320
buffer_load_dwordx4 v[152:155], v48, s[12:15], s94 offen offset:384
buffer_load_dwordx4 v[156:159], v48, s[12:15], s94 offen offset:448
s_add_u32 s94, s94, 8192
s_waitcnt vmcnt(0)
v_mfma_f32_16x16x32_bf16 v[44:47], v[128:131], v[96:99], 0
v_mfma_f32_16x16x32_bf16 v[44:47], v[132:135], v[100:103], v[44:47]
v_mfma_f32_16x16x32_bf16 v[44:47], v[136:139], v[104:107], v[44:47]
v_mfma_f32_16x16x32_bf16 v[44:47], v[140:143], v[108:111], v[44:47]
v_mfma_f32_16x16x32_bf16 v[44:47], v[144:147], v[112:115], v[44:47]
v_mfma_f32_16x16x32_bf16 v[44:47], v[148:151], v[116:119], v[44:47]
v_mfma_f32_16x16x32_bf16 v[44:47], v[152:155], v[120:123], v[44:47]
v_mfma_f32_16x16x32_bf16 v[44:47], v[156:159], v[124:127], v[44:47]
v_max3_f32 v8, v6, v32, v33
v_max3_f32 v8, v8, v34, v35
v_max3_f32 v8, v8, v36, v37
v_max3_f32 v8, v8, v38, v39
v_max3_f32 v8, v8, v40, v41
v_max3_f32 v8, v8, v42, v43
s_nop 1
v_max3_f32 v8, v8, v44, v45
v_max3_f32 v8, v8, v46, v47
v_mov_b32 v9, v8
s_nop 1
v_permlane16_swap_b32 v8, v9
v_max_f32 v8, v8, v9
v_mov_b32 v9, v8
s_nop 1
v_permlane32_swap_b32 v8, v9
v_max_f32 v8, v8, v9
v_sub_f32 v10, v6, v8
v_mul_f32 v10, s35, v10
v_exp_f32 v10, v10
v_mov_b32 v6, v8
v_sub_f32 v32, v32, v6
v_sub_f32 v33, v33, v6
v_sub_f32 v34, v34, v6
v_sub_f32 v35, v35, v6
v_sub_f32 v36, v36, v6
v_sub_f32 v37, v37, v6
v_sub_f32 v38, v38, v6
v_sub_f32 v39, v39, v6
v_sub_f32 v40, v40, v6
v_sub_f32 v41, v41, v6
v_sub_f32 v42, v42, v6
v_sub_f32 v43, v43, v6
v_sub_f32 v44, v44, v6
v_sub_f32 v45, v45, v6
v_sub_f32 v46, v46, v6
v_sub_f32 v47, v47, v6
v_mul_f32 v32, s35, v32
v_mul_f32 v33, s35, v33
v_mul_f32 v34, s35, v34
v_mul_f32 v35, s35, v35
v_mul_f32 v36, s35, v36
v_mul_f32 v37, s35, v37
v_mul_f32 v38, s35, v38
v_mul_f32 v39, s35, v39
v_mul_f32 v40, s35, v40
v_mul_f32 v41, s35, v41
v_mul_f32 v42, s35, v42
v_mul_f32 v43, s35, v43
v_mul_f32 v44, s35, v44
v_mul_f32 v45, s35, v45
v_mul_f32 v46, s35, v46
v_mul_f32 v47, s35, v47
v_exp_f32 v32, v32
v_exp_f32 v33, v33
v_exp_f32 v34, v34
v_exp_f32 v35, v35
v_exp_f32 v36, v36
v_exp_f32 v37, v37
v_exp_f32 v38, v38
v_exp_f32 v39, v39
v_exp_f32 v40, v40
v_exp_f32 v41, v41
v_exp_f32 v42, v42
v_exp_f32 v43, v43
v_exp_f32 v44, v44
v_exp_f32 v45, v45
v_exp_f32 v46, v46
v_exp_f32 v47, v47
v_mul_f32 v7, v7, v10
v_add_f32 v7, v7, v32
v_add_f32 v7, v7, v33
v_add_f32 v7, v7, v34
v_add_f32 v7, v7, v35
v_add_f32 v7, v7, v36
v_add_f32 v7, v7, v37
v_add_f32 v7, v7, v38
v_add_f32 v7, v7, v39
v_add_f32 v7, v7, v40
v_add_f32 v7, v7, v41
v_add_f32 v7, v7, v42
v_add_f32 v7, v7, v43
v_add_f32 v7, v7, v44
v_add_f32 v7, v7, v45
v_add_f32 v7, v7, v46
v_add_f32 v7, v7, v47
v_mul_f32 v160, v160, v10
v_mul_f32 v161, v161, v10
v_mul_f32 v162, v162, v10
v_mul_f32 v163, v163, v10
v_mul_f32 v164, v164, v10
v_mul_f32 v165, v165, v10
v_mul_f32 v166, v166, v10
v_mul_f32 v167, v167, v10
v_mul_f32 v168, v168, v10
v_mul_f32 v169, v169, v10
v_mul_f32 v170, v170, v10
v_mul_f32 v171, v171, v10
v_mul_f32 v172, v172, v10
v_mul_f32 v173, v173, v10
v_mul_f32 v174, v174, v10
v_mul_f32 v175, v175, v10
v_mul_f32 v176, v176, v10
v_mul_f32 v177, v177, v10
v_mul_f32 v178, v178, v10
v_mul_f32 v179, v179, v10
v_mul_f32 v180, v180, v10
v_mul_f32 v181, v181, v10
v_mul_f32 v182, v182, v10
v_mul_f32 v183, v183, v10
v_mul_f32 v184, v184, v10
v_mul_f32 v185, v185, v10
v_mul_f32 v186, v186, v10
v_mul_f32 v187, v187, v10
v_mul_f32 v188, v188, v10
v_mul_f32 v189, v189, v10
v_mul_f32 v190, v190, v10
v_mul_f32 v191, v191, v10
v_mul_f32 v192, v192, v10
v_mul_f32 v193, v193, v10
v_mul_f32 v194, v194, v10
v_mul_f32 v195, v195, v10
v_mul_f32 v196, v196, v10
v_mul_f32 v197, v197, v10
v_mul_f32 v198, v198, v10
v_mul_f32 v199, v199, v10
v_mul_f32 v200, v200, v10
v_mul_f32 v201, v201, v10
v_mul_f32 v202, v202, v10
v_mul_f32 v203, v203, v10
v_mul_f32 v204, v204, v10
v_mul_f32 v205, v205, v10
v_mul_f32 v206, v206, v10
v_mul_f32 v207, v207, v10
v_mul_f32 v208, v208, v10
v_mul_f32 v209, v209, v10
v_mul_f32 v210, v210, v10
v_mul_f32 v211, v211, v10
v_mul_f32 v212, v212, v10
v_mul_f32 v213, v213, v10
v_mul_f32 v214, v214, v10
v_mul_f32 v215, v215, v10
v_mul_f32 v216, v216, v10
v_mul_f32 v217, v217, v10
v_mul_f32 v218, v218, v10
v_mul_f32 v219, v219, v10
v_mul_f32 v220, v220, v10
v_mul_f32 v221, v221, v10
v_mul_f32 v222, v222, v10
v_mul_f32 v223, v223, v10
v_cvt_pk_bf16_f32 v16, v32, v33
v_cvt_pk_bf16_f32 v17, v34, v35
v_cvt_pk_bf16_f32 v18, v36, v37
v_cvt_pk_bf16_f32 v19, v38, v39
v_cvt_pk_bf16_f32 v20, v40, v41
v_cvt_pk_bf16_f32 v21, v42, v43
v_cvt_pk_bf16_f32 v22, v44, v45
v_cvt_pk_bf16_f32 v23, v46, v47
s_add_u32 s45, s95, 0
s_add_u32 m0, s26, 0
s_nop 0
buffer_load_dwordx4 v51, s[16:19], s45 offen offset:0 lds
s_add_u32 s45, s95, 4096
s_add_u32 m0, s26, 1024
s_nop 0
buffer_load_dwordx4 v51, s[16:19], s45 offen offset:0 lds
s_add_u32 s45, s95, 8192
s_add_u32 m0, s26, 2048
s_nop 0
buffer_load_dwordx4 v51, s[16:19], s45 offen offset:0 lds
s_add_u32 s45, s95, 12288
s_add_u32 m0, s26, 3072
s_nop 0
buffer_load_dwordx4 v51, s[16:19], s45 offen offset:0 lds
s_add_u32 s45, s95, 16384
s_add_u32 m0, s26, 4096
s_nop 0
buffer_load_dwordx4 v51, s[16:19], s45 offen offset:0 lds
s_add_u32 s45, s95, 20480
s_add_u32 m0, s26, 5120
s_nop 0
buffer_load_dwordx4 v51, s[16:19], s45 offen offset:0 lds
s_add_u32 s45, s95, 24576
s_add_u32 m0, s26, 6144
s_nop 0
buffer_load_dwordx4 v51, s[16:19], s45 offen offset:0 lds
s_add_u32 s45, s95, 28672
s_add_u32 m0, s26, 7168
s_nop 0
buffer_load_dwordx4 v51, s[16:19], s45 offen offset:0 lds
s_waitcnt vmcnt(0)
ds_read_b64_tr_b16 v[224:225], v49 offset:0
ds_read_b64_tr_b16 v[226:227], v49 offset:2048
ds_read_b64_tr_b16 v[228:229], v49 offset:4096
ds_read_b64_tr_b16 v[230:231], v49 offset:6144
ds_read_b64_tr_b16 v[232:233], v50 offset:0
ds_read_b64_tr_b16 v[234:235], v50 offset:2048
ds_read_b64_tr_b16 v[236:237], v50 offset:4096
ds_read_b64_tr_b16 v[238:239], v50 offset:6144
ds_read_b64_tr_b16 v[240:241], v49 offset:512
ds_read_b64_tr_b16 v[242:243], v49 offset:2560
ds_read_b64_tr_b16 v[244:245], v49 offset:4608
ds_read_b64_tr_b16 v[246:247], v49 offset:6656
ds_read_b64_tr_b16 v[248:249], v50 offset:512
ds_read_b64_tr_b16 v[250:251], v50 offset:2560
ds_read_b64_tr_b16 v[252:253], v50 offset:4608
ds_read_b64_tr_b16 v[254:255], v50 offset:6656
s_waitcnt lgkmcnt(0)
v_mfma_f32_16x16x32_bf16 v[160:163], v[224:227], v[16:19], v[160:163]
v_mfma_f32_16x16x32_bf16 v[160:163], v[228:231], v[20:23], v[160:163]
v_mfma_f32_16x16x32_bf16 v[164:167], v[232:235], v[16:19], v[164:167]
v_mfma_f32_16x16x32_bf16 v[164:167], v[236:239], v[20:23], v[164:167]
v_mfma_f32_16x16x32_bf16 v[168:171], v[240:243], v[16:19], v[168:171]
v_mfma_f32_16x16x32_bf16 v[168:171], v[244:247], v[20:23], v[168:171]
v_mfma_f32_16x16x32_bf16 v[172:175], v[248:251], v[16:19], v[172:175]
v_mfma_f32_16x16x32_bf16 v[172:175], v[252:255], v[20:23], v[172:175]
s_add_u32 s45, s95, 128
s_add_u32 m0, s26, 0
s_nop 0
buffer_load_dwordx4 v51, s[16:19], s45 offen offset:0 lds
s_add_u32 s45, s95, 4224
s_add_u32 m0, s26, 1024
s_nop 0
buffer_load_dwordx4 v51, s[16:19], s45 offen offset:0 lds
s_add_u32 s45, s95, 8320
s_add_u32 m0, s26, 2048
s_nop 0
buffer_load_dwordx4 v51, s[16:19], s45 offen offset:0 lds
s_add_u32 s45, s95, 12416
s_add_u32 m0, s26, 3072
s_nop 0
buffer_load_dwordx4 v51, s[16:19], s45 offen offset:0 lds
s_add_u32 s45, s95, 16512
s_add_u32 m0, s26, 4096
s_nop 0
buffer_load_dwordx4 v51, s[16:19], s45 offen offset:0 lds
s_add_u32 s45, s95, 20608
s_add_u32 m0, s26, 5120
s_nop 0
buffer_load_dwordx4 v51, s[16:19], s45 offen offset:0 lds
s_add_u32 s45, s95, 24704
s_add_u32 m0, s26, 6144
s_nop 0
buffer_load_dwordx4 v51, s[16:19], s45 offen offset:0 lds
s_add_u32 s45, s95, 28800
s_add_u32 m0, s26, 7168
s_nop 0
buffer_load_dwordx4 v51, s[16:19], s45 offen offset:0 lds
s_waitcnt vmcnt(0)
ds_read_b64_tr_b16 v[224:225], v49 offset:0
ds_read_b64_tr_b16 v[226:227], v49 offset:2048
ds_read_b64_tr_b16 v[228:229], v49 offset:4096
ds_read_b64_tr_b16 v[230:231], v49 offset:6144
ds_read_b64_tr_b16 v[232:233], v50 offset:0
ds_read_b64_tr_b16 v[234:235], v50 offset:2048
ds_read_b64_tr_b16 v[236:237], v50 offset:4096
ds_read_b64_tr_b16 v[238:239], v50 offset:6144
ds_read_b64_tr_b16 v[240:241], v49 offset:512
ds_read_b64_tr_b16 v[242:243], v49 offset:2560
ds_read_b64_tr_b16 v[244:245], v49 offset:4608
ds_read_b64_tr_b16 v[246:247], v49 offset:6656
ds_read_b64_tr_b16 v[248:249], v50 offset:512
ds_read_b64_tr_b16 v[250:251], v50 offset:2560
ds_read_b64_tr_b16 v[252:253], v50 offset:4608
ds_read_b64_tr_b16 v[254:255], v50 offset:6656
s_waitcnt lgkmcnt(0)
v_mfma_f32_16x16x32_bf16 v[176:179], v[224:227], v[16:19], v[176:179]
v_mfma_f32_16x16x32_bf16 v[176:179], v[228:231], v[20:23], v[176:179]
v_mfma_f32_16x16x32_bf16 v[180:183], v[232:235], v[16:19], v[180:183]
v_mfma_f32_16x16x32_bf16 v[180:183], v[236:239], v[20:23], v[180:183]
v_mfma_f32_16x16x32_bf16 v[184:187], v[240:243], v[16:19], v[184:187]
v_mfma_f32_16x16x32_bf16 v[184:187], v[244:247], v[20:23], v[184:187]
v_mfma_f32_16x16x32_bf16 v[188:191], v[248:251], v[16:19], v[188:191]
v_mfma_f32_16x16x32_bf16 v[188:191], v[252:255], v[20:23], v[188:191]
s_add_u32 s45, s95, 256
s_add_u32 m0, s26, 0
s_nop 0
buffer_load_dwordx4 v51, s[16:19], s45 offen offset:0 lds
s_add_u32 s45, s95, 4352
s_add_u32 m0, s26, 1024
s_nop 0
buffer_load_dwordx4 v51, s[16:19], s45 offen offset:0 lds
s_add_u32 s45, s95, 8448
s_add_u32 m0, s26, 2048
s_nop 0
buffer_load_dwordx4 v51, s[16:19], s45 offen offset:0 lds
s_add_u32 s45, s95, 12544
s_add_u32 m0, s26, 3072
s_nop 0
buffer_load_dwordx4 v51, s[16:19], s45 offen offset:0 lds
s_add_u32 s45, s95, 16640
s_add_u32 m0, s26, 4096
s_nop 0
buffer_load_dwordx4 v51, s[16:19], s45 offen offset:0 lds
s_add_u32 s45, s95, 20736
s_add_u32 m0, s26, 5120
s_nop 0
buffer_load_dwordx4 v51, s[16:19], s45 offen offset:0 lds
s_add_u32 s45, s95, 24832
s_add_u32 m0, s26, 6144
s_nop 0
buffer_load_dwordx4 v51, s[16:19], s45 offen offset:0 lds
s_add_u32 s45, s95, 28928
s_add_u32 m0, s26, 7168
s_nop 0
buffer_load_dwordx4 v51, s[16:19], s45 offen offset:0 lds
s_waitcnt vmcnt(0)
ds_read_b64_tr_b16 v[224:225], v49 offset:0
ds_read_b64_tr_b16 v[226:227], v49 offset:2048
ds_read_b64_tr_b16 v[228:229], v49 offset:4096
ds_read_b64_tr_b16 v[230:231], v49 offset:6144
ds_read_b64_tr_b16 v[232:233], v50 offset:0
ds_read_b64_tr_b16 v[234:235], v50 offset:2048
ds_read_b64_tr_b16 v[236:237], v50 offset:4096
ds_read_b64_tr_b16 v[238:239], v50 offset:6144
ds_read_b64_tr_b16 v[240:241], v49 offset:512
ds_read_b64_tr_b16 v[242:243], v49 offset:2560
ds_read_b64_tr_b16 v[244:245], v49 offset:4608
ds_read_b64_tr_b16 v[246:247], v49 offset:6656
ds_read_b64_tr_b16 v[248:249], v50 offset:512
ds_read_b64_tr_b16 v[250:251], v50 offset:2560
ds_read_b64_tr_b16 v[252:253], v50 offset:4608
ds_read_b64_tr_b16 v[254:255], v50 offset:6656
s_waitcnt lgkmcnt(0)
v_mfma_f32_16x16x32_bf16 v[192:195], v[224:227], v[16:19], v[192:195]
v_mfma_f32_16x16x32_bf16 v[192:195], v[228:231], v[20:23], v[192:195]
v_mfma_f32_16x16x32_bf16 v[196:199], v[232:235], v[16:19], v[196:199]
v_mfma_f32_16x16x32_bf16 v[196:199], v[236:239], v[20:23], v[196:199]
v_mfma_f32_16x16x32_bf16 v[200:203], v[240:243], v[16:19], v[200:203]
v_mfma_f32_16x16x32_bf16 v[200:203], v[244:247], v[20:23], v[200:203]
v_mfma_f32_16x16x32_bf16 v[204:207], v[248:251], v[16:19], v[204:207]
v_mfma_f32_16x16x32_bf16 v[204:207], v[252:255], v[20:23], v[204:207]
s_add_u32 s45, s95, 384
s_add_u32 m0, s26, 0
s_nop 0
buffer_load_dwordx4 v51, s[16:19], s45 offen offset:0 lds
s_add_u32 s45, s95, 4480
s_add_u32 m0, s26, 1024
s_nop 0
buffer_load_dwordx4 v51, s[16:19], s45 offen offset:0 lds
s_add_u32 s45, s95, 8576
s_add_u32 m0, s26, 2048
s_nop 0
buffer_load_dwordx4 v51, s[16:19], s45 offen offset:0 lds
s_add_u32 s45, s95, 12672
s_add_u32 m0, s26, 3072
s_nop 0
buffer_load_dwordx4 v51, s[16:19], s45 offen offset:0 lds
s_add_u32 s45, s95, 16768
s_add_u32 m0, s26, 4096
s_nop 0
buffer_load_dwordx4 v51, s[16:19], s45 offen offset:0 lds
s_add_u32 s45, s95, 20864
s_add_u32 m0, s26, 5120
s_nop 0
buffer_load_dwordx4 v51, s[16:19], s45 offen offset:0 lds
s_add_u32 s45, s95, 24960
s_add_u32 m0, s26, 6144
s_nop 0
buffer_load_dwordx4 v51, s[16:19], s45 offen offset:0 lds
s_add_u32 s45, s95, 29056
s_add_u32 m0, s26, 7168
s_nop 0
buffer_load_dwordx4 v51, s[16:19], s45 offen offset:0 lds
s_waitcnt vmcnt(0)
ds_read_b64_tr_b16 v[224:225], v49 offset:0
ds_read_b64_tr_b16 v[226:227], v49 offset:2048
ds_read_b64_tr_b16 v[228:229], v49 offset:4096
ds_read_b64_tr_b16 v[230:231], v49 offset:6144
ds_read_b64_tr_b16 v[232:233], v50 offset:0
ds_read_b64_tr_b16 v[234:235], v50 offset:2048
ds_read_b64_tr_b16 v[236:237], v50 offset:4096
ds_read_b64_tr_b16 v[238:239], v50 offset:6144
ds_read_b64_tr_b16 v[240:241], v49 offset:512
ds_read_b64_tr_b16 v[242:243], v49 offset:2560
ds_read_b64_tr_b16 v[244:245], v49 offset:4608
ds_read_b64_tr_b16 v[246:247], v49 offset:6656
ds_read_b64_tr_b16 v[248:249], v50 offset:512
ds_read_b64_tr_b16 v[250:251], v50 offset:2560
ds_read_b64_tr_b16 v[252:253], v50 offset:4608
ds_read_b64_tr_b16 v[254:255], v50 offset:6656
s_waitcnt lgkmcnt(0)
v_mfma_f32_16x16x32_bf16 v[208:211], v[224:227], v[16:19], v[208:211]
v_mfma_f32_16x16x32_bf16 v[208:211], v[228:231], v[20:23], v[208:211]
v_mfma_f32_16x16x32_bf16 v[212:215], v[232:235], v[16:19], v[212:215]
v_mfma_f32_16x16x32_bf16 v[212:215], v[236:239], v[20:23], v[212:215]
v_mfma_f32_16x16x32_bf16 v[216:219], v[240:243], v[16:19], v[216:219]
v_mfma_f32_16x16x32_bf16 v[216:219], v[244:247], v[20:23], v[216:219]
v_mfma_f32_16x16x32_bf16 v[220:223], v[248:251], v[16:19], v[220:223]
v_mfma_f32_16x16x32_bf16 v[220:223], v[252:255], v[20:23], v[220:223]
s_nop 9
s_add_u32 s95, s95, 32768
s_add_u32 s92, s92, 1
s_cmp_lt_u32 s92, 8
s_cbranch_scc1 L_rj
v_mov_b32 v9, v7
s_nop 1
v_permlane16_swap_b32 v7, v9
v_add_f32 v7, v7, v9
v_mov_b32 v9, v7
s_nop 1
v_permlane32_swap_b32 v7, v9
v_add_f32 v7, v7, v9
v_rcp_f32 v10, v7
s_nop 0
v_mul_f32 v160, v160, v10
v_mul_f32 v161, v161, v10
v_mul_f32 v162, v162, v10
v_mul_f32 v163, v163, v10
v_cvt_pk_bf16_f32 v160, v160, v161
v_cvt_pk_bf16_f32 v161, v162, v163
buffer_store_dwordx2 v[160:161], v52, s[20:23], s93 offen offset:0
v_mul_f32 v164, v164, v10
v_mul_f32 v165, v165, v10
v_mul_f32 v166, v166, v10
v_mul_f32 v167, v167, v10
v_cvt_pk_bf16_f32 v164, v164, v165
v_cvt_pk_bf16_f32 v165, v166, v167
buffer_store_dwordx2 v[164:165], v52, s[20:23], s93 offen offset:32
v_mul_f32 v168, v168, v10
v_mul_f32 v169, v169, v10
v_mul_f32 v170, v170, v10
v_mul_f32 v171, v171, v10
v_cvt_pk_bf16_f32 v168, v168, v169
v_cvt_pk_bf16_f32 v169, v170, v171
buffer_store_dwordx2 v[168:169], v52, s[20:23], s93 offen offset:64
v_mul_f32 v172, v172, v10
v_mul_f32 v173, v173, v10
v_mul_f32 v174, v174, v10
v_mul_f32 v175, v175, v10
v_cvt_pk_bf16_f32 v172, v172, v173
v_cvt_pk_bf16_f32 v173, v174, v175
buffer_store_dwordx2 v[172:173], v52, s[20:23], s93 offen offset:96
v_mul_f32 v176, v176, v10
v_mul_f32 v177, v177, v10
v_mul_f32 v178, v178, v10
v_mul_f32 v179, v179, v10
v_cvt_pk_bf16_f32 v176, v176, v177
v_cvt_pk_bf16_f32 v177, v178, v179
buffer_store_dwordx2 v[176:177], v52, s[20:23], s93 offen offset:128
v_mul_f32 v180, v180, v10
v_mul_f32 v181, v181, v10
v_mul_f32 v182, v182, v10
v_mul_f32 v183, v183, v10
v_cvt_pk_bf16_f32 v180, v180, v181
v_cvt_pk_bf16_f32 v181, v182, v183
buffer_store_dwordx2 v[180:181], v52, s[20:23], s93 offen offset:160
v_mul_f32 v184, v184, v10
v_mul_f32 v185, v185, v10
v_mul_f32 v186, v186, v10
v_mul_f32 v187, v187, v10
v_cvt_pk_bf16_f32 v184, v184, v185
v_cvt_pk_bf16_f32 v185, v186, v187
buffer_store_dwordx2 v[184:185], v52, s[20:23], s93 offen offset:192
v_mul_f32 v188, v188, v10
v_mul_f32 v189, v189, v10
v_mul_f32 v190, v190, v10
v_mul_f32 v191, v191, v10
v_cvt_pk_bf16_f32 v188, v188, v189
v_cvt_pk_bf16_f32 v189, v190, v191
buffer_store_dwordx2 v[188:189], v52, s[20:23], s93 offen offset:224
v_mul_f32 v192, v192, v10
v_mul_f32 v193, v193, v10
v_mul_f32 v194, v194, v10
v_mul_f32 v195, v195, v10
v_cvt_pk_bf16_f32 v192, v192, v193
v_cvt_pk_bf16_f32 v193, v194, v195
buffer_store_dwordx2 v[192:193], v52, s[20:23], s93 offen offset:256
v_mul_f32 v196, v196, v10
v_mul_f32 v197, v197, v10
v_mul_f32 v198, v198, v10
v_mul_f32 v199, v199, v10
v_cvt_pk_bf16_f32 v196, v196, v197
v_cvt_pk_bf16_f32 v197, v198, v199
buffer_store_dwordx2 v[196:197], v52, s[20:23], s93 offen offset:288
v_mul_f32 v200, v200, v10
v_mul_f32 v201, v201, v10
v_mul_f32 v202, v202, v10
v_mul_f32 v203, v203, v10
v_cvt_pk_bf16_f32 v200, v200, v201
v_cvt_pk_bf16_f32 v201, v202, v203
buffer_store_dwordx2 v[200:201], v52, s[20:23], s93 offen offset:320
v_mul_f32 v204, v204, v10
v_mul_f32 v205, v205, v10
v_mul_f32 v206, v206, v10
v_mul_f32 v207, v207, v10
v_cvt_pk_bf16_f32 v204, v204, v205
v_cvt_pk_bf16_f32 v205, v206, v207
buffer_store_dwordx2 v[204:205], v52, s[20:23], s93 offen offset:352
v_mul_f32 v208, v208, v10
v_mul_f32 v209, v209, v10
v_mul_f32 v210, v210, v10
v_mul_f32 v211, v211, v10
v_cvt_pk_bf16_f32 v208, v208, v209
v_cvt_pk_bf16_f32 v209, v210, v211
buffer_store_dwordx2 v[208:209], v52, s[20:23], s93 offen offset:384
v_mul_f32 v212, v212, v10
v_mul_f32 v213, v213, v10
v_mul_f32 v214, v214, v10
v_mul_f32 v215, v215, v10
v_cvt_pk_bf16_f32 v212, v212, v213
v_cvt_pk_bf16_f32 v213, v214, v215
buffer_store_dwordx2 v[212:213], v52, s[20:23], s93 offen offset:416
v_mul_f32 v216, v216, v10
v_mul_f32 v217, v217, v10
v_mul_f32 v218, v218, v10
v_mul_f32 v219, v219, v10
v_cvt_pk_bf16_f32 v216, v216, v217
v_cvt_pk_bf16_f32 v217, v218, v219
buffer_store_dwordx2 v[216:217], v52, s[20:23], s93 offen offset:448
v_mul_f32 v220, v220, v10
v_mul_f32 v221, v221, v10
v_mul_f32 v222, v222, v10
v_mul_f32 v223, v223, v10
v_cvt_pk_bf16_f32 v220, v220, v221
v_cvt_pk_bf16_f32 v221, v222, v223
buffer_store_dwordx2 v[220:221], v52, s[20:23], s93 offen offset:480
s_waitcnt vmcnt(0)
s_add_u32 s91, s91, 1
s_cmp_lt_u32 s91, s82
s_cbranch_scc1 L_rb
L_rp_next:
s_mov_b32 s80, s83
s_mov_b32 s81, s84
s_mov_b32 s82, s85
s_mov_b32 s83, s86
s_mov_b32 s84, s87
s_mov_b32 s85, s88
s_add_u32 s90, s90, 1
s_cmp_lt_u32 s90, 3
s_cbranch_scc1 L_rp
s_branch L_fin
.p2align 6
.type L_table,@object
L_table:
.long 0, 0, 12, 1097728, 262144, 16, 1900544, 524288, 14, 0, 2147418112, 0, 12, 1, 0, 0
.long 10747904, 4194304, 12, 11845632, 4456448, 16, 12648448, 4718592, 14, 0, 2147418112, 0, 12, 1, 0, 0
.long 21495808, 8388608, 12, 22593536, 8650752, 16, 23396352, 8912896, 14, 0, 2147418112, 0, 12, 1, 0, 0
.long 32243712, 12582912, 12, 33341440, 12845056, 16, 34144256, 13107200, 14, 0, 2147418112, 0, 12, 1, 0, 0
.long 42991616, 16777216, 12, 44089344, 17039360, 16, 44892160, 17301504, 14, 0, 2147418112, 0, 12, 1, 0, 0
.long 53739520, 20971520, 12, 54837248, 21233664, 16, 55640064, 21495808, 14, 0, 2147418112, 0, 12, 1, 0, 0
.long 64487424, 25165824, 12, 65585152, 25427968, 16, 66387968, 25690112, 14, 0, 2147418112, 0, 12, 1, 0, 0
.long 75235328, 29360128, 12, 76333056, 29622272, 16, 77135872, 29884416, 14, 0, 2147418112, 0, 12, 1, 0, 0
.long 98304, 0, 12, 1228800, 262144, 14, 1638400, 524288, 16, 0, 2147418112, 1, 12, 1, 0, 0
.long 10846208, 4194304, 12, 11976704, 4456448, 14, 12386304, 4718592, 16, 0, 2147418112, 1, 12, 1, 0, 0
.long 21594112, 8388608, 12, 22724608, 8650752, 14, 23134208, 8912896, 16, 0, 2147418112, 1, 12, 1, 0, 0
.long 32342016, 12582912, 12, 33472512, 12845056, 14, 33882112, 13107200, 16, 0, 2147418112, 1, 12, 1, 0, 0
.long 43089920, 16777216, 12, 44220416, 17039360, 14, 44630016, 17301504, 16, 0, 2147418112, 1, 12, 1, 0, 0
.long 53837824, 20971520, 12, 54968320, 21233664, 14, 55377920, 21495808, 16, 0, 2147418112, 1, 12, 1, 0, 0
.long 64585728, 25165824, 12, 65716224, 25427968, 14, 66125824, 25690112, 16, 0, 2147418112, 1, 12, 1, 0, 0
.long 75333632, 29360128, 12, 76464128, 29622272, 14, 76873728, 29884416, 16, 0, 2147418112, 1, 12, 1, 0, 0
.long 196608, 0, 12, 966656, 262144, 16, 1769472, 524288, 16, 0, 2147418112, 2, 12, 1, 0, 0
.long 10944512, 4194304, 12, 11714560, 4456448, 16, 12517376, 4718592, 16, 0, 2147418112, 2, 12, 1, 0, 0
.long 21692416, 8388608, 12, 22462464, 8650752, 16, 23265280, 8912896, 16, 0, 2147418112, 2, 12, 1, 0, 0
.long 32440320, 12582912, 12, 33210368, 12845056, 16, 34013184, 13107200, 16, 0, 2147418112, 2, 12, 1, 0, 0
.long 43188224, 16777216, 12, 43958272, 17039360, 16, 44761088, 17301504, 16, 0, 2147418112, 2, 12, 1, 0, 0
.long 53936128, 20971520, 12, 54706176, 21233664, 16, 55508992, 21495808, 16, 0, 2147418112, 2, 12, 1, 0, 0
.long 64684032, 25165824, 12, 65454080, 25427968, 16, 66256896, 25690112, 16, 0, 2147418112, 2, 12, 1, 0, 0
.long 75431936, 29360128, 12, 76201984, 29622272, 16, 77004800, 29884416, 16, 0, 2147418112, 2, 12, 1, 0, 0
.long 2015232, 786432, 12, 3112960, 1048576, 16, 3915776, 1310720, 14, 0, 2147418112, 0, 12, 1, 0, 0
.long 12763136, 4980736, 12, 13860864, 5242880, 16, 14663680, 5505024, 14, 0, 2147418112, 0, 12, 1, 0, 0
.long 23511040, 9175040, 12, 24608768, 9437184, 16, 25411584, 9699328, 14, 0, 2147418112, 0, 12, 1, 0, 0
.long 34258944, 13369344, 12, 35356672, 13631488, 16, 36159488, 13893632, 14, 0, 2147418112, 0, 12, 1, 0, 0
.long 45006848, 17563648, 12, 46104576, 17825792, 16, 46907392, 18087936, 14, 0, 2147418112, 0, 12, 1, 0, 0
.long 55754752, 21757952, 12, 56852480, 22020096, 16, 57655296, 22282240, 14, 0, 2147418112, 0, 12, 1, 0, 0
.long 66502656, 25952256, 12, 67600384, 26214400, 16, 68403200, 26476544, 14, 0, 2147418112, 0, 12, 1, 0, 0
.long 77250560, 30146560, 12, 78348288, 30408704, 16, 79151104, 30670848, 14, 0, 2147418112, 0, 12, 1, 0, 0
.long 294912, 0, 16, 671744, 262144, 12, 1343488, 524288, 12, 0, 0, 0, 12, 0, 0, 0
.long 11042816, 4194304, 16, 11419648, 4456448, 12, 12091392, 4718592, 12, 0, 10747904, 0, 12, 0, 0, 0
.long 21790720, 8388608, 16, 22167552, 8650752, 12, 22839296, 8912896, 12, 0, 21495808, 0, 12, 0, 0, 0
.long 32538624, 12582912, 16, 32915456, 12845056, 12, 33587200, 13107200, 12, 0, 32243712, 0, 12, 0, 0, 0
.long 43286528, 16777216, 16, 43663360, 17039360, 12, 44335104, 17301504, 12, 0, 42991616, 0, 12, 0, 0, 0
.long 54034432, 20971520, 16, 54411264, 21233664, 12, 55083008, 21495808, 12, 0, 53739520, 0, 12, 0, 0, 0
.long 64782336, 25165824, 16, 65159168, 25427968, 12, 65830912, 25690112, 12, 0, 64487424, 0, 12, 0, 0, 0
.long 75530240, 29360128, 16, 75907072, 29622272, 12, 76578816, 29884416, 12, 0, 75235328, 0, 12, 0, 0, 0
.long 425984, 0, 16, 770048, 262144, 12, 1441792, 524288, 12, 0, 98304, 1, 12, 0, 0, 0
.long 11173888, 4194304, 16, 11517952, 4456448, 12, 12189696, 4718592, 12, 0, 10846208, 1, 12, 0, 0, 0
.long 21921792, 8388608, 16, 22265856, 8650752, 12, 22937600, 8912896, 12, 0, 21594112, 1, 12, 0, 0, 0
.long 32669696, 12582912, 16, 33013760, 12845056, 12, 33685504, 13107200, 12, 0, 32342016, 1, 12, 0, 0, 0
.long 43417600, 16777216, 16, 43761664, 17039360, 12, 44433408, 17301504, 12, 0, 43089920, 1, 12, 0, 0, 0
.long 54165504, 20971520, 16, 54509568, 21233664, 12, 55181312, 21495808, 12, 0, 53837824, 1, 12, 0, 0, 0
.long 64913408, 25165824, 16, 65257472, 25427968, 12, 65929216, 25690112, 12, 0, 64585728, 1, 12, 0, 0, 0
.long 75661312, 29360128, 16, 76005376, 29622272, 12, 76677120, 29884416, 12, 0, 75333632, 1, 12, 0, 0, 0
.long 557056, 0, 14, 868352, 262144, 12, 1540096, 524288, 12, 0, 196608, 2, 12, 0, 0, 0
.long 11304960, 4194304, 14, 11616256, 4456448, 12, 12288000, 4718592, 12, 0, 10944512, 2, 12, 0, 0, 0
.long 22052864, 8388608, 14, 22364160, 8650752, 12, 23035904, 8912896, 12, 0, 21692416, 2, 12, 0, 0, 0
.long 32800768, 12582912, 14, 33112064, 12845056, 12, 33783808, 13107200, 12, 0, 32440320, 2, 12, 0, 0, 0
.long 43548672, 16777216, 14, 43859968, 17039360, 12, 44531712, 17301504, 12, 0, 43188224, 2, 12, 0, 0, 0
.long 54296576, 20971520, 14, 54607872, 21233664, 12, 55279616, 21495808, 12, 0, 53936128, 2, 12, 0, 0, 0
.long 65044480, 25165824, 14, 65355776, 25427968, 12, 66027520, 25690112, 12, 0, 64684032, 2, 12, 0, 0, 0
.long 75792384, 29360128, 14, 76103680, 29622272, 12, 76775424, 29884416, 12, 0, 75431936, 2, 12, 0, 0, 0
.long 2310144, 786432, 16, 2686976, 1048576, 12, 3358720, 1310720, 12, 0, 2015232, 0, 12, 0, 0, 0
.long 13058048, 4980736, 16, 13434880, 5242880, 12, 14106624, 5505024, 12, 0, 12763136, 0, 12, 0, 0, 0
.long 23805952, 9175040, 16, 24182784, 9437184, 12, 24854528, 9699328, 12, 0, 23511040, 0, 12, 0, 0, 0
.long 34553856, 13369344, 16, 34930688, 13631488, 12, 35602432, 13893632, 12, 0, 34258944, 0, 12, 0, 0, 0
.long 45301760, 17563648, 16, 45678592, 17825792, 12, 46350336, 18087936, 12, 0, 45006848, 0, 12, 0, 0, 0
.long 56049664, 21757952, 16, 56426496, 22020096, 12, 57098240, 22282240, 12, 0, 55754752, 0, 12, 0, 0, 0
.long 66797568, 25952256, 16, 67174400, 26214400, 12, 67846144, 26476544, 12, 0, 66502656, 0, 12, 0, 0, 0
.long 77545472, 30146560, 16, 77922304, 30408704, 12, 78594048, 30670848, 12, 0, 77250560, 0, 12, 0, 0, 0
.long 2113536, 786432, 12, 3244032, 1048576, 14, 3653632, 1310720, 16, 0, 2147418112, 1, 12, 1, 0, 0
.long 12861440, 4980736, 12, 13991936, 5242880, 14, 14401536, 5505024, 16, 0, 2147418112, 1, 12, 1, 0, 0
.long 23609344, 9175040, 12, 24739840, 9437184, 14, 25149440, 9699328, 16, 0, 2147418112, 1, 12, 1, 0, 0
.long 34357248, 13369344, 12, 35487744, 13631488, 14, 35897344, 13893632, 16, 0, 2147418112, 1, 12, 1, 0, 0
.long 45105152, 17563648, 12, 46235648, 17825792, 14, 46645248, 18087936, 16, 0, 2147418112, 1, 12, 1, 0, 0
.long 55853056, 21757952, 12, 56983552, 22020096, 14, 57393152, 22282240, 16, 0, 2147418112, 1, 12, 1, 0, 0
.long 66600960, 25952256, 12, 67731456, 26214400, 14, 68141056, 26476544, 16, 0, 2147418112, 1, 12, 1, 0, 0
.long 77348864, 30146560, 12, 78479360, 30408704, 14, 78888960, 30670848, 16, 0, 2147418112, 1, 12, 1, 0, 0
.long 2211840, 786432, 12, 2981888, 1048576, 16, 3784704, 1310720, 16, 0, 2147418112, 2, 12, 1, 0, 0
.long 12959744, 4980736, 12, 13729792, 5242880, 16, 14532608, 5505024, 16, 0, 2147418112, 2, 12, 1, 0, 0
.long 23707648, 9175040, 12, 24477696, 9437184, 16, 25280512, 9699328, 16, 0, 2147418112, 2, 12, 1, 0, 0
.long 34455552, 13369344, 12, 35225600, 13631488, 16, 36028416, 13893632, 16, 0, 2147418112, 2, 12, 1, 0, 0
.long 45203456, 17563648, 12, 45973504, 17825792, 16, 46776320, 18087936, 16, 0, 2147418112, 2, 12, 1, 0, 0
.long 55951360, 21757952, 12, 56721408, 22020096, 16, 57524224, 22282240, 16, 0, 2147418112, 2, 12, 1, 0, 0
.long 66699264, 25952256, 12, 67469312, 26214400, 16, 68272128, 26476544, 16, 0, 2147418112, 2, 12, 1, 0, 0
.long 77447168, 30146560, 12, 78217216, 30408704, 16, 79020032, 30670848, 16, 0, 2147418112, 2, 12, 1, 0, 0
.long 4030464, 1572864, 12, 5128192, 1835008, 16, 5931008, 2097152, 14, 0, 2147418112, 0, 12, 1, 0, 0
.long 14778368, 5767168, 12, 15876096, 6029312, 16, 16678912, 6291456, 14, 0, 2147418112, 0, 12, 1, 0, 0
.long 25526272, 9961472, 12, 26624000, 10223616, 16, 27426816, 10485760, 14, 0, 2147418112, 0, 12, 1, 0, 0
.long 36274176, 14155776, 12, 37371904, 14417920, 16, 38174720, 14680064, 14, 0, 2147418112, 0, 12, 1, 0, 0
.long 47022080, 18350080, 12, 48119808, 18612224, 16, 48922624, 18874368, 14, 0, 2147418112, 0, 12, 1, 0, 0
.long 57769984, 22544384, 12, 58867712, 22806528, 16, 59670528, 23068672, 14, 0, 2147418112, 0, 12, 1, 0, 0
.long 68517888, 26738688, 12, 69615616, 27000832, 16, 70418432, 27262976, 14, 0, 2147418112, 0, 12, 1, 0, 0
.long 79265792, 30932992, 12, 80363520, 31195136, 16, 81166336, 31457280, 14, 0, 2147418112, 0, 12, 1, 0, 0
.long 4128768, 1572864, 12, 5259264, 1835008, 14, 5668864, 2097152, 16, 0, 2147418112, 1, 12, 1, 0, 0
.long 14876672, 5767168, 12, 16007168, 6029312, 14, 16416768, 6291456, 16, 0, 2147418112, 1, 12, 1, 0, 0
.long 25624576, 9961472, 12, 26755072, 10223616, 14, 27164672, 10485760, 16, 0, 2147418112, 1, 12, 1, 0, 0
.long 36372480, 14155776, 12, 37502976, 14417920, 14, 37912576, 14680064, 16, 0, 2147418112, 1, 12, 1, 0, 0
.long 47120384, 18350080, 12, 48250880, 18612224, 14, 48660480, 18874368, 16, 0, 2147418112, 1, 12, 1, 0, 0
.long 57868288, 22544384, 12, 58998784, 22806528, 14, 59408384, 23068672, 16, 0, 2147418112, 1, 12, 1, 0, 0
.long 68616192, 26738688, 12, 69746688, 27000832, 14, 70156288, 27262976, 16, 0, 2147418112, 1, 12, 1, 0, 0
.long 79364096, 30932992, 12, 80494592, 31195136, 14, 80904192, 31457280, 16, 0, 2147418112, 1, 12, 1, 0, 0
.long 2441216, 786432, 16, 2785280, 1048576, 12, 3457024, 1310720, 12, 0, 2113536, 1, 12, 0, 0, 0
.long 13189120, 4980736, 16, 13533184, 5242880, 12, 14204928, 5505024, 12, 0, 12861440, 1, 12, 0, 0, 0
.long 23937024, 9175040, 16, 24281088, 9437184, 12, 24952832, 9699328, 12, 0, 23609344, 1, 12, 0, 0, 0
.long 34684928, 13369344, 16, 35028992, 13631488, 12, 35700736, 13893632, 12, 0, 34357248, 1, 12, 0, 0, 0
.long 45432832, 17563648, 16, 45776896, 17825792, 12, 46448640, 18087936, 12, 0, 45105152, 1, 12, 0, 0, 0
.long 56180736, 21757952, 16, 56524800, 22020096, 12, 57196544, 22282240, 12, 0, 55853056, 1, 12, 0, 0, 0
.long 66928640, 25952256, 16, 67272704, 26214400, 12, 67944448, 26476544, 12, 0, 66600960, 1, 12, 0, 0, 0
.long 77676544, 30146560, 16, 78020608, 30408704, 12, 78692352, 30670848, 12, 0, 77348864, 1, 12, 0, 0, 0
.long 2572288, 786432, 14, 2883584, 1048576, 12, 3555328, 1310720, 12, 0, 2211840, 2, 12, 0, 0, 0
.long 13320192, 4980736, 14, 13631488, 5242880, 12, 14303232, 5505024, 12, 0, 12959744, 2, 12, 0, 0, 0
.long 24068096, 9175040, 14, 24379392, 9437184, 12, 25051136, 9699328, 12, 0, 23707648, 2, 12, 0, 0, 0
.long 34816000, 13369344, 14, 35127296, 13631488, 12, 35799040, 13893632, 12, 0, 34455552, 2, 12, 0, 0, 0
.long 45563904, 17563648, 14, 45875200, 17825792, 12, 46546944, 18087936, 12, 0, 45203456, 2, 12, 0, 0, 0
.long 56311808, 21757952, 14, 56623104, 22020096, 12, 57294848, 22282240, 12, 0, 55951360, 2, 12, 0, 0, 0
.long 67059712, 25952256, 14, 67371008, 26214400, 12, 68042752, 26476544, 12, 0, 66699264, 2, 12, 0, 0, 0
.long 77807616, 30146560, 14, 78118912, 30408704, 12, 78790656, 30670848, 12, 0, 77447168, 2, 12, 0, 0, 0
.long 4325376, 1572864, 16, 4702208, 1835008, 12, 5373952, 2097152, 12, 0, 4030464, 0, 12, 0, 0, 0
.long 15073280, 5767168, 16, 15450112, 6029312, 12, 16121856, 6291456, 12, 0, 14778368, 0, 12, 0, 0, 0
.long 25821184, 9961472, 16, 26198016, 10223616, 12, 26869760, 10485760, 12, 0, 25526272, 0, 12, 0, 0, 0
.long 36569088, 14155776, 16, 36945920, 14417920, 12, 37617664, 14680064, 12, 0, 36274176, 0, 12, 0, 0, 0
.long 47316992, 18350080, 16, 47693824, 18612224, 12, 48365568, 18874368, 12, 0, 47022080, 0, 12, 0, 0, 0
.long 58064896, 22544384, 16, 58441728, 22806528, 12, 59113472, 23068672, 12, 0, 57769984, 0, 12, 0, 0, 0
.long 68812800, 26738688, 16, 69189632, 27000832, 12, 69861376, 27262976, 12, 0, 68517888, 0, 12, 0, 0, 0
.long 79560704, 30932992, 16, 79937536, 31195136, 12, 80609280, 31457280, 12, 0, 79265792, 0, 12, 0, 0, 0
.long 4456448, 1572864, 16, 4800512, 1835008, 12, 5472256, 2097152, 12, 0, 4128768, 1, 12, 0, 0, 0
.long 15204352, 5767168, 16, 15548416, 6029312, 12, 16220160, 6291456, 12, 0, 14876672, 1, 12, 0, 0, 0
.long 25952256, 9961472, 16, 26296320, 10223616, 12, 26968064, 10485760, 12, 0, 25624576, 1, 12, 0, 0, 0
.long 36700160, 14155776, 16, 37044224, 14417920, 12, 37715968, 14680064, 12, 0, 36372480, 1, 12, 0, 0, 0
.long 47448064, 18350080, 16, 47792128, 18612224, 12, 48463872, 18874368, 12, 0, 47120384, 1, 12, 0, 0, 0
.long 58195968, 22544384, 16, 58540032, 22806528, 12, 59211776, 23068672, 12, 0, 57868288, 1, 12, 0, 0, 0
.long 68943872, 26738688, 16, 69287936, 27000832, 12, 69959680, 27262976, 12, 0, 68616192, 1, 12, 0, 0, 0
.long 79691776, 30932992, 16, 80035840, 31195136, 12, 80707584, 31457280, 12, 0, 79364096, 1, 12, 0, 0, 0
.long 4227072, 1572864, 12, 4997120, 1835008, 16, 5799936, 2097152, 16, 0, 2147418112, 2, 12, 1, 0, 0
.long 14974976, 5767168, 12, 15745024, 6029312, 16, 16547840, 6291456, 16, 0, 2147418112, 2, 12, 1, 0, 0
.long 25722880, 9961472, 12, 26492928, 10223616, 16, 27295744, 10485760, 16, 0, 2147418112, 2, 12, 1, 0, 0
.long 36470784, 14155776, 12, 37240832, 14417920, 16, 38043648, 14680064, 16, 0, 2147418112, 2, 12, 1, 0, 0
.long 47218688, 18350080, 12, 47988736, 18612224, 16, 48791552, 18874368, 16, 0, 2147418112, 2, 12, 1, 0, 0
.long 57966592, 22544384, 12, 58736640, 22806528, 16, 59539456, 23068672, 16, 0, 2147418112, 2, 12, 1, 0, 0
.long 68714496, 26738688, 12, 69484544, 27000832, 16, 70287360, 27262976, 16, 0, 2147418112, 2, 12, 1, 0, 0
.long 79462400, 30932992, 12, 80232448, 31195136, 16, 81035264, 31457280, 16, 0, 2147418112, 2, 12, 1, 0, 0
.long 6045696, 2359296, 12, 7143424, 2621440, 16, 7946240, 2883584, 14, 0, 2147418112, 0, 12, 1, 0, 0
.long 16793600, 6553600, 12, 17891328, 6815744, 16, 18694144, 7077888, 14, 0, 2147418112, 0, 12, 1, 0, 0
.long 27541504, 10747904, 12, 28639232, 11010048, 16, 29442048, 11272192, 14, 0, 2147418112, 0, 12, 1, 0, 0
.long 38289408, 14942208, 12, 39387136, 15204352, 16, 40189952, 15466496, 14, 0, 2147418112, 0, 12, 1, 0, 0
.long 49037312, 19136512, 12, 50135040, 19398656, 16, 50937856, 19660800, 14, 0, 2147418112, 0, 12, 1, 0, 0
.long 59785216, 23330816, 12, 60882944, 23592960, 16, 61685760, 23855104, 14, 0, 2147418112, 0, 12, 1, 0, 0
.long 70533120, 27525120, 12, 71630848, 27787264, 16, 72433664, 28049408, 14, 0, 2147418112, 0, 12, 1, 0, 0
.long 81281024, 31719424, 12, 82378752, 31981568, 16, 83181568, 32243712, 14, 0, 2147418112, 0, 12, 1, 0, 0
.long 6144000, 2359296, 12, 7274496, 2621440, 14, 7684096, 2883584, 16, 0, 2147418112, 1, 12, 1, 0, 0
.long 16891904, 6553600, 12, 18022400, 6815744, 14, 18432000, 7077888, 16, 0, 2147418112, 1, 12, 1, 0, 0
.long 27639808, 10747904, 12, 28770304, 11010048, 14, 29179904, 11272192, 16, 0, 2147418112, 1, 12, 1, 0, 0
.long 38387712, 14942208, 12, 39518208, 15204352, 14, 39927808, 15466496, 16, 0, 2147418112, 1, 12, 1, 0, 0
.long 49135616, 19136512, 12, 50266112, 19398656, 14, 50675712, 19660800, 16, 0, 2147418112, 1, 12, 1, 0, 0
.long 59883520, 23330816, 12, 61014016, 23592960, 14, 61423616, 23855104, 16, 0, 2147418112, 1, 12, 1, 0, 0
.long 70631424, 27525120, 12, 71761920, 27787264, 14, 72171520, 28049408, 16, 0, 2147418112, 1, 12, 1, 0, 0
.long 81379328, 31719424, 12, 82509824, 31981568, 14, 82919424, 32243712, 16, 0, 2147418112, 1, 12, 1, 0, 0
.long 6242304, 2359296, 12, 7012352, 2621440, 16, 7815168, 2883584, 16, 0, 2147418112, 2, 12, 1, 0, 0
.long 16990208, 6553600, 12, 17760256, 6815744, 16, 18563072, 7077888, 16, 0, 2147418112, 2, 12, 1, 0, 0
.long 27738112, 10747904, 12, 28508160, 11010048, 16, 29310976, 11272192, 16, 0, 2147418112, 2, 12, 1, 0, 0
.long 38486016, 14942208, 12, 39256064, 15204352, 16, 40058880, 15466496, 16, 0, 2147418112, 2, 12, 1, 0, 0
.long 49233920, 19136512, 12, 50003968, 19398656, 16, 50806784, 19660800, 16, 0, 2147418112, 2, 12, 1, 0, 0
.long 59981824, 23330816, 12, 60751872, 23592960, 16, 61554688, 23855104, 16, 0, 2147418112, 2, 12, 1, 0, 0
.long 70729728, 27525120, 12, 71499776, 27787264, 16, 72302592, 28049408, 16, 0, 2147418112, 2, 12, 1, 0, 0
.long 81477632, 31719424, 12, 82247680, 31981568, 16, 83050496, 32243712, 16, 0, 2147418112, 2, 12, 1, 0, 0
.long 4587520, 1572864, 14, 4898816, 1835008, 12, 5570560, 2097152, 12, 0, 4227072, 2, 12, 0, 0, 0
.long 15335424, 5767168, 14, 15646720, 6029312, 12, 16318464, 6291456, 12, 0, 14974976, 2, 12, 0, 0, 0
.long 26083328, 9961472, 14, 26394624, 10223616, 12, 27066368, 10485760, 12, 0, 25722880, 2, 12, 0, 0, 0
.long 36831232, 14155776, 14, 37142528, 14417920, 12, 37814272, 14680064, 12, 0, 36470784, 2, 12, 0, 0, 0
.long 47579136, 18350080, 14, 47890432, 18612224, 12, 48562176, 18874368, 12, 0, 47218688, 2, 12, 0, 0, 0
.long 58327040, 22544384, 14, 58638336, 22806528, 12, 59310080, 23068672, 12, 0, 57966592, 2, 12, 0, 0, 0
.long 69074944, 26738688, 14, 69386240, 27000832, 12, 70057984, 27262976, 12, 0, 68714496, 2, 12, 0, 0, 0
.long 79822848, 30932992, 14, 80134144, 31195136, 12, 80805888, 31457280, 12, 0, 79462400, 2, 12, 0, 0, 0
.long 6340608, 2359296, 16, 6717440, 2621440, 12, 7389184, 2883584, 12, 0, 6045696, 0, 12, 0, 0, 0
.long 17088512, 6553600, 16, 17465344, 6815744, 12, 18137088, 7077888, 12, 0, 16793600, 0, 12, 0, 0, 0
.long 27836416, 10747904, 16, 28213248, 11010048, 12, 28884992, 11272192, 12, 0, 27541504, 0, 12, 0, 0, 0
.long 38584320, 14942208, 16, 38961152, 15204352, 12, 39632896, 15466496, 12, 0, 38289408, 0, 12, 0, 0, 0
.long 49332224, 19136512, 16, 49709056, 19398656, 12, 50380800, 19660800, 12, 0, 49037312, 0, 12, 0, 0, 0
.long 60080128, 23330816, 16, 60456960, 23592960, 12, 61128704, 23855104, 12, 0, 59785216, 0, 12, 0, 0, 0
.long 70828032, 27525120, 16, 71204864, 27787264, 12, 71876608, 28049408, 12, 0, 70533120, 0, 12, 0, 0, 0
.long 81575936, 31719424, 16, 81952768, 31981568, 12, 82624512, 32243712, 12, 0, 81281024, 0, 12, 0, 0, 0
.long 6471680, 2359296, 16, 6815744, 2621440, 12, 7487488, 2883584, 12, 0, 6144000, 1, 12, 0, 0, 0
.long 17219584, 6553600, 16, 17563648, 6815744, 12, 18235392, 7077888, 12, 0, 16891904, 1, 12, 0, 0, 0
.long 27967488, 10747904, 16, 28311552, 11010048, 12, 28983296, 11272192, 12, 0, 27639808, 1, 12, 0, 0, 0
.long 38715392, 14942208, 16, 39059456, 15204352, 12, 39731200, 15466496, 12, 0, 38387712, 1, 12, 0, 0, 0
.long 49463296, 19136512, 16, 49807360, 19398656, 12, 50479104, 19660800, 12, 0, 49135616, 1, 12, 0, 0, 0
.long 60211200, 23330816, 16, 60555264, 23592960, 12, 61227008, 23855104, 12, 0, 59883520, 1, 12, 0, 0, 0
.long 70959104, 27525120, 16, 71303168, 27787264, 12, 71974912, 28049408, 12, 0, 70631424, 1, 12, 0, 0, 0
.long 81707008, 31719424, 16, 82051072, 31981568, 12, 82722816, 32243712, 12, 0, 81379328, 1, 12, 0, 0, 0
.long 6602752, 2359296, 14, 6914048, 2621440, 12, 7585792, 2883584, 12, 0, 6242304, 2, 12, 0, 0, 0
.long 17350656, 6553600, 14, 17661952, 6815744, 12, 18333696, 7077888, 12, 0, 16990208, 2, 12, 0, 0, 0
.long 28098560, 10747904, 14, 28409856, 11010048, 12, 29081600, 11272192, 12, 0, 27738112, 2, 12, 0, 0, 0
.long 38846464, 14942208, 14, 39157760, 15204352, 12, 39829504, 15466496, 12, 0, 38486016, 2, 12, 0, 0, 0
.long 49594368, 19136512, 14, 49905664, 19398656, 12, 50577408, 19660800, 12, 0, 49233920, 2, 12, 0, 0, 0
.long 60342272, 23330816, 14, 60653568, 23592960, 12, 61325312, 23855104, 12, 0, 59981824, 2, 12, 0, 0, 0
.long 71090176, 27525120, 14, 71401472, 27787264, 12, 72073216, 28049408, 12, 0, 70729728, 2, 12, 0, 0, 0
.long 81838080, 31719424, 14, 82149376, 31981568, 12, 82821120, 32243712, 12, 0, 81477632, 2, 12, 0, 0, 0
.long 8060928, 3145728, 12, 9158656, 3407872, 16, 9961472, 3670016, 14, 0, 2147418112, 0, 12, 1, 0, 0
.long 18808832, 7340032, 12, 19906560, 7602176, 16, 20709376, 7864320, 14, 0, 2147418112, 0, 12, 1, 0, 0
.long 29556736, 11534336, 12, 30654464, 11796480, 16, 31457280, 12058624, 14, 0, 2147418112, 0, 12, 1, 0, 0
.long 40304640, 15728640, 12, 41402368, 15990784, 16, 42205184, 16252928, 14, 0, 2147418112, 0, 12, 1, 0, 0
.long 51052544, 19922944, 12, 52150272, 20185088, 16, 52953088, 20447232, 14, 0, 2147418112, 0, 12, 1, 0, 0
.long 61800448, 24117248, 12, 62898176, 24379392, 16, 63700992, 24641536, 14, 0, 2147418112, 0, 12, 1, 0, 0
.long 72548352, 28311552, 12, 73646080, 28573696, 16, 74448896, 28835840, 14, 0, 2147418112, 0, 12, 1, 0, 0
.long 83296256, 32505856, 12, 84393984, 32768000, 16, 85196800, 33030144, 14, 0, 2147418112, 0, 12, 1, 0, 0
.long 8159232, 3145728, 12, 9289728, 3407872, 14, 9699328, 3670016, 16, 0, 2147418112, 1, 12, 1, 0, 0
.long 18907136, 7340032, 12, 20037632, 7602176, 14, 20447232, 7864320, 16, 0, 2147418112, 1, 12, 1, 0, 0
.long 29655040, 11534336, 12, 30785536, 11796480, 14, 31195136, 12058624, 16, 0, 2147418112, 1, 12, 1, 0, 0
.long 40402944, 15728640, 12, 41533440, 15990784, 14, 41943040, 16252928, 16, 0, 2147418112, 1, 12, 1, 0, 0
.long 51150848, 19922944, 12, 52281344, 20185088, 14, 52690944, 20447232, 16, 0, 2147418112, 1, 12, 1, 0, 0
.long 61898752, 24117248, 12, 63029248, 24379392, 14, 63438848, 24641536, 16, 0, 2147418112, 1, 12, 1, 0, 0
.long 72646656, 28311552, 12, 73777152, 28573696, 14, 74186752, 28835840, 16, 0, 2147418112, 1, 12, 1, 0, 0
.long 83394560, 32505856, 12, 84525056, 32768000, 14, 84934656, 33030144, 16, 0, 2147418112, 1, 12, 1, 0, 0
.long 8257536, 3145728, 12, 9027584, 3407872, 16, 9830400, 3670016, 16, 0, 2147418112, 2, 12, 1, 0, 0
.long 19005440, 7340032, 12, 19775488, 7602176, 16, 20578304, 7864320, 16, 0, 2147418112, 2, 12, 1, 0, 0
.long 29753344, 11534336, 12, 30523392, 11796480, 16, 31326208, 12058624, 16, 0, 2147418112, 2, 12, 1, 0, 0
.long 40501248, 15728640, 12, 41271296, 15990784, 16, 42074112, 16252928, 16, 0, 2147418112, 2, 12, 1, 0, 0
.long 51249152, 19922944, 12, 52019200, 20185088, 16, 52822016, 20447232, 16, 0, 2147418112, 2, 12, 1, 0, 0
.long 61997056, 24117248, 12, 62767104, 24379392, 16, 63569920, 24641536, 16, 0, 2147418112, 2, 12, 1, 0, 0
.long 72744960, 28311552, 12, 73515008, 28573696, 16, 74317824, 28835840, 16, 0, 2147418112, 2, 12, 1, 0, 0
.long 83492864, 32505856, 12, 84262912, 32768000, 16, 85065728, 33030144, 16, 0, 2147418112, 2, 12, 1, 0, 0
.long 10076160, 3932160, 12, 10502144, 3932160, 16, 10633216, 3932160, 14, 0, 2147418112, 0, 12, 1, 0, 0
.long 20824064, 8126464, 12, 21250048, 8126464, 16, 21381120, 8126464, 14, 0, 2147418112, 0, 12, 1, 0, 0
.long 31571968, 12320768, 12, 31997952, 12320768, 16, 32129024, 12320768, 14, 0, 2147418112, 0, 12, 1, 0, 0
.long 42319872, 16515072, 12, 42745856, 16515072, 16, 42876928, 16515072, 14, 0, 2147418112, 0, 12, 1, 0, 0
.long 53067776, 20709376, 12, 53493760, 20709376, 16, 53624832, 20709376, 14, 0, 2147418112, 0, 12, 1, 0, 0
.long 63815680, 24903680, 12, 64241664, 24903680, 16, 64372736, 24903680, 14, 0, 2147418112, 0, 12, 1, 0, 0
.long 74563584, 29097984, 12, 74989568, 29097984, 16, 75120640, 29097984, 14, 0, 2147418112, 0, 12, 1, 0, 0
.long 85311488, 33292288, 12, 85737472, 33292288, 16, 85868544, 33292288, 14, 0, 2147418112, 0, 12, 1, 0, 0
.long 8355840, 3145728, 16, 8732672, 3407872, 12, 9404416, 3670016, 12, 0, 8060928, 0, 12, 0, 0, 0
.long 19103744, 7340032, 16, 19480576, 7602176, 12, 20152320, 7864320, 12, 0, 18808832, 0, 12, 0, 0, 0
.long 29851648, 11534336, 16, 30228480, 11796480, 12, 30900224, 12058624, 12, 0, 29556736, 0, 12, 0, 0, 0
.long 40599552, 15728640, 16, 40976384, 15990784, 12, 41648128, 16252928, 12, 0, 40304640, 0, 12, 0, 0, 0
.long 51347456, 19922944, 16, 51724288, 20185088, 12, 52396032, 20447232, 12, 0, 51052544, 0, 12, 0, 0, 0
.long 62095360, 24117248, 16, 62472192, 24379392, 12, 63143936, 24641536, 12, 0, 61800448, 0, 12, 0, 0, 0
.long 72843264, 28311552, 16, 73220096, 28573696, 12, 73891840, 28835840, 12, 0, 72548352, 0, 12, 0, 0, 0
.long 83591168, 32505856, 16, 83968000, 32768000, 12, 84639744, 33030144, 12, 0, 83296256, 0, 12, 0, 0, 0
.long 8486912, 3145728, 16, 8830976, 3407872, 12, 9502720, 3670016, 12, 0, 8159232, 1, 12, 0, 0, 0
.long 19234816, 7340032, 16, 19578880, 7602176, 12, 20250624, 7864320, 12, 0, 18907136, 1, 12, 0, 0, 0
.long 29982720, 11534336, 16, 30326784, 11796480, 12, 30998528, 12058624, 12, 0, 29655040, 1, 12, 0, 0, 0
.long 40730624, 15728640, 16, 41074688, 15990784, 12, 41746432, 16252928, 12, 0, 40402944, 1, 12, 0, 0, 0
.long 51478528, 19922944, 16, 51822592, 20185088, 12, 52494336, 20447232, 12, 0, 51150848, 1, 12, 0, 0, 0
.long 62226432, 24117248, 16, 62570496, 24379392, 12, 63242240, 24641536, 12, 0, 61898752, 1, 12, 0, 0, 0
.long 72974336, 28311552, 16, 73318400, 28573696, 12, 73990144, 28835840, 12, 0, 72646656, 1, 12, 0, 0, 0
.long 83722240, 32505856, 16, 84066304, 32768000, 12, 84738048, 33030144, 12, 0, 83394560, 1, 12, 0, 0, 0
.long 8617984, 3145728, 14, 8929280, 3407872, 12, 9601024, 3670016, 12, 0, 8257536, 2, 12, 0, 0, 0
.long 19365888, 7340032, 14, 19677184, 7602176, 12, 20348928, 7864320, 12, 0, 19005440, 2, 12, 0, 0, 0
.long 30113792, 11534336, 14, 30425088, 11796480, 12, 31096832, 12058624, 12, 0, 29753344, 2, 12, 0, 0, 0
.long 40861696, 15728640, 14, 41172992, 15990784, 12, 41844736, 16252928, 12, 0, 40501248, 2, 12, 0, 0, 0
.long 51609600, 19922944, 14, 51920896, 20185088, 12, 52592640, 20447232, 12, 0, 51249152, 2, 12, 0, 0, 0
.long 62357504, 24117248, 14, 62668800, 24379392, 12, 63340544, 24641536, 12, 0, 61997056, 2, 12, 0, 0, 0
.long 73105408, 28311552, 14, 73416704, 28573696, 12, 74088448, 28835840, 12, 0, 72744960, 2, 12, 0, 0, 0
.long 83853312, 32505856, 14, 84164608, 32768000, 12, 84836352, 33030144, 12, 0, 83492864, 2, 12, 0, 0, 0
.long 10371072, 3932160, 16, 10174464, 3932160, 12, 10272768, 3932160, 12, 0, 10076160, 0, 12, 0, 0, 0
.long 21118976, 8126464, 16, 20922368, 8126464, 12, 21020672, 8126464, 12, 0, 20824064, 0, 12, 0, 0, 0
.long 31866880, 12320768, 16, 31670272, 12320768, 12, 31768576, 12320768, 12, 0, 31571968, 0, 12, 0, 0, 0
.long 42614784, 16515072, 16, 42418176, 16515072, 12, 42516480, 16515072, 12, 0, 42319872, 0, 12, 0, 0, 0
.long 53362688, 20709376, 16, 53166080, 20709376, 12, 53264384, 20709376, 12, 0, 53067776, 0, 12, 0, 0, 0
.long 64110592, 24903680, 16, 63913984, 24903680, 12, 64012288, 24903680, 12, 0, 63815680, 0, 12, 0, 0, 0
.long 74858496, 29097984, 16, 74661888, 29097984, 12, 74760192, 29097984, 12, 0, 74563584, 0, 12, 0, 0, 0
.long 85606400, 33292288, 16, 85409792, 33292288, 12, 85508096, 33292288, 12, 0, 85311488, 0, 12, 0, 0, 0
.size L_table, 16384
.section .rodata,"a"
.p2align 6
.amdhsa_kernel standalone__mha_softmax__near_ridge_kernel
  .amdhsa_next_free_vgpr 512
  .amdhsa_next_free_sgpr 102
  .amdhsa_accum_offset 256
  .amdhsa_group_segment_fixed_size 0
  .amdhsa_kernarg_size 48
  .amdhsa_user_sgpr_count 2
  .amdhsa_user_sgpr_kernarg_segment_ptr 1
  .amdhsa_system_sgpr_workgroup_id_x 1
.end_amdhsa_kernel
```
